```python
import torch

def _softmax(x, axis=-1):
    return torch.softmax(x, dim=axis)

def _gelu(x):
    return torch.nn.functional.gelu(x, approximate='tanh')

def _silu(x):
    return torch.nn.functional.silu(x)

def _sigmoid(x):
    return torch.sigmoid(x)

def _layernorm(x, axis=-1, eps=1e-05):
    m = x.mean(dim=axis, keepdim=True)
    v = x.var(dim=axis, keepdim=True, unbiased=False)
    return (x - m) / torch.sqrt(v + eps)

def _scatter_add(tgt, idx, src, axis=0):
    return tgt.clone().index_add_(axis, idx, src)

def _segment_sum(src, seg, n):
    out = torch.zeros((n,) + src.shape[1:], dtype=src.dtype)
    return out.index_add_(0, seg, src)

def _pad(x, pw):
    flat = tuple((v for pair in reversed(pw) for v in pair))
    return torch.nn.functional.pad(x, flat)
kernel_name = 'parallel_sum__memory_aug_recurrent_mem_tr__glu_gated_reglu__prompt'

def setup_inputs():

    _w = lambda a: (lambda t: t.to(torch.bfloat16) if t.is_floating_point() else t)(torch.as_tensor(a))

    def _A_setup():
        B, S, Dm = (1, 2048, 640)
        H, Dh = (32, 128)
        M, seg = (8, 32)
        seg = min(seg, S)
        S = S // seg * seg
        return {'x': _w((lambda *s: torch.randn(*s, dtype=torch.bfloat16) * 0.05)(B, S, Dm)), 'mem0': _w((lambda *s: torch.randn(*s, dtype=torch.bfloat16) * 0.2)(B, M, Dm)), 'Wq': _w((lambda *s: torch.randn(*s, dtype=torch.bfloat16) * 1.6)(Dm, H, Dh) * Dm ** (-0.5)), 'Wk': _w((lambda *s: torch.randn(*s, dtype=torch.bfloat16) * 1.6)(Dm, H, Dh) * Dm ** (-0.5)), 'Wv': _w((lambda *s: torch.randn(*s, dtype=torch.bfloat16) * 0.2)(Dm, H, Dh) * Dm ** (-0.5)), 'Wo': _w((lambda *s: torch.randn(*s, dtype=torch.bfloat16) * 0.2)(H, Dh, Dm) * (H * Dh) ** (-0.5)), 'seg_len': seg}
    _A_in = _A_setup()

    def _B_setup():
        B, S, D, F = (1, 2048, 640, 1728)
        return {'x': _w((lambda *s: torch.randn(*s, dtype=torch.bfloat16) * 0.05)(B, S, D)), 'W_gate': _w((lambda *s: torch.randn(*s, dtype=torch.bfloat16) * 0.2)(D, F) * (2.0 / D) ** 0.5), 'W_up': _w((lambda *s: torch.randn(*s, dtype=torch.bfloat16) * 0.2)(D, F) * (2.0 / D) ** 0.5), 'W_down': _w((lambda *s: torch.randn(*s, dtype=torch.bfloat16) * 0.2)(F, D) * (1.0 / F) ** 0.5)}
    _B_in = _B_setup()
    return {'A_x': _A_in['x'], 'A_mem0': _A_in['mem0'], 'A_Wq': _A_in['Wq'], 'A_Wk': _A_in['Wk'], 'A_Wv': _A_in['Wv'], 'A_Wo': _A_in['Wo'], 'A_seg_len': _A_in['seg_len'], 'B_x': _B_in['x'], 'B_W_gate': _B_in['W_gate'], 'B_W_up': _B_in['W_up'], 'B_W_down': _B_in['W_down']}

def reference(A_x, A_mem0, A_Wq, A_Wk, A_Wv, A_Wo, A_seg_len, B_x, B_W_gate, B_W_up, B_W_down):

    def _A_ref(x, mem0, Wq, Wk, Wv, Wo, seg_len):
        B, S, Dm = x.shape
        H, Dh = (Wq.shape[1], Wq.shape[2])
        M = mem0.shape[1]
        scale = Dh ** (-0.5)
        n_seg = S // seg_len
        L = M + seg_len
        idx = torch.arange(L)
        mask = (idx[:, None] < M) | (idx[:, None] >= idx[None, :])
        mem = mem0
        outs = []
        for s in range(n_seg):
            xs = x[:, s * seg_len:(s + 1) * seg_len, :].clone()
            h = torch.concatenate([mem, xs], axis=1)
            q = torch.einsum('btd,dhe->bhte', h, Wq)
            k = torch.einsum('btd,dhe->bhte', h, Wk)
            v = torch.einsum('btd,dhe->bhte', h, Wv)
            scores = torch.einsum('bhqe,bhke->bhqk', q, k) * scale
            scores = torch.where(mask[None, None], scores, -1000000000.0)
            p = _softmax(scores, axis=-1)
            o = torch.einsum('bhqk,bhke->bhqe', p, v)
            o = torch.einsum('bhte,hed->btd', o, Wo)
            mem = o[:, :M, :].clone()
            outs.append(o[:, M:, :])
        return torch.concatenate(outs, axis=1)

    def _B_ref(x, W_gate, W_up, W_down):
        gate = torch.einsum('bsd,df->bsf', x, W_gate)
        up = torch.einsum('bsd,df->bsf', x, W_up)
        gate = gate * (lambda x, dt: x.to(dt))(gate > 0, gate.dtype)
        h = gate * up
        return torch.einsum('bsf,fd->bsd', h, W_down)
    x = A_x
    xn = _layernorm(x, axis=-1)
    return x + _A_ref(xn, A_mem0, A_Wq, A_Wk, A_Wv, A_Wo, A_seg_len) + _B_ref(xn, B_W_gate, B_W_up, B_W_down)
```

```asm
; @launch grid=(256,1,1) block=(256,1,1) lds=163840
.amdgcn_target "amdgcn-amd-amdhsa--gfx950"
.text
.globl parallel_sum__memory_aug_recurrent_mem_tr__glu_gated_reglu__prompt_kernel
.p2align 8
.type parallel_sum__memory_aug_recurrent_mem_tr__glu_gated_reglu__prompt_kernel,@function
parallel_sum__memory_aug_recurrent_mem_tr__glu_gated_reglu__prompt_kernel:
    s_cmp_ge_u32 s2, 256
    s_cbranch_scc1 wk_exit
    s_load_dwordx4 s[12:15], s[0:1], 96
    s_getreg_b32 s18, hwreg(HW_REG_XCC_ID)
    s_and_b32 s18, s18, 7
    v_mov_b32 v127, v0
    v_lshrrev_b32 v1, 6, v0
    s_nop 0
    v_readfirstlane_b32 s19, v1
    s_mov_b32 s54, 0
    s_mov_b32 s47, s2
    s_waitcnt lgkmcnt(0)
    s_cmp_eq_u32 s19, 0
    s_cbranch_scc1 pf_done
    s_load_dwordx2 s[4:5], s[0:1], 0
    s_getpc_b64 s[6:7]
pf_pc:
    s_sleep 1
    v_subrev_u32 v2, 64, v0
    v_lshlrev_b32 v2, 7, v2
    v_min_u32 v3, wk_exit-pf_pc, v2
    global_load_dword v100, v3, s[6:7]
    v_add_u32 v2, 24576, v2
    v_min_u32 v3, wk_exit-pf_pc, v2
    global_load_dword v101, v3, s[6:7]
    v_add_u32 v2, 24576, v2
    v_min_u32 v3, wk_exit-pf_pc, v2
    global_load_dword v102, v3, s[6:7]
    v_add_u32 v2, 24576, v2
    v_min_u32 v3, wk_exit-pf_pc, v2
    global_load_dword v103, v3, s[6:7]
    s_mul_i32 s34, s2, 10240
    v_subrev_u32 v2, 64, v0
    v_min_u32 v2, 79, v2
    v_lshlrev_b32 v2, 7, v2
    v_add_u32 v2, s34, v2
    s_waitcnt lgkmcnt(0)
    global_load_dword v105, v2, s[4:5]
pf_done:
    s_cmp_lg_u32 s2, 0
    s_cbranch_scc1 el_noinit
    v_lshlrev_b32 v2, 4, v127
    v_add_u32 v2, 103809024, v2
    v_mov_b64 v[4:5], 0
    v_mov_b64 v[6:7], 0
    global_store_dwordx4 v2, v[4:7], s[14:15] sc1
    v_add_u32 v2, 4096, v2
    global_store_dwordx4 v2, v[4:7], s[14:15] sc1
    v_add_u32 v2, 4096, v2
    global_store_dwordx4 v2, v[4:7], s[14:15] sc1
    v_add_u32 v2, 4096, v2
    global_store_dwordx4 v2, v[4:7], s[14:15] sc1
    v_add_u32 v2, 4096, v2
    global_store_dwordx4 v2, v[4:7], s[14:15] sc1
    v_add_u32 v2, 4096, v2
    global_store_dwordx4 v2, v[4:7], s[14:15] sc1
    v_add_u32 v2, 4096, v2
    global_store_dwordx4 v2, v[4:7], s[14:15] sc1
    v_add_u32 v2, 4096, v2
    global_store_dwordx4 v2, v[4:7], s[14:15] sc1
    s_waitcnt vmcnt(0)
    s_barrier
    s_cmp_lg_u32 s19, 0
    s_cbranch_scc1 el_noinit
    s_mov_b64 exec, 1
    v_mov_b32 v2, 28
    v_mov_b32 v3, 1
    global_store_dword v2, v3, s[12:13] sc1
    s_mov_b64 exec, -1
el_noinit:
    s_mov_b32 s21, 0
    s_cmp_eq_u32 s18, 0
    s_cbranch_scc1 el_cand
    s_mov_b32 s21, 1
    s_cmp_lg_u32 s18, 2
    s_cbranch_scc1 wk_start
el_cand:
    s_cmp_lg_u32 s19, 0
    s_cbranch_scc1 el_f
    s_mov_b64 exec, 1
    s_lshl_b32 s34, s21, 2
    v_mov_b32 v124, s34
    v_mov_b32 v125, 1
    global_atomic_add v126, v124, v125, s[12:13] sc0 sc1
    s_waitcnt vmcnt(0)
    v_readfirstlane_b32 s49, v126
    v_mov_b32 v124, 163776
    s_nop 0
    v_mov_b32 v125, s49
    ds_write_b32 v124, v125 offset:0
    s_waitcnt lgkmcnt(0)
    s_mov_b64 exec, -1
el_f:
    s_barrier
    v_mov_b32 v124, 163776
    ds_read_b32 v125, v124 offset:0
    s_waitcnt lgkmcnt(0)
    v_readfirstlane_b32 s49, v125
    s_cmp_ge_u32 s49, 32
    s_cbranch_scc1 wk_start
    s_mov_b32 s20, s49
    s_mov_b32 s17, 1
ch_go:
    s_barrier
    s_load_dwordx2 s[4:5], s[0:1], 8
    s_load_dwordx4 s[8:11], s[0:1], 16
    s_load_dwordx4 s[76:79], s[0:1], 32
    v_and_b32 v8, 63, v0
    v_lshlrev_b32 v0, 4, v8
    v_and_b32 v9, 15, v8
    v_lshrrev_b32 v10, 4, v8
    s_mov_b32 s66, 0xf0f0f0f0
    s_mov_b32 s67, 0xf0f0f0f0
    s_mov_b32 s70, 0x00ff00ff
    s_mov_b32 s71, 0x00ff00ff
    s_mov_b32 s68, 0xffff0000
    s_mov_b32 s69, 0xffff0000
    s_mov_b32 s27, 1040356334
    s_mov_b32 s29, 1109393408
    v_bfe_u32 v11, v8, 1, 1
    v_mul_u32_u24 v11, 0xaaaa, v11
    v_bfe_u32 v12, v8, 2, 1
    v_mul_u32_u24 v12, 0xaaaa, v12
    v_lshl_or_b32 v11, v12, 16, v11
    v_or_b32 v1, 0x44444444, v11
    v_lshlrev_b32 v11, 4, v9
    v_lshl_add_u32 v4, v10, 2, v11
    v_lshrrev_b32 v11, 2, v8
    v_lshlrev_b32 v11, 4, v11
    v_bfe_u32 v12, v8, 1, 1
    v_lshl_add_u32 v5, v12, 3, v11
    v_mul_u32_u24 v11, 4096, v10
    v_lshl_add_u32 v11, v9, 3, v11
    s_lshl_b32 s23, s20, 7
    v_add_u32 v6, s23, v11
    s_lshl_b32 s23, s19, 12
    s_add_u32 s23, s23, 16384
    v_add_u32 v2, s23, v0
    v_add_u32 v3, 0x10000, v2
    s_lshl_b32 s72, s19, 5
    s_add_u32 s72, s72, s20
    s_mul_i32 s73, s72, 4096
    s_lshr_b32 s23, s72, 2
    s_lshl_b32 s23, s23, 9
    s_and_b32 s24, s72, 1
    s_lshl_b32 s24, s24, 8
    s_add_u32 s23, s23, s24
    s_and_b32 s24, s72, 2
    s_lshl_b32 s24, s24, 6
    s_add_u32 s23, s23, s24
    v_lshrrev_b32 v11, 5, v8
    v_lshlrev_b32 v11, 2, v11
    v_and_b32 v12, 1, v8
    v_lshl_add_u32 v11, v12, 1, v11
    v_and_b32 v12, 1, v10
    v_add_u32 v11, v11, v12
    v_lshlrev_b32 v11, 4, v11
    v_bfe_u32 v12, v8, 1, 2
    v_lshl_add_u32 v11, v12, 2, v11
    v_add_u32 v7, s23, v11
    s_lshl_b32 s23, s20, 13
    s_add_u32 s24, s23, 4096
    s_add_u32 s30, s14, s24
    s_addc_u32 s31, s15, 0
    s_add_u32 s24, s23, 16781312
    s_add_u32 s32, s14, s24
    s_addc_u32 s33, s15, 0
    s_lshl_b32 s23, s20, 12
    s_add_u32 s24, s23, 83886080
    s_add_u32 s34, s14, s24
    s_addc_u32 s35, s15, 0
    s_lshl_b32 s23, s20, 12
    s_add_u32 s24, s23, 217972736
    s_add_u32 s36, s14, s24
    s_addc_u32 s37, s15, 0
    s_cmp_eq_u32 s17, 2
    s_cselect_b32 s25, 8388608, 0
    s_add_u32 s74, s14, s25
    s_addc_u32 s75, s15, 0
    s_lshl_b32 s23, s21, 19
    s_add_u32 s24, s23, 100663296
    s_add_u32 s38, s74, s24
    s_addc_u32 s39, s75, 0
    s_lshl_b32 s23, s21, 15
    s_add_u32 s24, s23, 101711872
    s_add_u32 s40, s74, s24
    s_addc_u32 s41, s75, 0
    s_lshl_b32 s23, s21, 17
    s_add_u32 s24, s23, 102760448
    s_add_u32 s42, s74, s24
    s_addc_u32 s43, s75, 0
    s_xor_b32 s23, s23, 0x20000
    s_add_u32 s24, s23, 102760448
    s_add_u32 s44, s74, s24
    s_addc_u32 s45, s75, 0
    s_waitcnt lgkmcnt(0)
    s_cmp_ge_u32 s72, 40
    s_cbranch_scc1 ch_noinit
    s_and_b32 s23, s72, 2
    s_lshl_b32 s23, s23, 1
    v_add_u32 v11, s23, v10
    v_mul_u32_u24 v11, 1280, v11
    v_and_b32 v12, 7, v8
    v_lshl_add_u32 v11, v12, 2, v11
    s_lshr_b32 s23, s72, 2
    s_lshl_b32 s23, s23, 6
    s_and_b32 s24, s72, 1
    s_lshl_b32 s24, s24, 5
    s_add_u32 s23, s23, s24
    s_mul_i32 s24, s21, 640
    s_add_u32 s23, s23, s24
    v_add_u32 v11, s23, v11
    global_load_dword v27, v11, s[4:5]
    v_mov_b64 v[16:17], -1
    v_mov_b64 v[18:19], -1
    s_mov_b32 s23, s73
    v_add_u32 v11, s23, v0
    v_add_u32 v12, 0x40000, v11
    global_store_dwordx4 v11, v[16:19], s[38:39] offset:0 sc1
    global_store_dwordx4 v11, v[16:19], s[38:39] offset:1024 sc1
    global_store_dwordx4 v11, v[16:19], s[38:39] offset:2048 sc1
    global_store_dwordx4 v11, v[16:19], s[38:39] offset:3072 sc1
    v_add_u32 v11, 8192, v7
    global_store_dword v11, v16, s[40:41] sc1
    v_add_u32 v11, 16384, v7
    global_store_dword v11, v16, s[40:41] sc1
    v_add_u32 v11, 24576, v7
    global_store_dword v11, v16, s[40:41] sc1
ch_noinit:
    v_mov_b64 v[16:17], -1
    v_mov_b64 v[18:19], -1
    s_lshl_b32 s23, s72, 10
    v_add_u32 v11, s23, v0
    global_store_dwordx4 v11, v[16:19], s[42:43] sc1
    s_nop 1
    v_lshlrev_b32 v11, 1, v10
    v_xor_b32 v11, v11, v9
    v_lshlrev_b32 v11, 4, v11
    v_lshl_add_u32 v11, v10, 13, v11
    s_lshl_b32 s23, s19, 17
    s_lshl_b32 s24, s20, 8
    s_add_u32 s23, s23, s24
    v_add_u32 v14, s23, v11
    v_add_u32 v15, 32768, v14
    v_xor_b32 v16, 128, v14
    v_add_u32 v16, 65536, v16
    v_add_u32 v17, 32768, v16
    v_lshrrev_b32 v11, 3, v8
    v_mul_u32_u24 v11, 1280, v11
    v_and_b32 v12, 7, v8
    v_lshl_add_u32 v11, v12, 4, v11
    s_mul_i32 s23, s20, 163840
    s_mul_i32 s24, s19, 40960
    s_add_u32 s23, s23, s24
    s_mul_i32 s24, s21, 640
    s_add_u32 s23, s23, s24
    v_add_u32 v18, s23, v11
    v_add_u32 v19, 10240, v18
    v_add_u32 v20, 20480, v18
    v_add_u32 v21, 30720, v18
    v_lshrrev_b32 v11, 2, v9
    v_and_b32 v12, 1, v10
    v_lshl_or_b32 v12, v12, 2, v11
    v_lshlrev_b32 v12, 1, v12
    v_bfe_u32 v13, v8, 1, 1
    s_lshl_b32 s23, s19, 2
    v_add_u32 v13, s23, v13
    v_xor_b32 v12, v12, v13
    v_lshlrev_b32 v12, 4, v12
    v_lshl_add_u32 v11, v10, 3, v11
    v_lshl_add_u32 v12, v11, 8, v12
    v_and_b32 v11, 1, v8
    v_lshl_add_u32 v22, v11, 3, v12
    v_xor_b32 v23, 32, v22
    v_and_b32 v11, 1, v10
    v_lshlrev_b32 v11, 4, v11
    v_lshrrev_b32 v12, 1, v10
    v_lshl_add_u32 v11, v12, 2, v11
    v_bfe_u32 v12, v8, 2, 1
    v_add_u32 v11, v11, v12
    v_lshlrev_b32 v11, 7, v11
    v_bfe_u32 v12, v8, 3, 1
    v_lshl_add_u32 v11, v12, 5, v11
    v_and_b32 v12, 3, v8
    v_lshl_add_u32 v24, v12, 3, v11
    s_lshl_b32 s86, s19, 12
    s_mul_i32 s87, s21, 2621440
    s_sub_u32 s88, 2621440, s87
    s_add_u32 s23, s87, 0
    s_add_u32 s74, s8, s23
    s_addc_u32 s75, s9, 0
    s_add_u32 m0, s86, 81920
    s_nop 0
    global_load_lds_dwordx4 v14, s[74:75]
    s_addk_i32 m0, 0x400
    s_nop 0
    global_load_lds_dwordx4 v15, s[74:75]
    s_addk_i32 m0, 0x400
    s_nop 0
    global_load_lds_dwordx4 v16, s[74:75]
    s_addk_i32 m0, 0x400
    s_nop 0
    global_load_lds_dwordx4 v17, s[74:75]
    s_add_u32 s74, s74, 524288
    s_addc_u32 s75, s75, 0
    s_add_u32 m0, s86, 98304
    s_nop 0
    global_load_lds_dwordx4 v14, s[74:75]
    s_addk_i32 m0, 0x400
    s_nop 0
    global_load_lds_dwordx4 v15, s[74:75]
    s_addk_i32 m0, 0x400
    s_nop 0
    global_load_lds_dwordx4 v16, s[74:75]
    s_addk_i32 m0, 0x400
    s_nop 0
    global_load_lds_dwordx4 v17, s[74:75]
    s_add_u32 s74, s74, 524288
    s_addc_u32 s75, s75, 0
    s_add_u32 m0, s86, 114688
    s_nop 0
    global_load_lds_dwordx4 v14, s[74:75]
    s_addk_i32 m0, 0x400
    s_nop 0
    global_load_lds_dwordx4 v15, s[74:75]
    s_addk_i32 m0, 0x400
    s_nop 0
    global_load_lds_dwordx4 v16, s[74:75]
    s_addk_i32 m0, 0x400
    s_nop 0
    global_load_lds_dwordx4 v17, s[74:75]
    s_add_u32 s74, s74, 524288
    s_addc_u32 s75, s75, 0
    s_add_u32 m0, s86, 131072
    s_nop 0
    global_load_lds_dwordx4 v14, s[74:75]
    s_addk_i32 m0, 0x400
    s_nop 0
    global_load_lds_dwordx4 v15, s[74:75]
    s_addk_i32 m0, 0x400
    s_nop 0
    global_load_lds_dwordx4 v16, s[74:75]
    s_addk_i32 m0, 0x400
    s_nop 0
    global_load_lds_dwordx4 v17, s[74:75]
    s_add_u32 s74, s74, 524288
    s_addc_u32 s75, s75, 0
    s_add_u32 m0, s86, 147456
    s_nop 0
    global_load_lds_dwordx4 v14, s[74:75]
    s_addk_i32 m0, 0x400
    s_nop 0
    global_load_lds_dwordx4 v15, s[74:75]
    s_addk_i32 m0, 0x400
    s_nop 0
    global_load_lds_dwordx4 v16, s[74:75]
    s_addk_i32 m0, 0x400
    s_nop 0
    global_load_lds_dwordx4 v17, s[74:75]
    s_add_u32 s23, s88, 0
    s_add_u32 s74, s8, s23
    s_addc_u32 s75, s9, 0
    s_add_u32 m0, s86, 0
    s_nop 0
    global_load_lds_dwordx4 v14, s[74:75]
    s_addk_i32 m0, 0x400
    s_nop 0
    global_load_lds_dwordx4 v15, s[74:75]
    s_addk_i32 m0, 0x400
    s_nop 0
    global_load_lds_dwordx4 v16, s[74:75]
    s_addk_i32 m0, 0x400
    s_nop 0
    global_load_lds_dwordx4 v17, s[74:75]
    s_add_u32 s74, s74, 524288
    s_addc_u32 s75, s75, 0
    s_add_u32 m0, s86, 16384
    s_nop 0
    global_load_lds_dwordx4 v14, s[74:75]
    s_addk_i32 m0, 0x400
    s_nop 0
    global_load_lds_dwordx4 v15, s[74:75]
    s_addk_i32 m0, 0x400
    s_nop 0
    global_load_lds_dwordx4 v16, s[74:75]
    s_addk_i32 m0, 0x400
    s_nop 0
    global_load_lds_dwordx4 v17, s[74:75]
    s_add_u32 s74, s74, 524288
    s_addc_u32 s75, s75, 0
    s_add_u32 m0, s86, 32768
    s_nop 0
    global_load_lds_dwordx4 v14, s[74:75]
    s_addk_i32 m0, 0x400
    s_nop 0
    global_load_lds_dwordx4 v15, s[74:75]
    s_addk_i32 m0, 0x400
    s_nop 0
    global_load_lds_dwordx4 v16, s[74:75]
    s_addk_i32 m0, 0x400
    s_nop 0
    global_load_lds_dwordx4 v17, s[74:75]
    s_add_u32 s74, s74, 524288
    s_addc_u32 s75, s75, 0
    s_add_u32 m0, s86, 49152
    s_nop 0
    global_load_lds_dwordx4 v14, s[74:75]
    s_addk_i32 m0, 0x400
    s_nop 0
    global_load_lds_dwordx4 v15, s[74:75]
    s_addk_i32 m0, 0x400
    s_nop 0
    global_load_lds_dwordx4 v16, s[74:75]
    s_addk_i32 m0, 0x400
    s_nop 0
    global_load_lds_dwordx4 v17, s[74:75]
    s_waitcnt vmcnt(32) lgkmcnt(0)
    s_barrier
    s_add_u32 s74, s74, 524288
    s_addc_u32 s75, s75, 0
    s_add_u32 m0, s86, 65536
    s_nop 0
    global_load_lds_dwordx4 v14, s[74:75]
    s_addk_i32 m0, 0x400
    s_nop 0
    global_load_lds_dwordx4 v15, s[74:75]
    s_addk_i32 m0, 0x400
    s_nop 0
    global_load_lds_dwordx4 v16, s[74:75]
    s_addk_i32 m0, 0x400
    s_nop 0
    global_load_lds_dwordx4 v17, s[74:75]
    v_add_u32 v25, 81920, v22
    v_add_u32 v26, 81920, v23
    ds_read_b64_tr_b16 a[0:1], v25 offset:0
    ds_read_b64_tr_b16 a[2:3], v25 offset:1024
    ds_read_b64_tr_b16 a[4:5], v25 offset:8192
    ds_read_b64_tr_b16 a[6:7], v25 offset:9216
    ds_read_b64_tr_b16 a[8:9], v26 offset:0
    ds_read_b64_tr_b16 a[10:11], v26 offset:1024
    ds_read_b64_tr_b16 a[12:13], v26 offset:8192
    ds_read_b64_tr_b16 a[14:15], v26 offset:9216
    s_waitcnt vmcnt(32) lgkmcnt(0)
    s_barrier
    s_add_u32 s23, s87, 524288
    s_add_u32 s74, s10, s23
    s_addc_u32 s75, s11, 0
    s_add_u32 m0, s86, 81920
    s_nop 0
    global_load_lds_dwordx4 v14, s[74:75]
    s_addk_i32 m0, 0x400
    s_nop 0
    global_load_lds_dwordx4 v15, s[74:75]
    s_addk_i32 m0, 0x400
    s_nop 0
    global_load_lds_dwordx4 v16, s[74:75]
    s_addk_i32 m0, 0x400
    s_nop 0
    global_load_lds_dwordx4 v17, s[74:75]
    s_cmp_ge_u32 s72, 40
    s_cbranch_scc1 ch_nom0
    v_min_u32 v70, -2, v27
    global_store_dword v7, v70, s[40:41] sc1
ch_nom0:
    v_add_u32 v25, 98304, v22
    v_add_u32 v26, 98304, v23
    ds_read_b64_tr_b16 a[16:17], v25 offset:0
    ds_read_b64_tr_b16 a[18:19], v25 offset:1024
    ds_read_b64_tr_b16 a[20:21], v25 offset:8192
    ds_read_b64_tr_b16 a[22:23], v25 offset:9216
    ds_read_b64_tr_b16 a[24:25], v26 offset:0
    ds_read_b64_tr_b16 a[26:27], v26 offset:1024
    ds_read_b64_tr_b16 a[28:29], v26 offset:8192
    ds_read_b64_tr_b16 a[30:31], v26 offset:9216
    s_waitcnt vmcnt(32) lgkmcnt(0)
    s_barrier
    s_add_u32 s23, s87, 1572864
    s_add_u32 s74, s10, s23
    s_addc_u32 s75, s11, 0
    s_add_u32 m0, s86, 98304
    s_nop 0
    global_load_lds_dwordx4 v14, s[74:75]
    s_addk_i32 m0, 0x400
    s_nop 0
    global_load_lds_dwordx4 v15, s[74:75]
    s_addk_i32 m0, 0x400
    s_nop 0
    global_load_lds_dwordx4 v16, s[74:75]
    s_addk_i32 m0, 0x400
    s_nop 0
    global_load_lds_dwordx4 v17, s[74:75]
    v_add_u32 v25, 114688, v22
    v_add_u32 v26, 114688, v23
    ds_read_b64_tr_b16 a[32:33], v25 offset:0
    ds_read_b64_tr_b16 a[34:35], v25 offset:1024
    ds_read_b64_tr_b16 a[36:37], v25 offset:8192
    ds_read_b64_tr_b16 a[38:39], v25 offset:9216
    ds_read_b64_tr_b16 a[40:41], v26 offset:0
    ds_read_b64_tr_b16 a[42:43], v26 offset:1024
    ds_read_b64_tr_b16 a[44:45], v26 offset:8192
    ds_read_b64_tr_b16 a[46:47], v26 offset:9216
    s_waitcnt vmcnt(32) lgkmcnt(0)
    s_barrier
    s_add_u32 s23, s88, 0
    s_add_u32 s74, s10, s23
    s_addc_u32 s75, s11, 0
    s_add_u32 m0, s86, 114688
    s_nop 0
    global_load_lds_dwordx4 v14, s[74:75]
    s_addk_i32 m0, 0x400
    s_nop 0
    global_load_lds_dwordx4 v15, s[74:75]
    s_addk_i32 m0, 0x400
    s_nop 0
    global_load_lds_dwordx4 v16, s[74:75]
    s_addk_i32 m0, 0x400
    s_nop 0
    global_load_lds_dwordx4 v17, s[74:75]
    v_add_u32 v25, 131072, v22
    v_add_u32 v26, 131072, v23
    ds_read_b64_tr_b16 a[48:49], v25 offset:0
    ds_read_b64_tr_b16 a[50:51], v25 offset:1024
    ds_read_b64_tr_b16 a[52:53], v25 offset:8192
    ds_read_b64_tr_b16 a[54:55], v25 offset:9216
    ds_read_b64_tr_b16 a[56:57], v26 offset:0
    ds_read_b64_tr_b16 a[58:59], v26 offset:1024
    ds_read_b64_tr_b16 a[60:61], v26 offset:8192
    ds_read_b64_tr_b16 a[62:63], v26 offset:9216
    s_waitcnt vmcnt(32) lgkmcnt(0)
    s_barrier
    s_add_u32 s74, s74, 524288
    s_addc_u32 s75, s75, 0
    s_add_u32 m0, s86, 131072
    s_nop 0
    global_load_lds_dwordx4 v14, s[74:75]
    s_addk_i32 m0, 0x400
    s_nop 0
    global_load_lds_dwordx4 v15, s[74:75]
    s_addk_i32 m0, 0x400
    s_nop 0
    global_load_lds_dwordx4 v16, s[74:75]
    s_addk_i32 m0, 0x400
    s_nop 0
    global_load_lds_dwordx4 v17, s[74:75]
    v_add_u32 v25, 147456, v22
    v_add_u32 v26, 147456, v23
    ds_read_b64_tr_b16 a[64:65], v25 offset:0
    ds_read_b64_tr_b16 a[66:67], v25 offset:1024
    ds_read_b64_tr_b16 a[68:69], v25 offset:8192
    ds_read_b64_tr_b16 a[70:71], v25 offset:9216
    ds_read_b64_tr_b16 a[72:73], v26 offset:0
    ds_read_b64_tr_b16 a[74:75], v26 offset:1024
    ds_read_b64_tr_b16 a[76:77], v26 offset:8192
    ds_read_b64_tr_b16 a[78:79], v26 offset:9216
    s_waitcnt vmcnt(32) lgkmcnt(0)
    s_barrier
    s_add_u32 s74, s74, 524288
    s_addc_u32 s75, s75, 0
    s_add_u32 m0, s86, 147456
    s_nop 0
    global_load_lds_dwordx4 v14, s[74:75]
    s_addk_i32 m0, 0x400
    s_nop 0
    global_load_lds_dwordx4 v15, s[74:75]
    s_addk_i32 m0, 0x400
    s_nop 0
    global_load_lds_dwordx4 v16, s[74:75]
    s_addk_i32 m0, 0x400
    s_nop 0
    global_load_lds_dwordx4 v17, s[74:75]
    v_add_u32 v25, 0, v22
    v_add_u32 v26, 0, v23
    ds_read_b64_tr_b16 a[80:81], v25 offset:0
    ds_read_b64_tr_b16 a[82:83], v25 offset:1024
    ds_read_b64_tr_b16 a[84:85], v25 offset:8192
    ds_read_b64_tr_b16 a[86:87], v25 offset:9216
    ds_read_b64_tr_b16 a[88:89], v26 offset:0
    ds_read_b64_tr_b16 a[90:91], v26 offset:1024
    ds_read_b64_tr_b16 a[92:93], v26 offset:8192
    ds_read_b64_tr_b16 a[94:95], v26 offset:9216
    s_waitcnt vmcnt(32) lgkmcnt(0)
    s_barrier
    s_add_u32 s74, s74, 524288
    s_addc_u32 s75, s75, 0
    s_add_u32 m0, s86, 0
    s_nop 0
    global_load_lds_dwordx4 v14, s[74:75]
    s_addk_i32 m0, 0x400
    s_nop 0
    global_load_lds_dwordx4 v15, s[74:75]
    s_addk_i32 m0, 0x400
    s_nop 0
    global_load_lds_dwordx4 v16, s[74:75]
    s_addk_i32 m0, 0x400
    s_nop 0
    global_load_lds_dwordx4 v17, s[74:75]
    v_add_u32 v25, 16384, v22
    v_add_u32 v26, 16384, v23
    ds_read_b64_tr_b16 a[96:97], v25 offset:0
    ds_read_b64_tr_b16 a[98:99], v25 offset:1024
    ds_read_b64_tr_b16 a[100:101], v25 offset:8192
    ds_read_b64_tr_b16 a[102:103], v25 offset:9216
    ds_read_b64_tr_b16 a[104:105], v26 offset:0
    ds_read_b64_tr_b16 a[106:107], v26 offset:1024
    ds_read_b64_tr_b16 a[108:109], v26 offset:8192
    ds_read_b64_tr_b16 a[110:111], v26 offset:9216
    s_waitcnt vmcnt(32) lgkmcnt(0)
    s_barrier
    s_add_u32 s74, s74, 524288
    s_addc_u32 s75, s75, 0
    s_add_u32 m0, s86, 16384
    s_nop 0
    global_load_lds_dwordx4 v14, s[74:75]
    s_addk_i32 m0, 0x400
    s_nop 0
    global_load_lds_dwordx4 v15, s[74:75]
    s_addk_i32 m0, 0x400
    s_nop 0
    global_load_lds_dwordx4 v16, s[74:75]
    s_addk_i32 m0, 0x400
    s_nop 0
    global_load_lds_dwordx4 v17, s[74:75]
    v_add_u32 v25, 32768, v22
    v_add_u32 v26, 32768, v23
    ds_read_b64_tr_b16 a[112:113], v25 offset:0
    ds_read_b64_tr_b16 a[114:115], v25 offset:1024
    ds_read_b64_tr_b16 a[116:117], v25 offset:8192
    ds_read_b64_tr_b16 a[118:119], v25 offset:9216
    ds_read_b64_tr_b16 a[120:121], v26 offset:0
    ds_read_b64_tr_b16 a[122:123], v26 offset:1024
    ds_read_b64_tr_b16 a[124:125], v26 offset:8192
    ds_read_b64_tr_b16 a[126:127], v26 offset:9216
    s_waitcnt vmcnt(32) lgkmcnt(0)
    s_barrier
    s_add_u32 s23, s88, 0
    s_add_u32 s74, s76, s23
    s_addc_u32 s75, s77, 0
    s_add_u32 m0, s86, 32768
    s_nop 0
    global_load_lds_dwordx4 v14, s[74:75]
    s_addk_i32 m0, 0x400
    s_nop 0
    global_load_lds_dwordx4 v15, s[74:75]
    s_addk_i32 m0, 0x400
    s_nop 0
    global_load_lds_dwordx4 v16, s[74:75]
    s_addk_i32 m0, 0x400
    s_nop 0
    global_load_lds_dwordx4 v17, s[74:75]
    v_add_u32 v25, 49152, v22
    v_add_u32 v26, 49152, v23
    ds_read_b64_tr_b16 a[128:129], v25 offset:0
    ds_read_b64_tr_b16 a[130:131], v25 offset:1024
    ds_read_b64_tr_b16 a[132:133], v25 offset:8192
    ds_read_b64_tr_b16 a[134:135], v25 offset:9216
    ds_read_b64_tr_b16 a[136:137], v26 offset:0
    ds_read_b64_tr_b16 a[138:139], v26 offset:1024
    ds_read_b64_tr_b16 a[140:141], v26 offset:8192
    ds_read_b64_tr_b16 a[142:143], v26 offset:9216
    s_waitcnt vmcnt(32) lgkmcnt(0)
    s_barrier
    s_add_u32 s74, s74, 524288
    s_addc_u32 s75, s75, 0
    s_add_u32 m0, s86, 49152
    s_nop 0
    global_load_lds_dwordx4 v14, s[74:75]
    s_addk_i32 m0, 0x400
    s_nop 0
    global_load_lds_dwordx4 v15, s[74:75]
    s_addk_i32 m0, 0x400
    s_nop 0
    global_load_lds_dwordx4 v16, s[74:75]
    s_addk_i32 m0, 0x400
    s_nop 0
    global_load_lds_dwordx4 v17, s[74:75]
    v_add_u32 v25, 65536, v22
    v_add_u32 v26, 65536, v23
    ds_read_b64_tr_b16 a[144:145], v25 offset:0
    ds_read_b64_tr_b16 a[146:147], v25 offset:1024
    ds_read_b64_tr_b16 a[148:149], v25 offset:8192
    ds_read_b64_tr_b16 a[150:151], v25 offset:9216
    ds_read_b64_tr_b16 a[152:153], v26 offset:0
    ds_read_b64_tr_b16 a[154:155], v26 offset:1024
    ds_read_b64_tr_b16 a[156:157], v26 offset:8192
    ds_read_b64_tr_b16 a[158:159], v26 offset:9216
    s_waitcnt vmcnt(32) lgkmcnt(0)
    s_barrier
    s_add_u32 s74, s74, 524288
    s_addc_u32 s75, s75, 0
    s_add_u32 m0, s86, 65536
    s_nop 0
    global_load_lds_dwordx4 v14, s[74:75]
    s_addk_i32 m0, 0x400
    s_nop 0
    global_load_lds_dwordx4 v15, s[74:75]
    s_addk_i32 m0, 0x400
    s_nop 0
    global_load_lds_dwordx4 v16, s[74:75]
    s_addk_i32 m0, 0x400
    s_nop 0
    global_load_lds_dwordx4 v17, s[74:75]
    v_add_u32 v25, 81920, v22
    v_add_u32 v26, 81920, v23
    ds_read_b64_tr_b16 a[160:161], v25 offset:0
    ds_read_b64_tr_b16 a[162:163], v25 offset:1024
    ds_read_b64_tr_b16 a[164:165], v25 offset:8192
    ds_read_b64_tr_b16 a[166:167], v25 offset:9216
    ds_read_b64_tr_b16 a[168:169], v26 offset:0
    ds_read_b64_tr_b16 a[170:171], v26 offset:1024
    ds_read_b64_tr_b16 a[172:173], v26 offset:8192
    ds_read_b64_tr_b16 a[174:175], v26 offset:9216
    s_waitcnt vmcnt(32) lgkmcnt(0)
    s_barrier
    s_add_u32 s74, s74, 524288
    s_addc_u32 s75, s75, 0
    s_add_u32 m0, s86, 81920
    s_nop 0
    global_load_lds_dwordx4 v14, s[74:75]
    s_addk_i32 m0, 0x400
    s_nop 0
    global_load_lds_dwordx4 v15, s[74:75]
    s_addk_i32 m0, 0x400
    s_nop 0
    global_load_lds_dwordx4 v16, s[74:75]
    s_addk_i32 m0, 0x400
    s_nop 0
    global_load_lds_dwordx4 v17, s[74:75]
    v_add_u32 v25, 98304, v22
    v_add_u32 v26, 98304, v23
    ds_read_b64_tr_b16 a[176:177], v25 offset:0
    ds_read_b64_tr_b16 a[178:179], v25 offset:1024
    ds_read_b64_tr_b16 a[180:181], v25 offset:8192
    ds_read_b64_tr_b16 a[182:183], v25 offset:9216
    ds_read_b64_tr_b16 a[184:185], v26 offset:0
    ds_read_b64_tr_b16 a[186:187], v26 offset:1024
    ds_read_b64_tr_b16 a[188:189], v26 offset:8192
    ds_read_b64_tr_b16 a[190:191], v26 offset:9216
    s_waitcnt vmcnt(32) lgkmcnt(0)
    s_barrier
    s_add_u32 s74, s74, 524288
    s_addc_u32 s75, s75, 0
    s_add_u32 m0, s86, 98304
    s_nop 0
    global_load_lds_dwordx4 v14, s[74:75]
    s_addk_i32 m0, 0x400
    s_nop 0
    global_load_lds_dwordx4 v15, s[74:75]
    s_addk_i32 m0, 0x400
    s_nop 0
    global_load_lds_dwordx4 v16, s[74:75]
    s_addk_i32 m0, 0x400
    s_nop 0
    global_load_lds_dwordx4 v17, s[74:75]
    s_cmp_lg_u32 s19, 0
    s_cbranch_scc1 ch_noarr12
    s_or_b32 s23, s21, s20
    s_cmp_eq_u32 s23, 0
    s_cbranch_scc1 ch_noarr12
    s_mov_b64 exec, 1
    s_lshl_b32 s23, s17, 2
    s_add_u32 s23, s23, 12
    v_mov_b32 v27, s23
    v_mov_b32 v28, 1
    global_atomic_add v27, v28, s[12:13] sc1
    s_mov_b64 exec, -1
ch_noarr12:
    v_add_u32 v25, 114688, v22
    v_add_u32 v26, 114688, v23
    ds_read_b64_tr_b16 a[192:193], v25 offset:0
    ds_read_b64_tr_b16 a[194:195], v25 offset:1024
    ds_read_b64_tr_b16 a[196:197], v25 offset:8192
    ds_read_b64_tr_b16 a[198:199], v25 offset:9216
    ds_read_b64_tr_b16 a[200:201], v26 offset:0
    ds_read_b64_tr_b16 a[202:203], v26 offset:1024
    ds_read_b64_tr_b16 a[204:205], v26 offset:8192
    ds_read_b64_tr_b16 a[206:207], v26 offset:9216
    s_waitcnt vmcnt(32) lgkmcnt(0)
    s_barrier
    s_add_u32 s74, s78, 0
    s_addc_u32 s75, s79, 0
    s_add_u32 m0, s86, 114688
    s_nop 0
    global_load_lds_dwordx4 v18, s[74:75]
    s_addk_i32 m0, 0x400
    s_nop 0
    global_load_lds_dwordx4 v19, s[74:75]
    s_addk_i32 m0, 0x400
    s_nop 0
    global_load_lds_dwordx4 v20, s[74:75]
    s_addk_i32 m0, 0x400
    s_nop 0
    global_load_lds_dwordx4 v21, s[74:75]
    v_add_u32 v25, 131072, v22
    v_add_u32 v26, 131072, v23
    ds_read_b64_tr_b16 a[208:209], v25 offset:0
    ds_read_b64_tr_b16 a[210:211], v25 offset:1024
    ds_read_b64_tr_b16 a[212:213], v25 offset:8192
    ds_read_b64_tr_b16 a[214:215], v25 offset:9216
    ds_read_b64_tr_b16 a[216:217], v26 offset:0
    ds_read_b64_tr_b16 a[218:219], v26 offset:1024
    ds_read_b64_tr_b16 a[220:221], v26 offset:8192
    ds_read_b64_tr_b16 a[222:223], v26 offset:9216
    s_waitcnt vmcnt(32) lgkmcnt(0)
    s_barrier
    s_add_u32 s74, s78, 128
    s_addc_u32 s75, s79, 0
    s_add_u32 m0, s86, 131072
    s_nop 0
    global_load_lds_dwordx4 v18, s[74:75]
    s_addk_i32 m0, 0x400
    s_nop 0
    global_load_lds_dwordx4 v19, s[74:75]
    s_addk_i32 m0, 0x400
    s_nop 0
    global_load_lds_dwordx4 v20, s[74:75]
    s_addk_i32 m0, 0x400
    s_nop 0
    global_load_lds_dwordx4 v21, s[74:75]
    v_add_u32 v25, 147456, v22
    v_add_u32 v26, 147456, v23
    ds_read_b64_tr_b16 a[224:225], v25 offset:0
    ds_read_b64_tr_b16 a[226:227], v25 offset:1024
    ds_read_b64_tr_b16 a[228:229], v25 offset:8192
    ds_read_b64_tr_b16 a[230:231], v25 offset:9216
    ds_read_b64_tr_b16 a[232:233], v26 offset:0
    ds_read_b64_tr_b16 a[234:235], v26 offset:1024
    ds_read_b64_tr_b16 a[236:237], v26 offset:8192
    ds_read_b64_tr_b16 a[238:239], v26 offset:9216
    s_waitcnt vmcnt(32) lgkmcnt(0)
    s_barrier
    s_add_u32 s74, s78, 256
    s_addc_u32 s75, s79, 0
    s_add_u32 m0, s86, 147456
    s_nop 0
    global_load_lds_dwordx4 v18, s[74:75]
    s_addk_i32 m0, 0x400
    s_nop 0
    global_load_lds_dwordx4 v19, s[74:75]
    s_addk_i32 m0, 0x400
    s_nop 0
    global_load_lds_dwordx4 v20, s[74:75]
    s_addk_i32 m0, 0x400
    s_nop 0
    global_load_lds_dwordx4 v21, s[74:75]
    v_add_u32 v25, 0, v22
    v_add_u32 v26, 0, v23
    ds_read_b64_tr_b16 a[240:241], v25 offset:0
    ds_read_b64_tr_b16 a[242:243], v25 offset:1024
    ds_read_b64_tr_b16 a[244:245], v25 offset:8192
    ds_read_b64_tr_b16 a[246:247], v25 offset:9216
    ds_read_b64_tr_b16 a[248:249], v26 offset:0
    ds_read_b64_tr_b16 a[250:251], v26 offset:1024
    ds_read_b64_tr_b16 a[252:253], v26 offset:8192
    ds_read_b64_tr_b16 a[254:255], v26 offset:9216
    s_waitcnt vmcnt(32) lgkmcnt(0)
    s_barrier
    s_add_u32 s74, s78, 384
    s_addc_u32 s75, s79, 0
    s_add_u32 m0, s86, 0
    s_nop 0
    global_load_lds_dwordx4 v18, s[74:75]
    s_addk_i32 m0, 0x400
    s_nop 0
    global_load_lds_dwordx4 v19, s[74:75]
    s_addk_i32 m0, 0x400
    s_nop 0
    global_load_lds_dwordx4 v20, s[74:75]
    s_addk_i32 m0, 0x400
    s_nop 0
    global_load_lds_dwordx4 v21, s[74:75]
    v_add_u32 v25, 16384, v22
    v_add_u32 v26, 16384, v23
    ds_read_b64_tr_b16 v[96:97], v25 offset:0
    ds_read_b64_tr_b16 v[98:99], v25 offset:1024
    ds_read_b64_tr_b16 v[100:101], v25 offset:8192
    ds_read_b64_tr_b16 v[102:103], v25 offset:9216
    ds_read_b64_tr_b16 v[104:105], v26 offset:0
    ds_read_b64_tr_b16 v[106:107], v26 offset:1024
    ds_read_b64_tr_b16 v[108:109], v26 offset:8192
    ds_read_b64_tr_b16 v[110:111], v26 offset:9216
    s_waitcnt vmcnt(32) lgkmcnt(0)
    s_barrier
    s_add_u32 s23, s87, 0
    s_add_u32 s74, s76, s23
    s_addc_u32 s75, s77, 0
    s_add_u32 m0, s86, 16384
    s_nop 0
    global_load_lds_dwordx4 v14, s[74:75]
    s_addk_i32 m0, 0x400
    s_nop 0
    global_load_lds_dwordx4 v15, s[74:75]
    s_addk_i32 m0, 0x400
    s_nop 0
    global_load_lds_dwordx4 v16, s[74:75]
    s_addk_i32 m0, 0x400
    s_nop 0
    global_load_lds_dwordx4 v17, s[74:75]
    v_add_u32 v25, 32768, v22
    v_add_u32 v26, 32768, v23
    ds_read_b64_tr_b16 v[112:113], v25 offset:0
    ds_read_b64_tr_b16 v[114:115], v25 offset:1024
    ds_read_b64_tr_b16 v[116:117], v25 offset:8192
    ds_read_b64_tr_b16 v[118:119], v25 offset:9216
    ds_read_b64_tr_b16 v[120:121], v26 offset:0
    ds_read_b64_tr_b16 v[122:123], v26 offset:1024
    ds_read_b64_tr_b16 v[124:125], v26 offset:8192
    ds_read_b64_tr_b16 v[126:127], v26 offset:9216
    s_waitcnt vmcnt(32) lgkmcnt(0)
    s_barrier
    s_add_u32 s74, s74, 524288
    s_addc_u32 s75, s75, 0
    s_add_u32 m0, s86, 32768
    s_nop 0
    global_load_lds_dwordx4 v14, s[74:75]
    s_addk_i32 m0, 0x400
    s_nop 0
    global_load_lds_dwordx4 v15, s[74:75]
    s_addk_i32 m0, 0x400
    s_nop 0
    global_load_lds_dwordx4 v16, s[74:75]
    s_addk_i32 m0, 0x400
    s_nop 0
    global_load_lds_dwordx4 v17, s[74:75]
    v_add_u32 v25, 49152, v22
    v_add_u32 v26, 49152, v23
    ds_read_b64_tr_b16 v[128:129], v25 offset:0
    ds_read_b64_tr_b16 v[130:131], v25 offset:1024
    ds_read_b64_tr_b16 v[132:133], v25 offset:8192
    ds_read_b64_tr_b16 v[134:135], v25 offset:9216
    ds_read_b64_tr_b16 v[136:137], v26 offset:0
    ds_read_b64_tr_b16 v[138:139], v26 offset:1024
    ds_read_b64_tr_b16 v[140:141], v26 offset:8192
    ds_read_b64_tr_b16 v[142:143], v26 offset:9216
    s_waitcnt vmcnt(32) lgkmcnt(0)
    s_barrier
    s_add_u32 s74, s74, 524288
    s_addc_u32 s75, s75, 0
    s_add_u32 m0, s86, 49152
    s_nop 0
    global_load_lds_dwordx4 v14, s[74:75]
    s_addk_i32 m0, 0x400
    s_nop 0
    global_load_lds_dwordx4 v15, s[74:75]
    s_addk_i32 m0, 0x400
    s_nop 0
    global_load_lds_dwordx4 v16, s[74:75]
    s_addk_i32 m0, 0x400
    s_nop 0
    global_load_lds_dwordx4 v17, s[74:75]
    v_add_u32 v25, 65536, v22
    v_add_u32 v26, 65536, v23
    ds_read_b64_tr_b16 v[144:145], v25 offset:0
    ds_read_b64_tr_b16 v[146:147], v25 offset:1024
    ds_read_b64_tr_b16 v[148:149], v25 offset:8192
    ds_read_b64_tr_b16 v[150:151], v25 offset:9216
    ds_read_b64_tr_b16 v[152:153], v26 offset:0
    ds_read_b64_tr_b16 v[154:155], v26 offset:1024
    ds_read_b64_tr_b16 v[156:157], v26 offset:8192
    ds_read_b64_tr_b16 v[158:159], v26 offset:9216
    s_waitcnt vmcnt(32) lgkmcnt(0)
    s_barrier
    s_add_u32 s74, s74, 524288
    s_addc_u32 s75, s75, 0
    s_add_u32 m0, s86, 65536
    s_nop 0
    global_load_lds_dwordx4 v14, s[74:75]
    s_addk_i32 m0, 0x400
    s_nop 0
    global_load_lds_dwordx4 v15, s[74:75]
    s_addk_i32 m0, 0x400
    s_nop 0
    global_load_lds_dwordx4 v16, s[74:75]
    s_addk_i32 m0, 0x400
    s_nop 0
    global_load_lds_dwordx4 v17, s[74:75]
    v_mov_b32 v31, 28
    global_load_dword v31, v31, s[12:13] sc1
    v_add_u32 v25, 81920, v22
    v_add_u32 v26, 81920, v23
    ds_read_b64_tr_b16 v[160:161], v25 offset:0
    ds_read_b64_tr_b16 v[162:163], v25 offset:1024
    ds_read_b64_tr_b16 v[164:165], v25 offset:8192
    ds_read_b64_tr_b16 v[166:167], v25 offset:9216
    ds_read_b64_tr_b16 v[168:169], v26 offset:0
    ds_read_b64_tr_b16 v[170:171], v26 offset:1024
    ds_read_b64_tr_b16 v[172:173], v26 offset:8192
    ds_read_b64_tr_b16 v[174:175], v26 offset:9216
    s_waitcnt vmcnt(32) lgkmcnt(0)
    s_barrier
    s_add_u32 s74, s74, 524288
    s_addc_u32 s75, s75, 0
    s_add_u32 m0, s86, 81920
    s_nop 0
    global_load_lds_dwordx4 v14, s[74:75]
    s_addk_i32 m0, 0x400
    s_nop 0
    global_load_lds_dwordx4 v15, s[74:75]
    s_addk_i32 m0, 0x400
    s_nop 0
    global_load_lds_dwordx4 v16, s[74:75]
    s_addk_i32 m0, 0x400
    s_nop 0
    global_load_lds_dwordx4 v17, s[74:75]
    v_add_u32 v25, 98304, v22
    v_add_u32 v26, 98304, v23
    ds_read_b64_tr_b16 v[176:177], v25 offset:0
    ds_read_b64_tr_b16 v[178:179], v25 offset:1024
    ds_read_b64_tr_b16 v[180:181], v25 offset:8192
    ds_read_b64_tr_b16 v[182:183], v25 offset:9216
    ds_read_b64_tr_b16 v[184:185], v26 offset:0
    ds_read_b64_tr_b16 v[186:187], v26 offset:1024
    ds_read_b64_tr_b16 v[188:189], v26 offset:8192
    ds_read_b64_tr_b16 v[190:191], v26 offset:9216
    s_waitcnt vmcnt(32) lgkmcnt(0)
    s_barrier
    s_add_u32 s23, s87, 0
    s_add_u32 s74, s10, s23
    s_addc_u32 s75, s11, 0
    s_add_u32 m0, s86, 98304
    s_nop 0
    global_load_lds_dwordx4 v14, s[74:75]
    s_addk_i32 m0, 0x400
    s_nop 0
    global_load_lds_dwordx4 v15, s[74:75]
    s_addk_i32 m0, 0x400
    s_nop 0
    global_load_lds_dwordx4 v16, s[74:75]
    s_addk_i32 m0, 0x400
    s_nop 0
    global_load_lds_dwordx4 v17, s[74:75]
    s_or_b32 s23, s21, s72
    s_cmp_lg_u32 s23, 0
    s_cbranch_scc1 ch_nosug22
    s_mov_b64 exec, 1
    global_load_dword v30, v0, s[12:13] offset:32 sc1
    s_mov_b64 exec, -1
ch_nosug22:
    s_cmp_lg_u32 s19, 0
    s_cbranch_scc1 ch_now0
    v_add_u32 v25, 114688, v24
    ds_read_b64_tr_b16 v[192:193], v25 offset:0
    ds_read_b64_tr_b16 v[194:195], v25 offset:256
    ds_read_b64_tr_b16 v[196:197], v25 offset:1024
    ds_read_b64_tr_b16 v[198:199], v25 offset:1280
    ds_read_b64_tr_b16 v[200:201], v25 offset:4096
    ds_read_b64_tr_b16 v[202:203], v25 offset:4352
    ds_read_b64_tr_b16 v[204:205], v25 offset:5120
    ds_read_b64_tr_b16 v[206:207], v25 offset:5376
    ds_read_b64_tr_b16 v[208:209], v25 offset:8192
    ds_read_b64_tr_b16 v[210:211], v25 offset:8448
    ds_read_b64_tr_b16 v[212:213], v25 offset:9216
    ds_read_b64_tr_b16 v[214:215], v25 offset:9472
    ds_read_b64_tr_b16 v[216:217], v25 offset:12288
    ds_read_b64_tr_b16 v[218:219], v25 offset:12544
    ds_read_b64_tr_b16 v[220:221], v25 offset:13312
    ds_read_b64_tr_b16 v[222:223], v25 offset:13568
    ds_read_b64_tr_b16 v[224:225], v25 offset:64
    ds_read_b64_tr_b16 v[226:227], v25 offset:320
    ds_read_b64_tr_b16 v[228:229], v25 offset:1088
    ds_read_b64_tr_b16 v[230:231], v25 offset:1344
    ds_read_b64_tr_b16 v[232:233], v25 offset:4160
    ds_read_b64_tr_b16 v[234:235], v25 offset:4416
    ds_read_b64_tr_b16 v[236:237], v25 offset:5184
    ds_read_b64_tr_b16 v[238:239], v25 offset:5440
    ds_read_b64_tr_b16 v[240:241], v25 offset:8256
    ds_read_b64_tr_b16 v[242:243], v25 offset:8512
    ds_read_b64_tr_b16 v[244:245], v25 offset:9280
    ds_read_b64_tr_b16 v[246:247], v25 offset:9536
    ds_read_b64_tr_b16 v[248:249], v25 offset:12352
    ds_read_b64_tr_b16 v[250:251], v25 offset:12608
    ds_read_b64_tr_b16 v[252:253], v25 offset:13376
    ds_read_b64_tr_b16 v[254:255], v25 offset:13632
ch_now0:
    s_waitcnt vmcnt(32) lgkmcnt(0)
    s_barrier
    s_add_u32 s23, s87, 1048576
    s_add_u32 s74, s10, s23
    s_addc_u32 s75, s11, 0
    s_add_u32 m0, s86, 114688
    s_nop 0
    global_load_lds_dwordx4 v14, s[74:75]
    s_addk_i32 m0, 0x400
    s_nop 0
    global_load_lds_dwordx4 v15, s[74:75]
    s_addk_i32 m0, 0x400
    s_nop 0
    global_load_lds_dwordx4 v16, s[74:75]
    s_addk_i32 m0, 0x400
    s_nop 0
    global_load_lds_dwordx4 v17, s[74:75]
    s_cmp_lg_u32 s19, 1
    s_cbranch_scc1 ch_now1
    v_add_u32 v25, 131072, v24
    ds_read_b64_tr_b16 v[192:193], v25 offset:0
    ds_read_b64_tr_b16 v[194:195], v25 offset:256
    ds_read_b64_tr_b16 v[196:197], v25 offset:1024
    ds_read_b64_tr_b16 v[198:199], v25 offset:1280
    ds_read_b64_tr_b16 v[200:201], v25 offset:4096
    ds_read_b64_tr_b16 v[202:203], v25 offset:4352
    ds_read_b64_tr_b16 v[204:205], v25 offset:5120
    ds_read_b64_tr_b16 v[206:207], v25 offset:5376
    ds_read_b64_tr_b16 v[208:209], v25 offset:8192
    ds_read_b64_tr_b16 v[210:211], v25 offset:8448
    ds_read_b64_tr_b16 v[212:213], v25 offset:9216
    ds_read_b64_tr_b16 v[214:215], v25 offset:9472
    ds_read_b64_tr_b16 v[216:217], v25 offset:12288
    ds_read_b64_tr_b16 v[218:219], v25 offset:12544
    ds_read_b64_tr_b16 v[220:221], v25 offset:13312
    ds_read_b64_tr_b16 v[222:223], v25 offset:13568
    ds_read_b64_tr_b16 v[224:225], v25 offset:64
    ds_read_b64_tr_b16 v[226:227], v25 offset:320
    ds_read_b64_tr_b16 v[228:229], v25 offset:1088
    ds_read_b64_tr_b16 v[230:231], v25 offset:1344
    ds_read_b64_tr_b16 v[232:233], v25 offset:4160
    ds_read_b64_tr_b16 v[234:235], v25 offset:4416
    ds_read_b64_tr_b16 v[236:237], v25 offset:5184
    ds_read_b64_tr_b16 v[238:239], v25 offset:5440
    ds_read_b64_tr_b16 v[240:241], v25 offset:8256
    ds_read_b64_tr_b16 v[242:243], v25 offset:8512
    ds_read_b64_tr_b16 v[244:245], v25 offset:9280
    ds_read_b64_tr_b16 v[246:247], v25 offset:9536
    ds_read_b64_tr_b16 v[248:249], v25 offset:12352
    ds_read_b64_tr_b16 v[250:251], v25 offset:12608
    ds_read_b64_tr_b16 v[252:253], v25 offset:13376
    ds_read_b64_tr_b16 v[254:255], v25 offset:13632
ch_now1:
    s_waitcnt vmcnt(32) lgkmcnt(0)
    s_barrier
    s_add_u32 s23, s87, 2097152
    s_add_u32 s74, s10, s23
    s_addc_u32 s75, s11, 0
    s_add_u32 m0, s86, 131072
    s_nop 0
    global_load_lds_dwordx4 v14, s[74:75]
    s_addk_i32 m0, 0x400
    s_nop 0
    global_load_lds_dwordx4 v15, s[74:75]
    s_addk_i32 m0, 0x400
    s_nop 0
    global_load_lds_dwordx4 v16, s[74:75]
    s_addk_i32 m0, 0x400
    s_nop 0
    global_load_lds_dwordx4 v17, s[74:75]
    s_cmp_lg_u32 s19, 2
    s_cbranch_scc1 ch_now2
    v_add_u32 v25, 147456, v24
    ds_read_b64_tr_b16 v[192:193], v25 offset:0
    ds_read_b64_tr_b16 v[194:195], v25 offset:256
    ds_read_b64_tr_b16 v[196:197], v25 offset:1024
    ds_read_b64_tr_b16 v[198:199], v25 offset:1280
    ds_read_b64_tr_b16 v[200:201], v25 offset:4096
    ds_read_b64_tr_b16 v[202:203], v25 offset:4352
    ds_read_b64_tr_b16 v[204:205], v25 offset:5120
    ds_read_b64_tr_b16 v[206:207], v25 offset:5376
    ds_read_b64_tr_b16 v[208:209], v25 offset:8192
    ds_read_b64_tr_b16 v[210:211], v25 offset:8448
    ds_read_b64_tr_b16 v[212:213], v25 offset:9216
    ds_read_b64_tr_b16 v[214:215], v25 offset:9472
    ds_read_b64_tr_b16 v[216:217], v25 offset:12288
    ds_read_b64_tr_b16 v[218:219], v25 offset:12544
    ds_read_b64_tr_b16 v[220:221], v25 offset:13312
    ds_read_b64_tr_b16 v[222:223], v25 offset:13568
    ds_read_b64_tr_b16 v[224:225], v25 offset:64
    ds_read_b64_tr_b16 v[226:227], v25 offset:320
    ds_read_b64_tr_b16 v[228:229], v25 offset:1088
    ds_read_b64_tr_b16 v[230:231], v25 offset:1344
    ds_read_b64_tr_b16 v[232:233], v25 offset:4160
    ds_read_b64_tr_b16 v[234:235], v25 offset:4416
    ds_read_b64_tr_b16 v[236:237], v25 offset:5184
    ds_read_b64_tr_b16 v[238:239], v25 offset:5440
    ds_read_b64_tr_b16 v[240:241], v25 offset:8256
    ds_read_b64_tr_b16 v[242:243], v25 offset:8512
    ds_read_b64_tr_b16 v[244:245], v25 offset:9280
    ds_read_b64_tr_b16 v[246:247], v25 offset:9536
    ds_read_b64_tr_b16 v[248:249], v25 offset:12352
    ds_read_b64_tr_b16 v[250:251], v25 offset:12608
    ds_read_b64_tr_b16 v[252:253], v25 offset:13376
    ds_read_b64_tr_b16 v[254:255], v25 offset:13632
ch_now2:
    s_waitcnt vmcnt(32) lgkmcnt(0)
    s_barrier
    s_add_u32 s74, s78, 512
    s_addc_u32 s75, s79, 0
    s_add_u32 m0, s86, 147456
    s_nop 0
    global_load_lds_dwordx4 v18, s[74:75]
    s_addk_i32 m0, 0x400
    s_nop 0
    global_load_lds_dwordx4 v19, s[74:75]
    s_addk_i32 m0, 0x400
    s_nop 0
    global_load_lds_dwordx4 v20, s[74:75]
    s_addk_i32 m0, 0x400
    s_nop 0
    global_load_lds_dwordx4 v21, s[74:75]
    s_cmp_lg_u32 s19, 3
    s_cbranch_scc1 ch_now3
    v_add_u32 v25, 0, v24
    ds_read_b64_tr_b16 v[192:193], v25 offset:0
    ds_read_b64_tr_b16 v[194:195], v25 offset:256
    ds_read_b64_tr_b16 v[196:197], v25 offset:1024
    ds_read_b64_tr_b16 v[198:199], v25 offset:1280
    ds_read_b64_tr_b16 v[200:201], v25 offset:4096
    ds_read_b64_tr_b16 v[202:203], v25 offset:4352
    ds_read_b64_tr_b16 v[204:205], v25 offset:5120
    ds_read_b64_tr_b16 v[206:207], v25 offset:5376
    ds_read_b64_tr_b16 v[208:209], v25 offset:8192
    ds_read_b64_tr_b16 v[210:211], v25 offset:8448
    ds_read_b64_tr_b16 v[212:213], v25 offset:9216
    ds_read_b64_tr_b16 v[214:215], v25 offset:9472
    ds_read_b64_tr_b16 v[216:217], v25 offset:12288
    ds_read_b64_tr_b16 v[218:219], v25 offset:12544
    ds_read_b64_tr_b16 v[220:221], v25 offset:13312
    ds_read_b64_tr_b16 v[222:223], v25 offset:13568
    ds_read_b64_tr_b16 v[224:225], v25 offset:64
    ds_read_b64_tr_b16 v[226:227], v25 offset:320
    ds_read_b64_tr_b16 v[228:229], v25 offset:1088
    ds_read_b64_tr_b16 v[230:231], v25 offset:1344
    ds_read_b64_tr_b16 v[232:233], v25 offset:4160
    ds_read_b64_tr_b16 v[234:235], v25 offset:4416
    ds_read_b64_tr_b16 v[236:237], v25 offset:5184
    ds_read_b64_tr_b16 v[238:239], v25 offset:5440
    ds_read_b64_tr_b16 v[240:241], v25 offset:8256
    ds_read_b64_tr_b16 v[242:243], v25 offset:8512
    ds_read_b64_tr_b16 v[244:245], v25 offset:9280
    ds_read_b64_tr_b16 v[246:247], v25 offset:9536
    ds_read_b64_tr_b16 v[248:249], v25 offset:12352
    ds_read_b64_tr_b16 v[250:251], v25 offset:12608
    ds_read_b64_tr_b16 v[252:253], v25 offset:13376
    ds_read_b64_tr_b16 v[254:255], v25 offset:13632
ch_now3:
    s_waitcnt vmcnt(32) lgkmcnt(0)
    s_barrier
    v_add_u32 v25, 16384, v22
    v_add_u32 v26, 16384, v23
    ds_read_b64_tr_b16 v[32:33], v25 offset:0
    ds_read_b64_tr_b16 v[34:35], v25 offset:1024
    ds_read_b64_tr_b16 v[36:37], v25 offset:8192
    ds_read_b64_tr_b16 v[38:39], v25 offset:9216
    ds_read_b64_tr_b16 v[40:41], v26 offset:0
    ds_read_b64_tr_b16 v[42:43], v26 offset:1024
    ds_read_b64_tr_b16 v[44:45], v26 offset:8192
    ds_read_b64_tr_b16 v[46:47], v26 offset:9216
    s_waitcnt vmcnt(28) lgkmcnt(0)
    s_barrier
    v_add_u32 v29, 0, v2
    ds_write_b128 v29, v[32:35] offset:0
    ds_write_b128 v29, v[36:39] offset:1024
    ds_write_b128 v29, v[40:43] offset:2048
    ds_write_b128 v29, v[44:47] offset:3072
    v_add_u32 v25, 32768, v22
    v_add_u32 v26, 32768, v23
    ds_read_b64_tr_b16 v[32:33], v25 offset:0
    ds_read_b64_tr_b16 v[34:35], v25 offset:1024
    ds_read_b64_tr_b16 v[36:37], v25 offset:8192
    ds_read_b64_tr_b16 v[38:39], v25 offset:9216
    ds_read_b64_tr_b16 v[40:41], v26 offset:0
    ds_read_b64_tr_b16 v[42:43], v26 offset:1024
    ds_read_b64_tr_b16 v[44:45], v26 offset:8192
    ds_read_b64_tr_b16 v[46:47], v26 offset:9216
    s_waitcnt vmcnt(24) lgkmcnt(0)
    s_barrier
    v_add_u32 v29, 16384, v2
    ds_write_b128 v29, v[32:35] offset:0
    ds_write_b128 v29, v[36:39] offset:1024
    ds_write_b128 v29, v[40:43] offset:2048
    ds_write_b128 v29, v[44:47] offset:3072
    v_add_u32 v25, 49152, v22
    v_add_u32 v26, 49152, v23
    ds_read_b64_tr_b16 v[32:33], v25 offset:0
    ds_read_b64_tr_b16 v[34:35], v25 offset:1024
    ds_read_b64_tr_b16 v[36:37], v25 offset:8192
    ds_read_b64_tr_b16 v[38:39], v25 offset:9216
    ds_read_b64_tr_b16 v[40:41], v26 offset:0
    ds_read_b64_tr_b16 v[42:43], v26 offset:1024
    ds_read_b64_tr_b16 v[44:45], v26 offset:8192
    ds_read_b64_tr_b16 v[46:47], v26 offset:9216
    s_waitcnt vmcnt(20) lgkmcnt(0)
    s_barrier
    v_add_u32 v29, 32768, v2
    ds_write_b128 v29, v[32:35] offset:0
    ds_write_b128 v29, v[36:39] offset:1024
    ds_write_b128 v29, v[40:43] offset:2048
    ds_write_b128 v29, v[44:47] offset:3072
    v_add_u32 v25, 65536, v22
    v_add_u32 v26, 65536, v23
    ds_read_b64_tr_b16 v[32:33], v25 offset:0
    ds_read_b64_tr_b16 v[34:35], v25 offset:1024
    ds_read_b64_tr_b16 v[36:37], v25 offset:8192
    ds_read_b64_tr_b16 v[38:39], v25 offset:9216
    ds_read_b64_tr_b16 v[40:41], v26 offset:0
    ds_read_b64_tr_b16 v[42:43], v26 offset:1024
    ds_read_b64_tr_b16 v[44:45], v26 offset:8192
    ds_read_b64_tr_b16 v[46:47], v26 offset:9216
    s_waitcnt vmcnt(16) lgkmcnt(0)
    s_barrier
    v_add_u32 v29, 49152, v2
    ds_write_b128 v29, v[32:35] offset:0
    ds_write_b128 v29, v[36:39] offset:1024
    ds_write_b128 v29, v[40:43] offset:2048
    ds_write_b128 v29, v[44:47] offset:3072
    v_add_u32 v25, 81920, v22
    v_add_u32 v26, 81920, v23
    ds_read_b64_tr_b16 v[32:33], v25 offset:0
    ds_read_b64_tr_b16 v[34:35], v25 offset:1024
    ds_read_b64_tr_b16 v[36:37], v25 offset:8192
    ds_read_b64_tr_b16 v[38:39], v25 offset:9216
    ds_read_b64_tr_b16 v[40:41], v26 offset:0
    ds_read_b64_tr_b16 v[42:43], v26 offset:1024
    ds_read_b64_tr_b16 v[44:45], v26 offset:8192
    ds_read_b64_tr_b16 v[46:47], v26 offset:9216
    s_waitcnt vmcnt(12) lgkmcnt(0)
    s_barrier
    v_add_u32 v29, 65536, v2
    ds_write_b128 v29, v[32:35] offset:0
    ds_write_b128 v29, v[36:39] offset:1024
    ds_write_b128 v29, v[40:43] offset:2048
    ds_write_b128 v29, v[44:47] offset:3072
    s_or_b32 s23, s21, s72
    s_cmp_lg_u32 s23, 0
    s_cbranch_scc1 ch_nosug31
    s_mov_b64 exec, 1
    global_store_dword v0, v30, s[12:13] offset:24 sc1
    s_mov_b64 exec, -1
ch_nosug31:
    v_add_u32 v25, 98304, v22
    v_add_u32 v26, 98304, v23
    ds_read_b64_tr_b16 v[32:33], v25 offset:0
    ds_read_b64_tr_b16 v[34:35], v25 offset:1024
    ds_read_b64_tr_b16 v[36:37], v25 offset:8192
    ds_read_b64_tr_b16 v[38:39], v25 offset:9216
    ds_read_b64_tr_b16 v[40:41], v26 offset:0
    ds_read_b64_tr_b16 v[42:43], v26 offset:1024
    ds_read_b64_tr_b16 v[44:45], v26 offset:8192
    ds_read_b64_tr_b16 v[46:47], v26 offset:9216
    s_waitcnt vmcnt(8) lgkmcnt(0)
    s_barrier
    v_add_u32 v29, 81920, v2
    ds_write_b128 v29, v[32:35] offset:0
    ds_write_b128 v29, v[36:39] offset:1024
    ds_write_b128 v29, v[40:43] offset:2048
    ds_write_b128 v29, v[44:47] offset:3072
    v_add_u32 v25, 114688, v22
    v_add_u32 v26, 114688, v23
    ds_read_b64_tr_b16 v[32:33], v25 offset:0
    ds_read_b64_tr_b16 v[34:35], v25 offset:1024
    ds_read_b64_tr_b16 v[36:37], v25 offset:8192
    ds_read_b64_tr_b16 v[38:39], v25 offset:9216
    ds_read_b64_tr_b16 v[40:41], v26 offset:0
    ds_read_b64_tr_b16 v[42:43], v26 offset:1024
    ds_read_b64_tr_b16 v[44:45], v26 offset:8192
    ds_read_b64_tr_b16 v[46:47], v26 offset:9216
    s_waitcnt vmcnt(4) lgkmcnt(0)
    s_barrier
    v_add_u32 v29, 98304, v2
    ds_write_b128 v29, v[32:35] offset:0
    ds_write_b128 v29, v[36:39] offset:1024
    ds_write_b128 v29, v[40:43] offset:2048
    ds_write_b128 v29, v[44:47] offset:3072
    v_add_u32 v25, 131072, v22
    v_add_u32 v26, 131072, v23
    ds_read_b64_tr_b16 v[32:33], v25 offset:0
    ds_read_b64_tr_b16 v[34:35], v25 offset:1024
    ds_read_b64_tr_b16 v[36:37], v25 offset:8192
    ds_read_b64_tr_b16 v[38:39], v25 offset:9216
    ds_read_b64_tr_b16 v[40:41], v26 offset:0
    ds_read_b64_tr_b16 v[42:43], v26 offset:1024
    ds_read_b64_tr_b16 v[44:45], v26 offset:8192
    ds_read_b64_tr_b16 v[46:47], v26 offset:9216
    s_waitcnt vmcnt(0) lgkmcnt(0)
    s_barrier
    v_add_u32 v29, 114688, v2
    ds_write_b128 v29, v[32:35] offset:0
    ds_write_b128 v29, v[36:39] offset:1024
    ds_write_b128 v29, v[40:43] offset:2048
    ds_write_b128 v29, v[44:47] offset:3072
    s_cmp_lg_u32 s19, 0
    s_cbranch_scc1 ch_noarr34
    s_or_b32 s23, s21, s20
    s_cmp_lg_u32 s23, 0
    s_cbranch_scc1 ch_noarr34
    s_mov_b64 exec, 1
    s_lshl_b32 s23, s17, 2
    s_add_u32 s23, s23, 12
    v_mov_b32 v27, s23
    v_mov_b32 v28, 1
    global_atomic_add v27, v28, s[12:13] sc1
    s_mov_b64 exec, -1
ch_noarr34:
    v_add_u32 v25, s86, v24
    v_add_u32 v25, 147456, v25
    ds_read_b64_tr_b16 v[32:33], v25 offset:0
    ds_read_b64_tr_b16 v[34:35], v25 offset:256
    ds_read_b64_tr_b16 v[36:37], v25 offset:1024
    ds_read_b64_tr_b16 v[38:39], v25 offset:1280
    ds_read_b64_tr_b16 v[40:41], v25 offset:64
    ds_read_b64_tr_b16 v[42:43], v25 offset:320
    ds_read_b64_tr_b16 v[44:45], v25 offset:1088
    ds_read_b64_tr_b16 v[46:47], v25 offset:1344
    s_waitcnt lgkmcnt(0)
    s_barrier
    s_lshr_b32 s23, s86, 1
    s_add_u32 s23, s23, 147456
    v_add_u32 v29, s23, v0
    ds_write_b128 v29, v[32:35] offset:0
    ds_write_b128 v29, v[36:39] offset:1024
    ds_write_b128 v29, v[40:43] offset:8192
    ds_write_b128 v29, v[44:47] offset:9216
    s_cmp_eq_u32 s19, 1
    s_cbranch_scc1 ch_wave1
    s_cmp_eq_u32 s19, 2
    s_cbranch_scc1 ch_wave2
    s_cmp_eq_u32 s19, 3
    s_cbranch_scc1 ch_wave3
ch_wave0:
    v_bfe_u32 v8, v0, 4, 4
    v_lshrrev_b32 v9, 3, v8
    v_and_b32 v10, 3, v8
    v_lshl_add_u32 v9, v10, 1, v9
    v_and_b32 v10, 4, v8
    v_lshlrev_b32 v10, 2, v10
    v_mov_b32 v11, 0x3f80
    v_lshlrev_b32 v10, v10, v11
    v_cmp_eq_u32 vcc, 0, v9
    s_nop 1
    v_cndmask_b32 v12, 0, v10, vcc
    v_cmp_eq_u32 vcc, 1, v9
    s_nop 1
    v_cndmask_b32 v13, 0, v10, vcc
    v_cmp_eq_u32 vcc, 2, v9
    s_nop 1
    v_cndmask_b32 v14, 0, v10, vcc
    v_cmp_eq_u32 vcc, 3, v9
    s_nop 1
    v_cndmask_b32 v15, 0, v10, vcc
    ds_write_b128 v0, v[12:15] offset:15360
    s_mov_b64 exec, 1
    s_mov_b32 s26, 0
    v_mov_b32 v8, 103810048
    v_readfirstlane_b32 s25, v31
ch_cbar:
    global_load_dwordx4 v[12:15], v0, s[12:13] offset:16 sc1
    global_load_dword v9, v8, s[14:15] sc1
    s_add_u32 s26, s26, 1
    s_cmp_gt_u32 s26, 1048576
    s_cbranch_scc1 ch_fail
    s_waitcnt vmcnt(0)
    v_readfirstlane_b32 s23, v12
    v_readfirstlane_b32 s24, v13
    s_cmp_eq_u32 s17, 2
    s_cselect_b32 s23, s24, s23
    s_cmp_ge_u32 s23, 65536
    s_cbranch_scc1 ch_cfb
    s_cmp_ge_u32 s23, 64
    s_cbranch_scc1 ch_cgo
    s_cmp_lg_u32 s17, 1
    s_cbranch_scc1 ch_cbar
    s_cmp_lt_u32 s26, 5000
    s_cbranch_scc1 ch_cbar
    v_mov_b32 v11, v12
    v_or_b32 v10, 65536, v12
    global_atomic_cmpswap v0, v[10:11], s[12:13] offset:16 sc1
    s_branch ch_cbar
ch_cfb:
    v_mov_b32 v14, 1
    s_branch ch_cput
ch_cgo:
    s_cmp_eq_u32 s25, 0
    v_readfirstlane_b32 s25, v15
    s_cbranch_scc1 ch_cbar
    v_readfirstlane_b32 s23, v9
    s_cmp_lt_u32 s23, 64
    s_cbranch_scc1 ch_cbar
    v_and_b32 v14, 0x6800, v14
ch_cput:
    ds_write_b32 v0, v14 offset:7680
    s_mov_b64 exec, -1
    s_waitcnt lgkmcnt(0)
    s_barrier
    v_mov_b32 v10, 7680
    ds_read_b32 v10, v10
    s_waitcnt lgkmcnt(0)
    v_readfirstlane_b32 s23, v10
    s_bitcmp1_b32 s23, 0
    s_cbranch_scc1 wk_restart
    s_and_b32 s23, s23, 0x6800
    s_xor_b32 s23, s23, 0
    s_cmp_eq_u32 s17, 2
    s_cselect_b32 s23, 0, s23
    s_add_u32 s24, s23, 0
    s_add_u32 s44, s44, s24
    s_addc_u32 s45, s45, 0
    s_and_b32 s24, s20, 16
    s_lshl_b32 s24, s24, 7
    s_add_u32 s24, s24, s23
    s_add_u32 s42, s42, s24
    s_addc_u32 s43, s43, 0
    s_mov_b64 exec, s[70:71]
    global_store_dword v7, v70, s[42:43] sc1
    s_mov_b64 exec, -1
    s_mov_b32 s22, 0
    s_cmp_eq_u32 s21, 0
    s_cselect_b32 s6, -1, 0
    s_cselect_b32 s7, 0, -1
    s_and_b32 s23, s20, 4
    s_and_b32 s24, s20, 1
    s_lshl_b32 s24, s24, 1
    s_add_u32 s23, s23, s24
    s_bfe_u32 s24, s20, 0x10001
    s_add_u32 s23, s23, s24
    s_lshl_b32 s23, s23, 3
    s_mov_b64 s[4:5], 0xff
    s_lshl_b64 s[4:5], s[4:5], s23
    s_lshr_b32 s23, s20, 3
    s_cmp_eq_u32 s23, 0
    s_cselect_b64 s[4:5], s[4:5], 0
    s_and_b32 s23, s22, 3
    s_lshl_b32 s23, s23, 13
    s_add_u32 s24, s23, 2048
    s_add_u32 s54, s40, s24
    s_addc_u32 s55, s41, 0
    s_lshl_b32 s23, s23, 2
    s_add_u32 s56, s44, s23
    s_addc_u32 s57, s45, 0
    s_add_u32 s46, s38, 0
    s_addc_u32 s47, s39, 0
    s_add_u32 s48, s38, 16384
    s_addc_u32 s49, s39, 0
    s_add_u32 s52, s38, s73
    s_addc_u32 s53, s39, 0
    s_lshl_b32 s23, s21, 5
    s_add_u32 s23, s23, s20
    s_lshl_b32 s23, s23, 7
    s_add_u32 s23, s23, 103817216
    s_add_u32 s8, s14, s23
    s_addc_u32 s9, s15, 0
    s_cmp_eq_u32 s17, 2
    s_cbranch_scc1 ch_slowmode0
    v_lshlrev_b32 v68, 3, v0
    s_mov_b32 m0, 7168
    s_add_u32 s74, s30, 0
    s_addc_u32 s75, s31, 0
    s_sub_u32 s74, s74, 4096
    s_subb_u32 s75, s75, 0
    global_load_lds_dword v68, s[74:75] sc1
    ds_read_b128 v[72:75], v2 offset:0
    ds_read_b128 v[76:79], v2 offset:1024
    ds_read_b128 v[80:83], v3 offset:16384
    ds_read_b128 v[84:87], v3 offset:17408
    ds_read_b128 v[88:91], v2 offset:2048
    ds_read_b128 v[92:95], v2 offset:3072
    v_mov_b64 v[8:9], 0
    v_mov_b64 v[10:11], 0
    v_mov_b64 v[12:13], 0
    v_mov_b64 v[14:15], 0
    v_mov_b64 v[16:17], 0
    v_mov_b64 v[18:19], 0
    v_mov_b64 v[20:21], 0
    v_mov_b64 v[22:23], 0
    v_mov_b64 v[24:25], 0
    v_mov_b64 v[26:27], 0
    v_mov_b64 v[28:29], 0
    v_mov_b64 v[30:31], 0
    s_mov_b32 s26, 0
    s_branch ch_w0f_loop
.p2align 6
ch_w0f_loop:
    s_waitcnt lgkmcnt(0)
    global_load_dwordx4 v[48:51], v0, s[54:55] offset:-2048 sc1
    s_nop 0
    s_sleep 1
    global_load_dwordx4 v[48:51], v0, s[54:55] offset:-2048 sc1
    s_nop 0
    s_sleep 1
ch_w0f_gown:
    global_load_dwordx4 v[48:51], v0, s[54:55] offset:-2048 sc1
    s_add_u32 s26, s26, 1
    s_cmp_gt_u32 s26, 1048576
    s_cbranch_scc1 ch_fail
    s_waitcnt vmcnt(2)
ch_w0f_gw:
    v_max3_u32 v68, v48, v49, v50
    v_max_u32 v68, v68, v51
    v_cmpx_eq_u32 vcc, -1, v68
    s_cbranch_execnz ch_w0f_gown
ch_w0f_gok:
    s_mov_b64 exec, -1
    ds_write_b128 v0, v[48:51] offset:0
    s_nop 0
    v_smfmac_f32_16x16x64_bf16 v[8:11], v[48:51], a[0:7], v1
    s_nop 0
    v_smfmac_f32_16x16x64_bf16 v[24:27], v[48:51], v[72:79], v1
    ds_read_b128 v[72:75], v3 offset:18432
    ds_read_b128 v[76:79], v3 offset:19456
    global_load_dwordx4 v[40:43], v0, s[56:57] sc1
    v_smfmac_f32_16x16x64_bf16 v[16:19], v[48:51], v[80:87], v1
    ds_read_b128 v[80:83], v2 offset:16384
    ds_read_b128 v[84:87], v2 offset:17408
    s_waitcnt lgkmcnt(4)
    s_barrier
    ds_read_b128 v[52:55], v0 offset:1024
    ds_read_b128 v[56:59], v0 offset:2048
    ds_read_b128 v[60:63], v0 offset:3072
    v_smfmac_f32_16x16x64_bf16 v[12:15], v[48:51], a[8:15], v1
    s_and_b32 s16, s22, 1
    s_add_u32 s23, s22, 1
    v_smfmac_f32_16x16x64_bf16 v[28:31], v[48:51], v[88:95], v1
    ds_read_b128 v[88:91], v2 offset:18432
    ds_read_b128 v[92:95], v2 offset:19456
    s_waitcnt lgkmcnt(7)
    v_smfmac_f32_16x16x64_bf16 v[20:23], v[48:51], v[72:79], v1
    ds_read_b128 v[72:75], v2 offset:32768
    ds_read_b128 v[76:79], v2 offset:33792
    s_waitcnt lgkmcnt(6)
    v_smfmac_f32_16x16x64_bf16 v[8:11], v[52:55], a[16:23], v1
    s_and_b32 s23, s23, 3
    s_lshl_b32 s23, s23, 13
    v_smfmac_f32_16x16x64_bf16 v[24:27], v[52:55], v[80:87], v1
    ds_read_b128 v[80:83], v3 offset:32768
    ds_read_b128 v[84:87], v3 offset:33792
    v_smfmac_f32_16x16x64_bf16 v[16:19], v[52:55], a[160:167], v1
    s_add_u32 s58, s40, s23
    s_addc_u32 s59, s41, 0
    s_lshl_b32 s23, s23, 2
    v_smfmac_f32_16x16x64_bf16 v[12:15], v[52:55], a[24:31], v1
    s_add_u32 s60, s42, s23
    s_addc_u32 s61, s43, 0
    s_add_u32 s23, s22, 2
    s_waitcnt lgkmcnt(4)
    v_smfmac_f32_16x16x64_bf16 v[28:31], v[52:55], v[88:95], v1
    ds_read_b128 v[88:91], v2 offset:34816
    ds_read_b128 v[92:95], v2 offset:35840
    v_smfmac_f32_16x16x64_bf16 v[20:23], v[52:55], a[168:175], v1
    s_and_b32 s23, s23, 3
    s_lshl_b32 s23, s23, 13
    v_smfmac_f32_16x16x64_bf16 v[8:11], v[56:59], a[32:39], v1
    s_add_u32 s62, s40, s23
    s_addc_u32 s63, s41, 0
    s_lshl_b32 s23, s23, 2
    s_waitcnt lgkmcnt(4)
    v_smfmac_f32_16x16x64_bf16 v[24:27], v[56:59], v[72:79], v1
    ds_read_b128 v[72:75], v3 offset:34816
    ds_read_b128 v[76:79], v3 offset:35840
    s_waitcnt lgkmcnt(4)
    v_smfmac_f32_16x16x64_bf16 v[16:19], v[56:59], v[80:87], v1
    ds_read_b128 v[80:83], v2 offset:49152
    ds_read_b128 v[84:87], v2 offset:50176
    v_smfmac_f32_16x16x64_bf16 v[12:15], v[56:59], a[40:47], v1
    s_add_u32 s64, s42, s23
    s_addc_u32 s65, s43, 0
    s_waitcnt lgkmcnt(4)
    v_smfmac_f32_16x16x64_bf16 v[28:31], v[56:59], v[88:95], v1
    ds_read_b128 v[88:91], v2 offset:51200
    ds_read_b128 v[92:95], v2 offset:52224
    s_waitcnt vmcnt(0)
ch_w0f_grem_chk:
    ds_write_b128 v0, v[40:43] offset:8192
    v_max3_u32 v68, v40, v41, v42
    v_max_u32_e64 v68, v68, v43
    v_cmp_eq_u32 vcc, -1, v68
    s_cbranch_vccnz ch_w0f_grem
    s_waitcnt lgkmcnt(5)
    v_smfmac_f32_16x16x64_bf16 v[20:23], v[56:59], v[72:79], v1
    ds_read_b128 v[72:75], v3 offset:0
    ds_read_b128 v[76:79], v3 offset:1024
    v_smfmac_f32_16x16x64_bf16 v[8:11], v[60:63], a[48:55], v1
    global_load_dwordx4 v[32:35], v0, s[30:31] offset:-4096 sc1
    global_load_dwordx4 v[36:39], v0, s[30:31] offset:0 sc1
    s_waitcnt lgkmcnt(5)
    v_smfmac_f32_16x16x64_bf16 v[24:27], v[60:63], v[80:87], v1
    ds_read_b128 v[80:83], v3 offset:49152
    ds_read_b128 v[84:87], v3 offset:50176
    v_smfmac_f32_16x16x64_bf16 v[16:19], v[60:63], a[176:183], v1
    global_load_dwordx4 v[40:43], v0, s[32:33] offset:-4096 sc1
    v_smfmac_f32_16x16x64_bf16 v[12:15], v[60:63], a[56:63], v1
    global_load_dwordx4 v[44:47], v0, s[32:33] offset:-3072 sc1
    s_waitcnt lgkmcnt(4)
    s_barrier
    ds_read_b128 v[64:67], v0 offset:4096
    ds_read_b128 v[48:51], v0 offset:8192
    ds_read_b128 v[52:55], v0 offset:9216
    ds_read_b128 v[56:59], v0 offset:10240
    v_smfmac_f32_16x16x64_bf16 v[28:31], v[60:63], v[88:95], v1
    ds_read_b128 v[88:91], v3 offset:2048
    ds_read_b128 v[92:95], v3 offset:3072
    v_smfmac_f32_16x16x64_bf16 v[20:23], v[60:63], a[184:191], v1
    s_waitcnt lgkmcnt(5)
    v_smfmac_f32_16x16x64_bf16 v[8:11], v[64:67], a[64:71], v1
    ds_read_b128 v[60:63], v0 offset:11264
    s_nop 0
    v_smfmac_f32_16x16x64_bf16 v[24:27], v[64:67], v[72:79], v1
    ds_read_b128 v[72:75], v3 offset:51200
    ds_read_b128 v[76:79], v3 offset:52224
    v_smfmac_f32_16x16x64_bf16 v[16:19], v[64:67], v[80:87], v1
    v_smfmac_f32_16x16x64_bf16 v[12:15], v[64:67], a[72:79], v1
    s_waitcnt lgkmcnt(3)
    v_smfmac_f32_16x16x64_bf16 v[28:31], v[64:67], v[88:95], v1
    s_waitcnt lgkmcnt(0)
    v_smfmac_f32_16x16x64_bf16 v[20:23], v[64:67], v[72:79], v1
    ds_read_b128 v[64:67], v0 offset:12288
    v_smfmac_f32_16x16x64_bf16 v[8:11], v[48:51], a[80:87], v1
    v_mov_b32 v69, -1
    v_lshrrev_b32_e64 v68, 1, v0
    v_smfmac_f32_16x16x64_bf16 v[12:15], v[48:51], a[88:95], v1
    s_add_u32 s22, s22, 1
    s_and_b32 s23, s22, 3
    v_smfmac_f32_16x16x64_bf16 v[8:11], v[52:55], a[96:103], v1
    s_lshl_b32 s23, s23, 13
    s_add_u32 s24, s23, 2048
    v_smfmac_f32_16x16x64_bf16 v[12:15], v[52:55], a[104:111], v1
    s_add_u32 s54, s40, s24
    s_addc_u32 s55, s41, 0
    s_lshl_b32 s23, s23, 2
    v_smfmac_f32_16x16x64_bf16 v[8:11], v[56:59], a[112:119], v1
    s_add_u32 s56, s44, s23
    s_addc_u32 s57, s45, 0
    s_mov_b64 vcc, s[66:67]
    v_smfmac_f32_16x16x64_bf16 v[12:15], v[56:59], a[120:127], v1
    v_smfmac_f32_16x16x64_bf16 v[8:11], v[60:63], a[128:135], v1
    s_nop 0
    v_smfmac_f32_16x16x64_bf16 v[12:15], v[60:63], a[136:143], v1
    s_waitcnt lgkmcnt(0)
    v_smfmac_f32_16x16x64_bf16 v[8:11], v[64:67], a[144:151], v1
    v_smfmac_f32_16x16x64_bf16 v[12:15], v[64:67], a[152:159], v1
    s_nop 0
    v_smfmac_f32_16x16x64_bf16 v[16:19], v[48:51], a[192:199], v1
    s_nop 2
    s_nop 0
    v_smfmac_f32_16x16x64_bf16 v[20:23], v[48:51], a[200:207], v1
    s_nop 1
    v_add_f32_e64 v8, v8, v10
    v_add_f32_e64 v9, v9, v11
    v_smfmac_f32_16x16x64_bf16 v[16:19], v[52:55], a[208:215], v1
    v_add_f32_e64 v12, v12, v14
    v_add_f32_e64 v13, v13, v15
    v_cvt_pk_bf16_f32 v8, v8, v9
    v_cvt_pk_bf16_f32 v9, v12, v13
    ds_write2st64_b32 v4, v8, v9 offset0:20 offset1:21
    ds_read_b64_tr_b16 v[72:73], v5 offset:5120
    ds_read_b64_tr_b16 v[74:75], v5 offset:5376
    v_smfmac_f32_16x16x64_bf16 v[20:23], v[52:55], a[216:223], v1
    v_mov_b32 v88, 0x3f803f80
    v_smfmac_f32_16x16x64_bf16 v[16:19], v[56:59], a[224:231], v1
    v_mov_b32 v89, 0x3f803f80
    v_smfmac_f32_16x16x64_bf16 v[20:23], v[56:59], a[232:239], v1
    v_mov_b32 v90, 0x3f803f80
    v_smfmac_f32_16x16x64_bf16 v[16:19], v[60:63], a[240:247], v1
    v_mov_b32 v91, 0x3f803f80
    v_smfmac_f32_16x16x64_bf16 v[20:23], v[60:63], a[248:255], v1
    s_mov_b64 exec, s[6:7]
    global_store_dwordx2 v68, v[70:71], s[36:37] offset:0 sc1
    s_mov_b64 exec, -1
    v_smfmac_f32_16x16x64_bf16 v[16:19], v[64:67], v[96:103], v1
    s_mov_b64 exec, s[70:71]
    global_store_dword v7, v69, s[62:63]
    global_store_dword v7, v69, s[64:65] sc1
    s_mov_b64 exec, -1
    v_smfmac_f32_16x16x64_bf16 v[20:23], v[64:67], v[104:111], v1
    s_waitcnt lgkmcnt(0)
    s_waitcnt vmcnt(5)
    v_mfma_f32_16x16x32_bf16 v[8:11], v[32:35], v[72:75], 0
    s_nop 1
    v_mfma_f32_16x16x32_bf16 v[12:15], v[36:39], v[72:75], 0
    v_add_f32 v16, v16, v18
    v_add_f32 v17, v17, v19
    v_smfmac_f32_16x16x64_bf16 v[24:27], v[48:51], v[112:119], v1
    v_add_f32 v20, v20, v22
    v_add_f32_e64 v21, v21, v23
    v_cvt_pk_bf16_f32 v16, v16, v17
    v_cvt_pk_bf16_f32 v17, v20, v21
    ds_write2st64_b32 v4, v16, v17 offset0:52 offset1:53
    v_smfmac_f32_16x16x64_bf16 v[28:31], v[48:51], v[120:127], v1
    v_cndmask_b32 v8, v8, v12, vcc
    v_cndmask_b32 v9, v9, v13, vcc
    v_cndmask_b32 v10, v10, v14, vcc
    v_cndmask_b32 v11, v11, v15, vcc
    ds_write_b128 v0, v[8:11] offset:0
    ds_read_b64_tr_b16 v[16:17], v5 offset:13312
    ds_read_b64_tr_b16 v[18:19], v5 offset:13568
    v_smfmac_f32_16x16x64_bf16 v[24:27], v[52:55], v[128:135], v1
    s_mov_b64 vcc, s[68:69]
    v_smfmac_f32_16x16x64_bf16 v[28:31], v[52:55], v[136:143], v1
    s_nop 0
    v_smfmac_f32_16x16x64_bf16 v[24:27], v[56:59], v[144:151], v1
    v_smfmac_f32_16x16x64_bf16 v[28:31], v[56:59], v[152:159], v1
    s_waitcnt lgkmcnt(2)
    s_barrier
    ds_read_b128 v[32:35], v0 offset:1024
    ds_read_b128 v[36:39], v0 offset:2048
    ds_read_b128 v[92:95], v0 offset:3072
    v_smfmac_f32_16x16x64_bf16 v[24:27], v[60:63], v[160:167], v1
    ds_read_b64_tr_b16 v[76:77], v5 offset:5632
    ds_read_b64_tr_b16 v[48:49], v5 offset:13824
    ds_read_b64_tr_b16 v[78:79], v5 offset:5888
    v_smfmac_f32_16x16x64_bf16 v[28:31], v[60:63], v[168:175], v1
    ds_read_b64_tr_b16 v[50:51], v5 offset:14080
    ds_read_b64_tr_b16 v[80:81], v5 offset:6144
    ds_read_b64_tr_b16 v[52:53], v5 offset:14336
    v_smfmac_f32_16x16x64_bf16 v[24:27], v[64:67], v[176:183], v1
    ds_read_b64_tr_b16 v[82:83], v5 offset:6400
    ds_read_b64_tr_b16 v[54:55], v5 offset:14592
    ds_read_b64_tr_b16 v[84:85], v5 offset:6656
    v_smfmac_f32_16x16x64_bf16 v[28:31], v[64:67], v[184:191], v1
    ds_read_b64_tr_b16 v[56:57], v5 offset:14848
    ds_read_b64_tr_b16 v[86:87], v5 offset:6912
    ds_read_b64_tr_b16 v[58:59], v5 offset:15104
    s_waitcnt lgkmcnt(12)
    v_mfma_f32_16x16x32_bf16 v[20:23], v[16:19], v[72:75], 0
    s_mov_b64 exec, s[6:7]
    global_store_dwordx4 v0, v[16:19], s[34:35] offset:0 sc1
    s_mov_b64 exec, -1
    s_cmp_eq_u32 s22, 64
    s_cbranch_scc1 ch_w0f_last
    v_pk_add_f32 v[8:9], v[8:9], v[32:33]
    v_pk_add_f32 v[10:11], v[10:11], v[34:35]
    v_pk_add_f32 v[36:37], v[36:37], v[92:93]
    v_pk_add_f32 v[38:39], v[38:39], v[94:95]
    v_pk_add_f32 v[8:9], v[8:9], v[36:37]
    v_pk_add_f32 v[10:11], v[10:11], v[38:39]
    v_mul_f32 v8, s27, v8
    v_mul_f32 v9, s27, v9
    v_mul_f32 v10, s27, v10
    v_mul_f32 v11, s27, v11
    s_waitcnt lgkmcnt(0)
    v_mfma_f32_16x16x32_bf16 v[20:23], v[48:51], v[76:79], v[20:23]
    v_exp_f32_e64 v12, v8
    v_mfma_f32_16x16x32_bf16 v[20:23], v[52:55], v[80:83], v[20:23]
    v_exp_f32 v13, v9
    v_mfma_f32_16x16x32_bf16 v[20:23], v[56:59], v[84:87], v[20:23]
    v_exp_f32 v14, v10
    v_exp_f32_e64 v15, v11
    v_cvt_pk_bf16_f32 v94, v12, v13
    v_cvt_pk_bf16_f32 v95, v14, v15
    v_cvt_pk_bf16_f32 v92, v12, v13
    v_cvt_pk_bf16_f32 v93, v14, v15
    v_add_f32 v24, v24, v26
    v_add_f32 v25, v25, v27
    v_mov_b32_dpp v92, v94 row_shr:4 row_mask:0xf bank_mask:0xa
    v_mov_b32_dpp v93, v95 row_shr:4 row_mask:0xf bank_mask:0xa
    v_mov_b32_dpp v94, v94 row_shl:4 row_mask:0xf bank_mask:0x5
    v_mov_b32_dpp v95, v95 row_shl:4 row_mask:0xf bank_mask:0x5
    v_cndmask_b32 v18, v20, v22, vcc
    v_cndmask_b32 v19, v21, v23, vcc
    s_waitcnt vmcnt(4)
    v_mfma_f32_16x16x32_bf16 v[12:15], v[88:91], v[92:95], 0
    v_mul_f32 v18, s27, v18
    v_mul_f32 v19, s27, v19
    v_mfma_f32_16x16x32_bf16 v[32:35], v[40:43], v[92:95], 0
    v_exp_f32 v20, v18
    v_mfma_f32_16x16x32_bf16 v[36:39], v[44:47], v[92:95], 0
    v_exp_f32 v21, v19
    v_add_f32 v28, v28, v30
    v_add_f32 v29, v29, v31
    v_cvt_pk_bf16_f32 v26, v20, v21
    v_mov_b32 v27, 0
    v_cvt_pk_bf16_f32 v70, v24, v25
    v_cvt_pk_bf16_f32 v71, v28, v29
    v_mfma_f32_16x16x16_bf16 v[12:15], v[88:89], v[26:27], v[12:15]
    v_cvt_pk_bf16_f32 v29, v20, v21
    v_mov_b32_e64 v28, 0
    v_mfma_f32_16x16x16_bf16 v[32:35], v[70:71], v[26:27], v[32:35]
    v_max3_f32 v68, abs(v8), abs(v9), abs(v10)
    v_mfma_f32_16x16x16_bf16 v[36:39], v[70:71], v[28:29], v[36:39]
    v_max3_f32 v68, v68, abs(v11), abs(v18)
    v_max_f32 v68, v68, abs(v19)
    v_cmp_nge_f32 vcc, s29, v68
    s_cbranch_vccnz ch_w0f_slow
ch_w0f_pvm:
    v_rcp_f32 v22, v12
    v_mov_b64 v[40:41], 0
    v_pk_mul_f32 v[32:33], v[32:33], v[22:23] op_sel_hi:[1,0]
    v_pk_mul_f32 v[34:35], v[34:35], v[22:23] op_sel_hi:[1,0]
    v_cvt_pk_bf16_f32 v16, v32, v33
    v_pk_mul_f32 v[36:37], v[36:37], v[22:23] op_sel_hi:[1,0]
    v_cvt_pk_bf16_f32 v17, v34, v35
    v_pk_mul_f32 v[38:39], v[38:39], v[22:23] op_sel_hi:[1,0]
    v_cvt_pk_bf16_f32 v18, v36, v37
    v_cvt_pk_bf16_f32 v19, v38, v39
    ds_write_b128 v0, v[16:19] offset:8192
    v_mov_b64 v[42:43], 0
    v_mov_b64 v[44:45], 0
    v_mov_b64_e64 v[46:47], 0
    v_smfmac_f32_16x16x64_bf16 v[40:43], v[16:19], v[192:199], v1 abid:1
    s_nop 0
    v_smfmac_f32_16x16x64_bf16 v[44:47], v[16:19], v[224:231], v1 abid:1
    s_waitcnt lgkmcnt(0)
    s_barrier
    ds_read_b128 v[20:23], v0 offset:9216
    ds_read_b128 v[28:31], v0 offset:10240
    ds_read_b128 v[12:15], v0 offset:11264
    s_waitcnt lgkmcnt(2)
    v_smfmac_f32_16x16x64_bf16 v[40:43], v[20:23], v[200:207], v1 abid:1
    s_waitcnt lgkmcnt(1)
    v_smfmac_f32_16x16x64_bf16 v[40:43], v[28:31], v[208:215], v1 abid:1
    s_waitcnt lgkmcnt(0)
    v_smfmac_f32_16x16x64_bf16 v[40:43], v[12:15], v[216:223], v1 abid:1
    s_nop 0
    v_smfmac_f32_16x16x64_bf16 v[44:47], v[20:23], v[232:239], v1 abid:1
    s_add_u32 s30, s30, 262144
    s_addc_u32 s31, s31, 0
    v_smfmac_f32_16x16x64_bf16 v[44:47], v[28:31], v[240:247], v1 abid:1
    s_add_u32 s32, s32, 262144
    s_addc_u32 s33, s33, 0
    v_smfmac_f32_16x16x64_bf16 v[44:47], v[12:15], v[248:255], v1 abid:1
    s_add_u32 s34, s34, 131072
    s_addc_u32 s35, s35, 0
    v_cvt_pk_bf16_f32 v40, v40, v41
    v_cvt_pk_bf16_f32 v41, v42, v43
    v_and_or_b32 v40, v40, -2, s16
    global_store_dwordx2 v6, v[40:41], s[46:47]
    s_nop 1
    v_cvt_pk_bf16_f32 v44, v44, v45
    v_cvt_pk_bf16_f32 v45, v46, v47
    v_and_or_b32 v44, v44, -2, s16
    global_store_dwordx2 v6, v[44:45], s[48:49]
    s_add_u32 s36, s36, 131072
    s_addc_u32 s37, s37, 0
    ds_read_b128 v[64:67], v0 offset:15360
    ds_read_b128 v[72:75], v2 offset:0
    ds_read_b128 v[76:79], v2 offset:1024
    ds_read_b128 v[80:83], v3 offset:16384
    ds_read_b128 v[84:87], v3 offset:17408
    ds_read_b128 v[88:91], v2 offset:2048
    ds_read_b128 v[92:95], v2 offset:3072
    v_mov_b64 v[8:9], 0
    v_mov_b64 v[10:11], 0
    v_mov_b64 v[12:13], 0
    v_mov_b64 v[14:15], 0
    v_mov_b64 v[16:17], 0
    v_mov_b64 v[18:19], 0
    v_mov_b64 v[20:21], 0
    v_mov_b64 v[22:23], 0
    v_mov_b64 v[24:25], 0
    v_mov_b64 v[26:27], 0
    v_mov_b64 v[28:29], 0
    v_mov_b64_e64 v[30:31], 0
    s_waitcnt vmcnt(0)
    global_load_dwordx4 v[48:51], v0, s[52:53] offset:0 sc1
    global_load_dwordx4 v[52:55], v0, s[52:53] offset:1024 sc1
    global_load_dwordx4 v[56:59], v0, s[52:53] offset:2048 sc1
    global_load_dwordx4 v[60:63], v0, s[52:53] offset:3072 sc1
    s_nop 0
    s_sleep 2
    global_load_dwordx4 v[32:35], v0, s[52:53] offset:0 sc1
    global_load_dwordx4 v[36:39], v0, s[52:53] offset:1024 sc1
    global_load_dwordx4 v[40:43], v0, s[52:53] offset:2048 sc1
    global_load_dwordx4 v[44:47], v0, s[52:53] offset:3072 sc1
    s_waitcnt lgkmcnt(0)
ch_w0f_rchk:
    s_waitcnt vmcnt(7)
    v_mfma_f32_16x16x32_bf16 v[8:11], v[64:67], v[48:51], 0
    v_xor_b32_e64 v68, s16, v48
    v_bitop3_b32 v68, v68, v50, s16 bitop3:0xf6
    s_waitcnt vmcnt(6)
    v_mfma_f32_16x16x32_bf16 v[8:11], v[64:67], v[52:55], v[8:11]
    v_bitop3_b32 v68, v68, v52, s16 bitop3:0xf6
    v_bitop3_b32 v68, v68, v54, s16 bitop3:0xf6
    s_waitcnt vmcnt(5)
    v_mfma_f32_16x16x32_bf16 v[8:11], v[64:67], v[56:59], v[8:11]
    v_bitop3_b32 v68, v68, v56, s16 bitop3:0xf6
    v_bitop3_b32 v68, v68, v58, s16 bitop3:0xf6
    s_waitcnt vmcnt(4)
    v_mfma_f32_16x16x32_bf16 v[8:11], v[64:67], v[60:63], v[8:11]
    v_bitop3_b32 v68, v68, v60, s16 bitop3:0xf6
    v_bitop3_b32 v68, v68, v62, s16 bitop3:0xf6
    v_and_b32 v68, 1, v68
    v_cmp_ne_u32 vcc, 0, v68
    s_cbranch_vccnz ch_w0f_rpoll
    s_nop 2
    v_add_f32_dpp v8, v8, v8 row_ror:8 row_mask:0xf bank_mask:0xf
    v_add_f32_dpp v9, v9, v9 row_ror:8 row_mask:0xf bank_mask:0xf
    s_mov_b64 exec, s[70:71]
    v_cvt_pk_bf16_f32 v8, v8, v9
    v_min_u32 v69, -2, v8
    global_store_dword v7, v69, s[58:59]
    global_store_dword v7, v69, s[60:61] sc1
ch_w0f_rok:
    s_mov_b64 exec, -1
    v_mov_b64_e64 v[8:9], 0
    v_mov_b64_e64 v[10:11], 0
    s_barrier
    s_sleep 2
    s_branch ch_w0f_loop
ch_w0f_grem:
    s_mov_b64 exec, vcc
    global_load_dwordx4 v[40:43], v0, s[56:57] sc1
    s_mov_b64 exec, -1
    s_add_u32 s26, s26, 1
    s_cmp_gt_u32 s26, 1048576
    s_cbranch_scc1 ch_fail
    s_waitcnt vmcnt(0)
    s_branch ch_w0f_grem_chk
ch_w0f_last:
    s_add_u32 s36, s36, 131072
    s_addc_u32 s37, s37, 0
    s_nop 7
    v_add_f32 v24, v24, v26
    v_add_f32_e64 v25, v25, v27
    v_add_f32_e64 v28, v28, v30
    v_add_f32_e64 v29, v29, v31
    v_cvt_pk_bf16_f32 v70, v24, v25
    v_cvt_pk_bf16_f32 v71, v28, v29
    s_mov_b64 exec, s[6:7]
    global_store_dwordx2 v68, v[70:71], s[36:37] offset:0 sc1
    s_mov_b64 exec, -1
    s_branch ch_done
ch_w0f_rpoll:
    s_mov_b64 exec, vcc
    global_load_dwordx4 v[48:51], v0, s[52:53] offset:0 sc1
    global_load_dwordx4 v[52:55], v0, s[52:53] offset:1024 sc1
    global_load_dwordx4 v[56:59], v0, s[52:53] offset:2048 sc1
    global_load_dwordx4 v[60:63], v0, s[52:53] offset:3072 sc1
    s_mov_b64 exec, -1
    s_waitcnt vmcnt(7)
    v_mfma_f32_16x16x32_bf16 v[8:11], v[64:67], v[32:35], 0
    v_xor_b32 v68, s16, v32
    v_bitop3_b32 v68, v68, v34, s16 bitop3:0xf6
    s_waitcnt vmcnt(6)
    v_mfma_f32_16x16x32_bf16 v[8:11], v[64:67], v[36:39], v[8:11]
    v_bitop3_b32 v68, v68, v36, s16 bitop3:0xf6
    v_bitop3_b32 v68, v68, v38, s16 bitop3:0xf6
    s_waitcnt vmcnt(5)
    v_mfma_f32_16x16x32_bf16 v[8:11], v[64:67], v[40:43], v[8:11]
    v_bitop3_b32 v68, v68, v40, s16 bitop3:0xf6
    v_bitop3_b32 v68, v68, v42, s16 bitop3:0xf6
    s_waitcnt vmcnt(4)
    v_mfma_f32_16x16x32_bf16 v[8:11], v[64:67], v[44:47], v[8:11]
    v_bitop3_b32 v68, v68, v44, s16 bitop3:0xf6
    v_bitop3_b32 v68, v68, v46, s16 bitop3:0xf6
    v_and_b32 v68, 1, v68
    v_cmp_ne_u32 vcc, 0, v68
    s_cbranch_vccnz ch_w0f_rpol2
    s_nop 2
    v_add_f32_dpp v8, v8, v8 row_ror:8 row_mask:0xf bank_mask:0xf
    v_add_f32_dpp v9, v9, v9 row_ror:8 row_mask:0xf bank_mask:0xf
    s_mov_b64 exec, s[70:71]
    v_cvt_pk_bf16_f32 v8, v8, v9
    v_min_u32 v69, -2, v8
    global_store_dword v7, v69, s[58:59]
    global_store_dword v7, v69, s[60:61] sc1
    s_branch ch_w0f_rok
ch_w0f_rpol2:
    s_mov_b64 exec, vcc
    global_load_dwordx4 v[32:35], v0, s[52:53] offset:0 sc1
    global_load_dwordx4 v[36:39], v0, s[52:53] offset:1024 sc1
    global_load_dwordx4 v[40:43], v0, s[52:53] offset:2048 sc1
    global_load_dwordx4 v[44:47], v0, s[52:53] offset:3072 sc1
    s_mov_b64 exec, -1
    s_add_u32 s26, s26, 1
    s_cmp_gt_u32 s26, 1048576
    s_cbranch_scc1 ch_fail
    s_branch ch_w0f_rchk
ch_w0f_slow:
    s_nop 7
    v_max3_f32 v68, v8, v9, v10
    v_max3_f32 v68, v68, v11, v18
    v_max_f32 v68, v68, v19
    v_mov_b32 v16, v68
    s_nop 1
    v_mov_b32_dpp v16, v68 row_shr:4 row_mask:0xf bank_mask:0xa
    s_nop 1
    v_mov_b32_dpp v16, v68 row_shl:4 row_mask:0xf bank_mask:0x5
    v_max_f32 v68, v68, v16
    v_mov_b32 v16, v68
    s_nop 1
    v_permlane16_swap_b32 v68, v16
    v_max_f32 v68, v68, v16
    v_mov_b32 v16, v68
    s_nop 1
    v_permlane32_swap_b32 v68, v16
    v_max_f32 v68, v68, v16
    v_sub_f32 v12, v8, v68
    v_exp_f32 v12, v12
    v_sub_f32 v13, v9, v68
    v_exp_f32 v13, v13
    v_sub_f32 v14, v10, v68
    v_exp_f32 v14, v14
    v_sub_f32 v15, v11, v68
    v_exp_f32 v15, v15
    v_sub_f32 v20, v18, v68
    v_exp_f32 v20, v20
    v_sub_f32 v21, v19, v68
    v_exp_f32_e64 v21, v21
    v_cvt_pk_bf16_f32 v94, v12, v13
    v_cvt_pk_bf16_f32 v95, v14, v15
    v_cvt_pk_bf16_f32 v92, v12, v13
    v_cvt_pk_bf16_f32 v93, v14, v15
    s_nop 0
    v_mov_b32_dpp v92, v94 row_shr:4 row_mask:0xf bank_mask:0xa
    v_mov_b32_dpp v93, v95 row_shr:4 row_mask:0xf bank_mask:0xa
    v_mov_b32_dpp v94, v94 row_shl:4 row_mask:0xf bank_mask:0x5
    v_mov_b32_dpp v95, v95 row_shl:4 row_mask:0xf bank_mask:0x5
    v_cvt_pk_bf16_f32 v26, v20, v21
    v_cvt_pk_bf16_f32 v29, v20, v21
    v_mfma_f32_16x16x32_bf16 v[12:15], v[88:91], v[92:95], 0
    v_mfma_f32_16x16x32_bf16 v[32:35], v[40:43], v[92:95], 0
    v_mfma_f32_16x16x32_bf16 v[36:39], v[44:47], v[92:95], 0
    v_mfma_f32_16x16x16_bf16 v[12:15], v[88:89], v[26:27], v[12:15]
    v_mfma_f32_16x16x16_bf16 v[32:35], v[70:71], v[26:27], v[32:35]
    v_mfma_f32_16x16x16_bf16 v[36:39], v[70:71], v[28:29], v[36:39]
    s_nop 7
    s_branch ch_w0f_pvm
ch_slowmode0:
    v_lshlrev_b32 v68, 3, v0
    s_mov_b32 m0, 7168
    s_add_u32 s74, s30, 0
    s_addc_u32 s75, s31, 0
    s_sub_u32 s74, s74, 4096
    s_subb_u32 s75, s75, 0
    global_load_lds_dword v68, s[74:75] sc1
    ds_read_b128 v[72:75], v2 offset:0
    ds_read_b128 v[76:79], v2 offset:1024
    ds_read_b128 v[80:83], v3 offset:16384
    ds_read_b128 v[84:87], v3 offset:17408
    ds_read_b128 v[88:91], v2 offset:2048
    ds_read_b128 v[92:95], v2 offset:3072
    v_mov_b64 v[8:9], 0
    v_mov_b64 v[10:11], 0
    v_mov_b64 v[12:13], 0
    v_mov_b64 v[14:15], 0
    v_mov_b64 v[16:17], 0
    v_mov_b64 v[18:19], 0
    v_mov_b64 v[20:21], 0
    v_mov_b64 v[22:23], 0
    v_mov_b64 v[24:25], 0
    v_mov_b64 v[26:27], 0
    v_mov_b64 v[28:29], 0
    v_mov_b64 v[30:31], 0
    s_mov_b32 s26, 0
    s_branch ch_w0s_loop
.p2align 6
ch_w0s_loop:
    s_waitcnt lgkmcnt(0)
    global_load_dwordx4 v[48:51], v0, s[54:55] offset:-2048 sc1
    s_nop 0
    s_sleep 1
    global_load_dwordx4 v[48:51], v0, s[54:55] offset:-2048 sc1
    s_nop 0
    s_sleep 1
ch_w0s_gown:
    global_load_dwordx4 v[48:51], v0, s[54:55] offset:-2048 sc1
    s_add_u32 s26, s26, 1
    s_cmp_gt_u32 s26, 1048576
    s_cbranch_scc1 ch_fail
    s_waitcnt vmcnt(2)
ch_w0s_gw:
    v_max3_u32 v68, v48, v49, v50
    v_max_u32 v68, v68, v51
    v_cmpx_eq_u32 vcc, -1, v68
    s_cbranch_execnz ch_w0s_gown
ch_w0s_gok:
    s_mov_b64 exec, -1
    ds_write_b128 v0, v[48:51] offset:0
    s_nop 0
    v_smfmac_f32_16x16x64_bf16 v[8:11], v[48:51], a[0:7], v1
    s_nop 0
    v_smfmac_f32_16x16x64_bf16 v[24:27], v[48:51], v[72:79], v1
    ds_read_b128 v[72:75], v3 offset:18432
    ds_read_b128 v[76:79], v3 offset:19456
    global_load_dwordx4 v[40:43], v0, s[56:57] sc1
    v_smfmac_f32_16x16x64_bf16 v[16:19], v[48:51], v[80:87], v1
    ds_read_b128 v[80:83], v2 offset:16384
    ds_read_b128 v[84:87], v2 offset:17408
    s_waitcnt lgkmcnt(4)
    s_barrier
    ds_read_b128 v[52:55], v0 offset:1024
    ds_read_b128 v[56:59], v0 offset:2048
    ds_read_b128 v[60:63], v0 offset:3072
    v_smfmac_f32_16x16x64_bf16 v[12:15], v[48:51], a[8:15], v1
    s_and_b32 s16, s22, 1
    s_add_u32 s23, s22, 1
    v_smfmac_f32_16x16x64_bf16 v[28:31], v[48:51], v[88:95], v1
    ds_read_b128 v[88:91], v2 offset:18432
    ds_read_b128 v[92:95], v2 offset:19456
    s_waitcnt lgkmcnt(7)
    v_smfmac_f32_16x16x64_bf16 v[20:23], v[48:51], v[72:79], v1
    ds_read_b128 v[72:75], v2 offset:32768
    ds_read_b128 v[76:79], v2 offset:33792
    s_waitcnt lgkmcnt(6)
    v_smfmac_f32_16x16x64_bf16 v[8:11], v[52:55], a[16:23], v1
    s_and_b32 s23, s23, 3
    s_lshl_b32 s23, s23, 13
    v_smfmac_f32_16x16x64_bf16 v[24:27], v[52:55], v[80:87], v1
    ds_read_b128 v[80:83], v3 offset:32768
    ds_read_b128 v[84:87], v3 offset:33792
    v_smfmac_f32_16x16x64_bf16 v[16:19], v[52:55], a[160:167], v1
    s_add_u32 s58, s40, s23
    s_addc_u32 s59, s41, 0
    s_lshl_b32 s23, s23, 2
    v_smfmac_f32_16x16x64_bf16 v[12:15], v[52:55], a[24:31], v1
    s_add_u32 s60, s42, s23
    s_addc_u32 s61, s43, 0
    s_add_u32 s23, s22, 2
    s_waitcnt lgkmcnt(4)
    v_smfmac_f32_16x16x64_bf16 v[28:31], v[52:55], v[88:95], v1
    ds_read_b128 v[88:91], v2 offset:34816
    ds_read_b128 v[92:95], v2 offset:35840
    v_smfmac_f32_16x16x64_bf16 v[20:23], v[52:55], a[168:175], v1
    s_and_b32 s23, s23, 3
    s_lshl_b32 s23, s23, 13
    v_smfmac_f32_16x16x64_bf16 v[8:11], v[56:59], a[32:39], v1
    s_add_u32 s62, s40, s23
    s_addc_u32 s63, s41, 0
    s_lshl_b32 s23, s23, 2
    s_waitcnt lgkmcnt(4)
    v_smfmac_f32_16x16x64_bf16 v[24:27], v[56:59], v[72:79], v1
    ds_read_b128 v[72:75], v3 offset:34816
    ds_read_b128 v[76:79], v3 offset:35840
    s_waitcnt lgkmcnt(4)
    v_smfmac_f32_16x16x64_bf16 v[16:19], v[56:59], v[80:87], v1
    ds_read_b128 v[80:83], v2 offset:49152
    ds_read_b128 v[84:87], v2 offset:50176
    v_smfmac_f32_16x16x64_bf16 v[12:15], v[56:59], a[40:47], v1
    s_add_u32 s64, s42, s23
    s_addc_u32 s65, s43, 0
    s_waitcnt lgkmcnt(4)
    v_smfmac_f32_16x16x64_bf16 v[28:31], v[56:59], v[88:95], v1
    ds_read_b128 v[88:91], v2 offset:51200
    ds_read_b128 v[92:95], v2 offset:52224
    s_waitcnt vmcnt(0)
ch_w0s_grem_chk:
    ds_write_b128 v0, v[40:43] offset:8192
    v_max3_u32 v68, v40, v41, v42
    v_max_u32_e64 v68, v68, v43
    v_cmp_eq_u32 vcc, -1, v68
    s_cbranch_vccnz ch_w0s_grem
    s_waitcnt lgkmcnt(5)
    v_smfmac_f32_16x16x64_bf16 v[20:23], v[56:59], v[72:79], v1
    ds_read_b128 v[72:75], v3 offset:0
    ds_read_b128 v[76:79], v3 offset:1024
    v_smfmac_f32_16x16x64_bf16 v[8:11], v[60:63], a[48:55], v1
    global_load_dwordx4 v[32:35], v0, s[30:31] offset:-4096 sc1
    global_load_dwordx4 v[36:39], v0, s[30:31] offset:0 sc1
    s_waitcnt lgkmcnt(5)
    v_smfmac_f32_16x16x64_bf16 v[24:27], v[60:63], v[80:87], v1
    ds_read_b128 v[80:83], v3 offset:49152
    ds_read_b128 v[84:87], v3 offset:50176
    v_smfmac_f32_16x16x64_bf16 v[16:19], v[60:63], a[176:183], v1
    global_load_dwordx4 v[40:43], v0, s[32:33] offset:-4096 sc1
    v_smfmac_f32_16x16x64_bf16 v[12:15], v[60:63], a[56:63], v1
    global_load_dwordx4 v[44:47], v0, s[32:33] offset:-3072 sc1
    s_waitcnt lgkmcnt(4)
    s_barrier
    ds_read_b128 v[64:67], v0 offset:4096
    ds_read_b128 v[48:51], v0 offset:8192
    ds_read_b128 v[52:55], v0 offset:9216
    ds_read_b128 v[56:59], v0 offset:10240
    v_smfmac_f32_16x16x64_bf16 v[28:31], v[60:63], v[88:95], v1
    ds_read_b128 v[88:91], v3 offset:2048
    ds_read_b128 v[92:95], v3 offset:3072
    v_smfmac_f32_16x16x64_bf16 v[20:23], v[60:63], a[184:191], v1
    s_waitcnt lgkmcnt(5)
    v_smfmac_f32_16x16x64_bf16 v[8:11], v[64:67], a[64:71], v1
    ds_read_b128 v[60:63], v0 offset:11264
    s_nop 0
    v_smfmac_f32_16x16x64_bf16 v[24:27], v[64:67], v[72:79], v1
    ds_read_b128 v[72:75], v3 offset:51200
    ds_read_b128 v[76:79], v3 offset:52224
    v_smfmac_f32_16x16x64_bf16 v[16:19], v[64:67], v[80:87], v1
    v_smfmac_f32_16x16x64_bf16 v[12:15], v[64:67], a[72:79], v1
    s_waitcnt lgkmcnt(3)
    v_smfmac_f32_16x16x64_bf16 v[28:31], v[64:67], v[88:95], v1
    s_waitcnt lgkmcnt(0)
    v_smfmac_f32_16x16x64_bf16 v[20:23], v[64:67], v[72:79], v1
    ds_read_b128 v[64:67], v0 offset:12288
    v_smfmac_f32_16x16x64_bf16 v[8:11], v[48:51], a[80:87], v1
    v_mov_b32 v69, -1
    v_lshrrev_b32_e64 v68, 1, v0
    v_smfmac_f32_16x16x64_bf16 v[12:15], v[48:51], a[88:95], v1
    s_add_u32 s22, s22, 1
    s_and_b32 s23, s22, 3
    v_smfmac_f32_16x16x64_bf16 v[8:11], v[52:55], a[96:103], v1
    s_lshl_b32 s23, s23, 13
    s_add_u32 s24, s23, 2048
    v_smfmac_f32_16x16x64_bf16 v[12:15], v[52:55], a[104:111], v1
    s_add_u32 s54, s40, s24
    s_addc_u32 s55, s41, 0
    s_lshl_b32 s23, s23, 2
    v_smfmac_f32_16x16x64_bf16 v[8:11], v[56:59], a[112:119], v1
    s_add_u32 s56, s44, s23
    s_addc_u32 s57, s45, 0
    s_mov_b64 vcc, s[66:67]
    v_smfmac_f32_16x16x64_bf16 v[12:15], v[56:59], a[120:127], v1
    v_smfmac_f32_16x16x64_bf16 v[8:11], v[60:63], a[128:135], v1
    s_nop 0
    v_smfmac_f32_16x16x64_bf16 v[12:15], v[60:63], a[136:143], v1
    s_waitcnt lgkmcnt(0)
    v_smfmac_f32_16x16x64_bf16 v[8:11], v[64:67], a[144:151], v1
    v_smfmac_f32_16x16x64_bf16 v[12:15], v[64:67], a[152:159], v1
    s_nop 0
    v_smfmac_f32_16x16x64_bf16 v[16:19], v[48:51], a[192:199], v1
    s_nop 2
    s_nop 0
    v_smfmac_f32_16x16x64_bf16 v[20:23], v[48:51], a[200:207], v1
    s_nop 1
    v_add_f32_e64 v8, v8, v10
    v_add_f32_e64 v9, v9, v11
    v_smfmac_f32_16x16x64_bf16 v[16:19], v[52:55], a[208:215], v1
    v_add_f32_e64 v12, v12, v14
    v_add_f32_e64 v13, v13, v15
    v_cvt_pk_bf16_f32 v8, v8, v9
    v_cvt_pk_bf16_f32 v9, v12, v13
    ds_write2st64_b32 v4, v8, v9 offset0:20 offset1:21
    ds_read_b64_tr_b16 v[72:73], v5 offset:5120
    ds_read_b64_tr_b16 v[74:75], v5 offset:5376
    v_smfmac_f32_16x16x64_bf16 v[20:23], v[52:55], a[216:223], v1
    v_mov_b32 v88, 0x3f803f80
    v_smfmac_f32_16x16x64_bf16 v[16:19], v[56:59], a[224:231], v1
    v_mov_b32 v89, 0x3f803f80
    v_smfmac_f32_16x16x64_bf16 v[20:23], v[56:59], a[232:239], v1
    v_mov_b32 v90, 0x3f803f80
    v_smfmac_f32_16x16x64_bf16 v[16:19], v[60:63], a[240:247], v1
    v_mov_b32 v91, 0x3f803f80
    v_smfmac_f32_16x16x64_bf16 v[20:23], v[60:63], a[248:255], v1
    s_mov_b64 exec, s[6:7]
    global_store_dwordx2 v68, v[70:71], s[36:37] offset:0 sc1
    s_mov_b64 exec, -1
    v_smfmac_f32_16x16x64_bf16 v[16:19], v[64:67], v[96:103], v1
    s_mov_b64 exec, s[70:71]
    global_store_dword v7, v69, s[62:63] sc1
    global_store_dword v7, v69, s[64:65] sc1
    s_mov_b64 exec, -1
    v_smfmac_f32_16x16x64_bf16 v[20:23], v[64:67], v[104:111], v1
    s_waitcnt lgkmcnt(0)
    s_waitcnt vmcnt(5)
    v_mfma_f32_16x16x32_bf16 v[8:11], v[32:35], v[72:75], 0
    s_nop 1
    v_mfma_f32_16x16x32_bf16 v[12:15], v[36:39], v[72:75], 0
    v_add_f32 v16, v16, v18
    v_add_f32 v17, v17, v19
    v_smfmac_f32_16x16x64_bf16 v[24:27], v[48:51], v[112:119], v1
    v_add_f32 v20, v20, v22
    v_add_f32_e64 v21, v21, v23
    v_cvt_pk_bf16_f32 v16, v16, v17
    v_cvt_pk_bf16_f32 v17, v20, v21
    ds_write2st64_b32 v4, v16, v17 offset0:52 offset1:53
    v_smfmac_f32_16x16x64_bf16 v[28:31], v[48:51], v[120:127], v1
    v_cndmask_b32 v8, v8, v12, vcc
    v_cndmask_b32 v9, v9, v13, vcc
    v_cndmask_b32 v10, v10, v14, vcc
    v_cndmask_b32 v11, v11, v15, vcc
    ds_write_b128 v0, v[8:11] offset:0
    ds_read_b64_tr_b16 v[16:17], v5 offset:13312
    ds_read_b64_tr_b16 v[18:19], v5 offset:13568
    v_smfmac_f32_16x16x64_bf16 v[24:27], v[52:55], v[128:135], v1
    s_mov_b64 vcc, s[68:69]
    v_smfmac_f32_16x16x64_bf16 v[28:31], v[52:55], v[136:143], v1
    s_nop 0
    v_smfmac_f32_16x16x64_bf16 v[24:27], v[56:59], v[144:151], v1
    v_smfmac_f32_16x16x64_bf16 v[28:31], v[56:59], v[152:159], v1
    s_waitcnt lgkmcnt(2)
    s_barrier
    ds_read_b128 v[32:35], v0 offset:1024
    ds_read_b128 v[36:39], v0 offset:2048
    ds_read_b128 v[92:95], v0 offset:3072
    v_smfmac_f32_16x16x64_bf16 v[24:27], v[60:63], v[160:167], v1
    ds_read_b64_tr_b16 v[76:77], v5 offset:5632
    ds_read_b64_tr_b16 v[48:49], v5 offset:13824
    ds_read_b64_tr_b16 v[78:79], v5 offset:5888
    v_smfmac_f32_16x16x64_bf16 v[28:31], v[60:63], v[168:175], v1
    ds_read_b64_tr_b16 v[50:51], v5 offset:14080
    ds_read_b64_tr_b16 v[80:81], v5 offset:6144
    ds_read_b64_tr_b16 v[52:53], v5 offset:14336
    v_smfmac_f32_16x16x64_bf16 v[24:27], v[64:67], v[176:183], v1
    ds_read_b64_tr_b16 v[82:83], v5 offset:6400
    ds_read_b64_tr_b16 v[54:55], v5 offset:14592
    ds_read_b64_tr_b16 v[84:85], v5 offset:6656
    v_smfmac_f32_16x16x64_bf16 v[28:31], v[64:67], v[184:191], v1
    ds_read_b64_tr_b16 v[56:57], v5 offset:14848
    ds_read_b64_tr_b16 v[86:87], v5 offset:6912
    ds_read_b64_tr_b16 v[58:59], v5 offset:15104
    s_waitcnt lgkmcnt(12)
    v_mfma_f32_16x16x32_bf16 v[20:23], v[16:19], v[72:75], 0
    s_mov_b64 exec, s[6:7]
    global_store_dwordx4 v0, v[16:19], s[34:35] offset:0 sc1
    s_mov_b64 exec, -1
    s_cmp_eq_u32 s22, 64
    s_cbranch_scc1 ch_w0s_last
    v_pk_add_f32 v[8:9], v[8:9], v[32:33]
    v_pk_add_f32 v[10:11], v[10:11], v[34:35]
    v_pk_add_f32 v[36:37], v[36:37], v[92:93]
    v_pk_add_f32 v[38:39], v[38:39], v[94:95]
    v_pk_add_f32 v[8:9], v[8:9], v[36:37]
    v_pk_add_f32 v[10:11], v[10:11], v[38:39]
    v_mul_f32 v8, s27, v8
    v_mul_f32 v9, s27, v9
    v_mul_f32 v10, s27, v10
    v_mul_f32 v11, s27, v11
    s_waitcnt lgkmcnt(0)
    v_mfma_f32_16x16x32_bf16 v[20:23], v[48:51], v[76:79], v[20:23]
    v_exp_f32_e64 v12, v8
    v_mfma_f32_16x16x32_bf16 v[20:23], v[52:55], v[80:83], v[20:23]
    v_exp_f32 v13, v9
    v_mfma_f32_16x16x32_bf16 v[20:23], v[56:59], v[84:87], v[20:23]
    v_exp_f32 v14, v10
    v_exp_f32_e64 v15, v11
    v_cvt_pk_bf16_f32 v94, v12, v13
    v_cvt_pk_bf16_f32 v95, v14, v15
    v_cvt_pk_bf16_f32 v92, v12, v13
    v_cvt_pk_bf16_f32 v93, v14, v15
    v_add_f32 v24, v24, v26
    v_add_f32 v25, v25, v27
    v_mov_b32_dpp v92, v94 row_shr:4 row_mask:0xf bank_mask:0xa
    v_mov_b32_dpp v93, v95 row_shr:4 row_mask:0xf bank_mask:0xa
    v_mov_b32_dpp v94, v94 row_shl:4 row_mask:0xf bank_mask:0x5
    v_mov_b32_dpp v95, v95 row_shl:4 row_mask:0xf bank_mask:0x5
    v_cndmask_b32 v18, v20, v22, vcc
    v_cndmask_b32 v19, v21, v23, vcc
    s_waitcnt vmcnt(4)
    v_mfma_f32_16x16x32_bf16 v[12:15], v[88:91], v[92:95], 0
    v_mul_f32 v18, s27, v18
    v_mul_f32 v19, s27, v19
    v_mfma_f32_16x16x32_bf16 v[32:35], v[40:43], v[92:95], 0
    v_exp_f32 v20, v18
    v_mfma_f32_16x16x32_bf16 v[36:39], v[44:47], v[92:95], 0
    v_exp_f32 v21, v19
    v_add_f32 v28, v28, v30
    v_add_f32 v29, v29, v31
    v_cvt_pk_bf16_f32 v26, v20, v21
    v_mov_b32 v27, 0
    v_cvt_pk_bf16_f32 v70, v24, v25
    v_cvt_pk_bf16_f32 v71, v28, v29
    v_mfma_f32_16x16x16_bf16 v[12:15], v[88:89], v[26:27], v[12:15]
    v_cvt_pk_bf16_f32 v29, v20, v21
    v_mov_b32_e64 v28, 0
    v_mfma_f32_16x16x16_bf16 v[32:35], v[70:71], v[26:27], v[32:35]
    v_max3_f32 v68, abs(v8), abs(v9), abs(v10)
    v_mfma_f32_16x16x16_bf16 v[36:39], v[70:71], v[28:29], v[36:39]
    v_max3_f32 v68, v68, abs(v11), abs(v18)
    v_max_f32 v68, v68, abs(v19)
    v_cmp_nge_f32 vcc, s29, v68
    s_cbranch_vccnz ch_w0s_slow
ch_w0s_pvm:
    v_rcp_f32 v22, v12
    v_mov_b64 v[40:41], 0
    v_pk_mul_f32 v[32:33], v[32:33], v[22:23] op_sel_hi:[1,0]
    v_pk_mul_f32 v[34:35], v[34:35], v[22:23] op_sel_hi:[1,0]
    v_cvt_pk_bf16_f32 v16, v32, v33
    v_pk_mul_f32 v[36:37], v[36:37], v[22:23] op_sel_hi:[1,0]
    v_cvt_pk_bf16_f32 v17, v34, v35
    v_pk_mul_f32 v[38:39], v[38:39], v[22:23] op_sel_hi:[1,0]
    v_cvt_pk_bf16_f32 v18, v36, v37
    v_cvt_pk_bf16_f32 v19, v38, v39
    ds_write_b128 v0, v[16:19] offset:8192
    v_mov_b64 v[42:43], 0
    v_mov_b64 v[44:45], 0
    v_mov_b64_e64 v[46:47], 0
    v_smfmac_f32_16x16x64_bf16 v[40:43], v[16:19], v[192:199], v1 abid:1
    s_nop 0
    v_smfmac_f32_16x16x64_bf16 v[44:47], v[16:19], v[224:231], v1 abid:1
    s_waitcnt lgkmcnt(0)
    s_barrier
    ds_read_b128 v[20:23], v0 offset:9216
    ds_read_b128 v[28:31], v0 offset:10240
    ds_read_b128 v[12:15], v0 offset:11264
    s_waitcnt lgkmcnt(2)
    v_smfmac_f32_16x16x64_bf16 v[40:43], v[20:23], v[200:207], v1 abid:1
    s_waitcnt lgkmcnt(1)
    v_smfmac_f32_16x16x64_bf16 v[40:43], v[28:31], v[208:215], v1 abid:1
    s_waitcnt lgkmcnt(0)
    v_smfmac_f32_16x16x64_bf16 v[40:43], v[12:15], v[216:223], v1 abid:1
    s_nop 0
    v_smfmac_f32_16x16x64_bf16 v[44:47], v[20:23], v[232:239], v1 abid:1
    s_add_u32 s30, s30, 262144
    s_addc_u32 s31, s31, 0
    v_smfmac_f32_16x16x64_bf16 v[44:47], v[28:31], v[240:247], v1 abid:1
    s_add_u32 s32, s32, 262144
    s_addc_u32 s33, s33, 0
    v_smfmac_f32_16x16x64_bf16 v[44:47], v[12:15], v[248:255], v1 abid:1
    s_add_u32 s34, s34, 131072
    s_addc_u32 s35, s35, 0
    v_cvt_pk_bf16_f32 v40, v40, v41
    v_cvt_pk_bf16_f32 v41, v42, v43
    v_and_or_b32 v40, v40, -2, s16
    global_store_dwordx2 v6, v[40:41], s[46:47] sc1
    s_nop 1
    v_cvt_pk_bf16_f32 v44, v44, v45
    v_cvt_pk_bf16_f32 v45, v46, v47
    v_and_or_b32 v44, v44, -2, s16
    global_store_dwordx2 v6, v[44:45], s[48:49] sc1
    s_add_u32 s36, s36, 131072
    s_addc_u32 s37, s37, 0
    ds_read_b128 v[64:67], v0 offset:15360
    ds_read_b128 v[72:75], v2 offset:0
    ds_read_b128 v[76:79], v2 offset:1024
    ds_read_b128 v[80:83], v3 offset:16384
    ds_read_b128 v[84:87], v3 offset:17408
    ds_read_b128 v[88:91], v2 offset:2048
    ds_read_b128 v[92:95], v2 offset:3072
    v_mov_b64 v[8:9], 0
    v_mov_b64 v[10:11], 0
    v_mov_b64 v[12:13], 0
    v_mov_b64 v[14:15], 0
    v_mov_b64 v[16:17], 0
    v_mov_b64 v[18:19], 0
    v_mov_b64 v[20:21], 0
    v_mov_b64 v[22:23], 0
    v_mov_b64 v[24:25], 0
    v_mov_b64 v[26:27], 0
    v_mov_b64 v[28:29], 0
    v_mov_b64_e64 v[30:31], 0
    s_waitcnt vmcnt(0)
    global_load_dwordx4 v[48:51], v0, s[52:53] offset:0 sc1
    global_load_dwordx4 v[52:55], v0, s[52:53] offset:1024 sc1
    global_load_dwordx4 v[56:59], v0, s[52:53] offset:2048 sc1
    global_load_dwordx4 v[60:63], v0, s[52:53] offset:3072 sc1
    s_nop 0
    s_sleep 2
    global_load_dwordx4 v[32:35], v0, s[52:53] offset:0 sc1
    global_load_dwordx4 v[36:39], v0, s[52:53] offset:1024 sc1
    global_load_dwordx4 v[40:43], v0, s[52:53] offset:2048 sc1
    global_load_dwordx4 v[44:47], v0, s[52:53] offset:3072 sc1
    s_waitcnt lgkmcnt(0)
ch_w0s_rchk:
    s_waitcnt vmcnt(7)
    v_mfma_f32_16x16x32_bf16 v[8:11], v[64:67], v[48:51], 0
    v_xor_b32_e64 v68, s16, v48
    v_bitop3_b32 v68, v68, v50, s16 bitop3:0xf6
    s_waitcnt vmcnt(6)
    v_mfma_f32_16x16x32_bf16 v[8:11], v[64:67], v[52:55], v[8:11]
    v_bitop3_b32 v68, v68, v52, s16 bitop3:0xf6
    v_bitop3_b32 v68, v68, v54, s16 bitop3:0xf6
    s_waitcnt vmcnt(5)
    v_mfma_f32_16x16x32_bf16 v[8:11], v[64:67], v[56:59], v[8:11]
    v_bitop3_b32 v68, v68, v56, s16 bitop3:0xf6
    v_bitop3_b32 v68, v68, v58, s16 bitop3:0xf6
    s_waitcnt vmcnt(4)
    v_mfma_f32_16x16x32_bf16 v[8:11], v[64:67], v[60:63], v[8:11]
    v_bitop3_b32 v68, v68, v60, s16 bitop3:0xf6
    v_bitop3_b32 v68, v68, v62, s16 bitop3:0xf6
    v_and_b32 v68, 1, v68
    v_cmp_ne_u32 vcc, 0, v68
    s_cbranch_vccnz ch_w0s_rpoll
    s_nop 2
    v_add_f32_dpp v8, v8, v8 row_ror:8 row_mask:0xf bank_mask:0xf
    v_add_f32_dpp v9, v9, v9 row_ror:8 row_mask:0xf bank_mask:0xf
    s_mov_b64 exec, s[70:71]
    v_cvt_pk_bf16_f32 v8, v8, v9
    v_min_u32 v69, -2, v8
    global_store_dword v7, v69, s[58:59] sc1
    global_store_dword v7, v69, s[60:61] sc1
ch_w0s_rok:
    s_mov_b64 exec, -1
    v_mov_b64_e64 v[8:9], 0
    v_mov_b64_e64 v[10:11], 0
    s_barrier
    s_sleep 2
    s_branch ch_w0s_loop
ch_w0s_grem:
    s_mov_b64 exec, vcc
    global_load_dwordx4 v[40:43], v0, s[56:57] sc1
    s_mov_b64 exec, -1
    s_add_u32 s26, s26, 1
    s_cmp_gt_u32 s26, 1048576
    s_cbranch_scc1 ch_fail
    s_waitcnt vmcnt(0)
    s_branch ch_w0s_grem_chk
ch_w0s_last:
    s_add_u32 s36, s36, 131072
    s_addc_u32 s37, s37, 0
    s_nop 7
    v_add_f32 v24, v24, v26
    v_add_f32_e64 v25, v25, v27
    v_add_f32_e64 v28, v28, v30
    v_add_f32_e64 v29, v29, v31
    v_cvt_pk_bf16_f32 v70, v24, v25
    v_cvt_pk_bf16_f32 v71, v28, v29
    s_mov_b64 exec, s[6:7]
    global_store_dwordx2 v68, v[70:71], s[36:37] offset:0 sc1
    s_mov_b64 exec, -1
    s_branch ch_done
ch_w0s_rpoll:
    s_mov_b64 exec, vcc
    global_load_dwordx4 v[48:51], v0, s[52:53] offset:0 sc1
    global_load_dwordx4 v[52:55], v0, s[52:53] offset:1024 sc1
    global_load_dwordx4 v[56:59], v0, s[52:53] offset:2048 sc1
    global_load_dwordx4 v[60:63], v0, s[52:53] offset:3072 sc1
    s_mov_b64 exec, -1
    s_waitcnt vmcnt(7)
    v_mfma_f32_16x16x32_bf16 v[8:11], v[64:67], v[32:35], 0
    v_xor_b32 v68, s16, v32
    v_bitop3_b32 v68, v68, v34, s16 bitop3:0xf6
    s_waitcnt vmcnt(6)
    v_mfma_f32_16x16x32_bf16 v[8:11], v[64:67], v[36:39], v[8:11]
    v_bitop3_b32 v68, v68, v36, s16 bitop3:0xf6
    v_bitop3_b32 v68, v68, v38, s16 bitop3:0xf6
    s_waitcnt vmcnt(5)
    v_mfma_f32_16x16x32_bf16 v[8:11], v[64:67], v[40:43], v[8:11]
    v_bitop3_b32 v68, v68, v40, s16 bitop3:0xf6
    v_bitop3_b32 v68, v68, v42, s16 bitop3:0xf6
    s_waitcnt vmcnt(4)
    v_mfma_f32_16x16x32_bf16 v[8:11], v[64:67], v[44:47], v[8:11]
    v_bitop3_b32 v68, v68, v44, s16 bitop3:0xf6
    v_bitop3_b32 v68, v68, v46, s16 bitop3:0xf6
    v_and_b32 v68, 1, v68
    v_cmp_ne_u32 vcc, 0, v68
    s_cbranch_vccnz ch_w0s_rpol2
    s_nop 2
    v_add_f32_dpp v8, v8, v8 row_ror:8 row_mask:0xf bank_mask:0xf
    v_add_f32_dpp v9, v9, v9 row_ror:8 row_mask:0xf bank_mask:0xf
    s_mov_b64 exec, s[70:71]
    v_cvt_pk_bf16_f32 v8, v8, v9
    v_min_u32 v69, -2, v8
    global_store_dword v7, v69, s[58:59] sc1
    global_store_dword v7, v69, s[60:61] sc1
    s_branch ch_w0s_rok
ch_w0s_rpol2:
    s_mov_b64 exec, vcc
    global_load_dwordx4 v[32:35], v0, s[52:53] offset:0 sc1
    global_load_dwordx4 v[36:39], v0, s[52:53] offset:1024 sc1
    global_load_dwordx4 v[40:43], v0, s[52:53] offset:2048 sc1
    global_load_dwordx4 v[44:47], v0, s[52:53] offset:3072 sc1
    s_mov_b64 exec, -1
    s_add_u32 s26, s26, 1
    s_cmp_gt_u32 s26, 1048576
    s_cbranch_scc1 ch_fail
    s_branch ch_w0s_rchk
ch_w0s_slow:
    s_nop 7
    v_max3_f32 v68, v8, v9, v10
    v_max3_f32 v68, v68, v11, v18
    v_max_f32 v68, v68, v19
    v_mov_b32 v16, v68
    s_nop 1
    v_mov_b32_dpp v16, v68 row_shr:4 row_mask:0xf bank_mask:0xa
    s_nop 1
    v_mov_b32_dpp v16, v68 row_shl:4 row_mask:0xf bank_mask:0x5
    v_max_f32 v68, v68, v16
    v_mov_b32 v16, v68
    s_nop 1
    v_permlane16_swap_b32 v68, v16
    v_max_f32 v68, v68, v16
    v_mov_b32 v16, v68
    s_nop 1
    v_permlane32_swap_b32 v68, v16
    v_max_f32 v68, v68, v16
    v_sub_f32 v12, v8, v68
    v_exp_f32 v12, v12
    v_sub_f32 v13, v9, v68
    v_exp_f32 v13, v13
    v_sub_f32 v14, v10, v68
    v_exp_f32 v14, v14
    v_sub_f32 v15, v11, v68
    v_exp_f32 v15, v15
    v_sub_f32 v20, v18, v68
    v_exp_f32 v20, v20
    v_sub_f32 v21, v19, v68
    v_exp_f32_e64 v21, v21
    v_cvt_pk_bf16_f32 v94, v12, v13
    v_cvt_pk_bf16_f32 v95, v14, v15
    v_cvt_pk_bf16_f32 v92, v12, v13
    v_cvt_pk_bf16_f32 v93, v14, v15
    s_nop 0
    v_mov_b32_dpp v92, v94 row_shr:4 row_mask:0xf bank_mask:0xa
    v_mov_b32_dpp v93, v95 row_shr:4 row_mask:0xf bank_mask:0xa
    v_mov_b32_dpp v94, v94 row_shl:4 row_mask:0xf bank_mask:0x5
    v_mov_b32_dpp v95, v95 row_shl:4 row_mask:0xf bank_mask:0x5
    v_cvt_pk_bf16_f32 v26, v20, v21
    v_cvt_pk_bf16_f32 v29, v20, v21
    v_mfma_f32_16x16x32_bf16 v[12:15], v[88:91], v[92:95], 0
    v_mfma_f32_16x16x32_bf16 v[32:35], v[40:43], v[92:95], 0
    v_mfma_f32_16x16x32_bf16 v[36:39], v[44:47], v[92:95], 0
    v_mfma_f32_16x16x16_bf16 v[12:15], v[88:89], v[26:27], v[12:15]
    v_mfma_f32_16x16x16_bf16 v[32:35], v[70:71], v[26:27], v[32:35]
    v_mfma_f32_16x16x16_bf16 v[36:39], v[70:71], v[28:29], v[36:39]
    s_nop 7
    s_branch ch_w0s_pvm
ch_wave1:
    s_waitcnt lgkmcnt(0)
    s_barrier
    v_mov_b32 v10, 7680
    ds_read_b32 v10, v10
    s_waitcnt lgkmcnt(0)
    v_readfirstlane_b32 s23, v10
    s_bitcmp1_b32 s23, 0
    s_cbranch_scc1 wk_restart
    s_and_b32 s23, s23, 0x6800
    s_xor_b32 s23, s23, 0
    s_cmp_eq_u32 s17, 2
    s_cselect_b32 s23, 0, s23
    s_add_u32 s24, s23, 1024
    s_add_u32 s44, s44, s24
    s_addc_u32 s45, s45, 0
    s_xor_b32 s24, s23, 2048
    s_cmp_lt_u32 s20, 8
    s_cselect_b32 s24, s24, 0x41000
    s_add_u32 s42, s42, s24
    s_addc_u32 s43, s43, 0
    s_sub_u32 s42, s42, 4096
    s_subb_u32 s43, s43, 0
    s_mov_b64 exec, s[70:71]
    global_store_dword v7, v70, s[42:43] sc1
    s_mov_b64 exec, -1
    s_mov_b32 s22, 0
    s_cmp_eq_u32 s21, 0
    s_cselect_b32 s6, -1, 0
    s_cselect_b32 s7, 0, -1
    s_and_b32 s23, s20, 4
    s_and_b32 s24, s20, 1
    s_lshl_b32 s24, s24, 1
    s_add_u32 s23, s23, s24
    s_bfe_u32 s24, s20, 0x10001
    s_add_u32 s23, s23, s24
    s_lshl_b32 s23, s23, 3
    s_mov_b64 s[4:5], 0xff
    s_lshl_b64 s[4:5], s[4:5], s23
    s_lshr_b32 s23, s20, 3
    s_cmp_eq_u32 s23, 1
    s_cselect_b64 s[4:5], s[4:5], 0
    s_and_b32 s23, s22, 3
    s_lshl_b32 s23, s23, 13
    s_add_u32 s24, s23, 2048
    s_add_u32 s54, s40, s24
    s_addc_u32 s55, s41, 0
    s_lshl_b32 s23, s23, 2
    s_add_u32 s56, s44, s23
    s_addc_u32 s57, s45, 0
    s_add_u32 s46, s38, 32768
    s_addc_u32 s47, s39, 0
    s_add_u32 s48, s38, 49152
    s_addc_u32 s49, s39, 0
    s_add_u32 s52, s38, s73
    s_addc_u32 s53, s39, 0
    s_lshl_b32 s23, s21, 5
    s_add_u32 s23, s23, s20
    s_lshl_b32 s23, s23, 7
    s_add_u32 s23, s23, 103817216
    s_add_u32 s8, s14, s23
    s_addc_u32 s9, s15, 0
    s_cmp_eq_u32 s17, 2
    s_cbranch_scc1 ch_slowmode1
    v_lshlrev_b32 v68, 3, v0
    s_mov_b32 m0, 7168
    s_add_u32 s74, s32, 0
    s_addc_u32 s75, s33, 0
    s_sub_u32 s74, s74, 4096
    s_subb_u32 s75, s75, 0
    global_load_lds_dword v68, s[74:75] sc1
    ds_read_b128 v[72:75], v2 offset:16384
    ds_read_b128 v[76:79], v2 offset:17408
    ds_read_b128 v[80:83], v2 offset:18432
    ds_read_b128 v[84:87], v2 offset:19456
    ds_read_b128 v[88:91], v2 offset:0
    ds_read_b128 v[92:95], v2 offset:1024
    v_mov_b64 v[8:9], 0
    v_mov_b64 v[10:11], 0
    v_mov_b64 v[12:13], 0
    v_mov_b64 v[14:15], 0
    v_mov_b64 v[16:17], 0
    v_mov_b64 v[18:19], 0
    v_mov_b64 v[20:21], 0
    v_mov_b64 v[22:23], 0
    v_mov_b64 v[24:25], 0
    v_mov_b64 v[26:27], 0
    v_mov_b64 v[28:29], 0
    v_mov_b64 v[30:31], 0
    s_mov_b32 s26, 0
    s_branch ch_w1f_loop
.p2align 6
ch_w1f_loop:
    s_waitcnt lgkmcnt(0)
    global_load_dwordx4 v[52:55], v0, s[54:55] offset:-1024 sc1
    s_nop 0
    s_sleep 1
    global_load_dwordx4 v[52:55], v0, s[54:55] offset:-1024 sc1
    s_nop 0
    s_sleep 1
ch_w1f_gown:
    global_load_dwordx4 v[52:55], v0, s[54:55] offset:-1024 sc1
    s_add_u32 s26, s26, 1
    s_cmp_gt_u32 s26, 1048576
    s_cbranch_scc1 ch_fail
    s_waitcnt vmcnt(2)
ch_w1f_gw:
    v_max3_u32 v68, v52, v53, v54
    v_max_u32 v68, v68, v55
    v_cmpx_eq_u32 vcc, -1, v68
    s_cbranch_execnz ch_w1f_gown
ch_w1f_gok:
    s_mov_b64 exec, -1
    ds_write_b128 v0, v[52:55] offset:1024
    s_nop 0
    v_smfmac_f32_16x16x64_bf16 v[8:11], v[52:55], a[16:23], v1
    s_nop 0
    v_smfmac_f32_16x16x64_bf16 v[24:27], v[52:55], v[72:79], v1
    ds_read_b128 v[72:75], v3 offset:16384
    ds_read_b128 v[76:79], v3 offset:17408
    global_load_dwordx4 v[40:43], v0, s[56:57] sc1
    v_smfmac_f32_16x16x64_bf16 v[16:19], v[52:55], a[160:167], v1
    s_waitcnt lgkmcnt(2)
    s_barrier
    ds_read_b128 v[48:51], v0 offset:0
    ds_read_b128 v[60:63], v0 offset:3072
    ds_read_b128 v[56:59], v0 offset:2048
    v_smfmac_f32_16x16x64_bf16 v[12:15], v[52:55], a[24:31], v1
    s_and_b32 s16, s22, 1
    s_add_u32 s23, s22, 1
    v_smfmac_f32_16x16x64_bf16 v[28:31], v[52:55], v[80:87], v1
    ds_read_b128 v[80:83], v2 offset:2048
    ds_read_b128 v[84:87], v2 offset:3072
    v_smfmac_f32_16x16x64_bf16 v[20:23], v[52:55], a[168:175], v1
    s_and_b32 s23, s23, 3
    s_lshl_b32 s23, s23, 13
    s_waitcnt lgkmcnt(4)
    v_smfmac_f32_16x16x64_bf16 v[8:11], v[48:51], a[0:7], v1
    s_add_u32 s58, s40, s23
    s_addc_u32 s59, s41, 0
    s_lshl_b32 s23, s23, 2
    v_smfmac_f32_16x16x64_bf16 v[24:27], v[48:51], v[88:95], v1
    ds_read_b128 v[88:91], v3 offset:18432
    ds_read_b128 v[92:95], v3 offset:19456
    v_smfmac_f32_16x16x64_bf16 v[16:19], v[48:51], v[72:79], v1
    ds_read_b128 v[72:75], v2 offset:49152
    ds_read_b128 v[76:79], v2 offset:50176
    v_smfmac_f32_16x16x64_bf16 v[12:15], v[48:51], a[8:15], v1
    s_add_u32 s60, s42, s23
    s_addc_u32 s61, s43, 0
    s_add_u32 s23, s22, 2
    s_waitcnt lgkmcnt(4)
    v_smfmac_f32_16x16x64_bf16 v[28:31], v[48:51], v[80:87], v1
    ds_read_b128 v[80:83], v2 offset:51200
    ds_read_b128 v[84:87], v2 offset:52224
    s_waitcnt lgkmcnt(4)
    v_smfmac_f32_16x16x64_bf16 v[20:23], v[48:51], v[88:95], v1
    ds_read_b128 v[88:91], v2 offset:32768
    ds_read_b128 v[92:95], v2 offset:33792
    v_smfmac_f32_16x16x64_bf16 v[8:11], v[60:63], a[48:55], v1
    s_and_b32 s23, s23, 3
    s_lshl_b32 s23, s23, 13
    s_waitcnt lgkmcnt(4)
    v_smfmac_f32_16x16x64_bf16 v[24:27], v[60:63], v[72:79], v1
    ds_read_b128 v[72:75], v3 offset:32768
    ds_read_b128 v[76:79], v3 offset:33792
    v_smfmac_f32_16x16x64_bf16 v[16:19], v[60:63], a[176:183], v1
    s_add_u32 s62, s40, s23
    s_addc_u32 s63, s41, 0
    s_lshl_b32 s23, s23, 2
    v_smfmac_f32_16x16x64_bf16 v[12:15], v[60:63], a[56:63], v1
    s_add_u32 s64, s42, s23
    s_addc_u32 s65, s43, 0
    s_waitcnt lgkmcnt(4)
    v_smfmac_f32_16x16x64_bf16 v[28:31], v[60:63], v[80:87], v1
    ds_read_b128 v[80:83], v2 offset:34816
    ds_read_b128 v[84:87], v2 offset:35840
    s_waitcnt vmcnt(0)
ch_w1f_grem_chk:
    ds_write_b128 v0, v[40:43] offset:9216
    v_max3_u32 v68, v40, v41, v42
    v_max_u32 v68, v68, v43
    v_cmp_eq_u32 vcc, -1, v68
    s_cbranch_vccnz ch_w1f_grem
    v_smfmac_f32_16x16x64_bf16 v[20:23], v[60:63], a[184:191], v1
    global_load_dwordx4 v[32:35], v0, s[30:31] offset:-3072 sc1
    global_load_dwordx4 v[36:39], v0, s[30:31] offset:1024 sc1
    v_smfmac_f32_16x16x64_bf16 v[8:11], v[56:59], a[32:39], v1
    global_load_dwordx4 v[40:43], v0, s[32:33] offset:-2048 sc1
    s_waitcnt lgkmcnt(5)
    v_smfmac_f32_16x16x64_bf16 v[24:27], v[56:59], v[88:95], v1
    ds_read_b128 v[88:91], v3 offset:34816
    ds_read_b128 v[92:95], v3 offset:35840
    s_waitcnt lgkmcnt(5)
    v_smfmac_f32_16x16x64_bf16 v[16:19], v[56:59], v[72:79], v1
    ds_read_b128 v[72:75], v3 offset:0
    ds_read_b128 v[76:79], v3 offset:1024
    v_smfmac_f32_16x16x64_bf16 v[12:15], v[56:59], a[40:47], v1
    global_load_dwordx4 v[44:47], v0, s[32:33] offset:-1024 sc1
    s_waitcnt lgkmcnt(4)
    s_barrier
    ds_read_b128 v[64:67], v0 offset:4096
    ds_read_b128 v[52:55], v0 offset:9216
    ds_read_b128 v[48:51], v0 offset:8192
    ds_read_b128 v[60:63], v0 offset:11264
    v_smfmac_f32_16x16x64_bf16 v[28:31], v[56:59], v[80:87], v1
    ds_read_b128 v[80:83], v3 offset:49152
    ds_read_b128 v[84:87], v3 offset:50176
    s_waitcnt lgkmcnt(8)
    v_smfmac_f32_16x16x64_bf16 v[20:23], v[56:59], v[88:95], v1
    ds_read_b128 v[88:91], v3 offset:2048
    ds_read_b128 v[92:95], v3 offset:3072
    s_waitcnt lgkmcnt(7)
    v_smfmac_f32_16x16x64_bf16 v[8:11], v[64:67], a[64:71], v1
    ds_read_b128 v[56:59], v0 offset:10240
    v_smfmac_f32_16x16x64_bf16 v[24:27], v[64:67], v[72:79], v1
    ds_read_b128 v[72:75], v3 offset:51200
    ds_read_b128 v[76:79], v3 offset:52224
    s_waitcnt lgkmcnt(5)
    v_smfmac_f32_16x16x64_bf16 v[16:19], v[64:67], v[80:87], v1
    v_smfmac_f32_16x16x64_bf16 v[12:15], v[64:67], a[72:79], v1
    s_waitcnt lgkmcnt(3)
    v_smfmac_f32_16x16x64_bf16 v[28:31], v[64:67], v[88:95], v1
    s_waitcnt lgkmcnt(0)
    s_nop 0
    v_smfmac_f32_16x16x64_bf16 v[20:23], v[64:67], v[72:79], v1
    ds_read_b128 v[64:67], v0 offset:12288
    v_smfmac_f32_16x16x64_bf16 v[8:11], v[52:55], a[96:103], v1
    v_mov_b32 v69, -1
    v_lshrrev_b32_e64 v68, 1, v0
    v_smfmac_f32_16x16x64_bf16 v[12:15], v[52:55], a[104:111], v1
    s_add_u32 s22, s22, 1
    s_and_b32 s23, s22, 3
    v_smfmac_f32_16x16x64_bf16 v[8:11], v[48:51], a[80:87], v1
    s_lshl_b32 s23, s23, 13
    s_add_u32 s24, s23, 2048
    v_smfmac_f32_16x16x64_bf16 v[12:15], v[48:51], a[88:95], v1
    s_add_u32 s54, s40, s24
    s_addc_u32 s55, s41, 0
    s_lshl_b32 s23, s23, 2
    v_smfmac_f32_16x16x64_bf16 v[8:11], v[60:63], a[128:135], v1
    s_add_u32 s56, s44, s23
    s_addc_u32 s57, s45, 0
    s_mov_b64 vcc, s[66:67]
    v_smfmac_f32_16x16x64_bf16 v[12:15], v[60:63], a[136:143], v1
    v_smfmac_f32_16x16x64_bf16 v[8:11], v[56:59], a[112:119], v1
    s_nop 0
    v_smfmac_f32_16x16x64_bf16 v[12:15], v[56:59], a[120:127], v1
    s_waitcnt lgkmcnt(0)
    v_smfmac_f32_16x16x64_bf16 v[8:11], v[64:67], a[144:151], v1
    v_smfmac_f32_16x16x64_bf16 v[12:15], v[64:67], a[152:159], v1
    s_nop 0
    v_smfmac_f32_16x16x64_bf16 v[16:19], v[48:51], a[192:199], v1
    s_nop 2
    s_nop 0
    v_smfmac_f32_16x16x64_bf16 v[20:23], v[48:51], a[200:207], v1
    s_nop 1
    v_add_f32_e64 v8, v8, v10
    v_add_f32_e64 v9, v9, v11
    v_smfmac_f32_16x16x64_bf16 v[16:19], v[52:55], a[208:215], v1
    v_add_f32_e64 v12, v12, v14
    v_add_f32_e64 v13, v13, v15
    v_cvt_pk_bf16_f32 v8, v8, v9
    v_cvt_pk_bf16_f32 v9, v12, v13
    ds_write2st64_b32 v4, v8, v9 offset0:22 offset1:23
    ds_read_b64_tr_b16 v[76:77], v5 offset:5632
    ds_read_b64_tr_b16 v[78:79], v5 offset:5888
    v_smfmac_f32_16x16x64_bf16 v[20:23], v[52:55], a[216:223], v1
    v_mov_b32 v88, 0x3f803f80
    v_smfmac_f32_16x16x64_bf16 v[16:19], v[56:59], a[224:231], v1
    v_mov_b32 v89, 0x3f803f80
    v_smfmac_f32_16x16x64_bf16 v[20:23], v[56:59], a[232:239], v1
    v_mov_b32 v90, 0x3f803f80
    v_smfmac_f32_16x16x64_bf16 v[16:19], v[60:63], a[240:247], v1
    v_mov_b32 v91, 0x3f803f80
    v_smfmac_f32_16x16x64_bf16 v[20:23], v[60:63], a[248:255], v1
    s_mov_b64 exec, s[6:7]
    global_store_dwordx2 v68, v[70:71], s[36:37] offset:512 sc1
    s_mov_b64 exec, -1
    v_smfmac_f32_16x16x64_bf16 v[16:19], v[64:67], v[96:103], v1
    s_mov_b64 exec, s[70:71]
    global_store_dword v7, v69, s[62:63]
    global_store_dword v7, v69, s[64:65] sc1
    s_mov_b64 exec, -1
    v_smfmac_f32_16x16x64_bf16 v[20:23], v[64:67], v[104:111], v1
    s_waitcnt lgkmcnt(0)
    s_waitcnt vmcnt(5)
    v_mfma_f32_16x16x32_bf16 v[8:11], v[32:35], v[76:79], 0
    s_nop 1
    v_mfma_f32_16x16x32_bf16 v[12:15], v[36:39], v[76:79], 0
    v_add_f32 v16, v16, v18
    v_add_f32 v17, v17, v19
    v_smfmac_f32_16x16x64_bf16 v[24:27], v[48:51], v[112:119], v1
    v_add_f32 v20, v20, v22
    v_add_f32_e64 v21, v21, v23
    v_cvt_pk_bf16_f32 v16, v16, v17
    v_cvt_pk_bf16_f32 v17, v20, v21
    ds_write2st64_b32 v4, v16, v17 offset0:54 offset1:55
    v_smfmac_f32_16x16x64_bf16 v[28:31], v[48:51], v[120:127], v1
    v_cndmask_b32 v8, v8, v12, vcc
    v_cndmask_b32 v9, v9, v13, vcc
    v_cndmask_b32 v10, v10, v14, vcc
    v_cndmask_b32 v11, v11, v15, vcc
    ds_write_b128 v0, v[8:11] offset:1024
    ds_read_b64_tr_b16 v[16:17], v5 offset:13824
    ds_read_b64_tr_b16 v[18:19], v5 offset:14080
    v_smfmac_f32_16x16x64_bf16 v[24:27], v[52:55], v[128:135], v1
    s_mov_b64 vcc, s[68:69]
    v_smfmac_f32_16x16x64_bf16 v[28:31], v[52:55], v[136:143], v1
    s_nop 0
    v_smfmac_f32_16x16x64_bf16 v[24:27], v[56:59], v[144:151], v1
    v_smfmac_f32_16x16x64_bf16 v[28:31], v[56:59], v[152:159], v1
    s_waitcnt lgkmcnt(2)
    s_barrier
    ds_read_b128 v[32:35], v0 offset:0
    ds_read_b128 v[36:39], v0 offset:2048
    ds_read_b128 v[92:95], v0 offset:3072
    v_smfmac_f32_16x16x64_bf16 v[24:27], v[60:63], v[160:167], v1
    ds_read_b64_tr_b16 v[72:73], v5 offset:5120
    ds_read_b64_tr_b16 v[48:49], v5 offset:13312
    ds_read_b64_tr_b16 v[74:75], v5 offset:5376
    v_smfmac_f32_16x16x64_bf16 v[28:31], v[60:63], v[168:175], v1
    ds_read_b64_tr_b16 v[50:51], v5 offset:13568
    ds_read_b64_tr_b16 v[80:81], v5 offset:6144
    ds_read_b64_tr_b16 v[52:53], v5 offset:14336
    v_smfmac_f32_16x16x64_bf16 v[24:27], v[64:67], v[176:183], v1
    ds_read_b64_tr_b16 v[82:83], v5 offset:6400
    ds_read_b64_tr_b16 v[54:55], v5 offset:14592
    ds_read_b64_tr_b16 v[84:85], v5 offset:6656
    v_smfmac_f32_16x16x64_bf16 v[28:31], v[64:67], v[184:191], v1
    ds_read_b64_tr_b16 v[56:57], v5 offset:14848
    ds_read_b64_tr_b16 v[86:87], v5 offset:6912
    ds_read_b64_tr_b16 v[58:59], v5 offset:15104
    s_waitcnt lgkmcnt(12)
    v_mfma_f32_16x16x32_bf16 v[20:23], v[16:19], v[76:79], 0
    s_mov_b64 exec, s[6:7]
    global_store_dwordx4 v0, v[16:19], s[34:35] offset:1024 sc1
    s_mov_b64 exec, -1
    s_cmp_eq_u32 s22, 64
    s_cbranch_scc1 ch_w1f_last
    v_pk_add_f32 v[8:9], v[8:9], v[32:33]
    v_pk_add_f32 v[10:11], v[10:11], v[34:35]
    v_pk_add_f32 v[36:37], v[36:37], v[92:93]
    v_pk_add_f32 v[38:39], v[38:39], v[94:95]
    v_pk_add_f32 v[8:9], v[8:9], v[36:37]
    v_pk_add_f32 v[10:11], v[10:11], v[38:39]
    v_mul_f32 v8, s27, v8
    v_mul_f32 v9, s27, v9
    v_mul_f32 v10, s27, v10
    v_mul_f32 v11, s27, v11
    s_waitcnt lgkmcnt(0)
    v_mfma_f32_16x16x32_bf16 v[20:23], v[48:51], v[72:75], v[20:23]
    v_exp_f32_e64 v12, v8
    v_mfma_f32_16x16x32_bf16 v[20:23], v[52:55], v[80:83], v[20:23]
    v_exp_f32 v13, v9
    v_mfma_f32_16x16x32_bf16 v[20:23], v[56:59], v[84:87], v[20:23]
    v_exp_f32 v14, v10
    v_exp_f32_e64 v15, v11
    v_cvt_pk_bf16_f32 v94, v12, v13
    v_cvt_pk_bf16_f32 v95, v14, v15
    v_cvt_pk_bf16_f32 v92, v12, v13
    v_cvt_pk_bf16_f32 v93, v14, v15
    v_add_f32 v24, v24, v26
    v_add_f32 v25, v25, v27
    v_mov_b32_dpp v92, v94 row_shr:4 row_mask:0xf bank_mask:0xa
    v_mov_b32_dpp v93, v95 row_shr:4 row_mask:0xf bank_mask:0xa
    v_mov_b32_dpp v94, v94 row_shl:4 row_mask:0xf bank_mask:0x5
    v_mov_b32_dpp v95, v95 row_shl:4 row_mask:0xf bank_mask:0x5
    v_cndmask_b32 v18, v20, v22, vcc
    v_cndmask_b32 v19, v21, v23, vcc
    s_waitcnt vmcnt(4)
    v_mfma_f32_16x16x32_bf16 v[12:15], v[88:91], v[92:95], 0
    v_mul_f32 v18, s27, v18
    v_mul_f32 v19, s27, v19
    v_mfma_f32_16x16x32_bf16 v[32:35], v[40:43], v[92:95], 0
    v_exp_f32 v20, v18
    v_mfma_f32_16x16x32_bf16 v[36:39], v[44:47], v[92:95], 0
    v_exp_f32 v21, v19
    v_add_f32 v28, v28, v30
    v_add_f32 v29, v29, v31
    v_cvt_pk_bf16_f32 v26, v20, v21
    v_mov_b32 v27, 0
    v_cvt_pk_bf16_f32 v70, v24, v25
    v_cvt_pk_bf16_f32 v71, v28, v29
    v_mfma_f32_16x16x16_bf16 v[12:15], v[88:89], v[26:27], v[12:15]
    v_cvt_pk_bf16_f32 v29, v20, v21
    v_mov_b32_e64 v28, 0
    v_mfma_f32_16x16x16_bf16 v[32:35], v[70:71], v[26:27], v[32:35]
    v_max3_f32 v68, abs(v8), abs(v9), abs(v10)
    v_mfma_f32_16x16x16_bf16 v[36:39], v[70:71], v[28:29], v[36:39]
    v_max3_f32 v68, v68, abs(v11), abs(v18)
    v_max_f32 v68, v68, abs(v19)
    v_cmp_nge_f32 vcc, s29, v68
    s_cbranch_vccnz ch_w1f_slow
ch_w1f_pvm:
    v_rcp_f32 v22, v12
    v_mov_b64 v[40:41], 0
    v_pk_mul_f32 v[32:33], v[32:33], v[22:23] op_sel_hi:[1,0]
    v_pk_mul_f32 v[34:35], v[34:35], v[22:23] op_sel_hi:[1,0]
    v_cvt_pk_bf16_f32 v16, v32, v33
    v_pk_mul_f32 v[36:37], v[36:37], v[22:23] op_sel_hi:[1,0]
    v_cvt_pk_bf16_f32 v17, v34, v35
    v_pk_mul_f32 v[38:39], v[38:39], v[22:23] op_sel_hi:[1,0]
    v_cvt_pk_bf16_f32 v18, v36, v37
    v_cvt_pk_bf16_f32 v19, v38, v39
    ds_write_b128 v0, v[16:19] offset:9216
    v_mov_b64 v[42:43], 0
    v_mov_b64 v[44:45], 0
    v_mov_b64_e64 v[46:47], 0
    v_smfmac_f32_16x16x64_bf16 v[40:43], v[16:19], v[200:207], v1 abid:1
    s_nop 0
    v_smfmac_f32_16x16x64_bf16 v[44:47], v[16:19], v[232:239], v1 abid:1
    s_waitcnt lgkmcnt(0)
    s_barrier
    ds_read_b128 v[20:23], v0 offset:8192
    ds_read_b128 v[28:31], v0 offset:10240
    ds_read_b128 v[12:15], v0 offset:11264
    s_waitcnt lgkmcnt(2)
    v_smfmac_f32_16x16x64_bf16 v[40:43], v[20:23], v[192:199], v1 abid:1
    s_waitcnt lgkmcnt(1)
    v_smfmac_f32_16x16x64_bf16 v[40:43], v[28:31], v[208:215], v1 abid:1
    s_waitcnt lgkmcnt(0)
    v_smfmac_f32_16x16x64_bf16 v[40:43], v[12:15], v[216:223], v1 abid:1
    s_nop 0
    v_smfmac_f32_16x16x64_bf16 v[44:47], v[20:23], v[224:231], v1 abid:1
    s_add_u32 s30, s30, 262144
    s_addc_u32 s31, s31, 0
    v_smfmac_f32_16x16x64_bf16 v[44:47], v[28:31], v[240:247], v1 abid:1
    s_add_u32 s32, s32, 262144
    s_addc_u32 s33, s33, 0
    v_smfmac_f32_16x16x64_bf16 v[44:47], v[12:15], v[248:255], v1 abid:1
    s_add_u32 s34, s34, 131072
    s_addc_u32 s35, s35, 0
    v_cvt_pk_bf16_f32 v40, v40, v41
    v_cvt_pk_bf16_f32 v41, v42, v43
    v_and_or_b32 v40, v40, -2, s16
    global_store_dwordx2 v6, v[40:41], s[46:47]
    s_nop 1
    v_cvt_pk_bf16_f32 v44, v44, v45
    v_cvt_pk_bf16_f32 v45, v46, v47
    v_and_or_b32 v44, v44, -2, s16
    global_store_dwordx2 v6, v[44:45], s[48:49]
    s_add_u32 s36, s36, 131072
    s_addc_u32 s37, s37, 0
    s_cmp_ge_u32 s20, 8
    s_cbranch_scc1 ch_w1f_nor
    ds_read_b128 v[64:67], v0 offset:15360
    ds_read_b128 v[72:75], v2 offset:16384
    ds_read_b128 v[76:79], v2 offset:17408
    ds_read_b128 v[80:83], v2 offset:18432
    ds_read_b128 v[84:87], v2 offset:19456
    ds_read_b128 v[88:91], v2 offset:0
    ds_read_b128 v[92:95], v2 offset:1024
    v_mov_b64 v[8:9], 0
    v_mov_b64 v[10:11], 0
    v_mov_b64 v[12:13], 0
    v_mov_b64 v[14:15], 0
    v_mov_b64 v[16:17], 0
    v_mov_b64 v[18:19], 0
    v_mov_b64 v[20:21], 0
    v_mov_b64 v[22:23], 0
    v_mov_b64 v[24:25], 0
    v_mov_b64 v[26:27], 0
    v_mov_b64 v[28:29], 0
    v_mov_b64 v[30:31], 0
    s_waitcnt vmcnt(0)
    s_sleep 1
    global_load_dwordx4 v[48:51], v0, s[52:53] offset:0 sc1
    global_load_dwordx4 v[52:55], v0, s[52:53] offset:1024 sc1
    global_load_dwordx4 v[56:59], v0, s[52:53] offset:2048 sc1
    global_load_dwordx4 v[60:63], v0, s[52:53] offset:3072 sc1
    s_nop 0
    s_sleep 2
    global_load_dwordx4 v[32:35], v0, s[52:53] offset:0 sc1
    global_load_dwordx4 v[36:39], v0, s[52:53] offset:1024 sc1
    global_load_dwordx4 v[40:43], v0, s[52:53] offset:2048 sc1
    global_load_dwordx4 v[44:47], v0, s[52:53] offset:3072 sc1
    s_waitcnt lgkmcnt(0)
ch_w1f_rchk:
    s_waitcnt vmcnt(7)
    v_mfma_f32_16x16x32_bf16 v[8:11], v[64:67], v[48:51], 0
    v_xor_b32 v68, s16, v48
    v_bitop3_b32 v68, v68, v50, s16 bitop3:0xf6
    s_waitcnt vmcnt(6)
    v_mfma_f32_16x16x32_bf16 v[8:11], v[64:67], v[52:55], v[8:11]
    v_bitop3_b32 v68, v68, v52, s16 bitop3:0xf6
    v_bitop3_b32 v68, v68, v54, s16 bitop3:0xf6
    s_waitcnt vmcnt(5)
    v_mfma_f32_16x16x32_bf16 v[8:11], v[64:67], v[56:59], v[8:11]
    v_bitop3_b32 v68, v68, v56, s16 bitop3:0xf6
    v_bitop3_b32 v68, v68, v58, s16 bitop3:0xf6
    s_waitcnt vmcnt(4)
    v_mfma_f32_16x16x32_bf16 v[8:11], v[64:67], v[60:63], v[8:11]
    v_bitop3_b32 v68, v68, v60, s16 bitop3:0xf6
    v_bitop3_b32 v68, v68, v62, s16 bitop3:0xf6
    v_and_b32 v68, 1, v68
    v_cmp_ne_u32 vcc, 0, v68
    s_cbranch_vccnz ch_w1f_rpoll
    s_nop 2
    v_add_f32_dpp v8, v8, v8 row_ror:8 row_mask:0xf bank_mask:0xf
    v_add_f32_dpp v9, v9, v9 row_ror:8 row_mask:0xf bank_mask:0xf
    s_mov_b64 exec, s[70:71]
    v_cvt_pk_bf16_f32 v8, v8, v9
    v_min_u32 v69, -2, v8
    global_store_dword v7, v69, s[58:59]
    global_store_dword v7, v69, s[60:61] sc1
ch_w1f_rok:
    s_mov_b64 exec, -1
    v_mov_b64 v[8:9], 0
    v_mov_b64 v[10:11], 0
    s_branch ch_w1f_rd
ch_w1f_nor:
    ds_read_b128 v[72:75], v2 offset:16384
    ds_read_b128 v[76:79], v2 offset:17408
    ds_read_b128 v[80:83], v2 offset:18432
    ds_read_b128 v[84:87], v2 offset:19456
    ds_read_b128 v[88:91], v2 offset:0
    ds_read_b128 v[92:95], v2 offset:1024
    v_mov_b64 v[8:9], 0
    v_mov_b64 v[10:11], 0
    v_mov_b64 v[12:13], 0
    v_mov_b64 v[14:15], 0
    v_mov_b64 v[16:17], 0
    v_mov_b64 v[18:19], 0
    v_mov_b64 v[20:21], 0
    v_mov_b64 v[22:23], 0
    v_mov_b64 v[24:25], 0
    v_mov_b64 v[26:27], 0
    v_mov_b64 v[28:29], 0
    v_mov_b64 v[30:31], 0
ch_w1f_rd:
    s_barrier
    s_sleep 2
    s_branch ch_w1f_loop
ch_w1f_grem:
    s_mov_b64 exec, vcc
    global_load_dwordx4 v[40:43], v0, s[56:57] sc1
    s_mov_b64 exec, -1
    s_add_u32 s26, s26, 1
    s_cmp_gt_u32 s26, 1048576
    s_cbranch_scc1 ch_fail
    s_waitcnt vmcnt(0)
    s_branch ch_w1f_grem_chk
ch_w1f_last:
    s_add_u32 s36, s36, 131072
    s_addc_u32 s37, s37, 0
    s_nop 7
    v_add_f32 v24, v24, v26
    v_add_f32_e64 v25, v25, v27
    v_add_f32_e64 v28, v28, v30
    v_add_f32_e64 v29, v29, v31
    v_cvt_pk_bf16_f32 v70, v24, v25
    v_cvt_pk_bf16_f32 v71, v28, v29
    s_mov_b64 exec, s[6:7]
    global_store_dwordx2 v68, v[70:71], s[36:37] offset:512 sc1
    s_mov_b64 exec, -1
    s_branch ch_done
ch_w1f_rpoll:
    s_mov_b64 exec, vcc
    global_load_dwordx4 v[48:51], v0, s[52:53] offset:0 sc1
    global_load_dwordx4 v[52:55], v0, s[52:53] offset:1024 sc1
    global_load_dwordx4 v[56:59], v0, s[52:53] offset:2048 sc1
    global_load_dwordx4 v[60:63], v0, s[52:53] offset:3072 sc1
    s_mov_b64 exec, -1
    s_waitcnt vmcnt(7)
    v_mfma_f32_16x16x32_bf16 v[8:11], v[64:67], v[32:35], 0
    v_xor_b32 v68, s16, v32
    v_bitop3_b32 v68, v68, v34, s16 bitop3:0xf6
    s_waitcnt vmcnt(6)
    v_mfma_f32_16x16x32_bf16 v[8:11], v[64:67], v[36:39], v[8:11]
    v_bitop3_b32 v68, v68, v36, s16 bitop3:0xf6
    v_bitop3_b32 v68, v68, v38, s16 bitop3:0xf6
    s_waitcnt vmcnt(5)
    v_mfma_f32_16x16x32_bf16 v[8:11], v[64:67], v[40:43], v[8:11]
    v_bitop3_b32 v68, v68, v40, s16 bitop3:0xf6
    v_bitop3_b32 v68, v68, v42, s16 bitop3:0xf6
    s_waitcnt vmcnt(4)
    v_mfma_f32_16x16x32_bf16 v[8:11], v[64:67], v[44:47], v[8:11]
    v_bitop3_b32 v68, v68, v44, s16 bitop3:0xf6
    v_bitop3_b32 v68, v68, v46, s16 bitop3:0xf6
    v_and_b32 v68, 1, v68
    v_cmp_ne_u32 vcc, 0, v68
    s_cbranch_vccnz ch_w1f_rpol2
    s_nop 2
    v_add_f32_dpp v8, v8, v8 row_ror:8 row_mask:0xf bank_mask:0xf
    v_add_f32_dpp v9, v9, v9 row_ror:8 row_mask:0xf bank_mask:0xf
    s_mov_b64 exec, s[70:71]
    v_cvt_pk_bf16_f32 v8, v8, v9
    v_min_u32 v69, -2, v8
    global_store_dword v7, v69, s[58:59]
    global_store_dword v7, v69, s[60:61] sc1
    s_branch ch_w1f_rok
ch_w1f_rpol2:
    s_mov_b64 exec, vcc
    global_load_dwordx4 v[32:35], v0, s[52:53] offset:0 sc1
    global_load_dwordx4 v[36:39], v0, s[52:53] offset:1024 sc1
    global_load_dwordx4 v[40:43], v0, s[52:53] offset:2048 sc1
    global_load_dwordx4 v[44:47], v0, s[52:53] offset:3072 sc1
    s_mov_b64 exec, -1
    s_add_u32 s26, s26, 1
    s_cmp_gt_u32 s26, 1048576
    s_cbranch_scc1 ch_fail
    s_branch ch_w1f_rchk
ch_w1f_slow:
    s_nop 7
    v_max3_f32 v68, v8, v9, v10
    v_max3_f32 v68, v68, v11, v18
    v_max_f32 v68, v68, v19
    v_mov_b32 v16, v68
    s_nop 1
    v_mov_b32_dpp v16, v68 row_shr:4 row_mask:0xf bank_mask:0xa
    s_nop 1
    v_mov_b32_dpp v16, v68 row_shl:4 row_mask:0xf bank_mask:0x5
    v_max_f32 v68, v68, v16
    v_mov_b32 v16, v68
    s_nop 1
    v_permlane16_swap_b32 v68, v16
    v_max_f32 v68, v68, v16
    v_mov_b32 v16, v68
    s_nop 1
    v_permlane32_swap_b32 v68, v16
    v_max_f32 v68, v68, v16
    v_sub_f32 v12, v8, v68
    v_exp_f32 v12, v12
    v_sub_f32 v13, v9, v68
    v_exp_f32 v13, v13
    v_sub_f32 v14, v10, v68
    v_exp_f32 v14, v14
    v_sub_f32 v15, v11, v68
    v_exp_f32 v15, v15
    v_sub_f32 v20, v18, v68
    v_exp_f32 v20, v20
    v_sub_f32 v21, v19, v68
    v_exp_f32_e64 v21, v21
    v_cvt_pk_bf16_f32 v94, v12, v13
    v_cvt_pk_bf16_f32 v95, v14, v15
    v_cvt_pk_bf16_f32 v92, v12, v13
    v_cvt_pk_bf16_f32 v93, v14, v15
    s_nop 0
    v_mov_b32_dpp v92, v94 row_shr:4 row_mask:0xf bank_mask:0xa
    v_mov_b32_dpp v93, v95 row_shr:4 row_mask:0xf bank_mask:0xa
    v_mov_b32_dpp v94, v94 row_shl:4 row_mask:0xf bank_mask:0x5
    v_mov_b32_dpp v95, v95 row_shl:4 row_mask:0xf bank_mask:0x5
    v_cvt_pk_bf16_f32 v26, v20, v21
    v_cvt_pk_bf16_f32 v29, v20, v21
    v_mfma_f32_16x16x32_bf16 v[12:15], v[88:91], v[92:95], 0
    v_mfma_f32_16x16x32_bf16 v[32:35], v[40:43], v[92:95], 0
    v_mfma_f32_16x16x32_bf16 v[36:39], v[44:47], v[92:95], 0
    v_mfma_f32_16x16x16_bf16 v[12:15], v[88:89], v[26:27], v[12:15]
    v_mfma_f32_16x16x16_bf16 v[32:35], v[70:71], v[26:27], v[32:35]
    v_mfma_f32_16x16x16_bf16 v[36:39], v[70:71], v[28:29], v[36:39]
    s_nop 7
    s_branch ch_w1f_pvm
ch_slowmode1:
    v_lshlrev_b32 v68, 3, v0
    s_mov_b32 m0, 7168
    s_add_u32 s74, s32, 0
    s_addc_u32 s75, s33, 0
    s_sub_u32 s74, s74, 4096
    s_subb_u32 s75, s75, 0
    global_load_lds_dword v68, s[74:75] sc1
    ds_read_b128 v[72:75], v2 offset:16384
    ds_read_b128 v[76:79], v2 offset:17408
    ds_read_b128 v[80:83], v2 offset:18432
    ds_read_b128 v[84:87], v2 offset:19456
    ds_read_b128 v[88:91], v2 offset:0
    ds_read_b128 v[92:95], v2 offset:1024
    v_mov_b64 v[8:9], 0
    v_mov_b64 v[10:11], 0
    v_mov_b64 v[12:13], 0
    v_mov_b64 v[14:15], 0
    v_mov_b64 v[16:17], 0
    v_mov_b64 v[18:19], 0
    v_mov_b64 v[20:21], 0
    v_mov_b64 v[22:23], 0
    v_mov_b64 v[24:25], 0
    v_mov_b64 v[26:27], 0
    v_mov_b64 v[28:29], 0
    v_mov_b64 v[30:31], 0
    s_mov_b32 s26, 0
    s_branch ch_w1s_loop
.p2align 6
ch_w1s_loop:
    s_waitcnt lgkmcnt(0)
    global_load_dwordx4 v[52:55], v0, s[54:55] offset:-1024 sc1
    s_nop 0
    s_sleep 1
    global_load_dwordx4 v[52:55], v0, s[54:55] offset:-1024 sc1
    s_nop 0
    s_sleep 1
ch_w1s_gown:
    global_load_dwordx4 v[52:55], v0, s[54:55] offset:-1024 sc1
    s_add_u32 s26, s26, 1
    s_cmp_gt_u32 s26, 1048576
    s_cbranch_scc1 ch_fail
    s_waitcnt vmcnt(2)
ch_w1s_gw:
    v_max3_u32 v68, v52, v53, v54
    v_max_u32 v68, v68, v55
    v_cmpx_eq_u32 vcc, -1, v68
    s_cbranch_execnz ch_w1s_gown
ch_w1s_gok:
    s_mov_b64 exec, -1
    ds_write_b128 v0, v[52:55] offset:1024
    s_nop 0
    v_smfmac_f32_16x16x64_bf16 v[8:11], v[52:55], a[16:23], v1
    s_nop 0
    v_smfmac_f32_16x16x64_bf16 v[24:27], v[52:55], v[72:79], v1
    ds_read_b128 v[72:75], v3 offset:16384
    ds_read_b128 v[76:79], v3 offset:17408
    global_load_dwordx4 v[40:43], v0, s[56:57] sc1
    v_smfmac_f32_16x16x64_bf16 v[16:19], v[52:55], a[160:167], v1
    s_waitcnt lgkmcnt(2)
    s_barrier
    ds_read_b128 v[48:51], v0 offset:0
    ds_read_b128 v[60:63], v0 offset:3072
    ds_read_b128 v[56:59], v0 offset:2048
    v_smfmac_f32_16x16x64_bf16 v[12:15], v[52:55], a[24:31], v1
    s_and_b32 s16, s22, 1
    s_add_u32 s23, s22, 1
    v_smfmac_f32_16x16x64_bf16 v[28:31], v[52:55], v[80:87], v1
    ds_read_b128 v[80:83], v2 offset:2048
    ds_read_b128 v[84:87], v2 offset:3072
    v_smfmac_f32_16x16x64_bf16 v[20:23], v[52:55], a[168:175], v1
    s_and_b32 s23, s23, 3
    s_lshl_b32 s23, s23, 13
    s_waitcnt lgkmcnt(4)
    v_smfmac_f32_16x16x64_bf16 v[8:11], v[48:51], a[0:7], v1
    s_add_u32 s58, s40, s23
    s_addc_u32 s59, s41, 0
    s_lshl_b32 s23, s23, 2
    v_smfmac_f32_16x16x64_bf16 v[24:27], v[48:51], v[88:95], v1
    ds_read_b128 v[88:91], v3 offset:18432
    ds_read_b128 v[92:95], v3 offset:19456
    v_smfmac_f32_16x16x64_bf16 v[16:19], v[48:51], v[72:79], v1
    ds_read_b128 v[72:75], v2 offset:49152
    ds_read_b128 v[76:79], v2 offset:50176
    v_smfmac_f32_16x16x64_bf16 v[12:15], v[48:51], a[8:15], v1
    s_add_u32 s60, s42, s23
    s_addc_u32 s61, s43, 0
    s_add_u32 s23, s22, 2
    s_waitcnt lgkmcnt(4)
    v_smfmac_f32_16x16x64_bf16 v[28:31], v[48:51], v[80:87], v1
    ds_read_b128 v[80:83], v2 offset:51200
    ds_read_b128 v[84:87], v2 offset:52224
    s_waitcnt lgkmcnt(4)
    v_smfmac_f32_16x16x64_bf16 v[20:23], v[48:51], v[88:95], v1
    ds_read_b128 v[88:91], v2 offset:32768
    ds_read_b128 v[92:95], v2 offset:33792
    v_smfmac_f32_16x16x64_bf16 v[8:11], v[60:63], a[48:55], v1
    s_and_b32 s23, s23, 3
    s_lshl_b32 s23, s23, 13
    s_waitcnt lgkmcnt(4)
    v_smfmac_f32_16x16x64_bf16 v[24:27], v[60:63], v[72:79], v1
    ds_read_b128 v[72:75], v3 offset:32768
    ds_read_b128 v[76:79], v3 offset:33792
    v_smfmac_f32_16x16x64_bf16 v[16:19], v[60:63], a[176:183], v1
    s_add_u32 s62, s40, s23
    s_addc_u32 s63, s41, 0
    s_lshl_b32 s23, s23, 2
    v_smfmac_f32_16x16x64_bf16 v[12:15], v[60:63], a[56:63], v1
    s_add_u32 s64, s42, s23
    s_addc_u32 s65, s43, 0
    s_waitcnt lgkmcnt(4)
    v_smfmac_f32_16x16x64_bf16 v[28:31], v[60:63], v[80:87], v1
    ds_read_b128 v[80:83], v2 offset:34816
    ds_read_b128 v[84:87], v2 offset:35840
    s_waitcnt vmcnt(0)
ch_w1s_grem_chk:
    ds_write_b128 v0, v[40:43] offset:9216
    v_max3_u32 v68, v40, v41, v42
    v_max_u32 v68, v68, v43
    v_cmp_eq_u32 vcc, -1, v68
    s_cbranch_vccnz ch_w1s_grem
    v_smfmac_f32_16x16x64_bf16 v[20:23], v[60:63], a[184:191], v1
    global_load_dwordx4 v[32:35], v0, s[30:31] offset:-3072 sc1
    global_load_dwordx4 v[36:39], v0, s[30:31] offset:1024 sc1
    v_smfmac_f32_16x16x64_bf16 v[8:11], v[56:59], a[32:39], v1
    global_load_dwordx4 v[40:43], v0, s[32:33] offset:-2048 sc1
    s_waitcnt lgkmcnt(5)
    v_smfmac_f32_16x16x64_bf16 v[24:27], v[56:59], v[88:95], v1
    ds_read_b128 v[88:91], v3 offset:34816
    ds_read_b128 v[92:95], v3 offset:35840
    s_waitcnt lgkmcnt(5)
    v_smfmac_f32_16x16x64_bf16 v[16:19], v[56:59], v[72:79], v1
    ds_read_b128 v[72:75], v3 offset:0
    ds_read_b128 v[76:79], v3 offset:1024
    v_smfmac_f32_16x16x64_bf16 v[12:15], v[56:59], a[40:47], v1
    global_load_dwordx4 v[44:47], v0, s[32:33] offset:-1024 sc1
    s_waitcnt lgkmcnt(4)
    s_barrier
    ds_read_b128 v[64:67], v0 offset:4096
    ds_read_b128 v[52:55], v0 offset:9216
    ds_read_b128 v[48:51], v0 offset:8192
    ds_read_b128 v[60:63], v0 offset:11264
    v_smfmac_f32_16x16x64_bf16 v[28:31], v[56:59], v[80:87], v1
    ds_read_b128 v[80:83], v3 offset:49152
    ds_read_b128 v[84:87], v3 offset:50176
    s_waitcnt lgkmcnt(8)
    v_smfmac_f32_16x16x64_bf16 v[20:23], v[56:59], v[88:95], v1
    ds_read_b128 v[88:91], v3 offset:2048
    ds_read_b128 v[92:95], v3 offset:3072
    s_waitcnt lgkmcnt(7)
    v_smfmac_f32_16x16x64_bf16 v[8:11], v[64:67], a[64:71], v1
    ds_read_b128 v[56:59], v0 offset:10240
    v_smfmac_f32_16x16x64_bf16 v[24:27], v[64:67], v[72:79], v1
    ds_read_b128 v[72:75], v3 offset:51200
    ds_read_b128 v[76:79], v3 offset:52224
    s_waitcnt lgkmcnt(5)
    v_smfmac_f32_16x16x64_bf16 v[16:19], v[64:67], v[80:87], v1
    v_smfmac_f32_16x16x64_bf16 v[12:15], v[64:67], a[72:79], v1
    s_waitcnt lgkmcnt(3)
    v_smfmac_f32_16x16x64_bf16 v[28:31], v[64:67], v[88:95], v1
    s_waitcnt lgkmcnt(0)
    s_nop 0
    v_smfmac_f32_16x16x64_bf16 v[20:23], v[64:67], v[72:79], v1
    ds_read_b128 v[64:67], v0 offset:12288
    v_smfmac_f32_16x16x64_bf16 v[8:11], v[52:55], a[96:103], v1
    v_mov_b32 v69, -1
    v_lshrrev_b32_e64 v68, 1, v0
    v_smfmac_f32_16x16x64_bf16 v[12:15], v[52:55], a[104:111], v1
    s_add_u32 s22, s22, 1
    s_and_b32 s23, s22, 3
    v_smfmac_f32_16x16x64_bf16 v[8:11], v[48:51], a[80:87], v1
    s_lshl_b32 s23, s23, 13
    s_add_u32 s24, s23, 2048
    v_smfmac_f32_16x16x64_bf16 v[12:15], v[48:51], a[88:95], v1
    s_add_u32 s54, s40, s24
    s_addc_u32 s55, s41, 0
    s_lshl_b32 s23, s23, 2
    v_smfmac_f32_16x16x64_bf16 v[8:11], v[60:63], a[128:135], v1
    s_add_u32 s56, s44, s23
    s_addc_u32 s57, s45, 0
    s_mov_b64 vcc, s[66:67]
    v_smfmac_f32_16x16x64_bf16 v[12:15], v[60:63], a[136:143], v1
    v_smfmac_f32_16x16x64_bf16 v[8:11], v[56:59], a[112:119], v1
    s_nop 0
    v_smfmac_f32_16x16x64_bf16 v[12:15], v[56:59], a[120:127], v1
    s_waitcnt lgkmcnt(0)
    v_smfmac_f32_16x16x64_bf16 v[8:11], v[64:67], a[144:151], v1
    v_smfmac_f32_16x16x64_bf16 v[12:15], v[64:67], a[152:159], v1
    s_nop 0
    v_smfmac_f32_16x16x64_bf16 v[16:19], v[48:51], a[192:199], v1
    s_nop 2
    s_nop 0
    v_smfmac_f32_16x16x64_bf16 v[20:23], v[48:51], a[200:207], v1
    s_nop 1
    v_add_f32_e64 v8, v8, v10
    v_add_f32_e64 v9, v9, v11
    v_smfmac_f32_16x16x64_bf16 v[16:19], v[52:55], a[208:215], v1
    v_add_f32_e64 v12, v12, v14
    v_add_f32_e64 v13, v13, v15
    v_cvt_pk_bf16_f32 v8, v8, v9
    v_cvt_pk_bf16_f32 v9, v12, v13
    ds_write2st64_b32 v4, v8, v9 offset0:22 offset1:23
    ds_read_b64_tr_b16 v[76:77], v5 offset:5632
    ds_read_b64_tr_b16 v[78:79], v5 offset:5888
    v_smfmac_f32_16x16x64_bf16 v[20:23], v[52:55], a[216:223], v1
    v_mov_b32 v88, 0x3f803f80
    v_smfmac_f32_16x16x64_bf16 v[16:19], v[56:59], a[224:231], v1
    v_mov_b32 v89, 0x3f803f80
    v_smfmac_f32_16x16x64_bf16 v[20:23], v[56:59], a[232:239], v1
    v_mov_b32 v90, 0x3f803f80
    v_smfmac_f32_16x16x64_bf16 v[16:19], v[60:63], a[240:247], v1
    v_mov_b32 v91, 0x3f803f80
    v_smfmac_f32_16x16x64_bf16 v[20:23], v[60:63], a[248:255], v1
    s_mov_b64 exec, s[6:7]
    global_store_dwordx2 v68, v[70:71], s[36:37] offset:512 sc1
    s_mov_b64 exec, -1
    v_smfmac_f32_16x16x64_bf16 v[16:19], v[64:67], v[96:103], v1
    s_mov_b64 exec, s[70:71]
    global_store_dword v7, v69, s[62:63] sc1
    global_store_dword v7, v69, s[64:65] sc1
    s_mov_b64 exec, -1
    v_smfmac_f32_16x16x64_bf16 v[20:23], v[64:67], v[104:111], v1
    s_waitcnt lgkmcnt(0)
    s_waitcnt vmcnt(5)
    v_mfma_f32_16x16x32_bf16 v[8:11], v[32:35], v[76:79], 0
    s_nop 1
    v_mfma_f32_16x16x32_bf16 v[12:15], v[36:39], v[76:79], 0
    v_add_f32 v16, v16, v18
    v_add_f32 v17, v17, v19
    v_smfmac_f32_16x16x64_bf16 v[24:27], v[48:51], v[112:119], v1
    v_add_f32 v20, v20, v22
    v_add_f32_e64 v21, v21, v23
    v_cvt_pk_bf16_f32 v16, v16, v17
    v_cvt_pk_bf16_f32 v17, v20, v21
    ds_write2st64_b32 v4, v16, v17 offset0:54 offset1:55
    v_smfmac_f32_16x16x64_bf16 v[28:31], v[48:51], v[120:127], v1
    v_cndmask_b32 v8, v8, v12, vcc
    v_cndmask_b32 v9, v9, v13, vcc
    v_cndmask_b32 v10, v10, v14, vcc
    v_cndmask_b32 v11, v11, v15, vcc
    ds_write_b128 v0, v[8:11] offset:1024
    ds_read_b64_tr_b16 v[16:17], v5 offset:13824
    ds_read_b64_tr_b16 v[18:19], v5 offset:14080
    v_smfmac_f32_16x16x64_bf16 v[24:27], v[52:55], v[128:135], v1
    s_mov_b64 vcc, s[68:69]
    v_smfmac_f32_16x16x64_bf16 v[28:31], v[52:55], v[136:143], v1
    s_nop 0
    v_smfmac_f32_16x16x64_bf16 v[24:27], v[56:59], v[144:151], v1
    v_smfmac_f32_16x16x64_bf16 v[28:31], v[56:59], v[152:159], v1
    s_waitcnt lgkmcnt(2)
    s_barrier
    ds_read_b128 v[32:35], v0 offset:0
    ds_read_b128 v[36:39], v0 offset:2048
    ds_read_b128 v[92:95], v0 offset:3072
    v_smfmac_f32_16x16x64_bf16 v[24:27], v[60:63], v[160:167], v1
    ds_read_b64_tr_b16 v[72:73], v5 offset:5120
    ds_read_b64_tr_b16 v[48:49], v5 offset:13312
    ds_read_b64_tr_b16 v[74:75], v5 offset:5376
    v_smfmac_f32_16x16x64_bf16 v[28:31], v[60:63], v[168:175], v1
    ds_read_b64_tr_b16 v[50:51], v5 offset:13568
    ds_read_b64_tr_b16 v[80:81], v5 offset:6144
    ds_read_b64_tr_b16 v[52:53], v5 offset:14336
    v_smfmac_f32_16x16x64_bf16 v[24:27], v[64:67], v[176:183], v1
    ds_read_b64_tr_b16 v[82:83], v5 offset:6400
    ds_read_b64_tr_b16 v[54:55], v5 offset:14592
    ds_read_b64_tr_b16 v[84:85], v5 offset:6656
    v_smfmac_f32_16x16x64_bf16 v[28:31], v[64:67], v[184:191], v1
    ds_read_b64_tr_b16 v[56:57], v5 offset:14848
    ds_read_b64_tr_b16 v[86:87], v5 offset:6912
    ds_read_b64_tr_b16 v[58:59], v5 offset:15104
    s_waitcnt lgkmcnt(12)
    v_mfma_f32_16x16x32_bf16 v[20:23], v[16:19], v[76:79], 0
    s_mov_b64 exec, s[6:7]
    global_store_dwordx4 v0, v[16:19], s[34:35] offset:1024 sc1
    s_mov_b64 exec, -1
    s_cmp_eq_u32 s22, 64
    s_cbranch_scc1 ch_w1s_last
    v_pk_add_f32 v[8:9], v[8:9], v[32:33]
    v_pk_add_f32 v[10:11], v[10:11], v[34:35]
    v_pk_add_f32 v[36:37], v[36:37], v[92:93]
    v_pk_add_f32 v[38:39], v[38:39], v[94:95]
    v_pk_add_f32 v[8:9], v[8:9], v[36:37]
    v_pk_add_f32 v[10:11], v[10:11], v[38:39]
    v_mul_f32 v8, s27, v8
    v_mul_f32 v9, s27, v9
    v_mul_f32 v10, s27, v10
    v_mul_f32 v11, s27, v11
    s_waitcnt lgkmcnt(0)
    v_mfma_f32_16x16x32_bf16 v[20:23], v[48:51], v[72:75], v[20:23]
    v_exp_f32_e64 v12, v8
    v_mfma_f32_16x16x32_bf16 v[20:23], v[52:55], v[80:83], v[20:23]
    v_exp_f32 v13, v9
    v_mfma_f32_16x16x32_bf16 v[20:23], v[56:59], v[84:87], v[20:23]
    v_exp_f32 v14, v10
    v_exp_f32_e64 v15, v11
    v_cvt_pk_bf16_f32 v94, v12, v13
    v_cvt_pk_bf16_f32 v95, v14, v15
    v_cvt_pk_bf16_f32 v92, v12, v13
    v_cvt_pk_bf16_f32 v93, v14, v15
    v_add_f32 v24, v24, v26
    v_add_f32 v25, v25, v27
    v_mov_b32_dpp v92, v94 row_shr:4 row_mask:0xf bank_mask:0xa
    v_mov_b32_dpp v93, v95 row_shr:4 row_mask:0xf bank_mask:0xa
    v_mov_b32_dpp v94, v94 row_shl:4 row_mask:0xf bank_mask:0x5
    v_mov_b32_dpp v95, v95 row_shl:4 row_mask:0xf bank_mask:0x5
    v_cndmask_b32 v18, v20, v22, vcc
    v_cndmask_b32 v19, v21, v23, vcc
    s_waitcnt vmcnt(4)
    v_mfma_f32_16x16x32_bf16 v[12:15], v[88:91], v[92:95], 0
    v_mul_f32 v18, s27, v18
    v_mul_f32 v19, s27, v19
    v_mfma_f32_16x16x32_bf16 v[32:35], v[40:43], v[92:95], 0
    v_exp_f32 v20, v18
    v_mfma_f32_16x16x32_bf16 v[36:39], v[44:47], v[92:95], 0
    v_exp_f32 v21, v19
    v_add_f32 v28, v28, v30
    v_add_f32 v29, v29, v31
    v_cvt_pk_bf16_f32 v26, v20, v21
    v_mov_b32 v27, 0
    v_cvt_pk_bf16_f32 v70, v24, v25
    v_cvt_pk_bf16_f32 v71, v28, v29
    v_mfma_f32_16x16x16_bf16 v[12:15], v[88:89], v[26:27], v[12:15]
    v_cvt_pk_bf16_f32 v29, v20, v21
    v_mov_b32_e64 v28, 0
    v_mfma_f32_16x16x16_bf16 v[32:35], v[70:71], v[26:27], v[32:35]
    v_max3_f32 v68, abs(v8), abs(v9), abs(v10)
    v_mfma_f32_16x16x16_bf16 v[36:39], v[70:71], v[28:29], v[36:39]
    v_max3_f32 v68, v68, abs(v11), abs(v18)
    v_max_f32 v68, v68, abs(v19)
    v_cmp_nge_f32 vcc, s29, v68
    s_cbranch_vccnz ch_w1s_slow
ch_w1s_pvm:
    v_rcp_f32 v22, v12
    v_mov_b64 v[40:41], 0
    v_pk_mul_f32 v[32:33], v[32:33], v[22:23] op_sel_hi:[1,0]
    v_pk_mul_f32 v[34:35], v[34:35], v[22:23] op_sel_hi:[1,0]
    v_cvt_pk_bf16_f32 v16, v32, v33
    v_pk_mul_f32 v[36:37], v[36:37], v[22:23] op_sel_hi:[1,0]
    v_cvt_pk_bf16_f32 v17, v34, v35
    v_pk_mul_f32 v[38:39], v[38:39], v[22:23] op_sel_hi:[1,0]
    v_cvt_pk_bf16_f32 v18, v36, v37
    v_cvt_pk_bf16_f32 v19, v38, v39
    ds_write_b128 v0, v[16:19] offset:9216
    v_mov_b64 v[42:43], 0
    v_mov_b64 v[44:45], 0
    v_mov_b64_e64 v[46:47], 0
    v_smfmac_f32_16x16x64_bf16 v[40:43], v[16:19], v[200:207], v1 abid:1
    s_nop 0
    v_smfmac_f32_16x16x64_bf16 v[44:47], v[16:19], v[232:239], v1 abid:1
    s_waitcnt lgkmcnt(0)
    s_barrier
    ds_read_b128 v[20:23], v0 offset:8192
    ds_read_b128 v[28:31], v0 offset:10240
    ds_read_b128 v[12:15], v0 offset:11264
    s_waitcnt lgkmcnt(2)
    v_smfmac_f32_16x16x64_bf16 v[40:43], v[20:23], v[192:199], v1 abid:1
    s_waitcnt lgkmcnt(1)
    v_smfmac_f32_16x16x64_bf16 v[40:43], v[28:31], v[208:215], v1 abid:1
    s_waitcnt lgkmcnt(0)
    v_smfmac_f32_16x16x64_bf16 v[40:43], v[12:15], v[216:223], v1 abid:1
    s_nop 0
    v_smfmac_f32_16x16x64_bf16 v[44:47], v[20:23], v[224:231], v1 abid:1
    s_add_u32 s30, s30, 262144
    s_addc_u32 s31, s31, 0
    v_smfmac_f32_16x16x64_bf16 v[44:47], v[28:31], v[240:247], v1 abid:1
    s_add_u32 s32, s32, 262144
    s_addc_u32 s33, s33, 0
    v_smfmac_f32_16x16x64_bf16 v[44:47], v[12:15], v[248:255], v1 abid:1
    s_add_u32 s34, s34, 131072
    s_addc_u32 s35, s35, 0
    v_cvt_pk_bf16_f32 v40, v40, v41
    v_cvt_pk_bf16_f32 v41, v42, v43
    v_and_or_b32 v40, v40, -2, s16
    global_store_dwordx2 v6, v[40:41], s[46:47] sc1
    s_nop 1
    v_cvt_pk_bf16_f32 v44, v44, v45
    v_cvt_pk_bf16_f32 v45, v46, v47
    v_and_or_b32 v44, v44, -2, s16
    global_store_dwordx2 v6, v[44:45], s[48:49] sc1
    s_add_u32 s36, s36, 131072
    s_addc_u32 s37, s37, 0
    s_cmp_ge_u32 s20, 8
    s_cbranch_scc1 ch_w1s_nor
    ds_read_b128 v[64:67], v0 offset:15360
    ds_read_b128 v[72:75], v2 offset:16384
    ds_read_b128 v[76:79], v2 offset:17408
    ds_read_b128 v[80:83], v2 offset:18432
    ds_read_b128 v[84:87], v2 offset:19456
    ds_read_b128 v[88:91], v2 offset:0
    ds_read_b128 v[92:95], v2 offset:1024
    v_mov_b64 v[8:9], 0
    v_mov_b64 v[10:11], 0
    v_mov_b64 v[12:13], 0
    v_mov_b64 v[14:15], 0
    v_mov_b64 v[16:17], 0
    v_mov_b64 v[18:19], 0
    v_mov_b64 v[20:21], 0
    v_mov_b64 v[22:23], 0
    v_mov_b64 v[24:25], 0
    v_mov_b64 v[26:27], 0
    v_mov_b64 v[28:29], 0
    v_mov_b64 v[30:31], 0
    s_waitcnt vmcnt(0)
    s_sleep 1
    global_load_dwordx4 v[48:51], v0, s[52:53] offset:0 sc1
    global_load_dwordx4 v[52:55], v0, s[52:53] offset:1024 sc1
    global_load_dwordx4 v[56:59], v0, s[52:53] offset:2048 sc1
    global_load_dwordx4 v[60:63], v0, s[52:53] offset:3072 sc1
    s_nop 0
    s_sleep 2
    global_load_dwordx4 v[32:35], v0, s[52:53] offset:0 sc1
    global_load_dwordx4 v[36:39], v0, s[52:53] offset:1024 sc1
    global_load_dwordx4 v[40:43], v0, s[52:53] offset:2048 sc1
    global_load_dwordx4 v[44:47], v0, s[52:53] offset:3072 sc1
    s_waitcnt lgkmcnt(0)
ch_w1s_rchk:
    s_waitcnt vmcnt(7)
    v_mfma_f32_16x16x32_bf16 v[8:11], v[64:67], v[48:51], 0
    v_xor_b32 v68, s16, v48
    v_bitop3_b32 v68, v68, v50, s16 bitop3:0xf6
    s_waitcnt vmcnt(6)
    v_mfma_f32_16x16x32_bf16 v[8:11], v[64:67], v[52:55], v[8:11]
    v_bitop3_b32 v68, v68, v52, s16 bitop3:0xf6
    v_bitop3_b32 v68, v68, v54, s16 bitop3:0xf6
    s_waitcnt vmcnt(5)
    v_mfma_f32_16x16x32_bf16 v[8:11], v[64:67], v[56:59], v[8:11]
    v_bitop3_b32 v68, v68, v56, s16 bitop3:0xf6
    v_bitop3_b32 v68, v68, v58, s16 bitop3:0xf6
    s_waitcnt vmcnt(4)
    v_mfma_f32_16x16x32_bf16 v[8:11], v[64:67], v[60:63], v[8:11]
    v_bitop3_b32 v68, v68, v60, s16 bitop3:0xf6
    v_bitop3_b32 v68, v68, v62, s16 bitop3:0xf6
    v_and_b32 v68, 1, v68
    v_cmp_ne_u32 vcc, 0, v68
    s_cbranch_vccnz ch_w1s_rpoll
    s_nop 2
    v_add_f32_dpp v8, v8, v8 row_ror:8 row_mask:0xf bank_mask:0xf
    v_add_f32_dpp v9, v9, v9 row_ror:8 row_mask:0xf bank_mask:0xf
    s_mov_b64 exec, s[70:71]
    v_cvt_pk_bf16_f32 v8, v8, v9
    v_min_u32 v69, -2, v8
    global_store_dword v7, v69, s[58:59] sc1
    global_store_dword v7, v69, s[60:61] sc1
ch_w1s_rok:
    s_mov_b64 exec, -1
    v_mov_b64 v[8:9], 0
    v_mov_b64 v[10:11], 0
    s_branch ch_w1s_rd
ch_w1s_nor:
    ds_read_b128 v[72:75], v2 offset:16384
    ds_read_b128 v[76:79], v2 offset:17408
    ds_read_b128 v[80:83], v2 offset:18432
    ds_read_b128 v[84:87], v2 offset:19456
    ds_read_b128 v[88:91], v2 offset:0
    ds_read_b128 v[92:95], v2 offset:1024
    v_mov_b64 v[8:9], 0
    v_mov_b64 v[10:11], 0
    v_mov_b64 v[12:13], 0
    v_mov_b64 v[14:15], 0
    v_mov_b64 v[16:17], 0
    v_mov_b64 v[18:19], 0
    v_mov_b64 v[20:21], 0
    v_mov_b64 v[22:23], 0
    v_mov_b64 v[24:25], 0
    v_mov_b64 v[26:27], 0
    v_mov_b64 v[28:29], 0
    v_mov_b64 v[30:31], 0
ch_w1s_rd:
    s_barrier
    s_sleep 2
    s_branch ch_w1s_loop
ch_w1s_grem:
    s_mov_b64 exec, vcc
    global_load_dwordx4 v[40:43], v0, s[56:57] sc1
    s_mov_b64 exec, -1
    s_add_u32 s26, s26, 1
    s_cmp_gt_u32 s26, 1048576
    s_cbranch_scc1 ch_fail
    s_waitcnt vmcnt(0)
    s_branch ch_w1s_grem_chk
ch_w1s_last:
    s_add_u32 s36, s36, 131072
    s_addc_u32 s37, s37, 0
    s_nop 7
    v_add_f32 v24, v24, v26
    v_add_f32_e64 v25, v25, v27
    v_add_f32_e64 v28, v28, v30
    v_add_f32_e64 v29, v29, v31
    v_cvt_pk_bf16_f32 v70, v24, v25
    v_cvt_pk_bf16_f32 v71, v28, v29
    s_mov_b64 exec, s[6:7]
    global_store_dwordx2 v68, v[70:71], s[36:37] offset:512 sc1
    s_mov_b64 exec, -1
    s_branch ch_done
ch_w1s_rpoll:
    s_mov_b64 exec, vcc
    global_load_dwordx4 v[48:51], v0, s[52:53] offset:0 sc1
    global_load_dwordx4 v[52:55], v0, s[52:53] offset:1024 sc1
    global_load_dwordx4 v[56:59], v0, s[52:53] offset:2048 sc1
    global_load_dwordx4 v[60:63], v0, s[52:53] offset:3072 sc1
    s_mov_b64 exec, -1
    s_waitcnt vmcnt(7)
    v_mfma_f32_16x16x32_bf16 v[8:11], v[64:67], v[32:35], 0
    v_xor_b32 v68, s16, v32
    v_bitop3_b32 v68, v68, v34, s16 bitop3:0xf6
    s_waitcnt vmcnt(6)
    v_mfma_f32_16x16x32_bf16 v[8:11], v[64:67], v[36:39], v[8:11]
    v_bitop3_b32 v68, v68, v36, s16 bitop3:0xf6
    v_bitop3_b32 v68, v68, v38, s16 bitop3:0xf6
    s_waitcnt vmcnt(5)
    v_mfma_f32_16x16x32_bf16 v[8:11], v[64:67], v[40:43], v[8:11]
    v_bitop3_b32 v68, v68, v40, s16 bitop3:0xf6
    v_bitop3_b32 v68, v68, v42, s16 bitop3:0xf6
    s_waitcnt vmcnt(4)
    v_mfma_f32_16x16x32_bf16 v[8:11], v[64:67], v[44:47], v[8:11]
    v_bitop3_b32 v68, v68, v44, s16 bitop3:0xf6
    v_bitop3_b32 v68, v68, v46, s16 bitop3:0xf6
    v_and_b32 v68, 1, v68
    v_cmp_ne_u32 vcc, 0, v68
    s_cbranch_vccnz ch_w1s_rpol2
    s_nop 2
    v_add_f32_dpp v8, v8, v8 row_ror:8 row_mask:0xf bank_mask:0xf
    v_add_f32_dpp v9, v9, v9 row_ror:8 row_mask:0xf bank_mask:0xf
    s_mov_b64 exec, s[70:71]
    v_cvt_pk_bf16_f32 v8, v8, v9
    v_min_u32 v69, -2, v8
    global_store_dword v7, v69, s[58:59] sc1
    global_store_dword v7, v69, s[60:61] sc1
    s_branch ch_w1s_rok
ch_w1s_rpol2:
    s_mov_b64 exec, vcc
    global_load_dwordx4 v[32:35], v0, s[52:53] offset:0 sc1
    global_load_dwordx4 v[36:39], v0, s[52:53] offset:1024 sc1
    global_load_dwordx4 v[40:43], v0, s[52:53] offset:2048 sc1
    global_load_dwordx4 v[44:47], v0, s[52:53] offset:3072 sc1
    s_mov_b64 exec, -1
    s_add_u32 s26, s26, 1
    s_cmp_gt_u32 s26, 1048576
    s_cbranch_scc1 ch_fail
    s_branch ch_w1s_rchk
ch_w1s_slow:
    s_nop 7
    v_max3_f32 v68, v8, v9, v10
    v_max3_f32 v68, v68, v11, v18
    v_max_f32 v68, v68, v19
    v_mov_b32 v16, v68
    s_nop 1
    v_mov_b32_dpp v16, v68 row_shr:4 row_mask:0xf bank_mask:0xa
    s_nop 1
    v_mov_b32_dpp v16, v68 row_shl:4 row_mask:0xf bank_mask:0x5
    v_max_f32 v68, v68, v16
    v_mov_b32 v16, v68
    s_nop 1
    v_permlane16_swap_b32 v68, v16
    v_max_f32 v68, v68, v16
    v_mov_b32 v16, v68
    s_nop 1
    v_permlane32_swap_b32 v68, v16
    v_max_f32 v68, v68, v16
    v_sub_f32 v12, v8, v68
    v_exp_f32 v12, v12
    v_sub_f32 v13, v9, v68
    v_exp_f32 v13, v13
    v_sub_f32 v14, v10, v68
    v_exp_f32 v14, v14
    v_sub_f32 v15, v11, v68
    v_exp_f32 v15, v15
    v_sub_f32 v20, v18, v68
    v_exp_f32 v20, v20
    v_sub_f32 v21, v19, v68
    v_exp_f32_e64 v21, v21
    v_cvt_pk_bf16_f32 v94, v12, v13
    v_cvt_pk_bf16_f32 v95, v14, v15
    v_cvt_pk_bf16_f32 v92, v12, v13
    v_cvt_pk_bf16_f32 v93, v14, v15
    s_nop 0
    v_mov_b32_dpp v92, v94 row_shr:4 row_mask:0xf bank_mask:0xa
    v_mov_b32_dpp v93, v95 row_shr:4 row_mask:0xf bank_mask:0xa
    v_mov_b32_dpp v94, v94 row_shl:4 row_mask:0xf bank_mask:0x5
    v_mov_b32_dpp v95, v95 row_shl:4 row_mask:0xf bank_mask:0x5
    v_cvt_pk_bf16_f32 v26, v20, v21
    v_cvt_pk_bf16_f32 v29, v20, v21
    v_mfma_f32_16x16x32_bf16 v[12:15], v[88:91], v[92:95], 0
    v_mfma_f32_16x16x32_bf16 v[32:35], v[40:43], v[92:95], 0
    v_mfma_f32_16x16x32_bf16 v[36:39], v[44:47], v[92:95], 0
    v_mfma_f32_16x16x16_bf16 v[12:15], v[88:89], v[26:27], v[12:15]
    v_mfma_f32_16x16x16_bf16 v[32:35], v[70:71], v[26:27], v[32:35]
    v_mfma_f32_16x16x16_bf16 v[36:39], v[70:71], v[28:29], v[36:39]
    s_nop 7
    s_branch ch_w1s_pvm
ch_wave2:
    s_waitcnt lgkmcnt(0)
    s_barrier
    v_mov_b32 v10, 7680
    ds_read_b32 v10, v10
    s_waitcnt lgkmcnt(0)
    v_readfirstlane_b32 s23, v10
    s_bitcmp1_b32 s23, 0
    s_cbranch_scc1 wk_restart
    s_and_b32 s23, s23, 0x6800
    s_xor_b32 s23, s23, 0
    s_cmp_eq_u32 s17, 2
    s_cselect_b32 s23, 0, s23
    s_add_u32 s24, s23, 4096
    s_add_u32 s44, s44, s24
    s_addc_u32 s45, s45, 0
    s_mov_b32 s22, 0
    s_cmp_eq_u32 s21, 0
    s_cselect_b32 s6, -1, 0
    s_cselect_b32 s7, 0, -1
    s_and_b32 s23, s20, 4
    s_and_b32 s24, s20, 1
    s_lshl_b32 s24, s24, 1
    s_add_u32 s23, s23, s24
    s_bfe_u32 s24, s20, 0x10001
    s_add_u32 s23, s23, s24
    s_lshl_b32 s23, s23, 3
    s_mov_b64 s[4:5], 0xff
    s_lshl_b64 s[4:5], s[4:5], s23
    s_lshr_b32 s23, s20, 3
    s_cmp_eq_u32 s23, 2
    s_cselect_b64 s[4:5], s[4:5], 0
    s_and_b32 s23, s22, 3
    s_lshl_b32 s23, s23, 13
    s_add_u32 s24, s23, 2048
    s_add_u32 s54, s40, s24
    s_addc_u32 s55, s41, 0
    s_lshl_b32 s23, s23, 2
    s_add_u32 s56, s44, s23
    s_addc_u32 s57, s45, 0
    s_add_u32 s46, s38, 65536
    s_addc_u32 s47, s39, 0
    s_add_u32 s48, s38, 81920
    s_addc_u32 s49, s39, 0
    s_add_u32 s50, s38, 131072
    s_addc_u32 s51, s39, 0
    s_add_u32 s52, s38, s73
    s_addc_u32 s53, s39, 0
    s_lshl_b32 s23, s21, 5
    s_add_u32 s23, s23, s20
    s_lshl_b32 s23, s23, 7
    s_add_u32 s23, s23, 103817216
    s_add_u32 s8, s14, s23
    s_addc_u32 s9, s15, 0
    s_cmp_eq_u32 s17, 2
    s_cbranch_scc1 ch_slowmode2
    v_lshlrev_b32 v68, 3, v0
    s_mov_b32 m0, 7168
    s_add_u32 s74, s30, 262144
    s_addc_u32 s75, s31, 0
    s_sub_u32 s74, s74, 4096
    s_subb_u32 s75, s75, 0
    global_load_lds_dword v68, s[74:75] sc1
    ds_read_b128 v[72:75], v2 offset:32768
    ds_read_b128 v[76:79], v2 offset:33792
    ds_read_b128 v[80:83], v3 offset:32768
    ds_read_b128 v[84:87], v3 offset:33792
    ds_read_b128 v[88:91], v2 offset:34816
    ds_read_b128 v[92:95], v2 offset:35840
    v_mov_b64 v[8:9], 0
    v_mov_b64 v[10:11], 0
    v_mov_b64 v[12:13], 0
    v_mov_b64 v[14:15], 0
    v_mov_b64 v[16:17], 0
    v_mov_b64 v[18:19], 0
    v_mov_b64 v[20:21], 0
    v_mov_b64 v[22:23], 0
    v_mov_b64 v[24:25], 0
    v_mov_b64 v[26:27], 0
    v_mov_b64 v[28:29], 0
    v_mov_b64 v[30:31], 0
    s_mov_b32 s26, 0
    s_branch ch_w2f_loop
.p2align 6
ch_w2f_loop:
    s_waitcnt lgkmcnt(0)
    global_load_dwordx4 v[56:59], v0, s[54:55] offset:0 sc1
    s_nop 0
    s_sleep 1
    s_nop 0
    global_load_dwordx4 v[56:59], v0, s[54:55] offset:0 sc1
    s_nop 0
    s_sleep 1
ch_w2f_gown:
    global_load_dwordx4 v[56:59], v0, s[54:55] offset:0 sc1
    s_add_u32 s26, s26, 1
    s_cmp_gt_u32 s26, 1048576
    s_cbranch_scc1 ch_fail
    s_waitcnt vmcnt(2)
ch_w2f_gw:
    v_max3_u32 v68, v56, v57, v58
    v_max_u32_e64 v68, v68, v59
    v_cmpx_eq_u32 vcc, -1, v68
    s_cbranch_execnz ch_w2f_gown
ch_w2f_gok:
    s_mov_b64 exec, -1
    ds_write_b128 v0, v[56:59] offset:2048
    s_nop 0
    v_smfmac_f32_16x16x64_bf16 v[8:11], v[56:59], a[32:39], v1
    global_load_dwordx4 v[64:67], v0, s[54:55] offset:2048 sc1
    s_nop 0
    v_smfmac_f32_16x16x64_bf16 v[24:27], v[56:59], v[72:79], v1
    ds_read_b128 v[72:75], v3 offset:34816
    ds_read_b128 v[76:79], v3 offset:35840
    global_load_dwordx4 v[40:43], v0, s[56:57] sc1
    v_smfmac_f32_16x16x64_bf16 v[16:19], v[56:59], v[80:87], v1
    ds_read_b128 v[80:83], v2 offset:16384
    ds_read_b128 v[84:87], v2 offset:17408
    s_waitcnt lgkmcnt(4)
    s_barrier
    ds_read_b128 v[52:55], v0 offset:1024
    ds_read_b128 v[48:51], v0 offset:0
    ds_read_b128 v[60:63], v0 offset:3072
    v_smfmac_f32_16x16x64_bf16 v[12:15], v[56:59], a[40:47], v1
    s_and_b32 s16, s22, 1
    s_nop 0
    v_smfmac_f32_16x16x64_bf16 v[28:31], v[56:59], v[88:95], v1
    ds_read_b128 v[88:91], v2 offset:18432
    ds_read_b128 v[92:95], v2 offset:19456
    s_waitcnt lgkmcnt(7)
    v_smfmac_f32_16x16x64_bf16 v[20:23], v[56:59], v[72:79], v1
    ds_read_b128 v[72:75], v2 offset:0
    ds_read_b128 v[76:79], v2 offset:1024
    s_waitcnt lgkmcnt(6)
    v_smfmac_f32_16x16x64_bf16 v[8:11], v[52:55], a[16:23], v1
    v_smfmac_f32_16x16x64_bf16 v[24:27], v[52:55], v[80:87], v1
    ds_read_b128 v[80:83], v3 offset:16384
    ds_read_b128 v[84:87], v3 offset:17408
    v_smfmac_f32_16x16x64_bf16 v[16:19], v[52:55], a[160:167], v1
    v_smfmac_f32_16x16x64_bf16 v[12:15], v[52:55], a[24:31], v1
    s_waitcnt lgkmcnt(4)
    s_nop 0
    v_smfmac_f32_16x16x64_bf16 v[28:31], v[52:55], v[88:95], v1
    ds_read_b128 v[88:91], v2 offset:2048
    ds_read_b128 v[92:95], v2 offset:3072
    v_smfmac_f32_16x16x64_bf16 v[20:23], v[52:55], a[168:175], v1
    v_smfmac_f32_16x16x64_bf16 v[8:11], v[48:51], a[0:7], v1
    s_waitcnt lgkmcnt(4)
    v_smfmac_f32_16x16x64_bf16 v[24:27], v[48:51], v[72:79], v1
    ds_read_b128 v[72:75], v3 offset:18432
    ds_read_b128 v[76:79], v3 offset:19456
    s_waitcnt lgkmcnt(4)
    v_smfmac_f32_16x16x64_bf16 v[16:19], v[48:51], v[80:87], v1
    ds_read_b128 v[80:83], v2 offset:49152
    ds_read_b128 v[84:87], v2 offset:50176
    v_smfmac_f32_16x16x64_bf16 v[12:15], v[48:51], a[8:15], v1
    s_waitcnt lgkmcnt(4)
    v_smfmac_f32_16x16x64_bf16 v[28:31], v[48:51], v[88:95], v1
    ds_read_b128 v[88:91], v2 offset:51200
    ds_read_b128 v[92:95], v2 offset:52224
    s_waitcnt vmcnt(0)
ch_w2f_grem_chk:
    ds_write_b128 v0, v[40:43] offset:10240
    ds_write_b128 v0, v[64:67] offset:4096
    v_max3_u32 v68, v40, v41, v42
    v_max3_u32 v68, v68, v43, v64
    v_max3_u32 v68, v68, v65, v66
    v_max_u32_e64 v68, v68, v67
    v_cmp_eq_u32_e64 vcc, -1, v68
    s_cbranch_vccnz ch_w2f_grem
    s_waitcnt lgkmcnt(6)
    v_smfmac_f32_16x16x64_bf16 v[20:23], v[48:51], v[72:79], v1
    ds_read_b128 v[72:75], v3 offset:0
    ds_read_b128 v[76:79], v3 offset:1024
    v_smfmac_f32_16x16x64_bf16 v[8:11], v[60:63], a[48:55], v1
    global_load_dwordx4 v[32:35], v0, s[30:31] offset:-2048 sc1
    global_load_dwordx4 v[36:39], v0, s[30:31] offset:2048 sc1
    s_waitcnt lgkmcnt(6)
    v_smfmac_f32_16x16x64_bf16 v[24:27], v[60:63], v[80:87], v1
    ds_read_b128 v[80:83], v3 offset:49152
    ds_read_b128 v[84:87], v3 offset:50176
    v_smfmac_f32_16x16x64_bf16 v[16:19], v[60:63], a[176:183], v1
    global_load_dwordx4 v[40:43], v0, s[32:33] offset:0 sc1
    s_nop 0
    v_smfmac_f32_16x16x64_bf16 v[12:15], v[60:63], a[56:63], v1
    global_load_dwordx4 v[44:47], v0, s[32:33] offset:1024 sc1
    s_waitcnt lgkmcnt(4)
    s_barrier
    ds_read_b128 v[56:59], v0 offset:10240
    ds_read_b128 v[52:55], v0 offset:9216
    ds_read_b128 v[48:51], v0 offset:8192
    v_smfmac_f32_16x16x64_bf16 v[28:31], v[60:63], v[88:95], v1
    ds_read_b128 v[88:91], v3 offset:2048
    ds_read_b128 v[92:95], v3 offset:3072
    v_smfmac_f32_16x16x64_bf16 v[20:23], v[60:63], a[184:191], v1
    v_smfmac_f32_16x16x64_bf16 v[8:11], v[64:67], a[64:71], v1
    ds_read_b128 v[60:63], v0 offset:11264
    s_waitcnt lgkmcnt(8)
    v_smfmac_f32_16x16x64_bf16 v[24:27], v[64:67], v[72:79], v1
    ds_read_b128 v[72:75], v3 offset:51200
    ds_read_b128 v[76:79], v3 offset:52224
    s_waitcnt lgkmcnt(8)
    v_smfmac_f32_16x16x64_bf16 v[16:19], v[64:67], v[80:87], v1
    v_smfmac_f32_16x16x64_bf16 v[12:15], v[64:67], a[72:79], v1
    s_waitcnt lgkmcnt(3)
    v_smfmac_f32_16x16x64_bf16 v[28:31], v[64:67], v[88:95], v1
    s_waitcnt lgkmcnt(0)
    s_nop 0
    v_smfmac_f32_16x16x64_bf16 v[20:23], v[64:67], v[72:79], v1
    ds_read_b128 v[64:67], v0 offset:12288
    s_nop 0
    v_smfmac_f32_16x16x64_bf16 v[8:11], v[56:59], a[112:119], v1
    v_lshlrev_b32 v68, 3, v0
    s_mov_b32 m0, 7168
    v_smfmac_f32_16x16x64_bf16 v[12:15], v[56:59], a[120:127], v1
    s_add_u32 s74, s30, 520192
    s_addc_u32 s75, s31, 0
    global_load_lds_dword v68, s[74:75] sc1
    v_smfmac_f32_16x16x64_bf16 v[8:11], v[52:55], a[96:103], v1
    s_nop 0
    s_max_u32 s23, s22, 1
    v_smfmac_f32_16x16x64_bf16 v[12:15], v[52:55], a[104:111], v1
    s_sub_u32 s23, s23, 1
    v_mov_b32 v69, s23
    v_smfmac_f32_16x16x64_bf16 v[8:11], v[48:51], a[80:87], v1
    v_lshrrev_b32 v68, 1, v0
    s_add_u32 s22, s22, 1
    v_smfmac_f32_16x16x64_bf16 v[12:15], v[48:51], a[88:95], v1
    s_and_b32 s23, s22, 3
    s_lshl_b32 s23, s23, 13
    v_smfmac_f32_16x16x64_bf16 v[8:11], v[60:63], a[128:135], v1
    s_add_u32 s24, s23, 2048
    s_add_u32 s54, s40, s24
    s_addc_u32 s55, s41, 0
    v_smfmac_f32_16x16x64_bf16 v[12:15], v[60:63], a[136:143], v1
    s_lshl_b32 s23, s23, 2
    s_add_u32 s56, s44, s23
    s_addc_u32 s57, s45, 0
    s_waitcnt lgkmcnt(0)
    v_smfmac_f32_16x16x64_bf16 v[8:11], v[64:67], a[144:151], v1
    s_mov_b64 vcc, s[66:67]
    v_smfmac_f32_16x16x64_bf16 v[12:15], v[64:67], a[152:159], v1
    v_smfmac_f32_16x16x64_bf16 v[16:19], v[48:51], a[192:199], v1
    s_nop 2
    v_smfmac_f32_16x16x64_bf16 v[20:23], v[48:51], a[200:207], v1
    s_nop 1
    v_add_f32 v8, v8, v10
    v_add_f32 v9, v9, v11
    v_smfmac_f32_16x16x64_bf16 v[16:19], v[52:55], a[208:215], v1
    v_add_f32 v12, v12, v14
    v_add_f32_e64 v13, v13, v15
    v_cvt_pk_bf16_f32 v8, v8, v9
    v_cvt_pk_bf16_f32 v9, v12, v13
    ds_write2st64_b32 v4, v8, v9 offset0:24 offset1:25
    ds_read_b64_tr_b16 v[80:81], v5 offset:6144
    ds_read_b64_tr_b16 v[82:83], v5 offset:6400
    v_smfmac_f32_16x16x64_bf16 v[20:23], v[52:55], a[216:223], v1
    v_mov_b32 v88, 0x3f803f80
    v_smfmac_f32_16x16x64_bf16 v[16:19], v[56:59], a[224:231], v1
    v_mov_b32 v89, 0x3f803f80
    v_smfmac_f32_16x16x64_bf16 v[20:23], v[56:59], a[232:239], v1
    v_mov_b32 v90, 0x3f803f80
    v_smfmac_f32_16x16x64_bf16 v[16:19], v[60:63], a[240:247], v1
    v_mov_b32 v91, 0x3f803f80
    v_smfmac_f32_16x16x64_bf16 v[20:23], v[60:63], a[248:255], v1
    s_mov_b64 exec, s[6:7]
    global_store_dwordx2 v68, v[70:71], s[36:37] offset:1024 sc1
    s_mov_b64 exec, -1
    v_smfmac_f32_16x16x64_bf16 v[16:19], v[64:67], v[96:103], v1
    s_mov_b64 exec, 1
    global_store_dword v0, v69, s[8:9] sc1
    s_mov_b64 exec, -1
    v_smfmac_f32_16x16x64_bf16 v[20:23], v[64:67], v[104:111], v1
    s_waitcnt lgkmcnt(0)
    s_waitcnt vmcnt(5)
    v_mfma_f32_16x16x32_bf16 v[8:11], v[32:35], v[80:83], 0
    s_nop 1
    v_mfma_f32_16x16x32_bf16 v[12:15], v[36:39], v[80:83], 0
    v_add_f32 v16, v16, v18
    v_add_f32 v17, v17, v19
    v_smfmac_f32_16x16x64_bf16 v[24:27], v[48:51], v[112:119], v1
    v_add_f32 v20, v20, v22
    v_add_f32_e64 v21, v21, v23
    v_cvt_pk_bf16_f32 v16, v16, v17
    v_cvt_pk_bf16_f32 v17, v20, v21
    ds_write2st64_b32 v4, v16, v17 offset0:56 offset1:57
    v_smfmac_f32_16x16x64_bf16 v[28:31], v[48:51], v[120:127], v1
    v_cndmask_b32 v8, v8, v12, vcc
    v_cndmask_b32 v9, v9, v13, vcc
    v_cndmask_b32 v10, v10, v14, vcc
    v_cndmask_b32 v11, v11, v15, vcc
    ds_write_b128 v0, v[8:11] offset:2048
    ds_read_b64_tr_b16 v[16:17], v5 offset:14336
    ds_read_b64_tr_b16 v[18:19], v5 offset:14592
    v_smfmac_f32_16x16x64_bf16 v[24:27], v[52:55], v[128:135], v1
    s_mov_b64 vcc, s[68:69]
    v_smfmac_f32_16x16x64_bf16 v[28:31], v[52:55], v[136:143], v1
    s_nop 0
    v_smfmac_f32_16x16x64_bf16 v[24:27], v[56:59], v[144:151], v1
    v_smfmac_f32_16x16x64_bf16 v[28:31], v[56:59], v[152:159], v1
    s_waitcnt lgkmcnt(2)
    s_barrier
    ds_read_b128 v[32:35], v0 offset:0
    ds_read_b128 v[36:39], v0 offset:1024
    ds_read_b128 v[92:95], v0 offset:3072
    v_smfmac_f32_16x16x64_bf16 v[24:27], v[60:63], v[160:167], v1
    ds_read_b64_tr_b16 v[72:73], v5 offset:5120
    ds_read_b64_tr_b16 v[48:49], v5 offset:13312
    ds_read_b64_tr_b16 v[74:75], v5 offset:5376
    v_smfmac_f32_16x16x64_bf16 v[28:31], v[60:63], v[168:175], v1
    ds_read_b64_tr_b16 v[50:51], v5 offset:13568
    ds_read_b64_tr_b16 v[76:77], v5 offset:5632
    ds_read_b64_tr_b16 v[52:53], v5 offset:13824
    v_smfmac_f32_16x16x64_bf16 v[24:27], v[64:67], v[176:183], v1
    ds_read_b64_tr_b16 v[78:79], v5 offset:5888
    ds_read_b64_tr_b16 v[54:55], v5 offset:14080
    ds_read_b64_tr_b16 v[84:85], v5 offset:6656
    v_smfmac_f32_16x16x64_bf16 v[28:31], v[64:67], v[184:191], v1
    ds_read_b64_tr_b16 v[56:57], v5 offset:14848
    ds_read_b64_tr_b16 v[86:87], v5 offset:6912
    ds_read_b64_tr_b16 v[58:59], v5 offset:15104
    s_waitcnt lgkmcnt(12)
    v_mfma_f32_16x16x32_bf16 v[20:23], v[16:19], v[80:83], 0
    s_mov_b64 exec, s[6:7]
    global_store_dwordx4 v0, v[16:19], s[34:35] offset:2048 sc1
    s_mov_b64 exec, -1
    s_cmp_eq_u32 s22, 64
    s_cbranch_scc1 ch_w2f_last
    v_pk_add_f32 v[8:9], v[8:9], v[32:33]
    v_pk_add_f32 v[10:11], v[10:11], v[34:35]
    v_pk_add_f32 v[36:37], v[36:37], v[92:93]
    v_pk_add_f32 v[38:39], v[38:39], v[94:95]
    v_pk_add_f32 v[8:9], v[8:9], v[36:37]
    v_pk_add_f32 v[10:11], v[10:11], v[38:39]
    v_mul_f32 v8, s27, v8
    v_mul_f32 v9, s27, v9
    v_mul_f32 v10, s27, v10
    v_mul_f32 v11, s27, v11
    s_waitcnt lgkmcnt(0)
    v_mfma_f32_16x16x32_bf16 v[20:23], v[48:51], v[72:75], v[20:23]
    v_exp_f32_e64 v12, v8
    v_mfma_f32_16x16x32_bf16 v[20:23], v[52:55], v[76:79], v[20:23]
    v_exp_f32 v13, v9
    v_mfma_f32_16x16x32_bf16 v[20:23], v[56:59], v[84:87], v[20:23]
    v_exp_f32 v14, v10
    v_exp_f32_e64 v15, v11
    v_add_u32 v69, 147456, v0
    v_cvt_pk_bf16_f32 v94, v12, v13
    v_cvt_pk_bf16_f32 v95, v14, v15
    v_cvt_pk_bf16_f32 v92, v12, v13
    v_cvt_pk_bf16_f32 v93, v14, v15
    v_add_f32 v24, v24, v26
    v_add_f32 v25, v25, v27
    v_mov_b32_dpp v92, v94 row_shr:4 row_mask:0xf bank_mask:0xa
    v_mov_b32_dpp v93, v95 row_shr:4 row_mask:0xf bank_mask:0xa
    v_mov_b32_dpp v94, v94 row_shl:4 row_mask:0xf bank_mask:0x5
    v_mov_b32_dpp v95, v95 row_shl:4 row_mask:0xf bank_mask:0x5
    v_cndmask_b32 v18, v20, v22, vcc
    v_cndmask_b32_e64 v19, v21, v23, vcc
    s_waitcnt vmcnt(4)
    v_mfma_f32_16x16x32_bf16 v[12:15], v[88:91], v[92:95], 0
    v_mul_f32 v18, s27, v18
    v_mul_f32 v19, s27, v19
    v_mfma_f32_16x16x32_bf16 v[32:35], v[40:43], v[92:95], 0
    v_exp_f32_e64 v20, v18
    v_mfma_f32_16x16x32_bf16 v[36:39], v[44:47], v[92:95], 0
    v_exp_f32 v21, v19
    v_add_f32 v28, v28, v30
    v_add_f32 v29, v29, v31
    v_cvt_pk_bf16_f32 v26, v20, v21
    v_mov_b32 v27, 0
    v_cvt_pk_bf16_f32 v70, v24, v25
    v_cvt_pk_bf16_f32 v71, v28, v29
    v_mfma_f32_16x16x16_bf16 v[12:15], v[88:89], v[26:27], v[12:15]
    v_cvt_pk_bf16_f32 v29, v20, v21
    v_mov_b32_e64 v28, 0
    v_mfma_f32_16x16x16_bf16 v[32:35], v[70:71], v[26:27], v[32:35]
    v_max3_f32 v68, abs(v8), abs(v9), abs(v10)
    v_mfma_f32_16x16x16_bf16 v[36:39], v[70:71], v[28:29], v[36:39]
    v_max3_f32 v68, v68, abs(v11), abs(v18)
    v_max_f32 v68, v68, abs(v19)
    v_cmp_nge_f32 vcc, s29, v68
    s_cbranch_vccnz ch_w2f_slow
ch_w2f_pvm:
    v_rcp_f32_e64 v22, v12
    v_mov_b64_e64 v[40:41], 0
    v_pk_mul_f32 v[32:33], v[32:33], v[22:23] op_sel_hi:[1,0]
    v_pk_mul_f32 v[34:35], v[34:35], v[22:23] op_sel_hi:[1,0]
    v_cvt_pk_bf16_f32 v16, v32, v33
    v_pk_mul_f32 v[36:37], v[36:37], v[22:23] op_sel_hi:[1,0]
    v_cvt_pk_bf16_f32 v17, v34, v35
    v_pk_mul_f32 v[38:39], v[38:39], v[22:23] op_sel_hi:[1,0]
    v_cvt_pk_bf16_f32 v18, v36, v37
    v_cvt_pk_bf16_f32 v19, v38, v39
    ds_write_b128 v0, v[16:19] offset:10240
    v_mov_b64_e64 v[42:43], 0
    v_mov_b64_e64 v[44:45], 0
    v_mov_b64_e64 v[46:47], 0
    v_mov_b64_e64 v[8:9], 0
    v_mov_b64_e64 v[10:11], 0
    v_smfmac_f32_16x16x64_bf16 v[40:43], v[16:19], v[208:215], v1 abid:1
    v_smfmac_f32_16x16x64_bf16 v[44:47], v[16:19], v[240:247], v1 abid:1
    s_waitcnt lgkmcnt(0)
    s_barrier
    ds_read_b128 v[20:23], v0 offset:8192
    ds_read_b128 v[28:31], v0 offset:9216
    ds_read_b128 v[12:15], v0 offset:11264
    ds_read_b128 v[48:51], v69 offset:0
    ds_read_b128 v[52:55], v69 offset:1024
    ds_read_b128 v[56:59], v69 offset:2048
    ds_read_b128 v[60:63], v69 offset:3072
    ds_read_b128 v[72:75], v69 offset:4096
    ds_read_b128 v[76:79], v69 offset:5120
    ds_read_b128 v[80:83], v69 offset:6144
    ds_read_b128 v[84:87], v69 offset:7168
    s_waitcnt lgkmcnt(10)
    v_smfmac_f32_16x16x64_bf16 v[40:43], v[20:23], v[192:199], v1 abid:1
    s_waitcnt lgkmcnt(9)
    v_smfmac_f32_16x16x64_bf16 v[40:43], v[28:31], v[200:207], v1 abid:1
    s_waitcnt lgkmcnt(8)
    v_smfmac_f32_16x16x64_bf16 v[40:43], v[12:15], v[216:223], v1 abid:1
    s_nop 0
    v_smfmac_f32_16x16x64_bf16 v[44:47], v[20:23], v[224:231], v1 abid:1
    s_add_u32 s30, s30, 262144
    s_addc_u32 s31, s31, 0
    v_smfmac_f32_16x16x64_bf16 v[44:47], v[28:31], v[232:239], v1 abid:1
    s_add_u32 s32, s32, 262144
    s_addc_u32 s33, s33, 0
    v_smfmac_f32_16x16x64_bf16 v[44:47], v[12:15], v[248:255], v1 abid:1
    s_add_u32 s34, s34, 131072
    s_addc_u32 s35, s35, 0
    s_waitcnt lgkmcnt(0)
    v_smfmac_f32_16x16x64_bf16 v[8:11], v[16:19], v[72:79], v1 abid:1
    v_smfmac_f32_16x16x64_bf16 v[8:11], v[20:23], v[48:55], v1 abid:1
    v_cvt_pk_bf16_f32 v40, v40, v41
    v_cvt_pk_bf16_f32 v41, v42, v43
    v_smfmac_f32_16x16x64_bf16 v[8:11], v[28:31], v[56:63], v1 abid:1
    v_and_or_b32 v40, v40, -2, s16
    global_store_dwordx2 v6, v[40:41], s[46:47]
    v_smfmac_f32_16x16x64_bf16 v[8:11], v[12:15], v[80:87], v1 abid:1
    v_cvt_pk_bf16_f32 v44, v44, v45
    v_cvt_pk_bf16_f32 v45, v46, v47
    v_and_or_b32 v44, v44, -2, s16
    global_store_dwordx2 v6, v[44:45], s[48:49]
    s_nop 3
    v_cvt_pk_bf16_f32 v8, v8, v9
    v_cvt_pk_bf16_f32 v9, v10, v11
    v_and_or_b32 v8, v8, -2, s16
    global_store_dwordx2 v6, v[8:9], s[50:51]
    s_add_u32 s36, s36, 131072
    s_addc_u32 s37, s37, 0
    ds_read_b128 v[72:75], v2 offset:32768
    ds_read_b128 v[76:79], v2 offset:33792
    ds_read_b128 v[80:83], v3 offset:32768
    ds_read_b128 v[84:87], v3 offset:33792
    ds_read_b128 v[88:91], v2 offset:34816
    ds_read_b128 v[92:95], v2 offset:35840
    v_mov_b64 v[8:9], 0
    v_mov_b64 v[10:11], 0
    v_mov_b64 v[12:13], 0
    v_mov_b64 v[14:15], 0
    v_mov_b64 v[16:17], 0
    v_mov_b64 v[18:19], 0
    v_mov_b64 v[20:21], 0
    v_mov_b64 v[22:23], 0
    v_mov_b64 v[24:25], 0
    v_mov_b64 v[26:27], 0
    v_mov_b64_e64 v[28:29], 0
    v_mov_b64_e64 v[30:31], 0
    s_barrier
    s_sleep 2
    s_branch ch_w2f_loop
ch_w2f_grem:
    s_mov_b64 exec, vcc
    global_load_dwordx4 v[40:43], v0, s[56:57] sc1
    global_load_dwordx4 v[64:67], v0, s[54:55] offset:2048 sc1
    s_mov_b64 exec, -1
    s_add_u32 s26, s26, 1
    s_cmp_gt_u32 s26, 1048576
    s_cbranch_scc1 ch_fail
    s_waitcnt vmcnt(0)
    s_branch ch_w2f_grem_chk
ch_w2f_last:
    s_add_u32 s36, s36, 131072
    s_addc_u32 s37, s37, 0
    s_nop 7
    v_add_f32 v24, v24, v26
    v_add_f32 v25, v25, v27
    v_add_f32 v28, v28, v30
    v_add_f32 v29, v29, v31
    v_cvt_pk_bf16_f32 v70, v24, v25
    v_cvt_pk_bf16_f32 v71, v28, v29
    s_mov_b64 exec, s[6:7]
    global_store_dwordx2 v68, v[70:71], s[36:37] offset:1024 sc1
    s_mov_b64 exec, -1
    s_branch ch_done
ch_w2f_slow:
    s_nop 7
    v_max3_f32 v68, v8, v9, v10
    v_max3_f32 v68, v68, v11, v18
    v_max_f32 v68, v68, v19
    v_mov_b32 v16, v68
    s_nop 1
    v_mov_b32_dpp v16, v68 row_shr:4 row_mask:0xf bank_mask:0xa
    s_nop 1
    v_mov_b32_dpp v16, v68 row_shl:4 row_mask:0xf bank_mask:0x5
    v_max_f32 v68, v68, v16
    v_mov_b32 v16, v68
    s_nop 1
    v_permlane16_swap_b32 v68, v16
    v_max_f32 v68, v68, v16
    v_mov_b32 v16, v68
    s_nop 1
    v_permlane32_swap_b32 v68, v16
    v_max_f32 v68, v68, v16
    v_sub_f32 v12, v8, v68
    v_exp_f32 v12, v12
    v_sub_f32 v13, v9, v68
    v_exp_f32 v13, v13
    v_sub_f32 v14, v10, v68
    v_exp_f32 v14, v14
    v_sub_f32 v15, v11, v68
    v_exp_f32 v15, v15
    v_sub_f32 v20, v18, v68
    v_exp_f32 v20, v20
    v_sub_f32 v21, v19, v68
    v_exp_f32_e64 v21, v21
    v_cvt_pk_bf16_f32 v94, v12, v13
    v_cvt_pk_bf16_f32 v95, v14, v15
    v_cvt_pk_bf16_f32 v92, v12, v13
    v_cvt_pk_bf16_f32 v93, v14, v15
    s_nop 0
    v_mov_b32_dpp v92, v94 row_shr:4 row_mask:0xf bank_mask:0xa
    v_mov_b32_dpp v93, v95 row_shr:4 row_mask:0xf bank_mask:0xa
    v_mov_b32_dpp v94, v94 row_shl:4 row_mask:0xf bank_mask:0x5
    v_mov_b32_dpp v95, v95 row_shl:4 row_mask:0xf bank_mask:0x5
    v_cvt_pk_bf16_f32 v26, v20, v21
    v_cvt_pk_bf16_f32 v29, v20, v21
    v_mfma_f32_16x16x32_bf16 v[12:15], v[88:91], v[92:95], 0
    v_mfma_f32_16x16x32_bf16 v[32:35], v[40:43], v[92:95], 0
    v_mfma_f32_16x16x32_bf16 v[36:39], v[44:47], v[92:95], 0
    v_mfma_f32_16x16x16_bf16 v[12:15], v[88:89], v[26:27], v[12:15]
    v_mfma_f32_16x16x16_bf16 v[32:35], v[70:71], v[26:27], v[32:35]
    v_mfma_f32_16x16x16_bf16 v[36:39], v[70:71], v[28:29], v[36:39]
    s_nop 7
    s_branch ch_w2f_pvm
ch_slowmode2:
    v_lshlrev_b32 v68, 3, v0
    s_mov_b32 m0, 7168
    s_add_u32 s74, s30, 262144
    s_addc_u32 s75, s31, 0
    s_sub_u32 s74, s74, 4096
    s_subb_u32 s75, s75, 0
    global_load_lds_dword v68, s[74:75] sc1
    ds_read_b128 v[72:75], v2 offset:32768
    ds_read_b128 v[76:79], v2 offset:33792
    ds_read_b128 v[80:83], v3 offset:32768
    ds_read_b128 v[84:87], v3 offset:33792
    ds_read_b128 v[88:91], v2 offset:34816
    ds_read_b128 v[92:95], v2 offset:35840
    v_mov_b64 v[8:9], 0
    v_mov_b64 v[10:11], 0
    v_mov_b64 v[12:13], 0
    v_mov_b64 v[14:15], 0
    v_mov_b64 v[16:17], 0
    v_mov_b64 v[18:19], 0
    v_mov_b64 v[20:21], 0
    v_mov_b64 v[22:23], 0
    v_mov_b64 v[24:25], 0
    v_mov_b64 v[26:27], 0
    v_mov_b64 v[28:29], 0
    v_mov_b64 v[30:31], 0
    s_mov_b32 s26, 0
    s_branch ch_w2s_loop
.p2align 6
ch_w2s_loop:
    s_waitcnt lgkmcnt(0)
    global_load_dwordx4 v[56:59], v0, s[54:55] offset:0 sc1
    s_nop 0
    s_sleep 1
    s_nop 0
    global_load_dwordx4 v[56:59], v0, s[54:55] offset:0 sc1
    s_nop 0
    s_sleep 1
ch_w2s_gown:
    global_load_dwordx4 v[56:59], v0, s[54:55] offset:0 sc1
    s_add_u32 s26, s26, 1
    s_cmp_gt_u32 s26, 1048576
    s_cbranch_scc1 ch_fail
    s_waitcnt vmcnt(2)
ch_w2s_gw:
    v_max3_u32 v68, v56, v57, v58
    v_max_u32_e64 v68, v68, v59
    v_cmpx_eq_u32 vcc, -1, v68
    s_cbranch_execnz ch_w2s_gown
ch_w2s_gok:
    s_mov_b64 exec, -1
    ds_write_b128 v0, v[56:59] offset:2048
    s_nop 0
    v_smfmac_f32_16x16x64_bf16 v[8:11], v[56:59], a[32:39], v1
    global_load_dwordx4 v[64:67], v0, s[54:55] offset:2048 sc1
    s_nop 0
    v_smfmac_f32_16x16x64_bf16 v[24:27], v[56:59], v[72:79], v1
    ds_read_b128 v[72:75], v3 offset:34816
    ds_read_b128 v[76:79], v3 offset:35840
    global_load_dwordx4 v[40:43], v0, s[56:57] sc1
    v_smfmac_f32_16x16x64_bf16 v[16:19], v[56:59], v[80:87], v1
    ds_read_b128 v[80:83], v2 offset:16384
    ds_read_b128 v[84:87], v2 offset:17408
    s_waitcnt lgkmcnt(4)
    s_barrier
    ds_read_b128 v[52:55], v0 offset:1024
    ds_read_b128 v[48:51], v0 offset:0
    ds_read_b128 v[60:63], v0 offset:3072
    v_smfmac_f32_16x16x64_bf16 v[12:15], v[56:59], a[40:47], v1
    s_and_b32 s16, s22, 1
    s_nop 0
    v_smfmac_f32_16x16x64_bf16 v[28:31], v[56:59], v[88:95], v1
    ds_read_b128 v[88:91], v2 offset:18432
    ds_read_b128 v[92:95], v2 offset:19456
    s_waitcnt lgkmcnt(7)
    v_smfmac_f32_16x16x64_bf16 v[20:23], v[56:59], v[72:79], v1
    ds_read_b128 v[72:75], v2 offset:0
    ds_read_b128 v[76:79], v2 offset:1024
    s_waitcnt lgkmcnt(6)
    v_smfmac_f32_16x16x64_bf16 v[8:11], v[52:55], a[16:23], v1
    v_smfmac_f32_16x16x64_bf16 v[24:27], v[52:55], v[80:87], v1
    ds_read_b128 v[80:83], v3 offset:16384
    ds_read_b128 v[84:87], v3 offset:17408
    v_smfmac_f32_16x16x64_bf16 v[16:19], v[52:55], a[160:167], v1
    v_smfmac_f32_16x16x64_bf16 v[12:15], v[52:55], a[24:31], v1
    s_waitcnt lgkmcnt(4)
    s_nop 0
    v_smfmac_f32_16x16x64_bf16 v[28:31], v[52:55], v[88:95], v1
    ds_read_b128 v[88:91], v2 offset:2048
    ds_read_b128 v[92:95], v2 offset:3072
    v_smfmac_f32_16x16x64_bf16 v[20:23], v[52:55], a[168:175], v1
    v_smfmac_f32_16x16x64_bf16 v[8:11], v[48:51], a[0:7], v1
    s_waitcnt lgkmcnt(4)
    v_smfmac_f32_16x16x64_bf16 v[24:27], v[48:51], v[72:79], v1
    ds_read_b128 v[72:75], v3 offset:18432
    ds_read_b128 v[76:79], v3 offset:19456
    s_waitcnt lgkmcnt(4)
    v_smfmac_f32_16x16x64_bf16 v[16:19], v[48:51], v[80:87], v1
    ds_read_b128 v[80:83], v2 offset:49152
    ds_read_b128 v[84:87], v2 offset:50176
    v_smfmac_f32_16x16x64_bf16 v[12:15], v[48:51], a[8:15], v1
    s_waitcnt lgkmcnt(4)
    v_smfmac_f32_16x16x64_bf16 v[28:31], v[48:51], v[88:95], v1
    ds_read_b128 v[88:91], v2 offset:51200
    ds_read_b128 v[92:95], v2 offset:52224
    s_waitcnt vmcnt(0)
ch_w2s_grem_chk:
    ds_write_b128 v0, v[40:43] offset:10240
    ds_write_b128 v0, v[64:67] offset:4096
    v_max3_u32 v68, v40, v41, v42
    v_max3_u32 v68, v68, v43, v64
    v_max3_u32 v68, v68, v65, v66
    v_max_u32_e64 v68, v68, v67
    v_cmp_eq_u32_e64 vcc, -1, v68
    s_cbranch_vccnz ch_w2s_grem
    s_waitcnt lgkmcnt(6)
    v_smfmac_f32_16x16x64_bf16 v[20:23], v[48:51], v[72:79], v1
    ds_read_b128 v[72:75], v3 offset:0
    ds_read_b128 v[76:79], v3 offset:1024
    v_smfmac_f32_16x16x64_bf16 v[8:11], v[60:63], a[48:55], v1
    global_load_dwordx4 v[32:35], v0, s[30:31] offset:-2048 sc1
    global_load_dwordx4 v[36:39], v0, s[30:31] offset:2048 sc1
    s_waitcnt lgkmcnt(6)
    v_smfmac_f32_16x16x64_bf16 v[24:27], v[60:63], v[80:87], v1
    ds_read_b128 v[80:83], v3 offset:49152
    ds_read_b128 v[84:87], v3 offset:50176
    v_smfmac_f32_16x16x64_bf16 v[16:19], v[60:63], a[176:183], v1
    global_load_dwordx4 v[40:43], v0, s[32:33] offset:0 sc1
    s_nop 0
    v_smfmac_f32_16x16x64_bf16 v[12:15], v[60:63], a[56:63], v1
    global_load_dwordx4 v[44:47], v0, s[32:33] offset:1024 sc1
    s_waitcnt lgkmcnt(4)
    s_barrier
    ds_read_b128 v[56:59], v0 offset:10240
    ds_read_b128 v[52:55], v0 offset:9216
    ds_read_b128 v[48:51], v0 offset:8192
    v_smfmac_f32_16x16x64_bf16 v[28:31], v[60:63], v[88:95], v1
    ds_read_b128 v[88:91], v3 offset:2048
    ds_read_b128 v[92:95], v3 offset:3072
    v_smfmac_f32_16x16x64_bf16 v[20:23], v[60:63], a[184:191], v1
    v_smfmac_f32_16x16x64_bf16 v[8:11], v[64:67], a[64:71], v1
    ds_read_b128 v[60:63], v0 offset:11264
    s_waitcnt lgkmcnt(8)
    v_smfmac_f32_16x16x64_bf16 v[24:27], v[64:67], v[72:79], v1
    ds_read_b128 v[72:75], v3 offset:51200
    ds_read_b128 v[76:79], v3 offset:52224
    s_waitcnt lgkmcnt(8)
    v_smfmac_f32_16x16x64_bf16 v[16:19], v[64:67], v[80:87], v1
    v_smfmac_f32_16x16x64_bf16 v[12:15], v[64:67], a[72:79], v1
    s_waitcnt lgkmcnt(3)
    v_smfmac_f32_16x16x64_bf16 v[28:31], v[64:67], v[88:95], v1
    s_waitcnt lgkmcnt(0)
    s_nop 0
    v_smfmac_f32_16x16x64_bf16 v[20:23], v[64:67], v[72:79], v1
    ds_read_b128 v[64:67], v0 offset:12288
    s_nop 0
    v_smfmac_f32_16x16x64_bf16 v[8:11], v[56:59], a[112:119], v1
    v_lshlrev_b32 v68, 3, v0
    s_mov_b32 m0, 7168
    v_smfmac_f32_16x16x64_bf16 v[12:15], v[56:59], a[120:127], v1
    s_add_u32 s74, s30, 520192
    s_addc_u32 s75, s31, 0
    global_load_lds_dword v68, s[74:75] sc1
    v_smfmac_f32_16x16x64_bf16 v[8:11], v[52:55], a[96:103], v1
    s_nop 0
    s_max_u32 s23, s22, 1
    v_smfmac_f32_16x16x64_bf16 v[12:15], v[52:55], a[104:111], v1
    s_sub_u32 s23, s23, 1
    v_mov_b32 v69, s23
    v_smfmac_f32_16x16x64_bf16 v[8:11], v[48:51], a[80:87], v1
    v_lshrrev_b32 v68, 1, v0
    s_add_u32 s22, s22, 1
    v_smfmac_f32_16x16x64_bf16 v[12:15], v[48:51], a[88:95], v1
    s_and_b32 s23, s22, 3
    s_lshl_b32 s23, s23, 13
    v_smfmac_f32_16x16x64_bf16 v[8:11], v[60:63], a[128:135], v1
    s_add_u32 s24, s23, 2048
    s_add_u32 s54, s40, s24
    s_addc_u32 s55, s41, 0
    v_smfmac_f32_16x16x64_bf16 v[12:15], v[60:63], a[136:143], v1
    s_lshl_b32 s23, s23, 2
    s_add_u32 s56, s44, s23
    s_addc_u32 s57, s45, 0
    s_waitcnt lgkmcnt(0)
    v_smfmac_f32_16x16x64_bf16 v[8:11], v[64:67], a[144:151], v1
    s_mov_b64 vcc, s[66:67]
    v_smfmac_f32_16x16x64_bf16 v[12:15], v[64:67], a[152:159], v1
    v_smfmac_f32_16x16x64_bf16 v[16:19], v[48:51], a[192:199], v1
    s_nop 2
    v_smfmac_f32_16x16x64_bf16 v[20:23], v[48:51], a[200:207], v1
    s_nop 1
    v_add_f32 v8, v8, v10
    v_add_f32 v9, v9, v11
    v_smfmac_f32_16x16x64_bf16 v[16:19], v[52:55], a[208:215], v1
    v_add_f32 v12, v12, v14
    v_add_f32_e64 v13, v13, v15
    v_cvt_pk_bf16_f32 v8, v8, v9
    v_cvt_pk_bf16_f32 v9, v12, v13
    ds_write2st64_b32 v4, v8, v9 offset0:24 offset1:25
    ds_read_b64_tr_b16 v[80:81], v5 offset:6144
    ds_read_b64_tr_b16 v[82:83], v5 offset:6400
    v_smfmac_f32_16x16x64_bf16 v[20:23], v[52:55], a[216:223], v1
    v_mov_b32 v88, 0x3f803f80
    v_smfmac_f32_16x16x64_bf16 v[16:19], v[56:59], a[224:231], v1
    v_mov_b32 v89, 0x3f803f80
    v_smfmac_f32_16x16x64_bf16 v[20:23], v[56:59], a[232:239], v1
    v_mov_b32 v90, 0x3f803f80
    v_smfmac_f32_16x16x64_bf16 v[16:19], v[60:63], a[240:247], v1
    v_mov_b32 v91, 0x3f803f80
    v_smfmac_f32_16x16x64_bf16 v[20:23], v[60:63], a[248:255], v1
    s_mov_b64 exec, s[6:7]
    global_store_dwordx2 v68, v[70:71], s[36:37] offset:1024 sc1
    s_mov_b64 exec, -1
    v_smfmac_f32_16x16x64_bf16 v[16:19], v[64:67], v[96:103], v1
    s_mov_b64 exec, 1
    global_store_dword v0, v69, s[8:9] sc1
    s_mov_b64 exec, -1
    v_smfmac_f32_16x16x64_bf16 v[20:23], v[64:67], v[104:111], v1
    s_waitcnt lgkmcnt(0)
    s_waitcnt vmcnt(5)
    v_mfma_f32_16x16x32_bf16 v[8:11], v[32:35], v[80:83], 0
    s_nop 1
    v_mfma_f32_16x16x32_bf16 v[12:15], v[36:39], v[80:83], 0
    v_add_f32 v16, v16, v18
    v_add_f32 v17, v17, v19
    v_smfmac_f32_16x16x64_bf16 v[24:27], v[48:51], v[112:119], v1
    v_add_f32 v20, v20, v22
    v_add_f32_e64 v21, v21, v23
    v_cvt_pk_bf16_f32 v16, v16, v17
    v_cvt_pk_bf16_f32 v17, v20, v21
    ds_write2st64_b32 v4, v16, v17 offset0:56 offset1:57
    v_smfmac_f32_16x16x64_bf16 v[28:31], v[48:51], v[120:127], v1
    v_cndmask_b32 v8, v8, v12, vcc
    v_cndmask_b32 v9, v9, v13, vcc
    v_cndmask_b32 v10, v10, v14, vcc
    v_cndmask_b32 v11, v11, v15, vcc
    ds_write_b128 v0, v[8:11] offset:2048
    ds_read_b64_tr_b16 v[16:17], v5 offset:14336
    ds_read_b64_tr_b16 v[18:19], v5 offset:14592
    v_smfmac_f32_16x16x64_bf16 v[24:27], v[52:55], v[128:135], v1
    s_mov_b64 vcc, s[68:69]
    v_smfmac_f32_16x16x64_bf16 v[28:31], v[52:55], v[136:143], v1
    s_nop 0
    v_smfmac_f32_16x16x64_bf16 v[24:27], v[56:59], v[144:151], v1
    v_smfmac_f32_16x16x64_bf16 v[28:31], v[56:59], v[152:159], v1
    s_waitcnt lgkmcnt(2)
    s_barrier
    ds_read_b128 v[32:35], v0 offset:0
    ds_read_b128 v[36:39], v0 offset:1024
    ds_read_b128 v[92:95], v0 offset:3072
    v_smfmac_f32_16x16x64_bf16 v[24:27], v[60:63], v[160:167], v1
    ds_read_b64_tr_b16 v[72:73], v5 offset:5120
    ds_read_b64_tr_b16 v[48:49], v5 offset:13312
    ds_read_b64_tr_b16 v[74:75], v5 offset:5376
    v_smfmac_f32_16x16x64_bf16 v[28:31], v[60:63], v[168:175], v1
    ds_read_b64_tr_b16 v[50:51], v5 offset:13568
    ds_read_b64_tr_b16 v[76:77], v5 offset:5632
    ds_read_b64_tr_b16 v[52:53], v5 offset:13824
    v_smfmac_f32_16x16x64_bf16 v[24:27], v[64:67], v[176:183], v1
    ds_read_b64_tr_b16 v[78:79], v5 offset:5888
    ds_read_b64_tr_b16 v[54:55], v5 offset:14080
    ds_read_b64_tr_b16 v[84:85], v5 offset:6656
    v_smfmac_f32_16x16x64_bf16 v[28:31], v[64:67], v[184:191], v1
    ds_read_b64_tr_b16 v[56:57], v5 offset:14848
    ds_read_b64_tr_b16 v[86:87], v5 offset:6912
    ds_read_b64_tr_b16 v[58:59], v5 offset:15104
    s_waitcnt lgkmcnt(12)
    v_mfma_f32_16x16x32_bf16 v[20:23], v[16:19], v[80:83], 0
    s_mov_b64 exec, s[6:7]
    global_store_dwordx4 v0, v[16:19], s[34:35] offset:2048 sc1
    s_mov_b64 exec, -1
    s_cmp_eq_u32 s22, 64
    s_cbranch_scc1 ch_w2s_last
    v_pk_add_f32 v[8:9], v[8:9], v[32:33]
    v_pk_add_f32 v[10:11], v[10:11], v[34:35]
    v_pk_add_f32 v[36:37], v[36:37], v[92:93]
    v_pk_add_f32 v[38:39], v[38:39], v[94:95]
    v_pk_add_f32 v[8:9], v[8:9], v[36:37]
    v_pk_add_f32 v[10:11], v[10:11], v[38:39]
    v_mul_f32 v8, s27, v8
    v_mul_f32 v9, s27, v9
    v_mul_f32 v10, s27, v10
    v_mul_f32 v11, s27, v11
    s_waitcnt lgkmcnt(0)
    v_mfma_f32_16x16x32_bf16 v[20:23], v[48:51], v[72:75], v[20:23]
    v_exp_f32_e64 v12, v8
    v_mfma_f32_16x16x32_bf16 v[20:23], v[52:55], v[76:79], v[20:23]
    v_exp_f32 v13, v9
    v_mfma_f32_16x16x32_bf16 v[20:23], v[56:59], v[84:87], v[20:23]
    v_exp_f32 v14, v10
    v_exp_f32_e64 v15, v11
    v_add_u32 v69, 147456, v0
    v_cvt_pk_bf16_f32 v94, v12, v13
    v_cvt_pk_bf16_f32 v95, v14, v15
    v_cvt_pk_bf16_f32 v92, v12, v13
    v_cvt_pk_bf16_f32 v93, v14, v15
    v_add_f32 v24, v24, v26
    v_add_f32 v25, v25, v27
    v_mov_b32_dpp v92, v94 row_shr:4 row_mask:0xf bank_mask:0xa
    v_mov_b32_dpp v93, v95 row_shr:4 row_mask:0xf bank_mask:0xa
    v_mov_b32_dpp v94, v94 row_shl:4 row_mask:0xf bank_mask:0x5
    v_mov_b32_dpp v95, v95 row_shl:4 row_mask:0xf bank_mask:0x5
    v_cndmask_b32 v18, v20, v22, vcc
    v_cndmask_b32_e64 v19, v21, v23, vcc
    s_waitcnt vmcnt(4)
    v_mfma_f32_16x16x32_bf16 v[12:15], v[88:91], v[92:95], 0
    v_mul_f32 v18, s27, v18
    v_mul_f32 v19, s27, v19
    v_mfma_f32_16x16x32_bf16 v[32:35], v[40:43], v[92:95], 0
    v_exp_f32_e64 v20, v18
    v_mfma_f32_16x16x32_bf16 v[36:39], v[44:47], v[92:95], 0
    v_exp_f32 v21, v19
    v_add_f32 v28, v28, v30
    v_add_f32 v29, v29, v31
    v_cvt_pk_bf16_f32 v26, v20, v21
    v_mov_b32 v27, 0
    v_cvt_pk_bf16_f32 v70, v24, v25
    v_cvt_pk_bf16_f32 v71, v28, v29
    v_mfma_f32_16x16x16_bf16 v[12:15], v[88:89], v[26:27], v[12:15]
    v_cvt_pk_bf16_f32 v29, v20, v21
    v_mov_b32_e64 v28, 0
    v_mfma_f32_16x16x16_bf16 v[32:35], v[70:71], v[26:27], v[32:35]
    v_max3_f32 v68, abs(v8), abs(v9), abs(v10)
    v_mfma_f32_16x16x16_bf16 v[36:39], v[70:71], v[28:29], v[36:39]
    v_max3_f32 v68, v68, abs(v11), abs(v18)
    v_max_f32 v68, v68, abs(v19)
    v_cmp_nge_f32 vcc, s29, v68
    s_cbranch_vccnz ch_w2s_slow
ch_w2s_pvm:
    v_rcp_f32_e64 v22, v12
    v_mov_b64_e64 v[40:41], 0
    v_pk_mul_f32 v[32:33], v[32:33], v[22:23] op_sel_hi:[1,0]
    v_pk_mul_f32 v[34:35], v[34:35], v[22:23] op_sel_hi:[1,0]
    v_cvt_pk_bf16_f32 v16, v32, v33
    v_pk_mul_f32 v[36:37], v[36:37], v[22:23] op_sel_hi:[1,0]
    v_cvt_pk_bf16_f32 v17, v34, v35
    v_pk_mul_f32 v[38:39], v[38:39], v[22:23] op_sel_hi:[1,0]
    v_cvt_pk_bf16_f32 v18, v36, v37
    v_cvt_pk_bf16_f32 v19, v38, v39
    ds_write_b128 v0, v[16:19] offset:10240
    v_mov_b64_e64 v[42:43], 0
    v_mov_b64_e64 v[44:45], 0
    v_mov_b64_e64 v[46:47], 0
    v_mov_b64_e64 v[8:9], 0
    v_mov_b64_e64 v[10:11], 0
    v_smfmac_f32_16x16x64_bf16 v[40:43], v[16:19], v[208:215], v1 abid:1
    v_smfmac_f32_16x16x64_bf16 v[44:47], v[16:19], v[240:247], v1 abid:1
    s_waitcnt lgkmcnt(0)
    s_barrier
    ds_read_b128 v[20:23], v0 offset:8192
    ds_read_b128 v[28:31], v0 offset:9216
    ds_read_b128 v[12:15], v0 offset:11264
    ds_read_b128 v[48:51], v69 offset:0
    ds_read_b128 v[52:55], v69 offset:1024
    ds_read_b128 v[56:59], v69 offset:2048
    ds_read_b128 v[60:63], v69 offset:3072
    ds_read_b128 v[72:75], v69 offset:4096
    ds_read_b128 v[76:79], v69 offset:5120
    ds_read_b128 v[80:83], v69 offset:6144
    ds_read_b128 v[84:87], v69 offset:7168
    s_waitcnt lgkmcnt(10)
    v_smfmac_f32_16x16x64_bf16 v[40:43], v[20:23], v[192:199], v1 abid:1
    s_waitcnt lgkmcnt(9)
    v_smfmac_f32_16x16x64_bf16 v[40:43], v[28:31], v[200:207], v1 abid:1
    s_waitcnt lgkmcnt(8)
    v_smfmac_f32_16x16x64_bf16 v[40:43], v[12:15], v[216:223], v1 abid:1
    s_nop 0
    v_smfmac_f32_16x16x64_bf16 v[44:47], v[20:23], v[224:231], v1 abid:1
    s_add_u32 s30, s30, 262144
    s_addc_u32 s31, s31, 0
    v_smfmac_f32_16x16x64_bf16 v[44:47], v[28:31], v[232:239], v1 abid:1
    s_add_u32 s32, s32, 262144
    s_addc_u32 s33, s33, 0
    v_smfmac_f32_16x16x64_bf16 v[44:47], v[12:15], v[248:255], v1 abid:1
    s_add_u32 s34, s34, 131072
    s_addc_u32 s35, s35, 0
    s_waitcnt lgkmcnt(0)
    v_smfmac_f32_16x16x64_bf16 v[8:11], v[16:19], v[72:79], v1 abid:1
    v_smfmac_f32_16x16x64_bf16 v[8:11], v[20:23], v[48:55], v1 abid:1
    v_cvt_pk_bf16_f32 v40, v40, v41
    v_cvt_pk_bf16_f32 v41, v42, v43
    v_smfmac_f32_16x16x64_bf16 v[8:11], v[28:31], v[56:63], v1 abid:1
    v_and_or_b32 v40, v40, -2, s16
    global_store_dwordx2 v6, v[40:41], s[46:47] sc1
    v_smfmac_f32_16x16x64_bf16 v[8:11], v[12:15], v[80:87], v1 abid:1
    v_cvt_pk_bf16_f32 v44, v44, v45
    v_cvt_pk_bf16_f32 v45, v46, v47
    v_and_or_b32 v44, v44, -2, s16
    global_store_dwordx2 v6, v[44:45], s[48:49] sc1
    s_nop 3
    v_cvt_pk_bf16_f32 v8, v8, v9
    v_cvt_pk_bf16_f32 v9, v10, v11
    v_and_or_b32 v8, v8, -2, s16
    global_store_dwordx2 v6, v[8:9], s[50:51] sc1
    s_add_u32 s36, s36, 131072
    s_addc_u32 s37, s37, 0
    ds_read_b128 v[72:75], v2 offset:32768
    ds_read_b128 v[76:79], v2 offset:33792
    ds_read_b128 v[80:83], v3 offset:32768
    ds_read_b128 v[84:87], v3 offset:33792
    ds_read_b128 v[88:91], v2 offset:34816
    ds_read_b128 v[92:95], v2 offset:35840
    v_mov_b64 v[8:9], 0
    v_mov_b64 v[10:11], 0
    v_mov_b64 v[12:13], 0
    v_mov_b64 v[14:15], 0
    v_mov_b64 v[16:17], 0
    v_mov_b64 v[18:19], 0
    v_mov_b64 v[20:21], 0
    v_mov_b64 v[22:23], 0
    v_mov_b64 v[24:25], 0
    v_mov_b64 v[26:27], 0
    v_mov_b64_e64 v[28:29], 0
    v_mov_b64_e64 v[30:31], 0
    s_barrier
    s_sleep 2
    s_branch ch_w2s_loop
ch_w2s_grem:
    s_mov_b64 exec, vcc
    global_load_dwordx4 v[40:43], v0, s[56:57] sc1
    global_load_dwordx4 v[64:67], v0, s[54:55] offset:2048 sc1
    s_mov_b64 exec, -1
    s_add_u32 s26, s26, 1
    s_cmp_gt_u32 s26, 1048576
    s_cbranch_scc1 ch_fail
    s_waitcnt vmcnt(0)
    s_branch ch_w2s_grem_chk
ch_w2s_last:
    s_add_u32 s36, s36, 131072
    s_addc_u32 s37, s37, 0
    s_nop 7
    v_add_f32 v24, v24, v26
    v_add_f32 v25, v25, v27
    v_add_f32 v28, v28, v30
    v_add_f32 v29, v29, v31
    v_cvt_pk_bf16_f32 v70, v24, v25
    v_cvt_pk_bf16_f32 v71, v28, v29
    s_mov_b64 exec, s[6:7]
    global_store_dwordx2 v68, v[70:71], s[36:37] offset:1024 sc1
    s_mov_b64 exec, -1
    s_branch ch_done
ch_w2s_slow:
    s_nop 7
    v_max3_f32 v68, v8, v9, v10
    v_max3_f32 v68, v68, v11, v18
    v_max_f32 v68, v68, v19
    v_mov_b32 v16, v68
    s_nop 1
    v_mov_b32_dpp v16, v68 row_shr:4 row_mask:0xf bank_mask:0xa
    s_nop 1
    v_mov_b32_dpp v16, v68 row_shl:4 row_mask:0xf bank_mask:0x5
    v_max_f32 v68, v68, v16
    v_mov_b32 v16, v68
    s_nop 1
    v_permlane16_swap_b32 v68, v16
    v_max_f32 v68, v68, v16
    v_mov_b32 v16, v68
    s_nop 1
    v_permlane32_swap_b32 v68, v16
    v_max_f32 v68, v68, v16
    v_sub_f32 v12, v8, v68
    v_exp_f32 v12, v12
    v_sub_f32 v13, v9, v68
    v_exp_f32 v13, v13
    v_sub_f32 v14, v10, v68
    v_exp_f32 v14, v14
    v_sub_f32 v15, v11, v68
    v_exp_f32 v15, v15
    v_sub_f32 v20, v18, v68
    v_exp_f32 v20, v20
    v_sub_f32 v21, v19, v68
    v_exp_f32_e64 v21, v21
    v_cvt_pk_bf16_f32 v94, v12, v13
    v_cvt_pk_bf16_f32 v95, v14, v15
    v_cvt_pk_bf16_f32 v92, v12, v13
    v_cvt_pk_bf16_f32 v93, v14, v15
    s_nop 0
    v_mov_b32_dpp v92, v94 row_shr:4 row_mask:0xf bank_mask:0xa
    v_mov_b32_dpp v93, v95 row_shr:4 row_mask:0xf bank_mask:0xa
    v_mov_b32_dpp v94, v94 row_shl:4 row_mask:0xf bank_mask:0x5
    v_mov_b32_dpp v95, v95 row_shl:4 row_mask:0xf bank_mask:0x5
    v_cvt_pk_bf16_f32 v26, v20, v21
    v_cvt_pk_bf16_f32 v29, v20, v21
    v_mfma_f32_16x16x32_bf16 v[12:15], v[88:91], v[92:95], 0
    v_mfma_f32_16x16x32_bf16 v[32:35], v[40:43], v[92:95], 0
    v_mfma_f32_16x16x32_bf16 v[36:39], v[44:47], v[92:95], 0
    v_mfma_f32_16x16x16_bf16 v[12:15], v[88:89], v[26:27], v[12:15]
    v_mfma_f32_16x16x16_bf16 v[32:35], v[70:71], v[26:27], v[32:35]
    v_mfma_f32_16x16x16_bf16 v[36:39], v[70:71], v[28:29], v[36:39]
    s_nop 7
    s_branch ch_w2s_pvm
ch_wave3:
    s_waitcnt lgkmcnt(0)
    s_barrier
    v_mov_b32 v10, 7680
    ds_read_b32 v10, v10
    s_waitcnt lgkmcnt(0)
    v_readfirstlane_b32 s23, v10
    s_bitcmp1_b32 s23, 0
    s_cbranch_scc1 wk_restart
    s_and_b32 s23, s23, 0x6800
    s_xor_b32 s23, s23, 0
    s_cmp_eq_u32 s17, 2
    s_cselect_b32 s23, 0, s23
    s_xor_b32 s24, s23, 2048
    s_add_u32 s42, s44, s24
    s_addc_u32 s43, s45, 0
    s_add_u32 s24, s23, 5120
    s_add_u32 s44, s44, s24
    s_addc_u32 s45, s45, 0
    s_mov_b32 s22, 0
    s_cmp_eq_u32 s21, 0
    s_cselect_b32 s6, -1, 0
    s_cselect_b32 s7, 0, -1
    s_and_b32 s23, s20, 4
    s_and_b32 s24, s20, 1
    s_lshl_b32 s24, s24, 1
    s_add_u32 s23, s23, s24
    s_bfe_u32 s24, s20, 0x10001
    s_add_u32 s23, s23, s24
    s_lshl_b32 s23, s23, 3
    s_mov_b64 s[4:5], 0xff
    s_lshl_b64 s[4:5], s[4:5], s23
    s_lshr_b32 s23, s20, 3
    s_cmp_eq_u32 s23, 3
    s_cselect_b64 s[4:5], s[4:5], 0
    s_and_b32 s23, s22, 3
    s_lshl_b32 s23, s23, 13
    s_add_u32 s24, s23, 2048
    s_add_u32 s54, s40, s24
    s_addc_u32 s55, s41, 0
    s_lshl_b32 s23, s23, 2
    s_add_u32 s56, s44, s23
    s_addc_u32 s57, s45, 0
    s_add_u32 s60, s42, s23
    s_addc_u32 s61, s43, 0
    s_add_u32 s46, s38, 98304
    s_addc_u32 s47, s39, 0
    s_add_u32 s48, s38, 114688
    s_addc_u32 s49, s39, 0
    s_add_u32 s50, s38, 147456
    s_addc_u32 s51, s39, 0
    s_add_u32 s52, s38, s73
    s_addc_u32 s53, s39, 0
    s_lshl_b32 s23, s21, 5
    s_add_u32 s23, s23, s20
    s_lshl_b32 s23, s23, 7
    s_add_u32 s23, s23, 103817216
    s_add_u32 s8, s14, s23
    s_addc_u32 s9, s15, 0
    s_cmp_eq_u32 s17, 2
    s_cbranch_scc1 ch_slowmode3
    v_lshlrev_b32 v68, 3, v0
    s_mov_b32 m0, 7168
    s_add_u32 s74, s32, 262144
    s_addc_u32 s75, s33, 0
    s_sub_u32 s74, s74, 4096
    s_subb_u32 s75, s75, 0
    global_load_lds_dword v68, s[74:75] sc1
    ds_read_b128 v[72:75], v2 offset:49152
    ds_read_b128 v[76:79], v2 offset:50176
    ds_read_b128 v[80:83], v2 offset:51200
    ds_read_b128 v[84:87], v2 offset:52224
    ds_read_b128 v[88:91], v2 offset:0
    ds_read_b128 v[92:95], v2 offset:1024
    v_mov_b64 v[8:9], 0
    v_mov_b64 v[10:11], 0
    v_mov_b64 v[12:13], 0
    v_mov_b64 v[14:15], 0
    v_mov_b64 v[16:17], 0
    v_mov_b64 v[18:19], 0
    v_mov_b64 v[20:21], 0
    v_mov_b64 v[22:23], 0
    v_mov_b64 v[24:25], 0
    v_mov_b64 v[26:27], 0
    v_mov_b64 v[28:29], 0
    v_mov_b64 v[30:31], 0
    s_mov_b32 s26, 0
    s_branch ch_w3f_loop
.p2align 6
ch_w3f_loop:
    s_waitcnt lgkmcnt(0)
    global_load_dwordx4 v[60:63], v0, s[54:55] offset:1024 sc1
    s_nop 0
    s_sleep 1
    global_load_dwordx4 v[60:63], v0, s[54:55] offset:1024 sc1
    s_nop 0
    s_sleep 1
ch_w3f_gown:
    global_load_dwordx4 v[60:63], v0, s[54:55] offset:1024 sc1
    s_add_u32 s26, s26, 1
    s_cmp_gt_u32 s26, 1048576
    s_cbranch_scc1 ch_fail
    s_waitcnt vmcnt(2)
ch_w3f_gw:
    v_max3_u32 v68, v60, v61, v62
    v_max_u32 v68, v68, v63
    v_cmpx_eq_u32 vcc, -1, v68
    s_cbranch_execnz ch_w3f_gown
ch_w3f_gok:
    s_mov_b64 exec, -1
    ds_write_b128 v0, v[60:63] offset:3072
    s_nop 0
    v_smfmac_f32_16x16x64_bf16 v[8:11], v[60:63], a[48:55], v1
    s_nop 0
    v_smfmac_f32_16x16x64_bf16 v[24:27], v[60:63], v[72:79], v1
    ds_read_b128 v[72:75], v3 offset:16384
    ds_read_b128 v[76:79], v3 offset:17408
    global_load_dwordx4 v[40:43], v0, s[56:57] sc1
    v_smfmac_f32_16x16x64_bf16 v[16:19], v[60:63], a[176:183], v1
    s_waitcnt lgkmcnt(2)
    s_barrier
    ds_read_b128 v[48:51], v0 offset:0
    ds_read_b128 v[52:55], v0 offset:1024
    ds_read_b128 v[56:59], v0 offset:2048
    v_smfmac_f32_16x16x64_bf16 v[12:15], v[60:63], a[56:63], v1
    global_load_dwordx4 v[44:47], v0, s[60:61] sc1
    v_smfmac_f32_16x16x64_bf16 v[28:31], v[60:63], v[80:87], v1
    ds_read_b128 v[80:83], v2 offset:2048
    ds_read_b128 v[84:87], v2 offset:3072
    v_smfmac_f32_16x16x64_bf16 v[20:23], v[60:63], a[184:191], v1
    s_and_b32 s16, s22, 1
    s_waitcnt lgkmcnt(4)
    v_smfmac_f32_16x16x64_bf16 v[8:11], v[48:51], a[0:7], v1
    v_smfmac_f32_16x16x64_bf16 v[24:27], v[48:51], v[88:95], v1
    ds_read_b128 v[88:91], v3 offset:18432
    ds_read_b128 v[92:95], v3 offset:19456
    v_smfmac_f32_16x16x64_bf16 v[16:19], v[48:51], v[72:79], v1
    ds_read_b128 v[72:75], v2 offset:16384
    ds_read_b128 v[76:79], v2 offset:17408
    v_smfmac_f32_16x16x64_bf16 v[12:15], v[48:51], a[8:15], v1
    s_waitcnt lgkmcnt(4)
    v_smfmac_f32_16x16x64_bf16 v[28:31], v[48:51], v[80:87], v1
    ds_read_b128 v[80:83], v2 offset:18432
    ds_read_b128 v[84:87], v2 offset:19456
    s_waitcnt lgkmcnt(4)
    v_smfmac_f32_16x16x64_bf16 v[20:23], v[48:51], v[88:95], v1
    ds_read_b128 v[88:91], v2 offset:32768
    ds_read_b128 v[92:95], v2 offset:33792
    v_smfmac_f32_16x16x64_bf16 v[8:11], v[52:55], a[16:23], v1
    s_waitcnt lgkmcnt(4)
    s_nop 0
    v_smfmac_f32_16x16x64_bf16 v[24:27], v[52:55], v[72:79], v1
    ds_read_b128 v[72:75], v3 offset:32768
    ds_read_b128 v[76:79], v3 offset:33792
    v_smfmac_f32_16x16x64_bf16 v[16:19], v[52:55], a[160:167], v1
    v_smfmac_f32_16x16x64_bf16 v[12:15], v[52:55], a[24:31], v1
    s_waitcnt lgkmcnt(4)
    v_smfmac_f32_16x16x64_bf16 v[28:31], v[52:55], v[80:87], v1
    ds_read_b128 v[80:83], v2 offset:34816
    ds_read_b128 v[84:87], v2 offset:35840
    s_waitcnt vmcnt(1)
ch_w3f_grem_chk:
    ds_write_b128 v0, v[40:43] offset:11264
    v_max3_u32 v68, v40, v41, v42
    v_max_u32_e64 v68, v68, v43
    v_cmp_eq_u32_e64 vcc, -1, v68
    s_cbranch_vccnz ch_w3f_grem
    v_smfmac_f32_16x16x64_bf16 v[20:23], v[52:55], a[168:175], v1
    global_load_dwordx4 v[32:35], v0, s[30:31] offset:-1024 sc1
    global_load_dwordx4 v[36:39], v0, s[30:31] offset:3072 sc1
    s_waitcnt vmcnt(2)
ch_w3f_gre4_chk:
    ds_write_b128 v0, v[44:47] offset:12288
    v_max3_u32 v68, v44, v45, v46
    v_max_u32_e64 v68, v68, v47
    v_cmp_eq_u32_e64 vcc, -1, v68
    s_cbranch_vccnz ch_w3f_gre4
    v_smfmac_f32_16x16x64_bf16 v[8:11], v[56:59], a[32:39], v1
    global_load_dwordx4 v[44:47], v0, s[32:33] offset:3072 sc1
    s_waitcnt lgkmcnt(6)
    v_smfmac_f32_16x16x64_bf16 v[24:27], v[56:59], v[88:95], v1
    ds_read_b128 v[88:91], v3 offset:34816
    ds_read_b128 v[92:95], v3 offset:35840
    s_waitcnt lgkmcnt(6)
    v_smfmac_f32_16x16x64_bf16 v[16:19], v[56:59], v[72:79], v1
    ds_read_b128 v[72:75], v3 offset:0
    ds_read_b128 v[76:79], v3 offset:1024
    v_smfmac_f32_16x16x64_bf16 v[12:15], v[56:59], a[40:47], v1
    global_load_dwordx4 v[40:43], v0, s[32:33] offset:2048 sc1
    s_waitcnt lgkmcnt(4)
    s_nop 0
    s_barrier
    ds_read_b128 v[64:67], v0 offset:4096
    ds_read_b128 v[60:63], v0 offset:11264
    ds_read_b128 v[48:51], v0 offset:8192
    ds_read_b128 v[52:55], v0 offset:9216
    v_smfmac_f32_16x16x64_bf16 v[28:31], v[56:59], v[80:87], v1
    ds_read_b128 v[80:83], v3 offset:49152
    ds_read_b128 v[84:87], v3 offset:50176
    s_waitcnt lgkmcnt(8)
    v_smfmac_f32_16x16x64_bf16 v[20:23], v[56:59], v[88:95], v1
    ds_read_b128 v[88:91], v3 offset:2048
    ds_read_b128 v[92:95], v3 offset:3072
    s_waitcnt lgkmcnt(7)
    v_smfmac_f32_16x16x64_bf16 v[8:11], v[64:67], a[64:71], v1
    ds_read_b128 v[56:59], v0 offset:10240
    v_smfmac_f32_16x16x64_bf16 v[24:27], v[64:67], v[72:79], v1
    ds_read_b128 v[72:75], v3 offset:51200
    ds_read_b128 v[76:79], v3 offset:52224
    s_waitcnt lgkmcnt(5)
    v_smfmac_f32_16x16x64_bf16 v[16:19], v[64:67], v[80:87], v1
    v_smfmac_f32_16x16x64_bf16 v[12:15], v[64:67], a[72:79], v1
    s_waitcnt lgkmcnt(3)
    v_smfmac_f32_16x16x64_bf16 v[28:31], v[64:67], v[88:95], v1
    s_waitcnt lgkmcnt(0)
    s_nop 0
    v_smfmac_f32_16x16x64_bf16 v[20:23], v[64:67], v[72:79], v1
    ds_read_b128 v[64:67], v0 offset:12288
    v_smfmac_f32_16x16x64_bf16 v[8:11], v[60:63], a[128:135], v1
    v_lshlrev_b32_e64 v68, 3, v0
    s_mov_b32 m0, 7168
    v_smfmac_f32_16x16x64_bf16 v[12:15], v[60:63], a[136:143], v1
    s_add_u32 s74, s32, 520192
    s_addc_u32 s75, s33, 0
    global_load_lds_dword v68, s[74:75] sc1
    v_smfmac_f32_16x16x64_bf16 v[8:11], v[48:51], a[80:87], v1
    s_nop 0
    v_lshrrev_b32_e64 v68, 1, v0
    v_smfmac_f32_16x16x64_bf16 v[12:15], v[48:51], a[88:95], v1
    s_add_u32 s22, s22, 1
    s_and_b32 s23, s22, 3
    v_smfmac_f32_16x16x64_bf16 v[8:11], v[52:55], a[96:103], v1
    s_lshl_b32 s23, s23, 13
    s_add_u32 s24, s23, 2048
    v_smfmac_f32_16x16x64_bf16 v[12:15], v[52:55], a[104:111], v1
    s_add_u32 s54, s40, s24
    s_addc_u32 s55, s41, 0
    s_lshl_b32 s23, s23, 2
    v_smfmac_f32_16x16x64_bf16 v[8:11], v[56:59], a[112:119], v1
    s_add_u32 s56, s44, s23
    s_addc_u32 s57, s45, 0
    s_add_u32 s60, s42, s23
    s_addc_u32 s61, s43, 0
    v_smfmac_f32_16x16x64_bf16 v[12:15], v[56:59], a[120:127], v1
    s_mov_b64 vcc, s[66:67]
    s_waitcnt lgkmcnt(0)
    v_smfmac_f32_16x16x64_bf16 v[8:11], v[64:67], a[144:151], v1
    v_smfmac_f32_16x16x64_bf16 v[12:15], v[64:67], a[152:159], v1
    v_smfmac_f32_16x16x64_bf16 v[16:19], v[48:51], a[192:199], v1
    s_nop 2
    v_smfmac_f32_16x16x64_bf16 v[20:23], v[48:51], a[200:207], v1
    s_nop 1
    v_add_f32 v8, v8, v10
    v_add_f32 v9, v9, v11
    v_smfmac_f32_16x16x64_bf16 v[16:19], v[52:55], a[208:215], v1
    v_add_f32_e64 v12, v12, v14
    v_add_f32_e64 v13, v13, v15
    v_cvt_pk_bf16_f32 v8, v8, v9
    v_cvt_pk_bf16_f32 v9, v12, v13
    ds_write2st64_b32 v4, v8, v9 offset0:26 offset1:27
    ds_read_b64_tr_b16 v[84:85], v5 offset:6656
    ds_read_b64_tr_b16 v[86:87], v5 offset:6912
    v_smfmac_f32_16x16x64_bf16 v[20:23], v[52:55], a[216:223], v1
    v_mov_b32 v88, 0x3f803f80
    v_smfmac_f32_16x16x64_bf16 v[16:19], v[56:59], a[224:231], v1
    v_mov_b32 v89, 0x3f803f80
    v_smfmac_f32_16x16x64_bf16 v[20:23], v[56:59], a[232:239], v1
    v_mov_b32 v90, 0x3f803f80
    v_smfmac_f32_16x16x64_bf16 v[16:19], v[60:63], a[240:247], v1
    v_mov_b32 v91, 0x3f803f80
    v_smfmac_f32_16x16x64_bf16 v[20:23], v[60:63], a[248:255], v1
    s_mov_b64 exec, s[6:7]
    global_store_dwordx2 v68, v[70:71], s[36:37] offset:1536 sc1
    s_mov_b64 exec, -1
    v_smfmac_f32_16x16x64_bf16 v[16:19], v[64:67], v[96:103], v1
    v_smfmac_f32_16x16x64_bf16 v[20:23], v[64:67], v[104:111], v1
    s_waitcnt lgkmcnt(0)
    s_waitcnt vmcnt(4)
    v_mfma_f32_16x16x32_bf16 v[8:11], v[32:35], v[84:87], 0
    s_nop 1
    v_mfma_f32_16x16x32_bf16 v[12:15], v[36:39], v[84:87], 0
    s_nop 0
    v_add_f32 v16, v16, v18
    v_add_f32 v17, v17, v19
    v_smfmac_f32_16x16x64_bf16 v[24:27], v[48:51], v[112:119], v1
    v_add_f32 v20, v20, v22
    v_add_f32 v21, v21, v23
    v_cvt_pk_bf16_f32 v16, v16, v17
    v_cvt_pk_bf16_f32 v17, v20, v21
    ds_write2st64_b32 v4, v16, v17 offset0:58 offset1:59
    v_smfmac_f32_16x16x64_bf16 v[28:31], v[48:51], v[120:127], v1
    v_cndmask_b32 v8, v8, v12, vcc
    v_cndmask_b32 v9, v9, v13, vcc
    v_cndmask_b32 v10, v10, v14, vcc
    v_cndmask_b32 v11, v11, v15, vcc
    ds_write_b128 v0, v[8:11] offset:3072
    ds_read_b64_tr_b16 v[16:17], v5 offset:14848
    ds_read_b64_tr_b16 v[18:19], v5 offset:15104
    v_smfmac_f32_16x16x64_bf16 v[24:27], v[52:55], v[128:135], v1
    s_mov_b64 vcc, s[68:69]
    v_smfmac_f32_16x16x64_bf16 v[28:31], v[52:55], v[136:143], v1
    s_nop 0
    v_smfmac_f32_16x16x64_bf16 v[24:27], v[56:59], v[144:151], v1
    v_smfmac_f32_16x16x64_bf16 v[28:31], v[56:59], v[152:159], v1
    s_waitcnt lgkmcnt(2)
    s_barrier
    ds_read_b128 v[32:35], v0 offset:0
    ds_read_b128 v[36:39], v0 offset:1024
    ds_read_b128 v[92:95], v0 offset:2048
    v_smfmac_f32_16x16x64_bf16 v[24:27], v[60:63], v[160:167], v1
    ds_read_b64_tr_b16 v[72:73], v5 offset:5120
    ds_read_b64_tr_b16 v[48:49], v5 offset:13312
    ds_read_b64_tr_b16 v[74:75], v5 offset:5376
    v_smfmac_f32_16x16x64_bf16 v[28:31], v[60:63], v[168:175], v1
    ds_read_b64_tr_b16 v[50:51], v5 offset:13568
    ds_read_b64_tr_b16 v[76:77], v5 offset:5632
    ds_read_b64_tr_b16 v[52:53], v5 offset:13824
    v_smfmac_f32_16x16x64_bf16 v[24:27], v[64:67], v[176:183], v1
    ds_read_b64_tr_b16 v[78:79], v5 offset:5888
    ds_read_b64_tr_b16 v[54:55], v5 offset:14080
    ds_read_b64_tr_b16 v[80:81], v5 offset:6144
    v_smfmac_f32_16x16x64_bf16 v[28:31], v[64:67], v[184:191], v1
    ds_read_b64_tr_b16 v[56:57], v5 offset:14336
    ds_read_b64_tr_b16 v[82:83], v5 offset:6400
    ds_read_b64_tr_b16 v[58:59], v5 offset:14592
    s_waitcnt lgkmcnt(12)
    v_mfma_f32_16x16x32_bf16 v[20:23], v[16:19], v[84:87], 0
    s_mov_b64 exec, s[6:7]
    global_store_dwordx4 v0, v[16:19], s[34:35] offset:3072 sc1
    s_mov_b64 exec, -1
    s_cmp_eq_u32 s22, 64
    s_cbranch_scc1 ch_w3f_last
    v_pk_add_f32 v[8:9], v[8:9], v[32:33]
    v_pk_add_f32 v[10:11], v[10:11], v[34:35]
    v_pk_add_f32 v[36:37], v[36:37], v[92:93]
    v_pk_add_f32 v[38:39], v[38:39], v[94:95]
    v_pk_add_f32 v[8:9], v[8:9], v[36:37]
    v_pk_add_f32 v[10:11], v[10:11], v[38:39]
    v_mul_f32 v8, s27, v8
    v_mul_f32 v9, s27, v9
    v_mul_f32 v10, s27, v10
    v_mul_f32 v11, s27, v11
    s_waitcnt lgkmcnt(0)
    v_mfma_f32_16x16x32_bf16 v[20:23], v[48:51], v[72:75], v[20:23]
    v_exp_f32_e64 v12, v8
    v_mfma_f32_16x16x32_bf16 v[20:23], v[52:55], v[76:79], v[20:23]
    v_exp_f32 v13, v9
    v_mfma_f32_16x16x32_bf16 v[20:23], v[56:59], v[80:83], v[20:23]
    v_exp_f32 v14, v10
    v_exp_f32_e64 v15, v11
    v_add_u32 v69, 155648, v0
    v_cvt_pk_bf16_f32 v94, v12, v13
    v_cvt_pk_bf16_f32 v95, v14, v15
    v_cvt_pk_bf16_f32 v92, v12, v13
    v_cvt_pk_bf16_f32 v93, v14, v15
    v_add_f32 v24, v24, v26
    v_add_f32 v25, v25, v27
    v_mov_b32_dpp v92, v94 row_shr:4 row_mask:0xf bank_mask:0xa
    v_mov_b32_dpp v93, v95 row_shr:4 row_mask:0xf bank_mask:0xa
    v_mov_b32_dpp v94, v94 row_shl:4 row_mask:0xf bank_mask:0x5
    v_mov_b32_dpp v95, v95 row_shl:4 row_mask:0xf bank_mask:0x5
    v_cndmask_b32 v18, v20, v22, vcc
    v_cndmask_b32_e64 v19, v21, v23, vcc
    s_waitcnt vmcnt(3)
    v_mfma_f32_16x16x32_bf16 v[12:15], v[88:91], v[92:95], 0
    v_mul_f32 v18, s27, v18
    v_mul_f32 v19, s27, v19
    v_mfma_f32_16x16x32_bf16 v[32:35], v[40:43], v[92:95], 0
    v_exp_f32_e64 v20, v18
    v_mfma_f32_16x16x32_bf16 v[36:39], v[44:47], v[92:95], 0
    v_exp_f32 v21, v19
    v_add_f32 v28, v28, v30
    v_add_f32 v29, v29, v31
    v_cvt_pk_bf16_f32 v26, v20, v21
    v_mov_b32 v27, 0
    v_cvt_pk_bf16_f32 v70, v24, v25
    v_cvt_pk_bf16_f32 v71, v28, v29
    v_mfma_f32_16x16x16_bf16 v[12:15], v[88:89], v[26:27], v[12:15]
    v_cvt_pk_bf16_f32 v29, v20, v21
    v_mov_b32_e64 v28, 0
    v_mfma_f32_16x16x16_bf16 v[32:35], v[70:71], v[26:27], v[32:35]
    v_max3_f32 v68, abs(v8), abs(v9), abs(v10)
    v_mfma_f32_16x16x16_bf16 v[36:39], v[70:71], v[28:29], v[36:39]
    v_max3_f32 v68, v68, abs(v11), abs(v18)
    v_max_f32 v68, v68, abs(v19)
    v_cmp_nge_f32 vcc, s29, v68
    s_cbranch_vccnz ch_w3f_slow
ch_w3f_pvm:
    v_rcp_f32_e64 v22, v12
    v_mov_b64_e64 v[40:41], 0
    v_pk_mul_f32 v[32:33], v[32:33], v[22:23] op_sel_hi:[1,0]
    v_pk_mul_f32 v[34:35], v[34:35], v[22:23] op_sel_hi:[1,0]
    v_cvt_pk_bf16_f32 v16, v32, v33
    v_pk_mul_f32 v[36:37], v[36:37], v[22:23] op_sel_hi:[1,0]
    v_cvt_pk_bf16_f32 v17, v34, v35
    v_pk_mul_f32 v[38:39], v[38:39], v[22:23] op_sel_hi:[1,0]
    v_cvt_pk_bf16_f32 v18, v36, v37
    v_cvt_pk_bf16_f32 v19, v38, v39
    ds_write_b128 v0, v[16:19] offset:11264
    v_mov_b64_e64 v[42:43], 0
    v_mov_b64_e64 v[44:45], 0
    v_mov_b64_e64 v[46:47], 0
    v_mov_b64_e64 v[8:9], 0
    v_mov_b64_e64 v[10:11], 0
    v_smfmac_f32_16x16x64_bf16 v[40:43], v[16:19], v[216:223], v1 abid:1
    v_smfmac_f32_16x16x64_bf16 v[44:47], v[16:19], v[248:255], v1 abid:1
    s_waitcnt lgkmcnt(0)
    s_barrier
    ds_read_b128 v[20:23], v0 offset:8192
    ds_read_b128 v[28:31], v0 offset:9216
    ds_read_b128 v[12:15], v0 offset:10240
    ds_read_b128 v[48:51], v69 offset:0
    ds_read_b128 v[52:55], v69 offset:1024
    ds_read_b128 v[56:59], v69 offset:2048
    ds_read_b128 v[60:63], v69 offset:3072
    ds_read_b128 v[72:75], v69 offset:4096
    ds_read_b128 v[76:79], v69 offset:5120
    ds_read_b128 v[80:83], v69 offset:6144
    ds_read_b128 v[84:87], v69 offset:7168
    s_waitcnt lgkmcnt(10)
    v_smfmac_f32_16x16x64_bf16 v[40:43], v[20:23], v[192:199], v1 abid:1
    s_waitcnt lgkmcnt(9)
    v_smfmac_f32_16x16x64_bf16 v[40:43], v[28:31], v[200:207], v1 abid:1
    s_waitcnt lgkmcnt(8)
    v_smfmac_f32_16x16x64_bf16 v[40:43], v[12:15], v[208:215], v1 abid:1
    s_nop 0
    v_smfmac_f32_16x16x64_bf16 v[44:47], v[20:23], v[224:231], v1 abid:1
    s_add_u32 s30, s30, 262144
    s_addc_u32 s31, s31, 0
    v_smfmac_f32_16x16x64_bf16 v[44:47], v[28:31], v[232:239], v1 abid:1
    s_add_u32 s32, s32, 262144
    s_addc_u32 s33, s33, 0
    v_smfmac_f32_16x16x64_bf16 v[44:47], v[12:15], v[240:247], v1 abid:1
    s_add_u32 s34, s34, 131072
    s_addc_u32 s35, s35, 0
    s_waitcnt lgkmcnt(0)
    v_smfmac_f32_16x16x64_bf16 v[8:11], v[16:19], v[80:87], v1 abid:1
    v_smfmac_f32_16x16x64_bf16 v[8:11], v[20:23], v[48:55], v1 abid:1
    v_cvt_pk_bf16_f32 v40, v40, v41
    v_cvt_pk_bf16_f32 v41, v42, v43
    v_smfmac_f32_16x16x64_bf16 v[8:11], v[28:31], v[56:63], v1 abid:1
    v_and_or_b32 v40, v40, -2, s16
    global_store_dwordx2 v6, v[40:41], s[46:47]
    v_smfmac_f32_16x16x64_bf16 v[8:11], v[12:15], v[72:79], v1 abid:1
    v_cvt_pk_bf16_f32 v44, v44, v45
    v_cvt_pk_bf16_f32 v45, v46, v47
    v_and_or_b32 v44, v44, -2, s16
    global_store_dwordx2 v6, v[44:45], s[48:49]
    s_nop 3
    v_cvt_pk_bf16_f32 v8, v8, v9
    v_cvt_pk_bf16_f32 v9, v10, v11
    v_and_or_b32 v8, v8, -2, s16
    global_store_dwordx2 v6, v[8:9], s[50:51]
    s_add_u32 s36, s36, 131072
    s_addc_u32 s37, s37, 0
    ds_read_b128 v[72:75], v2 offset:49152
    ds_read_b128 v[76:79], v2 offset:50176
    ds_read_b128 v[80:83], v2 offset:51200
    ds_read_b128 v[84:87], v2 offset:52224
    ds_read_b128 v[88:91], v2 offset:0
    ds_read_b128 v[92:95], v2 offset:1024
    v_mov_b64 v[8:9], 0
    v_mov_b64 v[10:11], 0
    v_mov_b64 v[12:13], 0
    v_mov_b64 v[14:15], 0
    v_mov_b64 v[16:17], 0
    v_mov_b64 v[18:19], 0
    v_mov_b64 v[20:21], 0
    v_mov_b64 v[22:23], 0
    v_mov_b64 v[24:25], 0
    v_mov_b64 v[26:27], 0
    v_mov_b64_e64 v[28:29], 0
    v_mov_b64 v[30:31], 0
    s_add_u32 s23, s22, 2
    s_and_b32 s24, s23, 0x47
    s_cmp_eq_u32 s24, 0
    s_cbranch_scc1 ch_w3f_kvw
ch_w3f_kvok:
    s_barrier
    s_sleep 2
    s_branch ch_w3f_loop
ch_w3f_grem:
    s_mov_b64 exec, vcc
    global_load_dwordx4 v[40:43], v0, s[56:57] sc1
    s_mov_b64 exec, -1
    s_add_u32 s26, s26, 1
    s_cmp_gt_u32 s26, 1048576
    s_cbranch_scc1 ch_fail
    s_waitcnt vmcnt(0)
    s_branch ch_w3f_grem_chk
ch_w3f_gre4:
    s_mov_b64 exec, vcc
    global_load_dwordx4 v[44:47], v0, s[60:61] sc1
    s_mov_b64 exec, -1
    s_add_u32 s26, s26, 1
    s_cmp_gt_u32 s26, 1048576
    s_cbranch_scc1 ch_fail
    s_waitcnt vmcnt(0)
    s_branch ch_w3f_gre4_chk
ch_w3f_last:
    s_add_u32 s36, s36, 131072
    s_addc_u32 s37, s37, 0
    s_nop 7
    v_add_f32 v24, v24, v26
    v_add_f32_e64 v25, v25, v27
    v_add_f32_e64 v28, v28, v30
    v_add_f32_e64 v29, v29, v31
    v_cvt_pk_bf16_f32 v70, v24, v25
    v_cvt_pk_bf16_f32 v71, v28, v29
    s_mov_b64 exec, s[6:7]
    global_store_dwordx2 v68, v[70:71], s[36:37] offset:1536 sc1
    s_mov_b64 exec, -1
    s_branch ch_done
ch_w3f_kvw:
    s_lshl_b32 s23, s23, 4
    s_add_u32 s23, s23, 103810048
    v_mov_b32 v68, s23
ch_w3f_kvw2:
    global_load_dword v69, v68, s[14:15] sc1
    s_add_u32 s26, s26, 1
    s_cmp_gt_u32 s26, 1048576
    s_cbranch_scc1 ch_fail
    s_waitcnt vmcnt(0)
    v_readfirstlane_b32 s24, v69
    s_cmp_lt_u32 s24, 64
    s_cbranch_scc1 ch_w3f_kvw2
    s_branch ch_w3f_kvok
ch_w3f_slow:
    s_nop 7
    v_max3_f32 v68, v8, v9, v10
    v_max3_f32 v68, v68, v11, v18
    v_max_f32 v68, v68, v19
    v_mov_b32 v16, v68
    s_nop 1
    v_mov_b32_dpp v16, v68 row_shr:4 row_mask:0xf bank_mask:0xa
    s_nop 1
    v_mov_b32_dpp v16, v68 row_shl:4 row_mask:0xf bank_mask:0x5
    v_max_f32 v68, v68, v16
    v_mov_b32 v16, v68
    s_nop 1
    v_permlane16_swap_b32 v68, v16
    v_max_f32 v68, v68, v16
    v_mov_b32 v16, v68
    s_nop 1
    v_permlane32_swap_b32 v68, v16
    v_max_f32 v68, v68, v16
    v_sub_f32 v12, v8, v68
    v_exp_f32 v12, v12
    v_sub_f32 v13, v9, v68
    v_exp_f32 v13, v13
    v_sub_f32 v14, v10, v68
    v_exp_f32 v14, v14
    v_sub_f32 v15, v11, v68
    v_exp_f32 v15, v15
    v_sub_f32 v20, v18, v68
    v_exp_f32 v20, v20
    v_sub_f32 v21, v19, v68
    v_exp_f32_e64 v21, v21
    v_cvt_pk_bf16_f32 v94, v12, v13
    v_cvt_pk_bf16_f32 v95, v14, v15
    v_cvt_pk_bf16_f32 v92, v12, v13
    v_cvt_pk_bf16_f32 v93, v14, v15
    s_nop 0
    v_mov_b32_dpp v92, v94 row_shr:4 row_mask:0xf bank_mask:0xa
    v_mov_b32_dpp v93, v95 row_shr:4 row_mask:0xf bank_mask:0xa
    v_mov_b32_dpp v94, v94 row_shl:4 row_mask:0xf bank_mask:0x5
    v_mov_b32_dpp v95, v95 row_shl:4 row_mask:0xf bank_mask:0x5
    v_cvt_pk_bf16_f32 v26, v20, v21
    v_cvt_pk_bf16_f32 v29, v20, v21
    v_mfma_f32_16x16x32_bf16 v[12:15], v[88:91], v[92:95], 0
    v_mfma_f32_16x16x32_bf16 v[32:35], v[40:43], v[92:95], 0
    v_mfma_f32_16x16x32_bf16 v[36:39], v[44:47], v[92:95], 0
    v_mfma_f32_16x16x16_bf16 v[12:15], v[88:89], v[26:27], v[12:15]
    v_mfma_f32_16x16x16_bf16 v[32:35], v[70:71], v[26:27], v[32:35]
    v_mfma_f32_16x16x16_bf16 v[36:39], v[70:71], v[28:29], v[36:39]
    s_nop 7
    s_branch ch_w3f_pvm
ch_slowmode3:
    v_lshlrev_b32 v68, 3, v0
    s_mov_b32 m0, 7168
    s_add_u32 s74, s32, 262144
    s_addc_u32 s75, s33, 0
    s_sub_u32 s74, s74, 4096
    s_subb_u32 s75, s75, 0
    global_load_lds_dword v68, s[74:75] sc1
    ds_read_b128 v[72:75], v2 offset:49152
    ds_read_b128 v[76:79], v2 offset:50176
    ds_read_b128 v[80:83], v2 offset:51200
    ds_read_b128 v[84:87], v2 offset:52224
    ds_read_b128 v[88:91], v2 offset:0
    ds_read_b128 v[92:95], v2 offset:1024
    v_mov_b64 v[8:9], 0
    v_mov_b64 v[10:11], 0
    v_mov_b64 v[12:13], 0
    v_mov_b64 v[14:15], 0
    v_mov_b64 v[16:17], 0
    v_mov_b64 v[18:19], 0
    v_mov_b64 v[20:21], 0
    v_mov_b64 v[22:23], 0
    v_mov_b64 v[24:25], 0
    v_mov_b64 v[26:27], 0
    v_mov_b64 v[28:29], 0
    v_mov_b64 v[30:31], 0
    s_mov_b32 s26, 0
    s_branch ch_w3s_loop
.p2align 6
ch_w3s_loop:
    s_waitcnt lgkmcnt(0)
    global_load_dwordx4 v[60:63], v0, s[54:55] offset:1024 sc1
    s_nop 0
    s_sleep 1
    global_load_dwordx4 v[60:63], v0, s[54:55] offset:1024 sc1
    s_nop 0
    s_sleep 1
ch_w3s_gown:
    global_load_dwordx4 v[60:63], v0, s[54:55] offset:1024 sc1
    s_add_u32 s26, s26, 1
    s_cmp_gt_u32 s26, 1048576
    s_cbranch_scc1 ch_fail
    s_waitcnt vmcnt(2)
ch_w3s_gw:
    v_max3_u32 v68, v60, v61, v62
    v_max_u32 v68, v68, v63
    v_cmpx_eq_u32 vcc, -1, v68
    s_cbranch_execnz ch_w3s_gown
ch_w3s_gok:
    s_mov_b64 exec, -1
    ds_write_b128 v0, v[60:63] offset:3072
    s_nop 0
    v_smfmac_f32_16x16x64_bf16 v[8:11], v[60:63], a[48:55], v1
    s_nop 0
    v_smfmac_f32_16x16x64_bf16 v[24:27], v[60:63], v[72:79], v1
    ds_read_b128 v[72:75], v3 offset:16384
    ds_read_b128 v[76:79], v3 offset:17408
    global_load_dwordx4 v[40:43], v0, s[56:57] sc1
    v_smfmac_f32_16x16x64_bf16 v[16:19], v[60:63], a[176:183], v1
    s_waitcnt lgkmcnt(2)
    s_barrier
    ds_read_b128 v[48:51], v0 offset:0
    ds_read_b128 v[52:55], v0 offset:1024
    ds_read_b128 v[56:59], v0 offset:2048
    v_smfmac_f32_16x16x64_bf16 v[12:15], v[60:63], a[56:63], v1
    global_load_dwordx4 v[44:47], v0, s[60:61] sc1
    v_smfmac_f32_16x16x64_bf16 v[28:31], v[60:63], v[80:87], v1
    ds_read_b128 v[80:83], v2 offset:2048
    ds_read_b128 v[84:87], v2 offset:3072
    v_smfmac_f32_16x16x64_bf16 v[20:23], v[60:63], a[184:191], v1
    s_and_b32 s16, s22, 1
    s_waitcnt lgkmcnt(4)
    v_smfmac_f32_16x16x64_bf16 v[8:11], v[48:51], a[0:7], v1
    v_smfmac_f32_16x16x64_bf16 v[24:27], v[48:51], v[88:95], v1
    ds_read_b128 v[88:91], v3 offset:18432
    ds_read_b128 v[92:95], v3 offset:19456
    v_smfmac_f32_16x16x64_bf16 v[16:19], v[48:51], v[72:79], v1
    ds_read_b128 v[72:75], v2 offset:16384
    ds_read_b128 v[76:79], v2 offset:17408
    v_smfmac_f32_16x16x64_bf16 v[12:15], v[48:51], a[8:15], v1
    s_waitcnt lgkmcnt(4)
    v_smfmac_f32_16x16x64_bf16 v[28:31], v[48:51], v[80:87], v1
    ds_read_b128 v[80:83], v2 offset:18432
    ds_read_b128 v[84:87], v2 offset:19456
    s_waitcnt lgkmcnt(4)
    v_smfmac_f32_16x16x64_bf16 v[20:23], v[48:51], v[88:95], v1
    ds_read_b128 v[88:91], v2 offset:32768
    ds_read_b128 v[92:95], v2 offset:33792
    v_smfmac_f32_16x16x64_bf16 v[8:11], v[52:55], a[16:23], v1
    s_waitcnt lgkmcnt(4)
    s_nop 0
    v_smfmac_f32_16x16x64_bf16 v[24:27], v[52:55], v[72:79], v1
    ds_read_b128 v[72:75], v3 offset:32768
    ds_read_b128 v[76:79], v3 offset:33792
    v_smfmac_f32_16x16x64_bf16 v[16:19], v[52:55], a[160:167], v1
    v_smfmac_f32_16x16x64_bf16 v[12:15], v[52:55], a[24:31], v1
    s_waitcnt lgkmcnt(4)
    v_smfmac_f32_16x16x64_bf16 v[28:31], v[52:55], v[80:87], v1
    ds_read_b128 v[80:83], v2 offset:34816
    ds_read_b128 v[84:87], v2 offset:35840
    s_waitcnt vmcnt(1)
ch_w3s_grem_chk:
    ds_write_b128 v0, v[40:43] offset:11264
    v_max3_u32 v68, v40, v41, v42
    v_max_u32_e64 v68, v68, v43
    v_cmp_eq_u32_e64 vcc, -1, v68
    s_cbranch_vccnz ch_w3s_grem
    v_smfmac_f32_16x16x64_bf16 v[20:23], v[52:55], a[168:175], v1
    global_load_dwordx4 v[32:35], v0, s[30:31] offset:-1024 sc1
    global_load_dwordx4 v[36:39], v0, s[30:31] offset:3072 sc1
    s_waitcnt vmcnt(2)
ch_w3s_gre4_chk:
    ds_write_b128 v0, v[44:47] offset:12288
    v_max3_u32 v68, v44, v45, v46
    v_max_u32_e64 v68, v68, v47
    v_cmp_eq_u32_e64 vcc, -1, v68
    s_cbranch_vccnz ch_w3s_gre4
    v_smfmac_f32_16x16x64_bf16 v[8:11], v[56:59], a[32:39], v1
    global_load_dwordx4 v[44:47], v0, s[32:33] offset:3072 sc1
    s_waitcnt lgkmcnt(6)
    v_smfmac_f32_16x16x64_bf16 v[24:27], v[56:59], v[88:95], v1
    ds_read_b128 v[88:91], v3 offset:34816
    ds_read_b128 v[92:95], v3 offset:35840
    s_waitcnt lgkmcnt(6)
    v_smfmac_f32_16x16x64_bf16 v[16:19], v[56:59], v[72:79], v1
    ds_read_b128 v[72:75], v3 offset:0
    ds_read_b128 v[76:79], v3 offset:1024
    v_smfmac_f32_16x16x64_bf16 v[12:15], v[56:59], a[40:47], v1
    global_load_dwordx4 v[40:43], v0, s[32:33] offset:2048 sc1
    s_waitcnt lgkmcnt(4)
    s_nop 0
    s_barrier
    ds_read_b128 v[64:67], v0 offset:4096
    ds_read_b128 v[60:63], v0 offset:11264
    ds_read_b128 v[48:51], v0 offset:8192
    ds_read_b128 v[52:55], v0 offset:9216
    v_smfmac_f32_16x16x64_bf16 v[28:31], v[56:59], v[80:87], v1
    ds_read_b128 v[80:83], v3 offset:49152
    ds_read_b128 v[84:87], v3 offset:50176
    s_waitcnt lgkmcnt(8)
    v_smfmac_f32_16x16x64_bf16 v[20:23], v[56:59], v[88:95], v1
    ds_read_b128 v[88:91], v3 offset:2048
    ds_read_b128 v[92:95], v3 offset:3072
    s_waitcnt lgkmcnt(7)
    v_smfmac_f32_16x16x64_bf16 v[8:11], v[64:67], a[64:71], v1
    ds_read_b128 v[56:59], v0 offset:10240
    v_smfmac_f32_16x16x64_bf16 v[24:27], v[64:67], v[72:79], v1
    ds_read_b128 v[72:75], v3 offset:51200
    ds_read_b128 v[76:79], v3 offset:52224
    s_waitcnt lgkmcnt(5)
    v_smfmac_f32_16x16x64_bf16 v[16:19], v[64:67], v[80:87], v1
    v_smfmac_f32_16x16x64_bf16 v[12:15], v[64:67], a[72:79], v1
    s_waitcnt lgkmcnt(3)
    v_smfmac_f32_16x16x64_bf16 v[28:31], v[64:67], v[88:95], v1
    s_waitcnt lgkmcnt(0)
    s_nop 0
    v_smfmac_f32_16x16x64_bf16 v[20:23], v[64:67], v[72:79], v1
    ds_read_b128 v[64:67], v0 offset:12288
    v_smfmac_f32_16x16x64_bf16 v[8:11], v[60:63], a[128:135], v1
    v_lshlrev_b32_e64 v68, 3, v0
    s_mov_b32 m0, 7168
    v_smfmac_f32_16x16x64_bf16 v[12:15], v[60:63], a[136:143], v1
    s_add_u32 s74, s32, 520192
    s_addc_u32 s75, s33, 0
    global_load_lds_dword v68, s[74:75] sc1
    v_smfmac_f32_16x16x64_bf16 v[8:11], v[48:51], a[80:87], v1
    s_nop 0
    v_lshrrev_b32_e64 v68, 1, v0
    v_smfmac_f32_16x16x64_bf16 v[12:15], v[48:51], a[88:95], v1
    s_add_u32 s22, s22, 1
    s_and_b32 s23, s22, 3
    v_smfmac_f32_16x16x64_bf16 v[8:11], v[52:55], a[96:103], v1
    s_lshl_b32 s23, s23, 13
    s_add_u32 s24, s23, 2048
    v_smfmac_f32_16x16x64_bf16 v[12:15], v[52:55], a[104:111], v1
    s_add_u32 s54, s40, s24
    s_addc_u32 s55, s41, 0
    s_lshl_b32 s23, s23, 2
    v_smfmac_f32_16x16x64_bf16 v[8:11], v[56:59], a[112:119], v1
    s_add_u32 s56, s44, s23
    s_addc_u32 s57, s45, 0
    s_add_u32 s60, s42, s23
    s_addc_u32 s61, s43, 0
    v_smfmac_f32_16x16x64_bf16 v[12:15], v[56:59], a[120:127], v1
    s_mov_b64 vcc, s[66:67]
    s_waitcnt lgkmcnt(0)
    v_smfmac_f32_16x16x64_bf16 v[8:11], v[64:67], a[144:151], v1
    v_smfmac_f32_16x16x64_bf16 v[12:15], v[64:67], a[152:159], v1
    v_smfmac_f32_16x16x64_bf16 v[16:19], v[48:51], a[192:199], v1
    s_nop 2
    v_smfmac_f32_16x16x64_bf16 v[20:23], v[48:51], a[200:207], v1
    s_nop 1
    v_add_f32 v8, v8, v10
    v_add_f32 v9, v9, v11
    v_smfmac_f32_16x16x64_bf16 v[16:19], v[52:55], a[208:215], v1
    v_add_f32_e64 v12, v12, v14
    v_add_f32_e64 v13, v13, v15
    v_cvt_pk_bf16_f32 v8, v8, v9
    v_cvt_pk_bf16_f32 v9, v12, v13
    ds_write2st64_b32 v4, v8, v9 offset0:26 offset1:27
    ds_read_b64_tr_b16 v[84:85], v5 offset:6656
    ds_read_b64_tr_b16 v[86:87], v5 offset:6912
    v_smfmac_f32_16x16x64_bf16 v[20:23], v[52:55], a[216:223], v1
    v_mov_b32 v88, 0x3f803f80
    v_smfmac_f32_16x16x64_bf16 v[16:19], v[56:59], a[224:231], v1
    v_mov_b32 v89, 0x3f803f80
    v_smfmac_f32_16x16x64_bf16 v[20:23], v[56:59], a[232:239], v1
    v_mov_b32 v90, 0x3f803f80
    v_smfmac_f32_16x16x64_bf16 v[16:19], v[60:63], a[240:247], v1
    v_mov_b32 v91, 0x3f803f80
    v_smfmac_f32_16x16x64_bf16 v[20:23], v[60:63], a[248:255], v1
    s_mov_b64 exec, s[6:7]
    global_store_dwordx2 v68, v[70:71], s[36:37] offset:1536 sc1
    s_mov_b64 exec, -1
    v_smfmac_f32_16x16x64_bf16 v[16:19], v[64:67], v[96:103], v1
    v_smfmac_f32_16x16x64_bf16 v[20:23], v[64:67], v[104:111], v1
    s_waitcnt lgkmcnt(0)
    s_waitcnt vmcnt(4)
    v_mfma_f32_16x16x32_bf16 v[8:11], v[32:35], v[84:87], 0
    s_nop 1
    v_mfma_f32_16x16x32_bf16 v[12:15], v[36:39], v[84:87], 0
    s_nop 0
    v_add_f32 v16, v16, v18
    v_add_f32 v17, v17, v19
    v_smfmac_f32_16x16x64_bf16 v[24:27], v[48:51], v[112:119], v1
    v_add_f32 v20, v20, v22
    v_add_f32 v21, v21, v23
    v_cvt_pk_bf16_f32 v16, v16, v17
    v_cvt_pk_bf16_f32 v17, v20, v21
    ds_write2st64_b32 v4, v16, v17 offset0:58 offset1:59
    v_smfmac_f32_16x16x64_bf16 v[28:31], v[48:51], v[120:127], v1
    v_cndmask_b32 v8, v8, v12, vcc
    v_cndmask_b32 v9, v9, v13, vcc
    v_cndmask_b32 v10, v10, v14, vcc
    v_cndmask_b32 v11, v11, v15, vcc
    ds_write_b128 v0, v[8:11] offset:3072
    ds_read_b64_tr_b16 v[16:17], v5 offset:14848
    ds_read_b64_tr_b16 v[18:19], v5 offset:15104
    v_smfmac_f32_16x16x64_bf16 v[24:27], v[52:55], v[128:135], v1
    s_mov_b64 vcc, s[68:69]
    v_smfmac_f32_16x16x64_bf16 v[28:31], v[52:55], v[136:143], v1
    s_nop 0
    v_smfmac_f32_16x16x64_bf16 v[24:27], v[56:59], v[144:151], v1
    v_smfmac_f32_16x16x64_bf16 v[28:31], v[56:59], v[152:159], v1
    s_waitcnt lgkmcnt(2)
    s_barrier
    ds_read_b128 v[32:35], v0 offset:0
    ds_read_b128 v[36:39], v0 offset:1024
    ds_read_b128 v[92:95], v0 offset:2048
    v_smfmac_f32_16x16x64_bf16 v[24:27], v[60:63], v[160:167], v1
    ds_read_b64_tr_b16 v[72:73], v5 offset:5120
    ds_read_b64_tr_b16 v[48:49], v5 offset:13312
    ds_read_b64_tr_b16 v[74:75], v5 offset:5376
    v_smfmac_f32_16x16x64_bf16 v[28:31], v[60:63], v[168:175], v1
    ds_read_b64_tr_b16 v[50:51], v5 offset:13568
    ds_read_b64_tr_b16 v[76:77], v5 offset:5632
    ds_read_b64_tr_b16 v[52:53], v5 offset:13824
    v_smfmac_f32_16x16x64_bf16 v[24:27], v[64:67], v[176:183], v1
    ds_read_b64_tr_b16 v[78:79], v5 offset:5888
    ds_read_b64_tr_b16 v[54:55], v5 offset:14080
    ds_read_b64_tr_b16 v[80:81], v5 offset:6144
    v_smfmac_f32_16x16x64_bf16 v[28:31], v[64:67], v[184:191], v1
    ds_read_b64_tr_b16 v[56:57], v5 offset:14336
    ds_read_b64_tr_b16 v[82:83], v5 offset:6400
    ds_read_b64_tr_b16 v[58:59], v5 offset:14592
    s_waitcnt lgkmcnt(12)
    v_mfma_f32_16x16x32_bf16 v[20:23], v[16:19], v[84:87], 0
    s_mov_b64 exec, s[6:7]
    global_store_dwordx4 v0, v[16:19], s[34:35] offset:3072 sc1
    s_mov_b64 exec, -1
    s_cmp_eq_u32 s22, 64
    s_cbranch_scc1 ch_w3s_last
    v_pk_add_f32 v[8:9], v[8:9], v[32:33]
    v_pk_add_f32 v[10:11], v[10:11], v[34:35]
    v_pk_add_f32 v[36:37], v[36:37], v[92:93]
    v_pk_add_f32 v[38:39], v[38:39], v[94:95]
    v_pk_add_f32 v[8:9], v[8:9], v[36:37]
    v_pk_add_f32 v[10:11], v[10:11], v[38:39]
    v_mul_f32 v8, s27, v8
    v_mul_f32 v9, s27, v9
    v_mul_f32 v10, s27, v10
    v_mul_f32 v11, s27, v11
    s_waitcnt lgkmcnt(0)
    v_mfma_f32_16x16x32_bf16 v[20:23], v[48:51], v[72:75], v[20:23]
    v_exp_f32_e64 v12, v8
    v_mfma_f32_16x16x32_bf16 v[20:23], v[52:55], v[76:79], v[20:23]
    v_exp_f32 v13, v9
    v_mfma_f32_16x16x32_bf16 v[20:23], v[56:59], v[80:83], v[20:23]
    v_exp_f32 v14, v10
    v_exp_f32_e64 v15, v11
    v_add_u32 v69, 155648, v0
    v_cvt_pk_bf16_f32 v94, v12, v13
    v_cvt_pk_bf16_f32 v95, v14, v15
    v_cvt_pk_bf16_f32 v92, v12, v13
    v_cvt_pk_bf16_f32 v93, v14, v15
    v_add_f32 v24, v24, v26
    v_add_f32 v25, v25, v27
    v_mov_b32_dpp v92, v94 row_shr:4 row_mask:0xf bank_mask:0xa
    v_mov_b32_dpp v93, v95 row_shr:4 row_mask:0xf bank_mask:0xa
    v_mov_b32_dpp v94, v94 row_shl:4 row_mask:0xf bank_mask:0x5
    v_mov_b32_dpp v95, v95 row_shl:4 row_mask:0xf bank_mask:0x5
    v_cndmask_b32 v18, v20, v22, vcc
    v_cndmask_b32_e64 v19, v21, v23, vcc
    s_waitcnt vmcnt(3)
    v_mfma_f32_16x16x32_bf16 v[12:15], v[88:91], v[92:95], 0
    v_mul_f32 v18, s27, v18
    v_mul_f32 v19, s27, v19
    v_mfma_f32_16x16x32_bf16 v[32:35], v[40:43], v[92:95], 0
    v_exp_f32_e64 v20, v18
    v_mfma_f32_16x16x32_bf16 v[36:39], v[44:47], v[92:95], 0
    v_exp_f32 v21, v19
    v_add_f32 v28, v28, v30
    v_add_f32 v29, v29, v31
    v_cvt_pk_bf16_f32 v26, v20, v21
    v_mov_b32 v27, 0
    v_cvt_pk_bf16_f32 v70, v24, v25
    v_cvt_pk_bf16_f32 v71, v28, v29
    v_mfma_f32_16x16x16_bf16 v[12:15], v[88:89], v[26:27], v[12:15]
    v_cvt_pk_bf16_f32 v29, v20, v21
    v_mov_b32_e64 v28, 0
    v_mfma_f32_16x16x16_bf16 v[32:35], v[70:71], v[26:27], v[32:35]
    v_max3_f32 v68, abs(v8), abs(v9), abs(v10)
    v_mfma_f32_16x16x16_bf16 v[36:39], v[70:71], v[28:29], v[36:39]
    v_max3_f32 v68, v68, abs(v11), abs(v18)
    v_max_f32 v68, v68, abs(v19)
    v_cmp_nge_f32 vcc, s29, v68
    s_cbranch_vccnz ch_w3s_slow
ch_w3s_pvm:
    v_rcp_f32_e64 v22, v12
    v_mov_b64_e64 v[40:41], 0
    v_pk_mul_f32 v[32:33], v[32:33], v[22:23] op_sel_hi:[1,0]
    v_pk_mul_f32 v[34:35], v[34:35], v[22:23] op_sel_hi:[1,0]
    v_cvt_pk_bf16_f32 v16, v32, v33
    v_pk_mul_f32 v[36:37], v[36:37], v[22:23] op_sel_hi:[1,0]
    v_cvt_pk_bf16_f32 v17, v34, v35
    v_pk_mul_f32 v[38:39], v[38:39], v[22:23] op_sel_hi:[1,0]
    v_cvt_pk_bf16_f32 v18, v36, v37
    v_cvt_pk_bf16_f32 v19, v38, v39
    ds_write_b128 v0, v[16:19] offset:11264
    v_mov_b64_e64 v[42:43], 0
    v_mov_b64_e64 v[44:45], 0
    v_mov_b64_e64 v[46:47], 0
    v_mov_b64_e64 v[8:9], 0
    v_mov_b64_e64 v[10:11], 0
    v_smfmac_f32_16x16x64_bf16 v[40:43], v[16:19], v[216:223], v1 abid:1
    v_smfmac_f32_16x16x64_bf16 v[44:47], v[16:19], v[248:255], v1 abid:1
    s_waitcnt lgkmcnt(0)
    s_barrier
    ds_read_b128 v[20:23], v0 offset:8192
    ds_read_b128 v[28:31], v0 offset:9216
    ds_read_b128 v[12:15], v0 offset:10240
    ds_read_b128 v[48:51], v69 offset:0
    ds_read_b128 v[52:55], v69 offset:1024
    ds_read_b128 v[56:59], v69 offset:2048
    ds_read_b128 v[60:63], v69 offset:3072
    ds_read_b128 v[72:75], v69 offset:4096
    ds_read_b128 v[76:79], v69 offset:5120
    ds_read_b128 v[80:83], v69 offset:6144
    ds_read_b128 v[84:87], v69 offset:7168
    s_waitcnt lgkmcnt(10)
    v_smfmac_f32_16x16x64_bf16 v[40:43], v[20:23], v[192:199], v1 abid:1
    s_waitcnt lgkmcnt(9)
    v_smfmac_f32_16x16x64_bf16 v[40:43], v[28:31], v[200:207], v1 abid:1
    s_waitcnt lgkmcnt(8)
    v_smfmac_f32_16x16x64_bf16 v[40:43], v[12:15], v[208:215], v1 abid:1
    s_nop 0
    v_smfmac_f32_16x16x64_bf16 v[44:47], v[20:23], v[224:231], v1 abid:1
    s_add_u32 s30, s30, 262144
    s_addc_u32 s31, s31, 0
    v_smfmac_f32_16x16x64_bf16 v[44:47], v[28:31], v[232:239], v1 abid:1
    s_add_u32 s32, s32, 262144
    s_addc_u32 s33, s33, 0
    v_smfmac_f32_16x16x64_bf16 v[44:47], v[12:15], v[240:247], v1 abid:1
    s_add_u32 s34, s34, 131072
    s_addc_u32 s35, s35, 0
    s_waitcnt lgkmcnt(0)
    v_smfmac_f32_16x16x64_bf16 v[8:11], v[16:19], v[80:87], v1 abid:1
    v_smfmac_f32_16x16x64_bf16 v[8:11], v[20:23], v[48:55], v1 abid:1
    v_cvt_pk_bf16_f32 v40, v40, v41
    v_cvt_pk_bf16_f32 v41, v42, v43
    v_smfmac_f32_16x16x64_bf16 v[8:11], v[28:31], v[56:63], v1 abid:1
    v_and_or_b32 v40, v40, -2, s16
    global_store_dwordx2 v6, v[40:41], s[46:47] sc1
    v_smfmac_f32_16x16x64_bf16 v[8:11], v[12:15], v[72:79], v1 abid:1
    v_cvt_pk_bf16_f32 v44, v44, v45
    v_cvt_pk_bf16_f32 v45, v46, v47
    v_and_or_b32 v44, v44, -2, s16
    global_store_dwordx2 v6, v[44:45], s[48:49] sc1
    s_nop 3
    v_cvt_pk_bf16_f32 v8, v8, v9
    v_cvt_pk_bf16_f32 v9, v10, v11
    v_and_or_b32 v8, v8, -2, s16
    global_store_dwordx2 v6, v[8:9], s[50:51] sc1
    s_add_u32 s36, s36, 131072
    s_addc_u32 s37, s37, 0
    ds_read_b128 v[72:75], v2 offset:49152
    ds_read_b128 v[76:79], v2 offset:50176
    ds_read_b128 v[80:83], v2 offset:51200
    ds_read_b128 v[84:87], v2 offset:52224
    ds_read_b128 v[88:91], v2 offset:0
    ds_read_b128 v[92:95], v2 offset:1024
    v_mov_b64 v[8:9], 0
    v_mov_b64 v[10:11], 0
    v_mov_b64 v[12:13], 0
    v_mov_b64 v[14:15], 0
    v_mov_b64 v[16:17], 0
    v_mov_b64 v[18:19], 0
    v_mov_b64 v[20:21], 0
    v_mov_b64 v[22:23], 0
    v_mov_b64 v[24:25], 0
    v_mov_b64 v[26:27], 0
    v_mov_b64_e64 v[28:29], 0
    v_mov_b64 v[30:31], 0
    s_add_u32 s23, s22, 2
    s_and_b32 s24, s23, 0x47
    s_cmp_eq_u32 s24, 0
    s_cbranch_scc1 ch_w3s_kvw
ch_w3s_kvok:
    s_barrier
    s_sleep 2
    s_branch ch_w3s_loop
ch_w3s_grem:
    s_mov_b64 exec, vcc
    global_load_dwordx4 v[40:43], v0, s[56:57] sc1
    s_mov_b64 exec, -1
    s_add_u32 s26, s26, 1
    s_cmp_gt_u32 s26, 1048576
    s_cbranch_scc1 ch_fail
    s_waitcnt vmcnt(0)
    s_branch ch_w3s_grem_chk
ch_w3s_gre4:
    s_mov_b64 exec, vcc
    global_load_dwordx4 v[44:47], v0, s[60:61] sc1
    s_mov_b64 exec, -1
    s_add_u32 s26, s26, 1
    s_cmp_gt_u32 s26, 1048576
    s_cbranch_scc1 ch_fail
    s_waitcnt vmcnt(0)
    s_branch ch_w3s_gre4_chk
ch_w3s_last:
    s_add_u32 s36, s36, 131072
    s_addc_u32 s37, s37, 0
    s_nop 7
    v_add_f32 v24, v24, v26
    v_add_f32_e64 v25, v25, v27
    v_add_f32_e64 v28, v28, v30
    v_add_f32_e64 v29, v29, v31
    v_cvt_pk_bf16_f32 v70, v24, v25
    v_cvt_pk_bf16_f32 v71, v28, v29
    s_mov_b64 exec, s[6:7]
    global_store_dwordx2 v68, v[70:71], s[36:37] offset:1536 sc1
    s_mov_b64 exec, -1
    s_branch ch_done
ch_w3s_kvw:
    s_lshl_b32 s23, s23, 4
    s_add_u32 s23, s23, 103810048
    v_mov_b32 v68, s23
ch_w3s_kvw2:
    global_load_dword v69, v68, s[14:15] sc1
    s_add_u32 s26, s26, 1
    s_cmp_gt_u32 s26, 1048576
    s_cbranch_scc1 ch_fail
    s_waitcnt vmcnt(0)
    v_readfirstlane_b32 s24, v69
    s_cmp_lt_u32 s24, 64
    s_cbranch_scc1 ch_w3s_kvw2
    s_branch ch_w3s_kvok
ch_w3s_slow:
    s_nop 7
    v_max3_f32 v68, v8, v9, v10
    v_max3_f32 v68, v68, v11, v18
    v_max_f32 v68, v68, v19
    v_mov_b32 v16, v68
    s_nop 1
    v_mov_b32_dpp v16, v68 row_shr:4 row_mask:0xf bank_mask:0xa
    s_nop 1
    v_mov_b32_dpp v16, v68 row_shl:4 row_mask:0xf bank_mask:0x5
    v_max_f32 v68, v68, v16
    v_mov_b32 v16, v68
    s_nop 1
    v_permlane16_swap_b32 v68, v16
    v_max_f32 v68, v68, v16
    v_mov_b32 v16, v68
    s_nop 1
    v_permlane32_swap_b32 v68, v16
    v_max_f32 v68, v68, v16
    v_sub_f32 v12, v8, v68
    v_exp_f32 v12, v12
    v_sub_f32 v13, v9, v68
    v_exp_f32 v13, v13
    v_sub_f32 v14, v10, v68
    v_exp_f32 v14, v14
    v_sub_f32 v15, v11, v68
    v_exp_f32 v15, v15
    v_sub_f32 v20, v18, v68
    v_exp_f32 v20, v20
    v_sub_f32 v21, v19, v68
    v_exp_f32_e64 v21, v21
    v_cvt_pk_bf16_f32 v94, v12, v13
    v_cvt_pk_bf16_f32 v95, v14, v15
    v_cvt_pk_bf16_f32 v92, v12, v13
    v_cvt_pk_bf16_f32 v93, v14, v15
    s_nop 0
    v_mov_b32_dpp v92, v94 row_shr:4 row_mask:0xf bank_mask:0xa
    v_mov_b32_dpp v93, v95 row_shr:4 row_mask:0xf bank_mask:0xa
    v_mov_b32_dpp v94, v94 row_shl:4 row_mask:0xf bank_mask:0x5
    v_mov_b32_dpp v95, v95 row_shl:4 row_mask:0xf bank_mask:0x5
    v_cvt_pk_bf16_f32 v26, v20, v21
    v_cvt_pk_bf16_f32 v29, v20, v21
    v_mfma_f32_16x16x32_bf16 v[12:15], v[88:91], v[92:95], 0
    v_mfma_f32_16x16x32_bf16 v[32:35], v[40:43], v[92:95], 0
    v_mfma_f32_16x16x32_bf16 v[36:39], v[44:47], v[92:95], 0
    v_mfma_f32_16x16x16_bf16 v[12:15], v[88:89], v[26:27], v[12:15]
    v_mfma_f32_16x16x16_bf16 v[32:35], v[70:71], v[26:27], v[32:35]
    v_mfma_f32_16x16x16_bf16 v[36:39], v[70:71], v[28:29], v[36:39]
    s_nop 7
    s_branch ch_w3s_pvm
ch_fail:
    v_mov_b32 v8, 8
    v_mov_b32 v9, s22
    v_add_u32 v9, 0x1000, v9
    global_store_dword v8, v9, s[12:13] sc1
    v_mov_b32 v8, 163776
    v_mov_b32 v10, 0xffff
    v_mov_b32 v11, 0xffff
    ds_write_b64 v8, v[10:11]
    ds_write_b64 v8, v[10:11] offset:8
    s_waitcnt vmcnt(0) lgkmcnt(0)
    s_endpgm
ch_done:
    s_waitcnt vmcnt(0)
    s_barrier
    v_mov_b32 v8, 64
    s_mov_b64 exec, 1
    global_store_dword v0, v8, s[8:9] sc1
    s_waitcnt vmcnt(0)
    s_endpgm
wk_restart:
    v_lshrrev_b32 v127, 4, v0
    s_lshl_b32 s34, s19, 6
    v_add_u32 v127, s34, v127
    s_mov_b32 s54, 0
    s_mov_b32 s47, s2
wk_start:
    s_load_dwordx2 s[4:5], s[0:1], 0
    s_load_dwordx4 s[56:59], s[0:1], 16
    s_load_dwordx2 s[60:61], s[0:1], 32
    s_load_dwordx4 s[64:67], s[0:1], 64
    s_barrier
    s_mov_b32 s48, s18
    s_cmp_gt_u32 s18, 2
    s_cselect_b32 s34, 1, 0
    s_sub_u32 s48, s48, s34
    s_cmp_gt_u32 s18, 0
    s_cselect_b32 s34, 1, 0
    s_sub_u32 s48, s48, s34
    s_min_u32 s48, s48, 5
    s_add_u32 s75, s48, 29
    s_cmp_lg_u32 s19, 0
    s_cbranch_scc1 st_f
    s_mov_b64 exec, 1
    s_lshl_b32 s34, s75, 2
    v_mov_b32 v124, s34
    v_mov_b32 v125, 65537
    global_atomic_add v126, v124, v125, s[12:13] sc0 sc1
    s_waitcnt vmcnt(0)
    v_readfirstlane_b32 s75, v126
    v_mov_b32 v124, 163776
    s_nop 0
    v_mov_b32 v125, s75
    ds_write_b32 v124, v125 offset:0
    s_waitcnt lgkmcnt(0)
    s_mov_b64 exec, -1
st_f:
    s_waitcnt vmcnt(0)
    s_barrier
    v_mov_b32 v124, 163776
    ds_read_b32 v125, v124 offset:0
    s_waitcnt lgkmcnt(0)
    v_readfirstlane_b32 s75, v125
    s_cmp_eq_u32 s75, 0xffff
    s_cbranch_scc1 wk_exit
    s_lshr_b32 s74, s75, 16
    s_lshl_b32 s34, s18, 8
    s_add_u32 s34, s34, s74
    s_lshl_b32 s35, s19, 16
    s_add_u32 s34, s34, s35
    s_cmp_lg_u32 s34, 287
    s_cbranch_scc1 st_nocal
    s_mov_b64 exec, 1
    s_mov_b32 s92, -1
    s_mov_b32 s93, 0
    s_mov_b32 s94, 0
st_cal:
    s_and_b32 s34, s94, 3
    s_lshl_b32 s34, s34, 13
    s_and_b32 s35, s94, 0
    s_lshl_b32 s35, s35, 9
    s_or_b32 s34, s34, s35
    s_add_u32 s35, s34, 102766592
    v_mov_b32 v11, s35
    v_mov_b32 v12, 0
    s_memtime s[88:89]
    s_waitcnt lgkmcnt(0)
    global_store_dword v11, v11, s[14:15] sc1
    s_waitcnt vmcnt(0)
    s_memtime s[90:91]
    s_waitcnt lgkmcnt(0)
    s_sub_u32 s88, s90, s88
    s_cmp_lt_u32 s88, s92
    s_cselect_b32 s92, s88, s92
    s_cselect_b32 s93, s34, s93
    s_add_u32 s94, s94, 1
    s_cmp_lt_u32 s94, 16
    s_cbranch_scc1 st_cal
    s_xor_b32 s93, s93, 16384
    v_mov_b32 v11, s93
    v_mov_b32 v12, 32
    global_store_dword v12, v11, s[12:13] sc1
    s_mov_b64 exec, -1
st_nocal:
    s_cmp_lt_u32 s48, 4
    s_cselect_b32 s35, 11, 10
    s_min_u32 s74, s74, 40
    s_sub_u32 s34, s74, s35
    s_mul_i32 s36, s34, 6
    s_add_u32 s36, s36, s48
    s_cmp_eq_u32 s34, 21
    s_cselect_b32 s34, 4, 0
    s_sub_u32 s36, s36, s34
    s_cmp_ge_u32 s74, 32
    s_cselect_b32 s49, 0xffff, s36
    s_and_b32 s75, s75, 0xffff
    s_min_u32 s75, s75, 88
    s_cmp_lt_u32 s48, 4
    s_cselect_b32 s34, 0, 18
    s_cselect_b32 s35, 11, 10
    s_add_u32 s34, s34, 187
    s_mul_i32 s42, s75, s34
    s_lshr_b32 s42, s42, 11
    s_mul_i32 s34, s42, s35
    s_sub_u32 s34, s75, s34
    s_mul_i32 s34, s34, 3
    s_lshr_b32 s35, s48, 1
    s_add_u32 s34, s34, s35
    s_and_b32 s35, s48, 1
    s_lshl_b32 s35, s35, 5
    s_add_u32 s43, s34, s35
    s_cmp_lt_u32 s42, 8
    s_cselect_b32 s50, 1, 0
    s_and_b32 s42, s42, 7
    s_mov_b32 s101, 8
    s_cmp_ge_u32 s49, 128
    s_cbranch_scc1 wk_g1
wk_ln:
    s_mov_b32 s101, 2
    s_cmp_ge_u32 s49, 128
    s_cbranch_scc1 ln_skip
    v_and_b32 v1, 63, v127
    v_lshlrev_b32 v0, 4, v1
    v_and_b32 v2, 15, v1
    v_lshrrev_b32 v3, 4, v1
    v_mul_u32_u24 v4, 1280, v2
    v_lshl_add_u32 v4, v3, 4, v4
    s_mul_i32 s34, s49, 20480
    s_mul_i32 s35, s19, 320
    s_add_u32 s34, s34, s35
    v_add_u32 v4, s34, v4
    global_load_dwordx4 v[80:83], v4, s[4:5] offset:0
    global_load_dwordx4 v[84:87], v4, s[4:5] offset:64
    global_load_dwordx4 v[88:91], v4, s[4:5] offset:128
    global_load_dwordx4 v[92:95], v4, s[4:5] offset:192
    global_load_dwordx4 v[96:99], v4, s[4:5] offset:256
    v_and_b32 v1, 63, v127
    v_lshlrev_b32 v0, 4, v1
    v_and_b32 v2, 15, v1
    s_lshl_b32 s35, s19, 2
    s_add_u32 s35, s35, 153600
    v_lshl_add_u32 v5, v2, 4, s35
    v_lshlrev_b32 v6, 4, v2
    v_add_u32 v6, 153600, v6
    s_waitcnt vmcnt(0)
    v_lshlrev_b32 v32, 16, v80
    v_and_b32 v33, 0xffff0000, v80
    v_lshlrev_b32 v34, 16, v81
    v_and_b32 v35, 0xffff0000, v81
    v_lshlrev_b32 v36, 16, v82
    v_and_b32 v37, 0xffff0000, v82
    v_lshlrev_b32 v38, 16, v83
    v_and_b32 v39, 0xffff0000, v83
    v_lshlrev_b32 v40, 16, v84
    v_and_b32 v41, 0xffff0000, v84
    v_lshlrev_b32 v42, 16, v85
    v_and_b32 v43, 0xffff0000, v85
    v_lshlrev_b32 v44, 16, v86
    v_and_b32 v45, 0xffff0000, v86
    v_lshlrev_b32 v46, 16, v87
    v_and_b32 v47, 0xffff0000, v87
    v_lshlrev_b32 v48, 16, v88
    v_and_b32 v49, 0xffff0000, v88
    v_lshlrev_b32 v50, 16, v89
    v_and_b32 v51, 0xffff0000, v89
    v_lshlrev_b32 v52, 16, v90
    v_and_b32 v53, 0xffff0000, v90
    v_lshlrev_b32 v54, 16, v91
    v_and_b32 v55, 0xffff0000, v91
    v_lshlrev_b32 v56, 16, v92
    v_and_b32 v57, 0xffff0000, v92
    v_lshlrev_b32 v58, 16, v93
    v_and_b32 v59, 0xffff0000, v93
    v_lshlrev_b32 v60, 16, v94
    v_and_b32 v61, 0xffff0000, v94
    v_lshlrev_b32 v62, 16, v95
    v_and_b32 v63, 0xffff0000, v95
    v_lshlrev_b32 v64, 16, v96
    v_and_b32 v65, 0xffff0000, v96
    v_lshlrev_b32 v66, 16, v97
    v_and_b32 v67, 0xffff0000, v97
    v_lshlrev_b32 v68, 16, v98
    v_and_b32 v69, 0xffff0000, v98
    v_lshlrev_b32 v70, 16, v99
    v_and_b32 v71, 0xffff0000, v99
    v_add_f32 v28, v32, v33
    v_add_f32 v28, v28, v34
    v_add_f32 v28, v28, v35
    v_add_f32 v28, v28, v36
    v_add_f32 v28, v28, v37
    v_add_f32 v28, v28, v38
    v_add_f32 v28, v28, v39
    v_add_f32 v28, v28, v40
    v_add_f32 v28, v28, v41
    v_add_f32 v28, v28, v42
    v_add_f32 v28, v28, v43
    v_add_f32 v28, v28, v44
    v_add_f32 v28, v28, v45
    v_add_f32 v28, v28, v46
    v_add_f32 v28, v28, v47
    v_add_f32 v28, v28, v48
    v_add_f32 v28, v28, v49
    v_add_f32 v28, v28, v50
    v_add_f32 v28, v28, v51
    v_add_f32 v28, v28, v52
    v_add_f32 v28, v28, v53
    v_add_f32 v28, v28, v54
    v_add_f32 v28, v28, v55
    v_add_f32 v28, v28, v56
    v_add_f32 v28, v28, v57
    v_add_f32 v28, v28, v58
    v_add_f32 v28, v28, v59
    v_add_f32 v28, v28, v60
    v_add_f32 v28, v28, v61
    v_add_f32 v28, v28, v62
    v_add_f32 v28, v28, v63
    v_add_f32 v28, v28, v64
    v_add_f32 v28, v28, v65
    v_add_f32 v28, v28, v66
    v_add_f32 v28, v28, v67
    v_add_f32 v28, v28, v68
    v_add_f32 v28, v28, v69
    v_add_f32 v28, v28, v70
    v_add_f32 v28, v28, v71
    v_mov_b32 v29, v28
    s_nop 1
    v_permlane16_swap_b32 v28, v29
    v_add_f32 v28, v28, v29
    v_mov_b32 v29, v28
    s_nop 1
    v_permlane32_swap_b32 v28, v29
    v_add_f32 v28, v28, v29
    ds_write_b32 v5, v28 offset:0
    s_waitcnt lgkmcnt(0)
    s_barrier
    ds_read_b128 v[72:75], v6 offset:0
    s_waitcnt lgkmcnt(0)
    v_add_f32 v72, v72, v73
    v_add_f32 v74, v74, v75
    v_add_f32 v28, v72, v74
    v_mul_f32 v28, 986500301, v28
    v_mov_b32 v30, v28
    v_mov_b32 v28, 0
    v_sub_f32 v31, v32, v30
    v_fmac_f32 v28, v31, v31
    v_sub_f32 v31, v33, v30
    v_fmac_f32 v28, v31, v31
    v_sub_f32 v31, v34, v30
    v_fmac_f32 v28, v31, v31
    v_sub_f32 v31, v35, v30
    v_fmac_f32 v28, v31, v31
    v_sub_f32 v31, v36, v30
    v_fmac_f32 v28, v31, v31
    v_sub_f32 v31, v37, v30
    v_fmac_f32 v28, v31, v31
    v_sub_f32 v31, v38, v30
    v_fmac_f32 v28, v31, v31
    v_sub_f32 v31, v39, v30
    v_fmac_f32 v28, v31, v31
    v_sub_f32 v31, v40, v30
    v_fmac_f32 v28, v31, v31
    v_sub_f32 v31, v41, v30
    v_fmac_f32 v28, v31, v31
    v_sub_f32 v31, v42, v30
    v_fmac_f32 v28, v31, v31
    v_sub_f32 v31, v43, v30
    v_fmac_f32 v28, v31, v31
    v_sub_f32 v31, v44, v30
    v_fmac_f32 v28, v31, v31
    v_sub_f32 v31, v45, v30
    v_fmac_f32 v28, v31, v31
    v_sub_f32 v31, v46, v30
    v_fmac_f32 v28, v31, v31
    v_sub_f32 v31, v47, v30
    v_fmac_f32 v28, v31, v31
    v_sub_f32 v31, v48, v30
    v_fmac_f32 v28, v31, v31
    v_sub_f32 v31, v49, v30
    v_fmac_f32 v28, v31, v31
    v_sub_f32 v31, v50, v30
    v_fmac_f32 v28, v31, v31
    v_sub_f32 v31, v51, v30
    v_fmac_f32 v28, v31, v31
    v_sub_f32 v31, v52, v30
    v_fmac_f32 v28, v31, v31
    v_sub_f32 v31, v53, v30
    v_fmac_f32 v28, v31, v31
    v_sub_f32 v31, v54, v30
    v_fmac_f32 v28, v31, v31
    v_sub_f32 v31, v55, v30
    v_fmac_f32 v28, v31, v31
    v_sub_f32 v31, v56, v30
    v_fmac_f32 v28, v31, v31
    v_sub_f32 v31, v57, v30
    v_fmac_f32 v28, v31, v31
    v_sub_f32 v31, v58, v30
    v_fmac_f32 v28, v31, v31
    v_sub_f32 v31, v59, v30
    v_fmac_f32 v28, v31, v31
    v_sub_f32 v31, v60, v30
    v_fmac_f32 v28, v31, v31
    v_sub_f32 v31, v61, v30
    v_fmac_f32 v28, v31, v31
    v_sub_f32 v31, v62, v30
    v_fmac_f32 v28, v31, v31
    v_sub_f32 v31, v63, v30
    v_fmac_f32 v28, v31, v31
    v_sub_f32 v31, v64, v30
    v_fmac_f32 v28, v31, v31
    v_sub_f32 v31, v65, v30
    v_fmac_f32 v28, v31, v31
    v_sub_f32 v31, v66, v30
    v_fmac_f32 v28, v31, v31
    v_sub_f32 v31, v67, v30
    v_fmac_f32 v28, v31, v31
    v_sub_f32 v31, v68, v30
    v_fmac_f32 v28, v31, v31
    v_sub_f32 v31, v69, v30
    v_fmac_f32 v28, v31, v31
    v_sub_f32 v31, v70, v30
    v_fmac_f32 v28, v31, v31
    v_sub_f32 v31, v71, v30
    v_fmac_f32 v28, v31, v31
    v_mov_b32 v29, v28
    s_nop 1
    v_permlane16_swap_b32 v28, v29
    v_add_f32 v28, v28, v29
    v_mov_b32 v29, v28
    s_nop 1
    v_permlane32_swap_b32 v28, v29
    v_add_f32 v28, v28, v29
    ds_write_b32 v5, v28 offset:256
    s_waitcnt lgkmcnt(0)
    s_barrier
    ds_read_b128 v[72:75], v6 offset:256
    s_waitcnt lgkmcnt(0)
    v_add_f32 v72, v72, v73
    v_add_f32 v74, v74, v75
    v_add_f32 v28, v72, v74
    v_mul_f32 v28, 986500301, v28
    v_cvt_pk_bf16_f32 v28, v28, v28
    v_lshlrev_b32 v28, 16, v28
    v_add_f32 v28, 925353388, v28
    v_cvt_pk_bf16_f32 v28, v28, v28
    v_lshlrev_b32 v28, 16, v28
    v_sqrt_f32 v28, v28
    s_nop 0
    v_cvt_pk_bf16_f32 v28, v28, v28
    v_lshlrev_b32 v28, 16, v28
    v_rcp_f32 v29, v28
    v_cvt_pk_bf16_f32 v30, v30, v30
    v_lshlrev_b32 v30, 16, v30
    v_sub_f32 v32, v32, v30
    v_sub_f32 v33, v33, v30
    v_cvt_pk_bf16_f32 v31, v32, v33
    v_lshlrev_b32 v32, 16, v31
    v_and_b32 v33, 0xffff0000, v31
    v_mul_f32 v76, v32, v29
    v_mul_f32 v77, v33, v29
    v_fma_f32 v78, -v76, v28, v32
    v_fma_f32 v79, -v77, v28, v33
    v_fmac_f32 v76, v78, v29
    v_fmac_f32 v77, v79, v29
    v_cvt_pk_bf16_f32 v8, v76, v77
    v_sub_f32 v34, v34, v30
    v_sub_f32 v35, v35, v30
    v_cvt_pk_bf16_f32 v31, v34, v35
    v_lshlrev_b32 v34, 16, v31
    v_and_b32 v35, 0xffff0000, v31
    v_mul_f32 v76, v34, v29
    v_mul_f32 v77, v35, v29
    v_fma_f32 v78, -v76, v28, v34
    v_fma_f32 v79, -v77, v28, v35
    v_fmac_f32 v76, v78, v29
    v_fmac_f32 v77, v79, v29
    v_cvt_pk_bf16_f32 v9, v76, v77
    v_sub_f32 v36, v36, v30
    v_sub_f32 v37, v37, v30
    v_cvt_pk_bf16_f32 v31, v36, v37
    v_lshlrev_b32 v36, 16, v31
    v_and_b32 v37, 0xffff0000, v31
    v_mul_f32 v76, v36, v29
    v_mul_f32 v77, v37, v29
    v_fma_f32 v78, -v76, v28, v36
    v_fma_f32 v79, -v77, v28, v37
    v_fmac_f32 v76, v78, v29
    v_fmac_f32 v77, v79, v29
    v_cvt_pk_bf16_f32 v10, v76, v77
    v_sub_f32 v38, v38, v30
    v_sub_f32 v39, v39, v30
    v_cvt_pk_bf16_f32 v31, v38, v39
    v_lshlrev_b32 v38, 16, v31
    v_and_b32 v39, 0xffff0000, v31
    v_mul_f32 v76, v38, v29
    v_mul_f32 v77, v39, v29
    v_fma_f32 v78, -v76, v28, v38
    v_fma_f32 v79, -v77, v28, v39
    v_fmac_f32 v76, v78, v29
    v_fmac_f32 v77, v79, v29
    v_cvt_pk_bf16_f32 v11, v76, v77
    v_sub_f32 v40, v40, v30
    v_sub_f32 v41, v41, v30
    v_cvt_pk_bf16_f32 v31, v40, v41
    v_lshlrev_b32 v40, 16, v31
    v_and_b32 v41, 0xffff0000, v31
    v_mul_f32 v76, v40, v29
    v_mul_f32 v77, v41, v29
    v_fma_f32 v78, -v76, v28, v40
    v_fma_f32 v79, -v77, v28, v41
    v_fmac_f32 v76, v78, v29
    v_fmac_f32 v77, v79, v29
    v_cvt_pk_bf16_f32 v12, v76, v77
    v_sub_f32 v42, v42, v30
    v_sub_f32 v43, v43, v30
    v_cvt_pk_bf16_f32 v31, v42, v43
    v_lshlrev_b32 v42, 16, v31
    v_and_b32 v43, 0xffff0000, v31
    v_mul_f32 v76, v42, v29
    v_mul_f32 v77, v43, v29
    v_fma_f32 v78, -v76, v28, v42
    v_fma_f32 v79, -v77, v28, v43
    v_fmac_f32 v76, v78, v29
    v_fmac_f32 v77, v79, v29
    v_cvt_pk_bf16_f32 v13, v76, v77
    v_sub_f32 v44, v44, v30
    v_sub_f32 v45, v45, v30
    v_cvt_pk_bf16_f32 v31, v44, v45
    v_lshlrev_b32 v44, 16, v31
    v_and_b32 v45, 0xffff0000, v31
    v_mul_f32 v76, v44, v29
    v_mul_f32 v77, v45, v29
    v_fma_f32 v78, -v76, v28, v44
    v_fma_f32 v79, -v77, v28, v45
    v_fmac_f32 v76, v78, v29
    v_fmac_f32 v77, v79, v29
    v_cvt_pk_bf16_f32 v14, v76, v77
    v_sub_f32 v46, v46, v30
    v_sub_f32 v47, v47, v30
    v_cvt_pk_bf16_f32 v31, v46, v47
    v_lshlrev_b32 v46, 16, v31
    v_and_b32 v47, 0xffff0000, v31
    v_mul_f32 v76, v46, v29
    v_mul_f32 v77, v47, v29
    v_fma_f32 v78, -v76, v28, v46
    v_fma_f32 v79, -v77, v28, v47
    v_fmac_f32 v76, v78, v29
    v_fmac_f32 v77, v79, v29
    v_cvt_pk_bf16_f32 v15, v76, v77
    v_sub_f32 v48, v48, v30
    v_sub_f32 v49, v49, v30
    v_cvt_pk_bf16_f32 v31, v48, v49
    v_lshlrev_b32 v48, 16, v31
    v_and_b32 v49, 0xffff0000, v31
    v_mul_f32 v76, v48, v29
    v_mul_f32 v77, v49, v29
    v_fma_f32 v78, -v76, v28, v48
    v_fma_f32 v79, -v77, v28, v49
    v_fmac_f32 v76, v78, v29
    v_fmac_f32 v77, v79, v29
    v_cvt_pk_bf16_f32 v16, v76, v77
    v_sub_f32 v50, v50, v30
    v_sub_f32 v51, v51, v30
    v_cvt_pk_bf16_f32 v31, v50, v51
    v_lshlrev_b32 v50, 16, v31
    v_and_b32 v51, 0xffff0000, v31
    v_mul_f32 v76, v50, v29
    v_mul_f32 v77, v51, v29
    v_fma_f32 v78, -v76, v28, v50
    v_fma_f32 v79, -v77, v28, v51
    v_fmac_f32 v76, v78, v29
    v_fmac_f32 v77, v79, v29
    v_cvt_pk_bf16_f32 v17, v76, v77
    v_sub_f32 v52, v52, v30
    v_sub_f32 v53, v53, v30
    v_cvt_pk_bf16_f32 v31, v52, v53
    v_lshlrev_b32 v52, 16, v31
    v_and_b32 v53, 0xffff0000, v31
    v_mul_f32 v76, v52, v29
    v_mul_f32 v77, v53, v29
    v_fma_f32 v78, -v76, v28, v52
    v_fma_f32 v79, -v77, v28, v53
    v_fmac_f32 v76, v78, v29
    v_fmac_f32 v77, v79, v29
    v_cvt_pk_bf16_f32 v18, v76, v77
    v_sub_f32 v54, v54, v30
    v_sub_f32 v55, v55, v30
    v_cvt_pk_bf16_f32 v31, v54, v55
    v_lshlrev_b32 v54, 16, v31
    v_and_b32 v55, 0xffff0000, v31
    v_mul_f32 v76, v54, v29
    v_mul_f32 v77, v55, v29
    v_fma_f32 v78, -v76, v28, v54
    v_fma_f32 v79, -v77, v28, v55
    v_fmac_f32 v76, v78, v29
    v_fmac_f32 v77, v79, v29
    v_cvt_pk_bf16_f32 v19, v76, v77
    v_sub_f32 v56, v56, v30
    v_sub_f32 v57, v57, v30
    v_cvt_pk_bf16_f32 v31, v56, v57
    v_lshlrev_b32 v56, 16, v31
    v_and_b32 v57, 0xffff0000, v31
    v_mul_f32 v76, v56, v29
    v_mul_f32 v77, v57, v29
    v_fma_f32 v78, -v76, v28, v56
    v_fma_f32 v79, -v77, v28, v57
    v_fmac_f32 v76, v78, v29
    v_fmac_f32 v77, v79, v29
    v_cvt_pk_bf16_f32 v20, v76, v77
    v_sub_f32 v58, v58, v30
    v_sub_f32 v59, v59, v30
    v_cvt_pk_bf16_f32 v31, v58, v59
    v_lshlrev_b32 v58, 16, v31
    v_and_b32 v59, 0xffff0000, v31
    v_mul_f32 v76, v58, v29
    v_mul_f32 v77, v59, v29
    v_fma_f32 v78, -v76, v28, v58
    v_fma_f32 v79, -v77, v28, v59
    v_fmac_f32 v76, v78, v29
    v_fmac_f32 v77, v79, v29
    v_cvt_pk_bf16_f32 v21, v76, v77
    v_sub_f32 v60, v60, v30
    v_sub_f32 v61, v61, v30
    v_cvt_pk_bf16_f32 v31, v60, v61
    v_lshlrev_b32 v60, 16, v31
    v_and_b32 v61, 0xffff0000, v31
    v_mul_f32 v76, v60, v29
    v_mul_f32 v77, v61, v29
    v_fma_f32 v78, -v76, v28, v60
    v_fma_f32 v79, -v77, v28, v61
    v_fmac_f32 v76, v78, v29
    v_fmac_f32 v77, v79, v29
    v_cvt_pk_bf16_f32 v22, v76, v77
    v_sub_f32 v62, v62, v30
    v_sub_f32 v63, v63, v30
    v_cvt_pk_bf16_f32 v31, v62, v63
    v_lshlrev_b32 v62, 16, v31
    v_and_b32 v63, 0xffff0000, v31
    v_mul_f32 v76, v62, v29
    v_mul_f32 v77, v63, v29
    v_fma_f32 v78, -v76, v28, v62
    v_fma_f32 v79, -v77, v28, v63
    v_fmac_f32 v76, v78, v29
    v_fmac_f32 v77, v79, v29
    v_cvt_pk_bf16_f32 v23, v76, v77
    v_sub_f32 v64, v64, v30
    v_sub_f32 v65, v65, v30
    v_cvt_pk_bf16_f32 v31, v64, v65
    v_lshlrev_b32 v64, 16, v31
    v_and_b32 v65, 0xffff0000, v31
    v_mul_f32 v76, v64, v29
    v_mul_f32 v77, v65, v29
    v_fma_f32 v78, -v76, v28, v64
    v_fma_f32 v79, -v77, v28, v65
    v_fmac_f32 v76, v78, v29
    v_fmac_f32 v77, v79, v29
    v_cvt_pk_bf16_f32 v24, v76, v77
    v_sub_f32 v66, v66, v30
    v_sub_f32 v67, v67, v30
    v_cvt_pk_bf16_f32 v31, v66, v67
    v_lshlrev_b32 v66, 16, v31
    v_and_b32 v67, 0xffff0000, v31
    v_mul_f32 v76, v66, v29
    v_mul_f32 v77, v67, v29
    v_fma_f32 v78, -v76, v28, v66
    v_fma_f32 v79, -v77, v28, v67
    v_fmac_f32 v76, v78, v29
    v_fmac_f32 v77, v79, v29
    v_cvt_pk_bf16_f32 v25, v76, v77
    v_sub_f32 v68, v68, v30
    v_sub_f32 v69, v69, v30
    v_cvt_pk_bf16_f32 v31, v68, v69
    v_lshlrev_b32 v68, 16, v31
    v_and_b32 v69, 0xffff0000, v31
    v_mul_f32 v76, v68, v29
    v_mul_f32 v77, v69, v29
    v_fma_f32 v78, -v76, v28, v68
    v_fma_f32 v79, -v77, v28, v69
    v_fmac_f32 v76, v78, v29
    v_fmac_f32 v77, v79, v29
    v_cvt_pk_bf16_f32 v26, v76, v77
    v_sub_f32 v70, v70, v30
    v_sub_f32 v71, v71, v30
    v_cvt_pk_bf16_f32 v31, v70, v71
    v_lshlrev_b32 v70, 16, v31
    v_and_b32 v71, 0xffff0000, v31
    v_mul_f32 v76, v70, v29
    v_mul_f32 v77, v71, v29
    v_fma_f32 v78, -v76, v28, v70
    v_fma_f32 v79, -v77, v28, v71
    v_fmac_f32 v76, v78, v29
    v_fmac_f32 v77, v79, v29
    v_cvt_pk_bf16_f32 v27, v76, v77
    s_mul_i32 s34, s49, 20480
    s_mul_i32 s35, s19, 5120
    s_add_u32 s34, s34, s35
    s_add_u32 s34, s34, 67110912
    v_add_u32 v4, s34, v0
    global_store_dwordx4 v4, v[8:11], s[14:15] offset:-2048 sc1
    global_store_dwordx4 v4, v[12:15], s[14:15] offset:-1024 sc1
    global_store_dwordx4 v4, v[16:19], s[14:15] offset:0 sc1
    global_store_dwordx4 v4, v[20:23], s[14:15] offset:1024 sc1
    global_store_dwordx4 v4, v[24:27], s[14:15] offset:2048 sc1
ln_skip:
    s_cmp_lg_u32 s19, 0
    s_cbranch_scc1 ln_i
    s_mov_b64 exec, 1
    v_mov_b32 v124, 28
poll_1:
    global_load_dword v125, v124, s[12:13] sc1
    s_add_u32 s54, s54, 1
    s_cmp_gt_u32 s54, 1048576
    s_cbranch_scc1 wk_fail
    s_waitcnt vmcnt(0)
    v_readfirstlane_b32 s35, v125
    s_cmp_ge_u32 s35, 1
    s_cbranch_scc1 poll_1_ok
    s_sleep 2
    s_branch poll_1
poll_1_ok:
    s_mov_b64 exec, -1
ln_i:
    s_waitcnt vmcnt(0)
    s_barrier
    s_cmp_lg_u32 s19, 0
    s_cbranch_scc1 ln_f
    s_mov_b64 exec, 1
    s_cmp_ge_u32 s49, 128
    s_cbranch_scc1 ln_nosig
    s_lshr_b32 s34, s49, 4
    s_lshl_b32 s34, s34, 7
    s_add_u32 s34, s34, 103809024
    v_mov_b32 v124, s34
    v_mov_b32 v125, 1
    global_atomic_add v124, v125, s[14:15] sc1
ln_nosig:
    s_mov_b64 exec, 63
    v_lshlrev_b32 v124, 2, v127
    global_load_dword v126, v124, s[12:13] offset:116 sc1
    s_waitcnt vmcnt(0)
    v_cmp_gt_u32 vcc, 2097152, v126
    s_mov_b64 exec, 1
    s_mov_b32 s49, 0xffff
    s_cbranch_vccz ln_put
    s_ff1_i32_b32 s74, vcc_lo
    s_add_u32 s75, s74, 29
    s_lshl_b32 s34, s75, 2
    v_mov_b32 v124, s34
    v_mov_b32 v125, 65536
    global_atomic_add v126, v124, v125, s[12:13] sc0 sc1
    s_waitcnt vmcnt(0)
    v_readfirstlane_b32 s75, v126
    s_lshr_b32 s75, s75, 16
    s_cmp_lt_u32 s74, 4
    s_cselect_b32 s35, 11, 10
    s_min_u32 s75, s75, 40
    s_sub_u32 s34, s75, s35
    s_mul_i32 s36, s34, 6
    s_add_u32 s36, s36, s74
    s_cmp_eq_u32 s34, 21
    s_cselect_b32 s34, 4, 0
    s_sub_u32 s36, s36, s34
    s_cmp_ge_u32 s75, 32
    s_cselect_b32 s49, 0xffff, s36
    s_cmp_ge_u32 s49, 128
    s_cbranch_scc1 ln_nosig
ln_put:
    v_mov_b32 v124, 163776
    v_mov_b32 v125, s49
    ds_write_b32 v124, v125 offset:0
    s_waitcnt lgkmcnt(0)
    s_mov_b64 exec, -1
ln_f:
    s_barrier
    v_mov_b32 v124, 163776
    ds_read_b32 v125, v124 offset:0
    s_waitcnt lgkmcnt(0)
    v_readfirstlane_b32 s49, v125
    s_cmp_lt_u32 s49, 128
    s_cbranch_scc1 wk_ln
wk_g1:
    v_mov_b32 v15, v127
    v_and_b32 v8, 63, v15
    v_lshlrev_b32 v0, 4, v8
    v_and_b32 v7, 15, v8
    v_lshrrev_b32 v9, 4, v8
    s_lshl_b32 s34, s19, 2
    v_lshl_add_u32 v6, v9, 4, s34
    v_lshrrev_b32 v10, 2, v7
    v_mul_u32_u24 v1, 1056, v10
    v_and_b32 v10, 1, v9
    v_mul_u32_u24 v10, 8576, v10
    v_add_u32 v1, v1, v10
    v_lshrrev_b32 v10, 1, v9
    v_lshl_add_u32 v1, v10, 8, v1
    v_and_b32 v10, 3, v7
    v_lshl_add_u32 v1, v10, 3, v1
    s_mul_i32 s38, s19, 4224
    s_lshr_b32 s34, s19, 1
    s_lshl_b32 s34, s34, 7
    s_add_u32 s38, s38, s34
    s_mov_b32 s26, 0
    s_mov_b32 s27, s38
    s_mov_b32 s21, 0
    s_mov_b32 s23, 0
    s_cmp_lg_u32 s50, 0
    s_cbranch_scc1 g1_ok
    s_barrier
    s_cmp_lg_u32 s19, 0
    s_cbranch_scc1 g1_f0
    s_mov_b64 exec, 1
    v_mov_b32 v124, 28
poll_2:
    global_load_dword v125, v124, s[12:13] sc1
    s_add_u32 s54, s54, 1
    s_cmp_gt_u32 s54, 1048576
    s_cbranch_scc1 wk_fail
    s_waitcnt vmcnt(0)
    v_readfirstlane_b32 s35, v125
    s_cmp_ge_u32 s35, 1
    s_cbranch_scc1 poll_2_ok
    s_sleep 2
    s_branch poll_2
poll_2_ok:
g1_fa_again:
    s_mov_b64 exec, -1
    v_lshlrev_b32 v124, 3, v0
    v_add_u32 v124, 103833600, v124
    global_load_dword v125, v124, s[14:15] sc1
    v_lshrrev_b32 v124, 2, v0
    v_min_u32 v124, 20, v124
    global_load_dword v126, v124, s[12:13] offset:116 sc1
    s_waitcnt vmcnt(0)
    v_cmp_gt_u32 s[68:69], 10, v125
    v_and_b32 v126, 0xffff, v126
    v_and_b32 v124, 16, v124
    v_lshrrev_b32 v124, 1, v124
    v_add_u32 v126, v126, v124
    v_cmp_gt_u32 vcc, 88, v126
    s_mov_b64 exec, 1
    s_and_b32 s69, s69, 0xffff
    s_and_b32 s36, vcc_lo, 63
    s_lshl_b32 s75, s48, 3
    s_lshr_b64 s[70:71], s[68:69], s75
    s_and_b32 s70, s70, 255
    s_mov_b32 s74, s48
    s_add_u32 s75, s75, s42
    s_bitcmp1_b32 s70, s42
    s_cbranch_scc1 g1_fa_cq
    s_bitcmp1_b32 s36, s48
    s_cbranch_scc1 g1_fa_gk
    s_sub_u32 s75, s75, s42
    s_ff1_i32_b32 s71, s70
    s_add_u32 s75, s75, s71
    s_cmp_lg_u32 s70, 0
    s_cbranch_scc1 g1_fa_cq
    s_ff1_i32_b32 s74, s36
    s_cmp_lg_u32 s36, 0
    s_cbranch_scc1 g1_fa_gk
    s_mov_b32 s45, 0xffff
    s_cmp_eq_u64 s[68:69], 0
    s_cbranch_scc1 g1_fa_done
    s_ff1_i32_b64 s75, s[68:69]
g1_fa_cq:
    s_lshl_b32 s34, s75, 7
    s_add_u32 s34, s34, 103833600
    v_mov_b32 v124, s34
    v_mov_b32 v125, 1
    global_atomic_add v126, v124, v125, s[14:15] sc0 sc1
    s_waitcnt vmcnt(0)
    v_readfirstlane_b32 s45, v126
    s_cmp_ge_u32 s45, 10
    s_cbranch_scc1 g1_fa_again
    s_mul_i32 s45, s45, 6
    s_lshr_b32 s34, s75, 3
    s_add_u32 s45, s45, s34
    s_add_u32 s45, s45, 64
    s_and_b32 s44, s75, 7
    s_cmp_ge_u32 s45, 123
    s_cbranch_scc1 g1_fa_again
    s_branch g1_fa_done
g1_fa_gk:
    s_add_u32 s75, s74, 29
    s_lshl_b32 s34, s75, 2
    v_mov_b32 v124, s34
    v_mov_b32 v125, 1
    global_atomic_add v126, v124, v125, s[12:13] sc0 sc1
    s_waitcnt vmcnt(0)
    v_readfirstlane_b32 s75, v126
    s_and_b32 s75, s75, 0xffff
    s_min_u32 s75, s75, 88
    s_cmp_lt_u32 s74, 4
    s_cselect_b32 s34, 0, 18
    s_cselect_b32 s35, 11, 10
    s_add_u32 s34, s34, 187
    s_mul_i32 s44, s75, s34
    s_lshr_b32 s44, s44, 11
    s_mul_i32 s34, s44, s35
    s_sub_u32 s34, s75, s34
    s_mul_i32 s34, s34, 3
    s_lshr_b32 s35, s74, 1
    s_add_u32 s34, s34, s35
    s_and_b32 s35, s74, 1
    s_lshl_b32 s35, s35, 5
    s_add_u32 s45, s34, s35
    s_cmp_ge_u32 s44, 8
    s_cbranch_scc1 g1_fa_again
g1_fa_done:
    v_mov_b32 v124, 163776
    v_mov_b32 v125, s44
    ds_write_b32 v124, v125 offset:0
    v_mov_b32 v125, s45
    ds_write_b32 v124, v125 offset:4
    s_waitcnt lgkmcnt(0)
    s_mov_b64 exec, -1
g1_f0:
    s_barrier
    v_mov_b32 v124, 163776
    ds_read_b32 v125, v124 offset:0
    s_waitcnt lgkmcnt(0)
    v_readfirstlane_b32 s42, v125
    ds_read_b32 v125, v124 offset:4
    s_waitcnt lgkmcnt(0)
    v_readfirstlane_b32 s43, v125
    s_cmp_ge_u32 s43, 123
    s_cbranch_scc1 wk_f2e
    s_mov_b32 s50, 1
g1_ok:
    s_cmp_ge_u32 s43, 123
    s_cbranch_scc1 g1_d0_e
    s_cmp_ge_u32 s43, 96
    s_cbranch_scc1 g1_d0_f
    s_cmp_lt_u32 s43, 32
    s_cselect_b32 s30, s58, s60
    s_cselect_b32 s31, s59, s61
    s_cmp_ge_u32 s43, 64
    s_cselect_b32 s30, s56, s30
    s_cselect_b32 s31, s57, s31
    s_and_b32 s34, s43, 31
    s_lshl_b32 s34, s34, 8
    s_add_u32 s30, s30, s34
    s_addc_u32 s31, s31, 0
    s_mov_b64 s[32:33], s[30:31]
    s_mov_b32 s29, 8192
    s_branch g1_d0_e
g1_d0_f:
    s_sub_u32 s34, s43, 96
    s_lshl_b32 s34, s34, 7
    s_add_u32 s30, s64, s34
    s_addc_u32 s31, s65, 0
    s_add_u32 s32, s66, s34
    s_addc_u32 s33, s67, 0
    s_sub_u32 s32, s32, 128
    s_subb_u32 s33, s33, 0
    s_mov_b32 s29, 3456
g1_d0_e:
    s_mov_b32 s20, s29
    s_mul_i32 s22, s29, 61
    v_mul_u32_u24 v12, s29, v6
    v_lshl_add_u32 v12, v7, 4, v12
    v_cmp_lt_u32 vcc, 7, v7
    v_mov_b32 v13, s30
    v_mov_b32 v14, s32
    v_cndmask_b32 v4, v13, v14, vcc
    v_mov_b32 v13, s31
    v_mov_b32 v14, s33
    v_cndmask_b32 v5, v13, v14, vcc
    v_add_co_u32 v4, vcc, v4, v12
    s_nop 1
    v_addc_co_u32 v5, vcc, 0, v5, vcc
    s_add_u32 m0, s27, 0
    s_nop 0
    global_load_lds_dwordx4 v[4:5], off
    v_lshl_add_u64 v[4:5], v[4:5], 0, s[20:21]
    s_add_u32 m0, s27, 1056
    s_nop 0
    global_load_lds_dwordx4 v[4:5], off
    v_lshl_add_u64 v[4:5], v[4:5], 0, s[20:21]
    s_add_u32 m0, s27, 2112
    s_nop 0
    global_load_lds_dwordx4 v[4:5], off
    v_lshl_add_u64 v[4:5], v[4:5], 0, s[20:21]
    s_add_u32 m0, s27, 3168
    s_nop 0
    global_load_lds_dwordx4 v[4:5], off
    v_lshl_add_u64 v[4:5], v[4:5], 0, s[22:23]
    s_add_u32 s27, s27, 17024
    s_cmp_ge_u32 s27, 153216
    s_cselect_b32 s27, s38, s27
    s_add_u32 m0, s27, 0
    s_nop 0
    global_load_lds_dwordx4 v[4:5], off
    v_lshl_add_u64 v[4:5], v[4:5], 0, s[20:21]
    s_add_u32 m0, s27, 1056
    s_nop 0
    global_load_lds_dwordx4 v[4:5], off
    v_lshl_add_u64 v[4:5], v[4:5], 0, s[20:21]
    s_add_u32 m0, s27, 2112
    s_nop 0
    global_load_lds_dwordx4 v[4:5], off
    v_lshl_add_u64 v[4:5], v[4:5], 0, s[20:21]
    s_add_u32 m0, s27, 3168
    s_nop 0
    global_load_lds_dwordx4 v[4:5], off
    v_lshl_add_u64 v[4:5], v[4:5], 0, s[22:23]
    s_add_u32 s27, s27, 17024
    s_cmp_ge_u32 s27, 153216
    s_cselect_b32 s27, s38, s27
    s_cmp_eq_u32 s101, 2
    s_cbranch_scc1 g1_p2
    s_mov_b32 s74, 6
g1_p1:
    s_add_u32 m0, s27, 0
    s_nop 0
    global_load_lds_dwordx4 v[4:5], off
    v_lshl_add_u64 v[4:5], v[4:5], 0, s[20:21]
    s_add_u32 m0, s27, 1056
    s_nop 0
    global_load_lds_dwordx4 v[4:5], off
    v_lshl_add_u64 v[4:5], v[4:5], 0, s[20:21]
    s_add_u32 m0, s27, 2112
    s_nop 0
    global_load_lds_dwordx4 v[4:5], off
    v_lshl_add_u64 v[4:5], v[4:5], 0, s[20:21]
    s_add_u32 m0, s27, 3168
    s_nop 0
    global_load_lds_dwordx4 v[4:5], off
    v_lshl_add_u64 v[4:5], v[4:5], 0, s[22:23]
    s_add_u32 s27, s27, 17024
    s_cmp_ge_u32 s27, 153216
    s_cselect_b32 s27, s38, s27
    s_sub_u32 s74, s74, 1
    s_cmp_lg_u32 s74, 0
    s_cbranch_scc1 g1_p1
g1_p2:
    s_barrier
    s_cmp_lg_u32 s19, 0
    s_cbranch_scc1 g1_f1
    s_mov_b64 exec, 1
    v_mov_b32 v124, 28
poll_3:
    global_load_dword v125, v124, s[12:13] sc1
    s_add_u32 s54, s54, 1
    s_cmp_gt_u32 s54, 1048576
    s_cbranch_scc1 wk_fail
    s_waitcnt vmcnt(0)
    v_readfirstlane_b32 s35, v125
    s_cmp_ge_u32 s35, 1
    s_cbranch_scc1 poll_3_ok
    s_sleep 2
    s_branch poll_3
poll_3_ok:
    s_lshl_b32 s34, s42, 7
    s_add_u32 s34, s34, 103809024
    v_mov_b32 v124, s34
    s_mov_b32 s74, 0
    s_mov_b32 s45, 0xfffe
g1_l1:
    global_load_dword v125, v124, s[14:15] sc1
    s_add_u32 s74, s74, 1
    s_cmp_gt_u32 s74, 5000
    s_cbranch_scc1 g1_fb_done
    s_waitcnt vmcnt(0)
    v_readfirstlane_b32 s35, v125
    s_cmp_lt_u32 s35, 16
    s_cbranch_scc1 g1_l1
    s_mov_b32 s45, 0xfffd
    s_mov_b32 s44, s42
    s_cmp_eq_u32 s101, 8
    s_cbranch_scc1 g1_fb_done
    s_lshl_b32 s75, s48, 3
    s_add_u32 s75, s75, s42
    s_branch g1_fb_cq
g1_fb_again:
    s_mov_b64 exec, -1
    v_lshlrev_b32 v124, 3, v0
    v_add_u32 v124, 103833600, v124
    global_load_dword v125, v124, s[14:15] sc1
    v_lshrrev_b32 v124, 2, v0
    v_min_u32 v124, 20, v124
    global_load_dword v126, v124, s[12:13] offset:116 sc1
    s_waitcnt vmcnt(0)
    v_cmp_gt_u32 s[68:69], 10, v125
    v_and_b32 v126, 0xffff, v126
    v_and_b32 v124, 16, v124
    v_lshrrev_b32 v124, 1, v124
    v_add_u32 v126, v126, v124
    v_cmp_gt_u32 vcc, 88, v126
    s_mov_b64 exec, 1
    s_and_b32 s69, s69, 0xffff
    s_and_b32 s36, vcc_lo, 63
    s_lshl_b32 s75, s48, 3
    s_lshr_b64 s[70:71], s[68:69], s75
    s_and_b32 s70, s70, 255
    s_mov_b32 s74, s48
    s_add_u32 s75, s75, s42
    s_bitcmp1_b32 s70, s42
    s_cbranch_scc1 g1_fb_cq
    s_bitcmp1_b32 s36, s48
    s_cbranch_scc1 g1_fb_gk
    s_sub_u32 s75, s75, s42
    s_ff1_i32_b32 s71, s70
    s_add_u32 s75, s75, s71
    s_cmp_lg_u32 s70, 0
    s_cbranch_scc1 g1_fb_cq
    s_ff1_i32_b32 s74, s36
    s_cmp_lg_u32 s36, 0
    s_cbranch_scc1 g1_fb_gk
    s_mov_b32 s45, 0xffff
    s_cmp_eq_u64 s[68:69], 0
    s_cbranch_scc1 g1_fb_done
    s_ff1_i32_b64 s75, s[68:69]
g1_fb_cq:
    s_lshl_b32 s34, s75, 7
    s_add_u32 s34, s34, 103833600
    v_mov_b32 v124, s34
    v_mov_b32 v125, 1
    global_atomic_add v126, v124, v125, s[14:15] sc0 sc1
    s_waitcnt vmcnt(0)
    v_readfirstlane_b32 s45, v126
    s_cmp_ge_u32 s45, 10
    s_cbranch_scc1 g1_fb_again
    s_mul_i32 s45, s45, 6
    s_lshr_b32 s34, s75, 3
    s_add_u32 s45, s45, s34
    s_add_u32 s45, s45, 64
    s_and_b32 s44, s75, 7
    s_cmp_ge_u32 s45, 123
    s_cbranch_scc1 g1_fb_again
    s_branch g1_fb_done
g1_fb_gk:
    s_add_u32 s75, s74, 29
    s_lshl_b32 s34, s75, 2
    v_mov_b32 v124, s34
    v_mov_b32 v125, 1
    global_atomic_add v126, v124, v125, s[12:13] sc0 sc1
    s_waitcnt vmcnt(0)
    v_readfirstlane_b32 s75, v126
    s_and_b32 s75, s75, 0xffff
    s_min_u32 s75, s75, 88
    s_cmp_lt_u32 s74, 4
    s_cselect_b32 s34, 0, 18
    s_cselect_b32 s35, 11, 10
    s_add_u32 s34, s34, 187
    s_mul_i32 s44, s75, s34
    s_lshr_b32 s44, s44, 11
    s_mul_i32 s34, s44, s35
    s_sub_u32 s34, s75, s34
    s_mul_i32 s34, s34, 3
    s_lshr_b32 s35, s74, 1
    s_add_u32 s34, s34, s35
    s_and_b32 s35, s74, 1
    s_lshl_b32 s35, s35, 5
    s_add_u32 s45, s34, s35
    s_cmp_ge_u32 s44, 8
    s_cbranch_scc1 g1_fb_again
g1_fb_done:
    v_mov_b32 v124, 163776
    v_mov_b32 v125, s44
    ds_write_b32 v124, v125 offset:0
    v_mov_b32 v125, s45
    ds_write_b32 v124, v125 offset:4
    s_waitcnt lgkmcnt(0)
    s_mov_b64 exec, -1
g1_f1:
    s_barrier
    v_mov_b32 v124, 163776
    ds_read_b32 v125, v124 offset:0
    s_waitcnt lgkmcnt(0)
    v_readfirstlane_b32 s44, v125
    ds_read_b32 v125, v124 offset:4
    s_waitcnt lgkmcnt(0)
    v_readfirstlane_b32 s45, v125
    s_cmp_lg_u32 s45, 0xfffe
    s_cbranch_scc1 g1_lnok
    s_add_u32 s54, s54, 4096
    s_cmp_gt_u32 s54, 1048576
    s_cbranch_scc1 wk_fail
    s_mov_b32 s49, 0xffff
    s_branch wk_ln
g1_lnok:
    s_mov_b32 s46, s42
    s_mov_b32 s72, 0
    s_cmp_eq_u32 s101, 8
    s_cbranch_scc1 g1_lda
    s_lshl_b32 s34, s42, 2
    s_add_u32 s34, s34, s19
    s_mul_i32 s34, s34, 81920
    s_add_u32 s34, s34, 67112960
    v_add_u32 v8, s34, v0
    v_add_u32 v9, 20480, v8
    v_add_u32 v10, 40960, v8
    v_add_u32 v11, 61440, v8
    global_load_dwordx4 a[0:3], v8, s[14:15] offset:-4096 sc1
    global_load_dwordx4 a[4:7], v9, s[14:15] offset:-4096 sc1
    global_load_dwordx4 a[8:11], v10, s[14:15] offset:-4096 sc1
    global_load_dwordx4 a[12:15], v11, s[14:15] offset:-4096 sc1
    global_load_dwordx4 a[16:19], v8, s[14:15] offset:-3072 sc1
    global_load_dwordx4 a[20:23], v9, s[14:15] offset:-3072 sc1
    global_load_dwordx4 a[24:27], v10, s[14:15] offset:-3072 sc1
    global_load_dwordx4 a[28:31], v11, s[14:15] offset:-3072 sc1
    global_load_dwordx4 a[32:35], v8, s[14:15] offset:-2048 sc1
    global_load_dwordx4 a[36:39], v9, s[14:15] offset:-2048 sc1
    global_load_dwordx4 a[40:43], v10, s[14:15] offset:-2048 sc1
    global_load_dwordx4 a[44:47], v11, s[14:15] offset:-2048 sc1
    global_load_dwordx4 a[48:51], v8, s[14:15] offset:-1024 sc1
    global_load_dwordx4 a[52:55], v9, s[14:15] offset:-1024 sc1
    global_load_dwordx4 a[56:59], v10, s[14:15] offset:-1024 sc1
    global_load_dwordx4 a[60:63], v11, s[14:15] offset:-1024 sc1
    global_load_dwordx4 a[64:67], v8, s[14:15] offset:0 sc1
    global_load_dwordx4 a[68:71], v9, s[14:15] offset:0 sc1
    global_load_dwordx4 a[72:75], v10, s[14:15] offset:0 sc1
    global_load_dwordx4 a[76:79], v11, s[14:15] offset:0 sc1
    global_load_dwordx4 a[80:83], v8, s[14:15] offset:1024 sc1
    global_load_dwordx4 a[84:87], v9, s[14:15] offset:1024 sc1
    global_load_dwordx4 a[88:91], v10, s[14:15] offset:1024 sc1
    global_load_dwordx4 a[92:95], v11, s[14:15] offset:1024 sc1
    global_load_dwordx4 a[96:99], v8, s[14:15] offset:2048 sc1
    global_load_dwordx4 a[100:103], v9, s[14:15] offset:2048 sc1
    global_load_dwordx4 a[104:107], v10, s[14:15] offset:2048 sc1
    global_load_dwordx4 a[108:111], v11, s[14:15] offset:2048 sc1
    global_load_dwordx4 a[112:115], v8, s[14:15] offset:3072 sc1
    global_load_dwordx4 a[116:119], v9, s[14:15] offset:3072 sc1
    global_load_dwordx4 a[120:123], v10, s[14:15] offset:3072 sc1
    global_load_dwordx4 a[124:127], v11, s[14:15] offset:3072 sc1
    s_add_u32 m0, s27, 0
    s_nop 0
    global_load_lds_dwordx4 v[4:5], off
    v_lshl_add_u64 v[4:5], v[4:5], 0, s[20:21]
    s_add_u32 m0, s27, 1056
    s_nop 0
    global_load_lds_dwordx4 v[4:5], off
    v_lshl_add_u64 v[4:5], v[4:5], 0, s[20:21]
    s_add_u32 m0, s27, 2112
    s_nop 0
    global_load_lds_dwordx4 v[4:5], off
    v_lshl_add_u64 v[4:5], v[4:5], 0, s[20:21]
    s_add_u32 m0, s27, 3168
    s_nop 0
    global_load_lds_dwordx4 v[4:5], off
    v_lshl_add_u64 v[4:5], v[4:5], 0, s[22:23]
    s_add_u32 s27, s27, 17024
    s_cmp_ge_u32 s27, 153216
    s_cselect_b32 s27, s38, s27
    s_add_u32 m0, s27, 0
    s_nop 0
    global_load_lds_dwordx4 v[4:5], off
    v_lshl_add_u64 v[4:5], v[4:5], 0, s[20:21]
    s_add_u32 m0, s27, 1056
    s_nop 0
    global_load_lds_dwordx4 v[4:5], off
    v_lshl_add_u64 v[4:5], v[4:5], 0, s[20:21]
    s_add_u32 m0, s27, 2112
    s_nop 0
    global_load_lds_dwordx4 v[4:5], off
    v_lshl_add_u64 v[4:5], v[4:5], 0, s[20:21]
    s_add_u32 m0, s27, 3168
    s_nop 0
    global_load_lds_dwordx4 v[4:5], off
    v_lshl_add_u64 v[4:5], v[4:5], 0, s[22:23]
    s_add_u32 s27, s27, 17024
    s_cmp_ge_u32 s27, 153216
    s_cselect_b32 s27, s38, s27
    s_add_u32 m0, s27, 0
    s_nop 0
    global_load_lds_dwordx4 v[4:5], off
    v_lshl_add_u64 v[4:5], v[4:5], 0, s[20:21]
    s_add_u32 m0, s27, 1056
    s_nop 0
    global_load_lds_dwordx4 v[4:5], off
    v_lshl_add_u64 v[4:5], v[4:5], 0, s[20:21]
    s_add_u32 m0, s27, 2112
    s_nop 0
    global_load_lds_dwordx4 v[4:5], off
    v_lshl_add_u64 v[4:5], v[4:5], 0, s[20:21]
    s_add_u32 m0, s27, 3168
    s_nop 0
    global_load_lds_dwordx4 v[4:5], off
    v_lshl_add_u64 v[4:5], v[4:5], 0, s[22:23]
    s_add_u32 s27, s27, 17024
    s_cmp_ge_u32 s27, 153216
    s_cselect_b32 s27, s38, s27
    s_add_u32 m0, s27, 0
    s_nop 0
    global_load_lds_dwordx4 v[4:5], off
    v_lshl_add_u64 v[4:5], v[4:5], 0, s[20:21]
    s_add_u32 m0, s27, 1056
    s_nop 0
    global_load_lds_dwordx4 v[4:5], off
    v_lshl_add_u64 v[4:5], v[4:5], 0, s[20:21]
    s_add_u32 m0, s27, 2112
    s_nop 0
    global_load_lds_dwordx4 v[4:5], off
    v_lshl_add_u64 v[4:5], v[4:5], 0, s[20:21]
    s_add_u32 m0, s27, 3168
    s_nop 0
    global_load_lds_dwordx4 v[4:5], off
    v_lshl_add_u64 v[4:5], v[4:5], 0, s[22:23]
    s_add_u32 s27, s27, 17024
    s_cmp_ge_u32 s27, 153216
    s_cselect_b32 s27, s38, s27
    s_add_u32 m0, s27, 0
    s_nop 0
    global_load_lds_dwordx4 v[4:5], off
    v_lshl_add_u64 v[4:5], v[4:5], 0, s[20:21]
    s_add_u32 m0, s27, 1056
    s_nop 0
    global_load_lds_dwordx4 v[4:5], off
    v_lshl_add_u64 v[4:5], v[4:5], 0, s[20:21]
    s_add_u32 m0, s27, 2112
    s_nop 0
    global_load_lds_dwordx4 v[4:5], off
    v_lshl_add_u64 v[4:5], v[4:5], 0, s[20:21]
    s_add_u32 m0, s27, 3168
    s_nop 0
    global_load_lds_dwordx4 v[4:5], off
    v_lshl_add_u64 v[4:5], v[4:5], 0, s[22:23]
    s_add_u32 s27, s27, 17024
    s_cmp_ge_u32 s27, 153216
    s_cselect_b32 s27, s38, s27
    s_add_u32 m0, s27, 0
    s_nop 0
    global_load_lds_dwordx4 v[4:5], off
    v_lshl_add_u64 v[4:5], v[4:5], 0, s[20:21]
    s_add_u32 m0, s27, 1056
    s_nop 0
    global_load_lds_dwordx4 v[4:5], off
    v_lshl_add_u64 v[4:5], v[4:5], 0, s[20:21]
    s_add_u32 m0, s27, 2112
    s_nop 0
    global_load_lds_dwordx4 v[4:5], off
    v_lshl_add_u64 v[4:5], v[4:5], 0, s[20:21]
    s_add_u32 m0, s27, 3168
    s_nop 0
    global_load_lds_dwordx4 v[4:5], off
    v_lshl_add_u64 v[4:5], v[4:5], 0, s[22:23]
    s_add_u32 s27, s27, 17024
    s_cmp_ge_u32 s27, 153216
    s_cselect_b32 s27, s38, s27
    s_mov_b32 s28, 1
    s_branch g1_havea
g1_tile:
    s_cmp_eq_u32 s46, s42
    s_cbranch_scc1 g1_havea
    s_cmp_lg_u32 s19, 0
    s_cbranch_scc1 g1_lw
    s_mov_b64 exec, 1
    s_lshl_b32 s34, s42, 7
    s_add_u32 s34, s34, 103809024
    v_mov_b32 v124, s34
poll_4:
    global_load_dword v125, v124, s[14:15] sc1
    s_add_u32 s54, s54, 1
    s_cmp_gt_u32 s54, 1048576
    s_cbranch_scc1 wk_fail
    s_waitcnt vmcnt(0)
    v_readfirstlane_b32 s35, v125
    s_cmp_ge_u32 s35, 16
    s_cbranch_scc1 poll_4_ok
    s_sleep 4
    s_branch poll_4
poll_4_ok:
    s_mov_b64 exec, -1
g1_lw:
    s_barrier
    s_mov_b32 s46, s42
g1_lda:
    s_lshl_b32 s34, s42, 2
    s_add_u32 s34, s34, s19
    s_mul_i32 s34, s34, 81920
    s_add_u32 s34, s34, 67112960
    v_add_u32 v8, s34, v0
    v_add_u32 v9, 20480, v8
    v_add_u32 v10, 40960, v8
    v_add_u32 v11, 61440, v8
    global_load_dwordx4 a[0:3], v8, s[14:15] offset:-4096 sc1
    global_load_dwordx4 a[4:7], v9, s[14:15] offset:-4096 sc1
    global_load_dwordx4 a[8:11], v10, s[14:15] offset:-4096 sc1
    global_load_dwordx4 a[12:15], v11, s[14:15] offset:-4096 sc1
    global_load_dwordx4 a[16:19], v8, s[14:15] offset:-3072 sc1
    global_load_dwordx4 a[20:23], v9, s[14:15] offset:-3072 sc1
    global_load_dwordx4 a[24:27], v10, s[14:15] offset:-3072 sc1
    global_load_dwordx4 a[28:31], v11, s[14:15] offset:-3072 sc1
    global_load_dwordx4 a[32:35], v8, s[14:15] offset:-2048 sc1
    global_load_dwordx4 a[36:39], v9, s[14:15] offset:-2048 sc1
    global_load_dwordx4 a[40:43], v10, s[14:15] offset:-2048 sc1
    global_load_dwordx4 a[44:47], v11, s[14:15] offset:-2048 sc1
    global_load_dwordx4 a[48:51], v8, s[14:15] offset:-1024 sc1
    global_load_dwordx4 a[52:55], v9, s[14:15] offset:-1024 sc1
    global_load_dwordx4 a[56:59], v10, s[14:15] offset:-1024 sc1
    global_load_dwordx4 a[60:63], v11, s[14:15] offset:-1024 sc1
    global_load_dwordx4 a[64:67], v8, s[14:15] offset:0 sc1
    global_load_dwordx4 a[68:71], v9, s[14:15] offset:0 sc1
    global_load_dwordx4 a[72:75], v10, s[14:15] offset:0 sc1
    global_load_dwordx4 a[76:79], v11, s[14:15] offset:0 sc1
    global_load_dwordx4 a[80:83], v8, s[14:15] offset:1024 sc1
    global_load_dwordx4 a[84:87], v9, s[14:15] offset:1024 sc1
    global_load_dwordx4 a[88:91], v10, s[14:15] offset:1024 sc1
    global_load_dwordx4 a[92:95], v11, s[14:15] offset:1024 sc1
    global_load_dwordx4 a[96:99], v8, s[14:15] offset:2048 sc1
    global_load_dwordx4 a[100:103], v9, s[14:15] offset:2048 sc1
    global_load_dwordx4 a[104:107], v10, s[14:15] offset:2048 sc1
    global_load_dwordx4 a[108:111], v11, s[14:15] offset:2048 sc1
    global_load_dwordx4 a[112:115], v8, s[14:15] offset:3072 sc1
    global_load_dwordx4 a[116:119], v9, s[14:15] offset:3072 sc1
    global_load_dwordx4 a[120:123], v10, s[14:15] offset:3072 sc1
    global_load_dwordx4 a[124:127], v11, s[14:15] offset:3072 sc1
    s_mov_b32 s28, 1
g1_havea:
    s_cmp_ge_u32 s45, 123
    s_cbranch_scc1 g1_d1_e
    s_cmp_ge_u32 s45, 96
    s_cbranch_scc1 g1_d1_f
    s_cmp_lt_u32 s45, 32
    s_cselect_b32 s30, s58, s60
    s_cselect_b32 s31, s59, s61
    s_cmp_ge_u32 s45, 64
    s_cselect_b32 s30, s56, s30
    s_cselect_b32 s31, s57, s31
    s_and_b32 s34, s45, 31
    s_lshl_b32 s34, s34, 8
    s_add_u32 s30, s30, s34
    s_addc_u32 s31, s31, 0
    s_mov_b64 s[32:33], s[30:31]
    s_mov_b32 s29, 8192
    s_branch g1_d1_e
g1_d1_f:
    s_sub_u32 s34, s45, 96
    s_lshl_b32 s34, s34, 7
    s_add_u32 s30, s64, s34
    s_addc_u32 s31, s65, 0
    s_add_u32 s32, s66, s34
    s_addc_u32 s33, s67, 0
    s_sub_u32 s32, s32, 128
    s_subb_u32 s33, s33, 0
    s_mov_b32 s29, 3456
g1_d1_e:
    s_cmp_ge_u32 s43, 96
    s_cbranch_scc1 g1_oh
    s_lshl_b32 s34, s42, 21
    s_and_b32 s35, s43, 31
    s_lshl_b32 s35, s35, 13
    s_add_u32 s34, s34, s35
    s_lshr_b32 s35, s43, 5
    s_lshl_b32 s35, s35, 24
    s_add_u32 s34, s34, s35
    s_branch g1_o
g1_oh:
    s_mul_i32 s34, s42, 884736
    s_lshl_b32 s35, s43, 11
    s_add_u32 s34, s34, s35
    s_add_u32 s34, s34, 71106560
g1_o:
    s_add_u32 s24, s14, s34
    s_addc_u32 s25, s15, 0
    s_lshr_b32 s35, s43, 5
    s_cmp_eq_u32 s35, 1
    s_cbranch_scc1 g1_v
    s_cmp_eq_u32 s28, 0
    s_cbranch_scc1 gsw_fa_5
    s_waitcnt vmcnt(24)
    v_add_u32 v8, 8192, v8
    v_add_u32 v9, 8192, v9
    v_add_u32 v10, 8192, v10
    v_add_u32 v11, 8192, v11
    global_load_dwordx4 a[128:131], v8, s[14:15] offset:-4096 sc1
    global_load_dwordx4 a[132:135], v9, s[14:15] offset:-4096 sc1
    global_load_dwordx4 a[136:139], v10, s[14:15] offset:-4096 sc1
    global_load_dwordx4 a[140:143], v11, s[14:15] offset:-4096 sc1
    global_load_dwordx4 a[144:147], v8, s[14:15] offset:-3072 sc1
    global_load_dwordx4 a[148:151], v9, s[14:15] offset:-3072 sc1
    global_load_dwordx4 a[152:155], v10, s[14:15] offset:-3072 sc1
    global_load_dwordx4 a[156:159], v11, s[14:15] offset:-3072 sc1
    global_load_dwordx4 a[160:163], v8, s[14:15] offset:-2048 sc1
    global_load_dwordx4 a[164:167], v9, s[14:15] offset:-2048 sc1
    global_load_dwordx4 a[168:171], v10, s[14:15] offset:-2048 sc1
    global_load_dwordx4 a[172:175], v11, s[14:15] offset:-2048 sc1
    global_load_dwordx4 a[176:179], v8, s[14:15] offset:-1024 sc1
    global_load_dwordx4 a[180:183], v9, s[14:15] offset:-1024 sc1
    global_load_dwordx4 a[184:187], v10, s[14:15] offset:-1024 sc1
    global_load_dwordx4 a[188:191], v11, s[14:15] offset:-1024 sc1
gsw_fa_5:
    s_barrier
    v_add_u32 v2, s26, v1
    s_add_u32 s26, s26, 17024
    s_cmp_ge_u32 s26, 153216
    s_cselect_b32 s26, 0, s26
    ds_read_b64_tr_b16 v[16:17], v2 offset:0
    ds_read_b64_tr_b16 v[18:19], v2 offset:4224
    ds_read_b64_tr_b16 v[20:21], v2 offset:32
    ds_read_b64_tr_b16 v[22:23], v2 offset:4256
    ds_read_b64_tr_b16 v[24:25], v2 offset:64
    ds_read_b64_tr_b16 v[26:27], v2 offset:4288
    ds_read_b64_tr_b16 v[28:29], v2 offset:96
    ds_read_b64_tr_b16 v[30:31], v2 offset:4320
    ds_read_b64_tr_b16 v[32:33], v2 offset:128
    ds_read_b64_tr_b16 v[34:35], v2 offset:4352
    ds_read_b64_tr_b16 v[36:37], v2 offset:160
    ds_read_b64_tr_b16 v[38:39], v2 offset:4384
    ds_read_b64_tr_b16 v[40:41], v2 offset:192
    ds_read_b64_tr_b16 v[42:43], v2 offset:4416
    ds_read_b64_tr_b16 v[44:45], v2 offset:224
    ds_read_b64_tr_b16 v[46:47], v2 offset:4448
    s_waitcnt lgkmcnt(8)
    v_mfma_f32_16x16x32_bf16 v[64:67], v[16:19], a[0:3], 0
    ds_read_b64_tr_b16 v[48:49], v2 offset:512
    v_mfma_f32_16x16x32_bf16 v[68:71], v[20:23], a[0:3], 0
    ds_read_b64_tr_b16 v[50:51], v2 offset:4736
    v_mfma_f32_16x16x32_bf16 v[72:75], v[24:27], a[0:3], 0
    ds_read_b64_tr_b16 v[52:53], v2 offset:544
    v_mfma_f32_16x16x32_bf16 v[76:79], v[28:31], a[0:3], 0
    ds_read_b64_tr_b16 v[54:55], v2 offset:4768
    v_mfma_f32_16x16x32_bf16 v[96:99], v[16:19], a[4:7], 0
    ds_read_b64_tr_b16 v[56:57], v2 offset:576
    v_mfma_f32_16x16x32_bf16 v[100:103], v[20:23], a[4:7], 0
    ds_read_b64_tr_b16 v[58:59], v2 offset:4800
    v_mfma_f32_16x16x32_bf16 v[104:107], v[24:27], a[4:7], 0
    ds_read_b64_tr_b16 v[60:61], v2 offset:608
    v_mfma_f32_16x16x32_bf16 v[108:111], v[28:31], a[4:7], 0
    ds_read_b64_tr_b16 v[62:63], v2 offset:4832
    v_mfma_f32_16x16x32_bf16 v[128:131], v[16:19], a[8:11], 0
    v_mfma_f32_16x16x32_bf16 v[132:135], v[20:23], a[8:11], 0
    v_mfma_f32_16x16x32_bf16 v[136:139], v[24:27], a[8:11], 0
    v_mfma_f32_16x16x32_bf16 v[140:143], v[28:31], a[8:11], 0
    v_mfma_f32_16x16x32_bf16 v[160:163], v[16:19], a[12:15], 0
    v_mfma_f32_16x16x32_bf16 v[164:167], v[20:23], a[12:15], 0
    v_mfma_f32_16x16x32_bf16 v[168:171], v[24:27], a[12:15], 0
    v_mfma_f32_16x16x32_bf16 v[172:175], v[28:31], a[12:15], 0
    s_waitcnt lgkmcnt(8)
    v_mfma_f32_16x16x32_bf16 v[80:83], v[32:35], a[0:3], 0
    ds_read_b64_tr_b16 v[16:17], v2 offset:640
    v_mfma_f32_16x16x32_bf16 v[84:87], v[36:39], a[0:3], 0
    ds_read_b64_tr_b16 v[18:19], v2 offset:4864
    v_mfma_f32_16x16x32_bf16 v[88:91], v[40:43], a[0:3], 0
    ds_read_b64_tr_b16 v[20:21], v2 offset:672
    v_mfma_f32_16x16x32_bf16 v[92:95], v[44:47], a[0:3], 0
    ds_read_b64_tr_b16 v[22:23], v2 offset:4896
    v_mfma_f32_16x16x32_bf16 v[112:115], v[32:35], a[4:7], 0
    ds_read_b64_tr_b16 v[24:25], v2 offset:704
    v_mfma_f32_16x16x32_bf16 v[116:119], v[36:39], a[4:7], 0
    ds_read_b64_tr_b16 v[26:27], v2 offset:4928
    v_mfma_f32_16x16x32_bf16 v[120:123], v[40:43], a[4:7], 0
    ds_read_b64_tr_b16 v[28:29], v2 offset:736
    v_mfma_f32_16x16x32_bf16 v[124:127], v[44:47], a[4:7], 0
    ds_read_b64_tr_b16 v[30:31], v2 offset:4960
    v_mfma_f32_16x16x32_bf16 v[144:147], v[32:35], a[8:11], 0
    v_mfma_f32_16x16x32_bf16 v[148:151], v[36:39], a[8:11], 0
    v_mfma_f32_16x16x32_bf16 v[152:155], v[40:43], a[8:11], 0
    v_mfma_f32_16x16x32_bf16 v[156:159], v[44:47], a[8:11], 0
    v_mfma_f32_16x16x32_bf16 v[176:179], v[32:35], a[12:15], 0
    v_mfma_f32_16x16x32_bf16 v[180:183], v[36:39], a[12:15], 0
    v_mfma_f32_16x16x32_bf16 v[184:187], v[40:43], a[12:15], 0
    v_mfma_f32_16x16x32_bf16 v[188:191], v[44:47], a[12:15], 0
    s_nop 0
    s_barrier
    s_waitcnt lgkmcnt(8)
    v_mfma_f32_16x16x32_bf16 v[64:67], v[48:51], a[16:19], v[64:67]
    v_add_u32 v2, s26, v1
    v_mfma_f32_16x16x32_bf16 v[68:71], v[52:55], a[16:19], v[68:71]
    s_add_u32 s26, s26, 17024
    s_cmp_ge_u32 s26, 153216
    s_cselect_b32 s26, 0, s26
    v_mfma_f32_16x16x32_bf16 v[72:75], v[56:59], a[16:19], v[72:75]
    ds_read_b64_tr_b16 v[32:33], v2 offset:0
    v_mfma_f32_16x16x32_bf16 v[76:79], v[60:63], a[16:19], v[76:79]
    ds_read_b64_tr_b16 v[34:35], v2 offset:4224
    v_mfma_f32_16x16x32_bf16 v[96:99], v[48:51], a[20:23], v[96:99]
    ds_read_b64_tr_b16 v[36:37], v2 offset:32
    v_mfma_f32_16x16x32_bf16 v[100:103], v[52:55], a[20:23], v[100:103]
    ds_read_b64_tr_b16 v[38:39], v2 offset:4256
    v_mfma_f32_16x16x32_bf16 v[104:107], v[56:59], a[20:23], v[104:107]
    ds_read_b64_tr_b16 v[40:41], v2 offset:64
    v_mfma_f32_16x16x32_bf16 v[108:111], v[60:63], a[20:23], v[108:111]
    ds_read_b64_tr_b16 v[42:43], v2 offset:4288
    v_mfma_f32_16x16x32_bf16 v[128:131], v[48:51], a[24:27], v[128:131]
    ds_read_b64_tr_b16 v[44:45], v2 offset:96
    v_mfma_f32_16x16x32_bf16 v[132:135], v[52:55], a[24:27], v[132:135]
    ds_read_b64_tr_b16 v[46:47], v2 offset:4320
    v_mfma_f32_16x16x32_bf16 v[136:139], v[56:59], a[24:27], v[136:139]
    v_mfma_f32_16x16x32_bf16 v[140:143], v[60:63], a[24:27], v[140:143]
    v_mfma_f32_16x16x32_bf16 v[160:163], v[48:51], a[28:31], v[160:163]
    v_mfma_f32_16x16x32_bf16 v[164:167], v[52:55], a[28:31], v[164:167]
    v_mfma_f32_16x16x32_bf16 v[168:171], v[56:59], a[28:31], v[168:171]
    v_mfma_f32_16x16x32_bf16 v[172:175], v[60:63], a[28:31], v[172:175]
    s_waitcnt lgkmcnt(8)
    v_mfma_f32_16x16x32_bf16 v[80:83], v[16:19], a[16:19], v[80:83]
    ds_read_b64_tr_b16 v[48:49], v2 offset:128
    ds_read_b64_tr_b16 v[50:51], v2 offset:4352
    v_mfma_f32_16x16x32_bf16 v[84:87], v[20:23], a[16:19], v[84:87]
    ds_read_b64_tr_b16 v[52:53], v2 offset:160
    ds_read_b64_tr_b16 v[54:55], v2 offset:4384
    v_mfma_f32_16x16x32_bf16 v[88:91], v[24:27], a[16:19], v[88:91]
    ds_read_b64_tr_b16 v[56:57], v2 offset:192
    ds_read_b64_tr_b16 v[58:59], v2 offset:4416
    v_mfma_f32_16x16x32_bf16 v[92:95], v[28:31], a[16:19], v[92:95]
    ds_read_b64_tr_b16 v[60:61], v2 offset:224
    ds_read_b64_tr_b16 v[62:63], v2 offset:4448
    v_mfma_f32_16x16x32_bf16 v[112:115], v[16:19], a[20:23], v[112:115]
    s_add_u32 m0, s27, 0
    s_nop 0
    global_load_lds_dwordx4 v[4:5], off
    v_mfma_f32_16x16x32_bf16 v[116:119], v[20:23], a[20:23], v[116:119]
    v_lshl_add_u64 v[4:5], v[4:5], 0, s[20:21]
    s_add_u32 m0, s27, 1056
    v_mfma_f32_16x16x32_bf16 v[120:123], v[24:27], a[20:23], v[120:123]
    global_load_lds_dwordx4 v[4:5], off
    v_lshl_add_u64 v[4:5], v[4:5], 0, s[20:21]
    v_mfma_f32_16x16x32_bf16 v[124:127], v[28:31], a[20:23], v[124:127]
    s_add_u32 m0, s27, 2112
    s_nop 0
    global_load_lds_dwordx4 v[4:5], off
    v_mfma_f32_16x16x32_bf16 v[144:147], v[16:19], a[24:27], v[144:147]
    v_lshl_add_u64 v[4:5], v[4:5], 0, s[20:21]
    s_add_u32 m0, s27, 3168
    v_mfma_f32_16x16x32_bf16 v[148:151], v[20:23], a[24:27], v[148:151]
    global_load_lds_dwordx4 v[4:5], off
    v_lshl_add_u64 v[4:5], v[4:5], 0, s[22:23]
    v_mfma_f32_16x16x32_bf16 v[152:155], v[24:27], a[24:27], v[152:155]
    s_add_u32 s27, s27, 17024
    s_cmp_ge_u32 s27, 153216
    s_cselect_b32 s27, s38, s27
    v_mfma_f32_16x16x32_bf16 v[156:159], v[28:31], a[24:27], v[156:159]
    v_mfma_f32_16x16x32_bf16 v[176:179], v[16:19], a[28:31], v[176:179]
    v_mfma_f32_16x16x32_bf16 v[180:183], v[20:23], a[28:31], v[180:183]
    v_mfma_f32_16x16x32_bf16 v[184:187], v[24:27], a[28:31], v[184:187]
    v_mfma_f32_16x16x32_bf16 v[188:191], v[28:31], a[28:31], v[188:191]
    s_cmp_eq_u32 s28, 0
    s_cbranch_scc1 gsw_fa_6
    s_waitcnt vmcnt(36)
    global_load_dwordx4 a[192:195], v8, s[14:15] offset:0 sc1
    global_load_dwordx4 a[196:199], v9, s[14:15] offset:0 sc1
    global_load_dwordx4 a[200:203], v10, s[14:15] offset:0 sc1
    global_load_dwordx4 a[204:207], v11, s[14:15] offset:0 sc1
    global_load_dwordx4 a[208:211], v8, s[14:15] offset:1024 sc1
    global_load_dwordx4 a[212:215], v9, s[14:15] offset:1024 sc1
    global_load_dwordx4 a[216:219], v10, s[14:15] offset:1024 sc1
    global_load_dwordx4 a[220:223], v11, s[14:15] offset:1024 sc1
    global_load_dwordx4 a[224:227], v8, s[14:15] offset:2048 sc1
    global_load_dwordx4 a[228:231], v9, s[14:15] offset:2048 sc1
    global_load_dwordx4 a[232:235], v10, s[14:15] offset:2048 sc1
    global_load_dwordx4 a[236:239], v11, s[14:15] offset:2048 sc1
    global_load_dwordx4 a[240:243], v8, s[14:15] offset:3072 sc1
    global_load_dwordx4 a[244:247], v9, s[14:15] offset:3072 sc1
    global_load_dwordx4 a[248:251], v10, s[14:15] offset:3072 sc1
    global_load_dwordx4 a[252:255], v11, s[14:15] offset:3072 sc1
gsw_fa_6:
    s_waitcnt lgkmcnt(8)
    v_mfma_f32_16x16x32_bf16 v[64:67], v[32:35], a[32:35], v[64:67]
    ds_read_b64_tr_b16 v[16:17], v2 offset:512
    v_mfma_f32_16x16x32_bf16 v[68:71], v[36:39], a[32:35], v[68:71]
    ds_read_b64_tr_b16 v[18:19], v2 offset:4736
    v_mfma_f32_16x16x32_bf16 v[72:75], v[40:43], a[32:35], v[72:75]
    ds_read_b64_tr_b16 v[20:21], v2 offset:544
    v_mfma_f32_16x16x32_bf16 v[76:79], v[44:47], a[32:35], v[76:79]
    ds_read_b64_tr_b16 v[22:23], v2 offset:4768
    v_mfma_f32_16x16x32_bf16 v[96:99], v[32:35], a[36:39], v[96:99]
    ds_read_b64_tr_b16 v[24:25], v2 offset:576
    v_mfma_f32_16x16x32_bf16 v[100:103], v[36:39], a[36:39], v[100:103]
    ds_read_b64_tr_b16 v[26:27], v2 offset:4800
    v_mfma_f32_16x16x32_bf16 v[104:107], v[40:43], a[36:39], v[104:107]
    ds_read_b64_tr_b16 v[28:29], v2 offset:608
    v_mfma_f32_16x16x32_bf16 v[108:111], v[44:47], a[36:39], v[108:111]
    ds_read_b64_tr_b16 v[30:31], v2 offset:4832
    v_mfma_f32_16x16x32_bf16 v[128:131], v[32:35], a[40:43], v[128:131]
    v_mfma_f32_16x16x32_bf16 v[132:135], v[36:39], a[40:43], v[132:135]
    v_mfma_f32_16x16x32_bf16 v[136:139], v[40:43], a[40:43], v[136:139]
    v_mfma_f32_16x16x32_bf16 v[140:143], v[44:47], a[40:43], v[140:143]
    v_mfma_f32_16x16x32_bf16 v[160:163], v[32:35], a[44:47], v[160:163]
    v_mfma_f32_16x16x32_bf16 v[164:167], v[36:39], a[44:47], v[164:167]
    v_mfma_f32_16x16x32_bf16 v[168:171], v[40:43], a[44:47], v[168:171]
    v_mfma_f32_16x16x32_bf16 v[172:175], v[44:47], a[44:47], v[172:175]
    s_waitcnt lgkmcnt(8)
    v_mfma_f32_16x16x32_bf16 v[80:83], v[48:51], a[32:35], v[80:83]
    ds_read_b64_tr_b16 v[32:33], v2 offset:640
    v_mfma_f32_16x16x32_bf16 v[84:87], v[52:55], a[32:35], v[84:87]
    ds_read_b64_tr_b16 v[34:35], v2 offset:4864
    v_mfma_f32_16x16x32_bf16 v[88:91], v[56:59], a[32:35], v[88:91]
    ds_read_b64_tr_b16 v[36:37], v2 offset:672
    v_mfma_f32_16x16x32_bf16 v[92:95], v[60:63], a[32:35], v[92:95]
    ds_read_b64_tr_b16 v[38:39], v2 offset:4896
    v_mfma_f32_16x16x32_bf16 v[112:115], v[48:51], a[36:39], v[112:115]
    ds_read_b64_tr_b16 v[40:41], v2 offset:704
    v_mfma_f32_16x16x32_bf16 v[116:119], v[52:55], a[36:39], v[116:119]
    ds_read_b64_tr_b16 v[42:43], v2 offset:4928
    v_mfma_f32_16x16x32_bf16 v[120:123], v[56:59], a[36:39], v[120:123]
    ds_read_b64_tr_b16 v[44:45], v2 offset:736
    v_mfma_f32_16x16x32_bf16 v[124:127], v[60:63], a[36:39], v[124:127]
    ds_read_b64_tr_b16 v[46:47], v2 offset:4960
    v_mfma_f32_16x16x32_bf16 v[144:147], v[48:51], a[40:43], v[144:147]
    v_mfma_f32_16x16x32_bf16 v[148:151], v[52:55], a[40:43], v[148:151]
    v_mfma_f32_16x16x32_bf16 v[152:155], v[56:59], a[40:43], v[152:155]
    v_mfma_f32_16x16x32_bf16 v[156:159], v[60:63], a[40:43], v[156:159]
    v_mfma_f32_16x16x32_bf16 v[176:179], v[48:51], a[44:47], v[176:179]
    v_mfma_f32_16x16x32_bf16 v[180:183], v[52:55], a[44:47], v[180:183]
    v_mfma_f32_16x16x32_bf16 v[184:187], v[56:59], a[44:47], v[184:187]
    v_mfma_f32_16x16x32_bf16 v[188:191], v[60:63], a[44:47], v[188:191]
    s_nop 0
    s_barrier
    s_waitcnt lgkmcnt(8)
    v_mfma_f32_16x16x32_bf16 v[64:67], v[16:19], a[48:51], v[64:67]
    v_add_u32 v2, s26, v1
    v_mfma_f32_16x16x32_bf16 v[68:71], v[20:23], a[48:51], v[68:71]
    s_add_u32 s26, s26, 17024
    s_cmp_ge_u32 s26, 153216
    s_cselect_b32 s26, 0, s26
    v_mfma_f32_16x16x32_bf16 v[72:75], v[24:27], a[48:51], v[72:75]
    ds_read_b64_tr_b16 v[48:49], v2 offset:0
    v_mfma_f32_16x16x32_bf16 v[76:79], v[28:31], a[48:51], v[76:79]
    ds_read_b64_tr_b16 v[50:51], v2 offset:4224
    v_mfma_f32_16x16x32_bf16 v[96:99], v[16:19], a[52:55], v[96:99]
    ds_read_b64_tr_b16 v[52:53], v2 offset:32
    v_mfma_f32_16x16x32_bf16 v[100:103], v[20:23], a[52:55], v[100:103]
    ds_read_b64_tr_b16 v[54:55], v2 offset:4256
    v_mfma_f32_16x16x32_bf16 v[104:107], v[24:27], a[52:55], v[104:107]
    ds_read_b64_tr_b16 v[56:57], v2 offset:64
    v_mfma_f32_16x16x32_bf16 v[108:111], v[28:31], a[52:55], v[108:111]
    ds_read_b64_tr_b16 v[58:59], v2 offset:4288
    v_mfma_f32_16x16x32_bf16 v[128:131], v[16:19], a[56:59], v[128:131]
    ds_read_b64_tr_b16 v[60:61], v2 offset:96
    v_mfma_f32_16x16x32_bf16 v[132:135], v[20:23], a[56:59], v[132:135]
    ds_read_b64_tr_b16 v[62:63], v2 offset:4320
    v_mfma_f32_16x16x32_bf16 v[136:139], v[24:27], a[56:59], v[136:139]
    v_mfma_f32_16x16x32_bf16 v[140:143], v[28:31], a[56:59], v[140:143]
    v_mfma_f32_16x16x32_bf16 v[160:163], v[16:19], a[60:63], v[160:163]
    v_mfma_f32_16x16x32_bf16 v[164:167], v[20:23], a[60:63], v[164:167]
    v_mfma_f32_16x16x32_bf16 v[168:171], v[24:27], a[60:63], v[168:171]
    v_mfma_f32_16x16x32_bf16 v[172:175], v[28:31], a[60:63], v[172:175]
    s_waitcnt lgkmcnt(8)
    v_mfma_f32_16x16x32_bf16 v[80:83], v[32:35], a[48:51], v[80:83]
    ds_read_b64_tr_b16 v[16:17], v2 offset:128
    ds_read_b64_tr_b16 v[18:19], v2 offset:4352
    v_mfma_f32_16x16x32_bf16 v[84:87], v[36:39], a[48:51], v[84:87]
    ds_read_b64_tr_b16 v[20:21], v2 offset:160
    ds_read_b64_tr_b16 v[22:23], v2 offset:4384
    v_mfma_f32_16x16x32_bf16 v[88:91], v[40:43], a[48:51], v[88:91]
    ds_read_b64_tr_b16 v[24:25], v2 offset:192
    ds_read_b64_tr_b16 v[26:27], v2 offset:4416
    v_mfma_f32_16x16x32_bf16 v[92:95], v[44:47], a[48:51], v[92:95]
    ds_read_b64_tr_b16 v[28:29], v2 offset:224
    ds_read_b64_tr_b16 v[30:31], v2 offset:4448
    v_mfma_f32_16x16x32_bf16 v[112:115], v[32:35], a[52:55], v[112:115]
    s_add_u32 m0, s27, 0
    s_nop 0
    global_load_lds_dwordx4 v[4:5], off
    v_mfma_f32_16x16x32_bf16 v[116:119], v[36:39], a[52:55], v[116:119]
    v_lshl_add_u64 v[4:5], v[4:5], 0, s[20:21]
    s_add_u32 m0, s27, 1056
    v_mfma_f32_16x16x32_bf16 v[120:123], v[40:43], a[52:55], v[120:123]
    global_load_lds_dwordx4 v[4:5], off
    v_lshl_add_u64 v[4:5], v[4:5], 0, s[20:21]
    v_mfma_f32_16x16x32_bf16 v[124:127], v[44:47], a[52:55], v[124:127]
    s_add_u32 m0, s27, 2112
    s_nop 0
    global_load_lds_dwordx4 v[4:5], off
    v_mfma_f32_16x16x32_bf16 v[144:147], v[32:35], a[56:59], v[144:147]
    v_lshl_add_u64 v[4:5], v[4:5], 0, s[20:21]
    s_add_u32 m0, s27, 3168
    v_mfma_f32_16x16x32_bf16 v[148:151], v[36:39], a[56:59], v[148:151]
    global_load_lds_dwordx4 v[4:5], off
    v_lshl_add_u64 v[4:5], v[4:5], 0, s[22:23]
    v_mfma_f32_16x16x32_bf16 v[152:155], v[40:43], a[56:59], v[152:155]
    s_add_u32 s27, s27, 17024
    s_cmp_ge_u32 s27, 153216
    s_cselect_b32 s27, s38, s27
    v_mfma_f32_16x16x32_bf16 v[156:159], v[44:47], a[56:59], v[156:159]
    v_mfma_f32_16x16x32_bf16 v[176:179], v[32:35], a[60:63], v[176:179]
    v_mfma_f32_16x16x32_bf16 v[180:183], v[36:39], a[60:63], v[180:183]
    v_mfma_f32_16x16x32_bf16 v[184:187], v[40:43], a[60:63], v[184:187]
    v_mfma_f32_16x16x32_bf16 v[188:191], v[44:47], a[60:63], v[188:191]
    s_cmp_eq_u32 s28, 0
    s_cbranch_scc1 gsw_fa_7
    s_waitcnt vmcnt(48)
    v_add_u32 v8, 8192, v8
    v_add_u32 v9, 8192, v9
    v_add_u32 v10, 8192, v10
    v_add_u32 v11, 8192, v11
    global_load_dwordx4 v[192:195], v8, s[14:15] offset:-4096 sc1
    global_load_dwordx4 v[196:199], v9, s[14:15] offset:-4096 sc1
    global_load_dwordx4 v[200:203], v10, s[14:15] offset:-4096 sc1
    global_load_dwordx4 v[204:207], v11, s[14:15] offset:-4096 sc1
    global_load_dwordx4 v[208:211], v8, s[14:15] offset:-3072 sc1
    global_load_dwordx4 v[212:215], v9, s[14:15] offset:-3072 sc1
    global_load_dwordx4 v[216:219], v10, s[14:15] offset:-3072 sc1
    global_load_dwordx4 v[220:223], v11, s[14:15] offset:-3072 sc1
    global_load_dwordx4 v[224:227], v8, s[14:15] offset:-2048 sc1
    global_load_dwordx4 v[228:231], v9, s[14:15] offset:-2048 sc1
    global_load_dwordx4 v[232:235], v10, s[14:15] offset:-2048 sc1
    global_load_dwordx4 v[236:239], v11, s[14:15] offset:-2048 sc1
    global_load_dwordx4 v[240:243], v8, s[14:15] offset:-1024 sc1
    global_load_dwordx4 v[244:247], v9, s[14:15] offset:-1024 sc1
    global_load_dwordx4 v[248:251], v10, s[14:15] offset:-1024 sc1
    global_load_dwordx4 v[252:255], v11, s[14:15] offset:-1024 sc1
gsw_fa_7:
    s_waitcnt lgkmcnt(8)
    v_mfma_f32_16x16x32_bf16 v[64:67], v[48:51], a[64:67], v[64:67]
    ds_read_b64_tr_b16 v[32:33], v2 offset:512
    v_mfma_f32_16x16x32_bf16 v[68:71], v[52:55], a[64:67], v[68:71]
    ds_read_b64_tr_b16 v[34:35], v2 offset:4736
    v_mfma_f32_16x16x32_bf16 v[72:75], v[56:59], a[64:67], v[72:75]
    ds_read_b64_tr_b16 v[36:37], v2 offset:544
    v_mfma_f32_16x16x32_bf16 v[76:79], v[60:63], a[64:67], v[76:79]
    ds_read_b64_tr_b16 v[38:39], v2 offset:4768
    v_mfma_f32_16x16x32_bf16 v[96:99], v[48:51], a[68:71], v[96:99]
    ds_read_b64_tr_b16 v[40:41], v2 offset:576
    v_mfma_f32_16x16x32_bf16 v[100:103], v[52:55], a[68:71], v[100:103]
    ds_read_b64_tr_b16 v[42:43], v2 offset:4800
    v_mfma_f32_16x16x32_bf16 v[104:107], v[56:59], a[68:71], v[104:107]
    ds_read_b64_tr_b16 v[44:45], v2 offset:608
    v_mfma_f32_16x16x32_bf16 v[108:111], v[60:63], a[68:71], v[108:111]
    ds_read_b64_tr_b16 v[46:47], v2 offset:4832
    v_mfma_f32_16x16x32_bf16 v[128:131], v[48:51], a[72:75], v[128:131]
    v_mfma_f32_16x16x32_bf16 v[132:135], v[52:55], a[72:75], v[132:135]
    v_mfma_f32_16x16x32_bf16 v[136:139], v[56:59], a[72:75], v[136:139]
    v_mfma_f32_16x16x32_bf16 v[140:143], v[60:63], a[72:75], v[140:143]
    v_mfma_f32_16x16x32_bf16 v[160:163], v[48:51], a[76:79], v[160:163]
    v_mfma_f32_16x16x32_bf16 v[164:167], v[52:55], a[76:79], v[164:167]
    v_mfma_f32_16x16x32_bf16 v[168:171], v[56:59], a[76:79], v[168:171]
    v_mfma_f32_16x16x32_bf16 v[172:175], v[60:63], a[76:79], v[172:175]
    s_waitcnt lgkmcnt(8)
    v_mfma_f32_16x16x32_bf16 v[80:83], v[16:19], a[64:67], v[80:83]
    ds_read_b64_tr_b16 v[48:49], v2 offset:640
    v_mfma_f32_16x16x32_bf16 v[84:87], v[20:23], a[64:67], v[84:87]
    ds_read_b64_tr_b16 v[50:51], v2 offset:4864
    v_mfma_f32_16x16x32_bf16 v[88:91], v[24:27], a[64:67], v[88:91]
    ds_read_b64_tr_b16 v[52:53], v2 offset:672
    v_mfma_f32_16x16x32_bf16 v[92:95], v[28:31], a[64:67], v[92:95]
    ds_read_b64_tr_b16 v[54:55], v2 offset:4896
    v_mfma_f32_16x16x32_bf16 v[112:115], v[16:19], a[68:71], v[112:115]
    ds_read_b64_tr_b16 v[56:57], v2 offset:704
    v_mfma_f32_16x16x32_bf16 v[116:119], v[20:23], a[68:71], v[116:119]
    ds_read_b64_tr_b16 v[58:59], v2 offset:4928
    v_mfma_f32_16x16x32_bf16 v[120:123], v[24:27], a[68:71], v[120:123]
    ds_read_b64_tr_b16 v[60:61], v2 offset:736
    v_mfma_f32_16x16x32_bf16 v[124:127], v[28:31], a[68:71], v[124:127]
    ds_read_b64_tr_b16 v[62:63], v2 offset:4960
    v_mfma_f32_16x16x32_bf16 v[144:147], v[16:19], a[72:75], v[144:147]
    v_mfma_f32_16x16x32_bf16 v[148:151], v[20:23], a[72:75], v[148:151]
    v_mfma_f32_16x16x32_bf16 v[152:155], v[24:27], a[72:75], v[152:155]
    v_mfma_f32_16x16x32_bf16 v[156:159], v[28:31], a[72:75], v[156:159]
    v_mfma_f32_16x16x32_bf16 v[176:179], v[16:19], a[76:79], v[176:179]
    v_mfma_f32_16x16x32_bf16 v[180:183], v[20:23], a[76:79], v[180:183]
    v_mfma_f32_16x16x32_bf16 v[184:187], v[24:27], a[76:79], v[184:187]
    v_mfma_f32_16x16x32_bf16 v[188:191], v[28:31], a[76:79], v[188:191]
    s_nop 0
    s_barrier
    s_waitcnt lgkmcnt(8)
    v_mfma_f32_16x16x32_bf16 v[64:67], v[32:35], a[80:83], v[64:67]
    v_add_u32 v2, s26, v1
    s_add_u32 s26, s26, 17024
    s_cmp_ge_u32 s26, 153216
    s_cselect_b32 s26, 0, s26
    v_mfma_f32_16x16x32_bf16 v[68:71], v[36:39], a[80:83], v[68:71]
    ds_read_b64_tr_b16 v[16:17], v2 offset:0
    ds_read_b64_tr_b16 v[18:19], v2 offset:4224
    v_mfma_f32_16x16x32_bf16 v[72:75], v[40:43], a[80:83], v[72:75]
    ds_read_b64_tr_b16 v[20:21], v2 offset:32
    ds_read_b64_tr_b16 v[22:23], v2 offset:4256
    v_mfma_f32_16x16x32_bf16 v[76:79], v[44:47], a[80:83], v[76:79]
    ds_read_b64_tr_b16 v[24:25], v2 offset:64
    ds_read_b64_tr_b16 v[26:27], v2 offset:4288
    v_mfma_f32_16x16x32_bf16 v[96:99], v[32:35], a[84:87], v[96:99]
    ds_read_b64_tr_b16 v[28:29], v2 offset:96
    ds_read_b64_tr_b16 v[30:31], v2 offset:4320
    v_mfma_f32_16x16x32_bf16 v[100:103], v[36:39], a[84:87], v[100:103]
    s_mov_b32 s20, s29
    s_mul_i32 s22, s29, 61
    v_mul_u32_u24 v12, s29, v6
    v_mfma_f32_16x16x32_bf16 v[104:107], v[40:43], a[84:87], v[104:107]
    v_lshl_add_u32 v12, v7, 4, v12
    v_cmp_lt_u32 vcc, 7, v7
    v_mfma_f32_16x16x32_bf16 v[108:111], v[44:47], a[84:87], v[108:111]
    v_mov_b32 v13, s30
    v_mov_b32 v14, s32
    v_mfma_f32_16x16x32_bf16 v[128:131], v[32:35], a[88:91], v[128:131]
    v_cndmask_b32 v4, v13, v14, vcc
    v_mov_b32 v13, s31
    v_mfma_f32_16x16x32_bf16 v[132:135], v[36:39], a[88:91], v[132:135]
    v_mov_b32 v14, s33
    v_cndmask_b32 v5, v13, v14, vcc
    v_mfma_f32_16x16x32_bf16 v[136:139], v[40:43], a[88:91], v[136:139]
    v_add_co_u32 v4, vcc, v4, v12
    s_nop 1
    v_addc_co_u32 v5, vcc, 0, v5, vcc
    v_mfma_f32_16x16x32_bf16 v[140:143], v[44:47], a[88:91], v[140:143]
    v_mfma_f32_16x16x32_bf16 v[160:163], v[32:35], a[92:95], v[160:163]
    v_mfma_f32_16x16x32_bf16 v[164:167], v[36:39], a[92:95], v[164:167]
    v_mfma_f32_16x16x32_bf16 v[168:171], v[40:43], a[92:95], v[168:171]
    v_mfma_f32_16x16x32_bf16 v[172:175], v[44:47], a[92:95], v[172:175]
    s_waitcnt lgkmcnt(8)
    v_mfma_f32_16x16x32_bf16 v[80:83], v[48:51], a[80:83], v[80:83]
    ds_read_b64_tr_b16 v[32:33], v2 offset:128
    ds_read_b64_tr_b16 v[34:35], v2 offset:4352
    v_mfma_f32_16x16x32_bf16 v[84:87], v[52:55], a[80:83], v[84:87]
    ds_read_b64_tr_b16 v[36:37], v2 offset:160
    ds_read_b64_tr_b16 v[38:39], v2 offset:4384
    v_mfma_f32_16x16x32_bf16 v[88:91], v[56:59], a[80:83], v[88:91]
    ds_read_b64_tr_b16 v[40:41], v2 offset:192
    ds_read_b64_tr_b16 v[42:43], v2 offset:4416
    v_mfma_f32_16x16x32_bf16 v[92:95], v[60:63], a[80:83], v[92:95]
    ds_read_b64_tr_b16 v[44:45], v2 offset:224
    ds_read_b64_tr_b16 v[46:47], v2 offset:4448
    v_mfma_f32_16x16x32_bf16 v[112:115], v[48:51], a[84:87], v[112:115]
    s_add_u32 m0, s27, 0
    s_nop 0
    global_load_lds_dwordx4 v[4:5], off
    v_mfma_f32_16x16x32_bf16 v[116:119], v[52:55], a[84:87], v[116:119]
    v_lshl_add_u64 v[4:5], v[4:5], 0, s[20:21]
    s_add_u32 m0, s27, 1056
    v_mfma_f32_16x16x32_bf16 v[120:123], v[56:59], a[84:87], v[120:123]
    global_load_lds_dwordx4 v[4:5], off
    v_lshl_add_u64 v[4:5], v[4:5], 0, s[20:21]
    v_mfma_f32_16x16x32_bf16 v[124:127], v[60:63], a[84:87], v[124:127]
    s_add_u32 m0, s27, 2112
    s_nop 0
    global_load_lds_dwordx4 v[4:5], off
    v_mfma_f32_16x16x32_bf16 v[144:147], v[48:51], a[88:91], v[144:147]
    v_lshl_add_u64 v[4:5], v[4:5], 0, s[20:21]
    s_add_u32 m0, s27, 3168
    v_mfma_f32_16x16x32_bf16 v[148:151], v[52:55], a[88:91], v[148:151]
    global_load_lds_dwordx4 v[4:5], off
    v_lshl_add_u64 v[4:5], v[4:5], 0, s[22:23]
    v_mfma_f32_16x16x32_bf16 v[152:155], v[56:59], a[88:91], v[152:155]
    s_add_u32 s27, s27, 17024
    s_cmp_ge_u32 s27, 153216
    s_cselect_b32 s27, s38, s27
    v_mfma_f32_16x16x32_bf16 v[156:159], v[60:63], a[88:91], v[156:159]
    v_mfma_f32_16x16x32_bf16 v[176:179], v[48:51], a[92:95], v[176:179]
    v_mfma_f32_16x16x32_bf16 v[180:183], v[52:55], a[92:95], v[180:183]
    v_mfma_f32_16x16x32_bf16 v[184:187], v[56:59], a[92:95], v[184:187]
    v_mfma_f32_16x16x32_bf16 v[188:191], v[60:63], a[92:95], v[188:191]
    s_cmp_eq_u32 s28, 0
    s_cbranch_scc1 gsw_fa_8
    s_waitcnt vmcnt(60)
gsw_fa_8:
    s_waitcnt lgkmcnt(8)
    v_mfma_f32_16x16x32_bf16 v[64:67], v[16:19], a[96:99], v[64:67]
    ds_read_b64_tr_b16 v[48:49], v2 offset:512
    v_mfma_f32_16x16x32_bf16 v[68:71], v[20:23], a[96:99], v[68:71]
    ds_read_b64_tr_b16 v[50:51], v2 offset:4736
    v_mfma_f32_16x16x32_bf16 v[72:75], v[24:27], a[96:99], v[72:75]
    ds_read_b64_tr_b16 v[52:53], v2 offset:544
    v_mfma_f32_16x16x32_bf16 v[76:79], v[28:31], a[96:99], v[76:79]
    ds_read_b64_tr_b16 v[54:55], v2 offset:4768
    v_mfma_f32_16x16x32_bf16 v[96:99], v[16:19], a[100:103], v[96:99]
    ds_read_b64_tr_b16 v[56:57], v2 offset:576
    v_mfma_f32_16x16x32_bf16 v[100:103], v[20:23], a[100:103], v[100:103]
    ds_read_b64_tr_b16 v[58:59], v2 offset:4800
    v_mfma_f32_16x16x32_bf16 v[104:107], v[24:27], a[100:103], v[104:107]
    ds_read_b64_tr_b16 v[60:61], v2 offset:608
    v_mfma_f32_16x16x32_bf16 v[108:111], v[28:31], a[100:103], v[108:111]
    ds_read_b64_tr_b16 v[62:63], v2 offset:4832
    v_mfma_f32_16x16x32_bf16 v[128:131], v[16:19], a[104:107], v[128:131]
    v_mfma_f32_16x16x32_bf16 v[132:135], v[20:23], a[104:107], v[132:135]
    v_mfma_f32_16x16x32_bf16 v[136:139], v[24:27], a[104:107], v[136:139]
    v_mfma_f32_16x16x32_bf16 v[140:143], v[28:31], a[104:107], v[140:143]
    v_mfma_f32_16x16x32_bf16 v[160:163], v[16:19], a[108:111], v[160:163]
    v_mfma_f32_16x16x32_bf16 v[164:167], v[20:23], a[108:111], v[164:167]
    v_mfma_f32_16x16x32_bf16 v[168:171], v[24:27], a[108:111], v[168:171]
    v_mfma_f32_16x16x32_bf16 v[172:175], v[28:31], a[108:111], v[172:175]
    s_waitcnt lgkmcnt(8)
    v_mfma_f32_16x16x32_bf16 v[80:83], v[32:35], a[96:99], v[80:83]
    ds_read_b64_tr_b16 v[16:17], v2 offset:640
    v_mfma_f32_16x16x32_bf16 v[84:87], v[36:39], a[96:99], v[84:87]
    ds_read_b64_tr_b16 v[18:19], v2 offset:4864
    v_mfma_f32_16x16x32_bf16 v[88:91], v[40:43], a[96:99], v[88:91]
    ds_read_b64_tr_b16 v[20:21], v2 offset:672
    v_mfma_f32_16x16x32_bf16 v[92:95], v[44:47], a[96:99], v[92:95]
    ds_read_b64_tr_b16 v[22:23], v2 offset:4896
    v_mfma_f32_16x16x32_bf16 v[112:115], v[32:35], a[100:103], v[112:115]
    ds_read_b64_tr_b16 v[24:25], v2 offset:704
    v_mfma_f32_16x16x32_bf16 v[116:119], v[36:39], a[100:103], v[116:119]
    ds_read_b64_tr_b16 v[26:27], v2 offset:4928
    v_mfma_f32_16x16x32_bf16 v[120:123], v[40:43], a[100:103], v[120:123]
    ds_read_b64_tr_b16 v[28:29], v2 offset:736
    v_mfma_f32_16x16x32_bf16 v[124:127], v[44:47], a[100:103], v[124:127]
    ds_read_b64_tr_b16 v[30:31], v2 offset:4960
    v_mfma_f32_16x16x32_bf16 v[144:147], v[32:35], a[104:107], v[144:147]
    v_mfma_f32_16x16x32_bf16 v[148:151], v[36:39], a[104:107], v[148:151]
    v_mfma_f32_16x16x32_bf16 v[152:155], v[40:43], a[104:107], v[152:155]
    v_mfma_f32_16x16x32_bf16 v[156:159], v[44:47], a[104:107], v[156:159]
    v_mfma_f32_16x16x32_bf16 v[176:179], v[32:35], a[108:111], v[176:179]
    v_mfma_f32_16x16x32_bf16 v[180:183], v[36:39], a[108:111], v[180:183]
    v_mfma_f32_16x16x32_bf16 v[184:187], v[40:43], a[108:111], v[184:187]
    v_mfma_f32_16x16x32_bf16 v[188:191], v[44:47], a[108:111], v[188:191]
    s_nop 0
    s_barrier
    s_waitcnt lgkmcnt(8)
    v_mfma_f32_16x16x32_bf16 v[64:67], v[48:51], a[112:115], v[64:67]
    v_add_u32 v2, s26, v1
    v_mfma_f32_16x16x32_bf16 v[68:71], v[52:55], a[112:115], v[68:71]
    s_add_u32 s26, s26, 17024
    s_cmp_ge_u32 s26, 153216
    s_cselect_b32 s26, 0, s26
    v_mfma_f32_16x16x32_bf16 v[72:75], v[56:59], a[112:115], v[72:75]
    ds_read_b64_tr_b16 v[32:33], v2 offset:0
    v_mfma_f32_16x16x32_bf16 v[76:79], v[60:63], a[112:115], v[76:79]
    ds_read_b64_tr_b16 v[34:35], v2 offset:4224
    v_mfma_f32_16x16x32_bf16 v[96:99], v[48:51], a[116:119], v[96:99]
    ds_read_b64_tr_b16 v[36:37], v2 offset:32
    v_mfma_f32_16x16x32_bf16 v[100:103], v[52:55], a[116:119], v[100:103]
    ds_read_b64_tr_b16 v[38:39], v2 offset:4256
    v_mfma_f32_16x16x32_bf16 v[104:107], v[56:59], a[116:119], v[104:107]
    ds_read_b64_tr_b16 v[40:41], v2 offset:64
    v_mfma_f32_16x16x32_bf16 v[108:111], v[60:63], a[116:119], v[108:111]
    ds_read_b64_tr_b16 v[42:43], v2 offset:4288
    v_mfma_f32_16x16x32_bf16 v[128:131], v[48:51], a[120:123], v[128:131]
    ds_read_b64_tr_b16 v[44:45], v2 offset:96
    v_mfma_f32_16x16x32_bf16 v[132:135], v[52:55], a[120:123], v[132:135]
    ds_read_b64_tr_b16 v[46:47], v2 offset:4320
    v_mfma_f32_16x16x32_bf16 v[136:139], v[56:59], a[120:123], v[136:139]
    v_mfma_f32_16x16x32_bf16 v[140:143], v[60:63], a[120:123], v[140:143]
    v_mfma_f32_16x16x32_bf16 v[160:163], v[48:51], a[124:127], v[160:163]
    v_mfma_f32_16x16x32_bf16 v[164:167], v[52:55], a[124:127], v[164:167]
    v_mfma_f32_16x16x32_bf16 v[168:171], v[56:59], a[124:127], v[168:171]
    v_mfma_f32_16x16x32_bf16 v[172:175], v[60:63], a[124:127], v[172:175]
    s_waitcnt lgkmcnt(8)
    v_mfma_f32_16x16x32_bf16 v[80:83], v[16:19], a[112:115], v[80:83]
    ds_read_b64_tr_b16 v[48:49], v2 offset:128
    ds_read_b64_tr_b16 v[50:51], v2 offset:4352
    v_mfma_f32_16x16x32_bf16 v[84:87], v[20:23], a[112:115], v[84:87]
    ds_read_b64_tr_b16 v[52:53], v2 offset:160
    ds_read_b64_tr_b16 v[54:55], v2 offset:4384
    v_mfma_f32_16x16x32_bf16 v[88:91], v[24:27], a[112:115], v[88:91]
    ds_read_b64_tr_b16 v[56:57], v2 offset:192
    ds_read_b64_tr_b16 v[58:59], v2 offset:4416
    v_mfma_f32_16x16x32_bf16 v[92:95], v[28:31], a[112:115], v[92:95]
    ds_read_b64_tr_b16 v[60:61], v2 offset:224
    ds_read_b64_tr_b16 v[62:63], v2 offset:4448
    v_mfma_f32_16x16x32_bf16 v[112:115], v[16:19], a[116:119], v[112:115]
    s_add_u32 m0, s27, 0
    s_nop 0
    global_load_lds_dwordx4 v[4:5], off
    v_mfma_f32_16x16x32_bf16 v[116:119], v[20:23], a[116:119], v[116:119]
    v_lshl_add_u64 v[4:5], v[4:5], 0, s[20:21]
    s_add_u32 m0, s27, 1056
    v_mfma_f32_16x16x32_bf16 v[120:123], v[24:27], a[116:119], v[120:123]
    global_load_lds_dwordx4 v[4:5], off
    v_lshl_add_u64 v[4:5], v[4:5], 0, s[20:21]
    v_mfma_f32_16x16x32_bf16 v[124:127], v[28:31], a[116:119], v[124:127]
    s_add_u32 m0, s27, 2112
    s_nop 0
    global_load_lds_dwordx4 v[4:5], off
    v_mfma_f32_16x16x32_bf16 v[144:147], v[16:19], a[120:123], v[144:147]
    v_lshl_add_u64 v[4:5], v[4:5], 0, s[20:21]
    s_add_u32 m0, s27, 3168
    v_mfma_f32_16x16x32_bf16 v[148:151], v[20:23], a[120:123], v[148:151]
    global_load_lds_dwordx4 v[4:5], off
    v_lshl_add_u64 v[4:5], v[4:5], 0, s[22:23]
    v_mfma_f32_16x16x32_bf16 v[152:155], v[24:27], a[120:123], v[152:155]
    s_add_u32 s27, s27, 17024
    s_cmp_ge_u32 s27, 153216
    s_cselect_b32 s27, s38, s27
    v_mfma_f32_16x16x32_bf16 v[156:159], v[28:31], a[120:123], v[156:159]
    v_mfma_f32_16x16x32_bf16 v[176:179], v[16:19], a[124:127], v[176:179]
    v_mfma_f32_16x16x32_bf16 v[180:183], v[20:23], a[124:127], v[180:183]
    v_mfma_f32_16x16x32_bf16 v[184:187], v[24:27], a[124:127], v[184:187]
    v_mfma_f32_16x16x32_bf16 v[188:191], v[28:31], a[124:127], v[188:191]
    s_cmp_eq_u32 s28, 0
    s_cbranch_scc1 gsw_fa_9
    s_waitcnt vmcnt(56)
gsw_fa_9:
    s_waitcnt lgkmcnt(8)
    v_mfma_f32_16x16x32_bf16 v[64:67], v[32:35], a[128:131], v[64:67]
    ds_read_b64_tr_b16 v[16:17], v2 offset:512
    v_mfma_f32_16x16x32_bf16 v[68:71], v[36:39], a[128:131], v[68:71]
    ds_read_b64_tr_b16 v[18:19], v2 offset:4736
    v_mfma_f32_16x16x32_bf16 v[72:75], v[40:43], a[128:131], v[72:75]
    ds_read_b64_tr_b16 v[20:21], v2 offset:544
    v_mfma_f32_16x16x32_bf16 v[76:79], v[44:47], a[128:131], v[76:79]
    ds_read_b64_tr_b16 v[22:23], v2 offset:4768
    v_mfma_f32_16x16x32_bf16 v[96:99], v[32:35], a[132:135], v[96:99]
    ds_read_b64_tr_b16 v[24:25], v2 offset:576
    v_mfma_f32_16x16x32_bf16 v[100:103], v[36:39], a[132:135], v[100:103]
    ds_read_b64_tr_b16 v[26:27], v2 offset:4800
    v_mfma_f32_16x16x32_bf16 v[104:107], v[40:43], a[132:135], v[104:107]
    ds_read_b64_tr_b16 v[28:29], v2 offset:608
    v_mfma_f32_16x16x32_bf16 v[108:111], v[44:47], a[132:135], v[108:111]
    ds_read_b64_tr_b16 v[30:31], v2 offset:4832
    v_mfma_f32_16x16x32_bf16 v[128:131], v[32:35], a[136:139], v[128:131]
    v_mfma_f32_16x16x32_bf16 v[132:135], v[36:39], a[136:139], v[132:135]
    v_mfma_f32_16x16x32_bf16 v[136:139], v[40:43], a[136:139], v[136:139]
    v_mfma_f32_16x16x32_bf16 v[140:143], v[44:47], a[136:139], v[140:143]
    v_mfma_f32_16x16x32_bf16 v[160:163], v[32:35], a[140:143], v[160:163]
    v_mfma_f32_16x16x32_bf16 v[164:167], v[36:39], a[140:143], v[164:167]
    v_mfma_f32_16x16x32_bf16 v[168:171], v[40:43], a[140:143], v[168:171]
    v_mfma_f32_16x16x32_bf16 v[172:175], v[44:47], a[140:143], v[172:175]
    s_waitcnt lgkmcnt(8)
    v_mfma_f32_16x16x32_bf16 v[80:83], v[48:51], a[128:131], v[80:83]
    ds_read_b64_tr_b16 v[32:33], v2 offset:640
    v_mfma_f32_16x16x32_bf16 v[84:87], v[52:55], a[128:131], v[84:87]
    ds_read_b64_tr_b16 v[34:35], v2 offset:4864
    v_mfma_f32_16x16x32_bf16 v[88:91], v[56:59], a[128:131], v[88:91]
    ds_read_b64_tr_b16 v[36:37], v2 offset:672
    v_mfma_f32_16x16x32_bf16 v[92:95], v[60:63], a[128:131], v[92:95]
    ds_read_b64_tr_b16 v[38:39], v2 offset:4896
    v_mfma_f32_16x16x32_bf16 v[112:115], v[48:51], a[132:135], v[112:115]
    ds_read_b64_tr_b16 v[40:41], v2 offset:704
    v_mfma_f32_16x16x32_bf16 v[116:119], v[52:55], a[132:135], v[116:119]
    ds_read_b64_tr_b16 v[42:43], v2 offset:4928
    v_mfma_f32_16x16x32_bf16 v[120:123], v[56:59], a[132:135], v[120:123]
    ds_read_b64_tr_b16 v[44:45], v2 offset:736
    v_mfma_f32_16x16x32_bf16 v[124:127], v[60:63], a[132:135], v[124:127]
    ds_read_b64_tr_b16 v[46:47], v2 offset:4960
    v_mfma_f32_16x16x32_bf16 v[144:147], v[48:51], a[136:139], v[144:147]
    v_mfma_f32_16x16x32_bf16 v[148:151], v[52:55], a[136:139], v[148:151]
    v_mfma_f32_16x16x32_bf16 v[152:155], v[56:59], a[136:139], v[152:155]
    v_mfma_f32_16x16x32_bf16 v[156:159], v[60:63], a[136:139], v[156:159]
    v_mfma_f32_16x16x32_bf16 v[176:179], v[48:51], a[140:143], v[176:179]
    v_mfma_f32_16x16x32_bf16 v[180:183], v[52:55], a[140:143], v[180:183]
    v_mfma_f32_16x16x32_bf16 v[184:187], v[56:59], a[140:143], v[184:187]
    v_mfma_f32_16x16x32_bf16 v[188:191], v[60:63], a[140:143], v[188:191]
    s_nop 0
    s_barrier
    s_waitcnt lgkmcnt(8)
    v_mfma_f32_16x16x32_bf16 v[64:67], v[16:19], a[144:147], v[64:67]
    v_add_u32 v2, s26, v1
    v_mfma_f32_16x16x32_bf16 v[68:71], v[20:23], a[144:147], v[68:71]
    s_add_u32 s26, s26, 17024
    s_cmp_ge_u32 s26, 153216
    s_cselect_b32 s26, 0, s26
    v_mfma_f32_16x16x32_bf16 v[72:75], v[24:27], a[144:147], v[72:75]
    ds_read_b64_tr_b16 v[48:49], v2 offset:0
    v_mfma_f32_16x16x32_bf16 v[76:79], v[28:31], a[144:147], v[76:79]
    ds_read_b64_tr_b16 v[50:51], v2 offset:4224
    v_mfma_f32_16x16x32_bf16 v[96:99], v[16:19], a[148:151], v[96:99]
    ds_read_b64_tr_b16 v[52:53], v2 offset:32
    v_mfma_f32_16x16x32_bf16 v[100:103], v[20:23], a[148:151], v[100:103]
    ds_read_b64_tr_b16 v[54:55], v2 offset:4256
    v_mfma_f32_16x16x32_bf16 v[104:107], v[24:27], a[148:151], v[104:107]
    ds_read_b64_tr_b16 v[56:57], v2 offset:64
    v_mfma_f32_16x16x32_bf16 v[108:111], v[28:31], a[148:151], v[108:111]
    ds_read_b64_tr_b16 v[58:59], v2 offset:4288
    v_mfma_f32_16x16x32_bf16 v[128:131], v[16:19], a[152:155], v[128:131]
    ds_read_b64_tr_b16 v[60:61], v2 offset:96
    v_mfma_f32_16x16x32_bf16 v[132:135], v[20:23], a[152:155], v[132:135]
    ds_read_b64_tr_b16 v[62:63], v2 offset:4320
    v_mfma_f32_16x16x32_bf16 v[136:139], v[24:27], a[152:155], v[136:139]
    v_mfma_f32_16x16x32_bf16 v[140:143], v[28:31], a[152:155], v[140:143]
    v_mfma_f32_16x16x32_bf16 v[160:163], v[16:19], a[156:159], v[160:163]
    v_mfma_f32_16x16x32_bf16 v[164:167], v[20:23], a[156:159], v[164:167]
    v_mfma_f32_16x16x32_bf16 v[168:171], v[24:27], a[156:159], v[168:171]
    v_mfma_f32_16x16x32_bf16 v[172:175], v[28:31], a[156:159], v[172:175]
    s_waitcnt lgkmcnt(8)
    v_mfma_f32_16x16x32_bf16 v[80:83], v[32:35], a[144:147], v[80:83]
    ds_read_b64_tr_b16 v[16:17], v2 offset:128
    ds_read_b64_tr_b16 v[18:19], v2 offset:4352
    v_mfma_f32_16x16x32_bf16 v[84:87], v[36:39], a[144:147], v[84:87]
    ds_read_b64_tr_b16 v[20:21], v2 offset:160
    ds_read_b64_tr_b16 v[22:23], v2 offset:4384
    v_mfma_f32_16x16x32_bf16 v[88:91], v[40:43], a[144:147], v[88:91]
    ds_read_b64_tr_b16 v[24:25], v2 offset:192
    ds_read_b64_tr_b16 v[26:27], v2 offset:4416
    v_mfma_f32_16x16x32_bf16 v[92:95], v[44:47], a[144:147], v[92:95]
    ds_read_b64_tr_b16 v[28:29], v2 offset:224
    ds_read_b64_tr_b16 v[30:31], v2 offset:4448
    v_mfma_f32_16x16x32_bf16 v[112:115], v[32:35], a[148:151], v[112:115]
    s_add_u32 m0, s27, 0
    s_nop 0
    global_load_lds_dwordx4 v[4:5], off
    v_mfma_f32_16x16x32_bf16 v[116:119], v[36:39], a[148:151], v[116:119]
    v_lshl_add_u64 v[4:5], v[4:5], 0, s[20:21]
    s_add_u32 m0, s27, 1056
    v_mfma_f32_16x16x32_bf16 v[120:123], v[40:43], a[148:151], v[120:123]
    global_load_lds_dwordx4 v[4:5], off
    v_lshl_add_u64 v[4:5], v[4:5], 0, s[20:21]
    v_mfma_f32_16x16x32_bf16 v[124:127], v[44:47], a[148:151], v[124:127]
    s_add_u32 m0, s27, 2112
    s_nop 0
    global_load_lds_dwordx4 v[4:5], off
    v_mfma_f32_16x16x32_bf16 v[144:147], v[32:35], a[152:155], v[144:147]
    v_lshl_add_u64 v[4:5], v[4:5], 0, s[20:21]
    s_add_u32 m0, s27, 3168
    v_mfma_f32_16x16x32_bf16 v[148:151], v[36:39], a[152:155], v[148:151]
    global_load_lds_dwordx4 v[4:5], off
    v_lshl_add_u64 v[4:5], v[4:5], 0, s[22:23]
    v_mfma_f32_16x16x32_bf16 v[152:155], v[40:43], a[152:155], v[152:155]
    s_add_u32 s27, s27, 17024
    s_cmp_ge_u32 s27, 153216
    s_cselect_b32 s27, s38, s27
    v_mfma_f32_16x16x32_bf16 v[156:159], v[44:47], a[152:155], v[156:159]
    v_mfma_f32_16x16x32_bf16 v[176:179], v[32:35], a[156:159], v[176:179]
    v_mfma_f32_16x16x32_bf16 v[180:183], v[36:39], a[156:159], v[180:183]
    v_mfma_f32_16x16x32_bf16 v[184:187], v[40:43], a[156:159], v[184:187]
    v_mfma_f32_16x16x32_bf16 v[188:191], v[44:47], a[156:159], v[188:191]
    s_cmp_eq_u32 s28, 0
    s_cbranch_scc1 gsw_fa_10
    s_waitcnt vmcnt(52)
gsw_fa_10:
    s_waitcnt lgkmcnt(8)
    v_mfma_f32_16x16x32_bf16 v[64:67], v[48:51], a[160:163], v[64:67]
    ds_read_b64_tr_b16 v[32:33], v2 offset:512
    v_mfma_f32_16x16x32_bf16 v[68:71], v[52:55], a[160:163], v[68:71]
    ds_read_b64_tr_b16 v[34:35], v2 offset:4736
    v_mfma_f32_16x16x32_bf16 v[72:75], v[56:59], a[160:163], v[72:75]
    ds_read_b64_tr_b16 v[36:37], v2 offset:544
    v_mfma_f32_16x16x32_bf16 v[76:79], v[60:63], a[160:163], v[76:79]
    ds_read_b64_tr_b16 v[38:39], v2 offset:4768
    v_mfma_f32_16x16x32_bf16 v[96:99], v[48:51], a[164:167], v[96:99]
    ds_read_b64_tr_b16 v[40:41], v2 offset:576
    v_mfma_f32_16x16x32_bf16 v[100:103], v[52:55], a[164:167], v[100:103]
    ds_read_b64_tr_b16 v[42:43], v2 offset:4800
    v_mfma_f32_16x16x32_bf16 v[104:107], v[56:59], a[164:167], v[104:107]
    ds_read_b64_tr_b16 v[44:45], v2 offset:608
    v_mfma_f32_16x16x32_bf16 v[108:111], v[60:63], a[164:167], v[108:111]
    ds_read_b64_tr_b16 v[46:47], v2 offset:4832
    v_mfma_f32_16x16x32_bf16 v[128:131], v[48:51], a[168:171], v[128:131]
    v_mfma_f32_16x16x32_bf16 v[132:135], v[52:55], a[168:171], v[132:135]
    v_mfma_f32_16x16x32_bf16 v[136:139], v[56:59], a[168:171], v[136:139]
    v_mfma_f32_16x16x32_bf16 v[140:143], v[60:63], a[168:171], v[140:143]
    v_mfma_f32_16x16x32_bf16 v[160:163], v[48:51], a[172:175], v[160:163]
    v_mfma_f32_16x16x32_bf16 v[164:167], v[52:55], a[172:175], v[164:167]
    v_mfma_f32_16x16x32_bf16 v[168:171], v[56:59], a[172:175], v[168:171]
    v_mfma_f32_16x16x32_bf16 v[172:175], v[60:63], a[172:175], v[172:175]
    s_waitcnt lgkmcnt(8)
    v_mfma_f32_16x16x32_bf16 v[80:83], v[16:19], a[160:163], v[80:83]
    ds_read_b64_tr_b16 v[48:49], v2 offset:640
    v_mfma_f32_16x16x32_bf16 v[84:87], v[20:23], a[160:163], v[84:87]
    ds_read_b64_tr_b16 v[50:51], v2 offset:4864
    v_mfma_f32_16x16x32_bf16 v[88:91], v[24:27], a[160:163], v[88:91]
    ds_read_b64_tr_b16 v[52:53], v2 offset:672
    v_mfma_f32_16x16x32_bf16 v[92:95], v[28:31], a[160:163], v[92:95]
    ds_read_b64_tr_b16 v[54:55], v2 offset:4896
    v_mfma_f32_16x16x32_bf16 v[112:115], v[16:19], a[164:167], v[112:115]
    ds_read_b64_tr_b16 v[56:57], v2 offset:704
    v_mfma_f32_16x16x32_bf16 v[116:119], v[20:23], a[164:167], v[116:119]
    ds_read_b64_tr_b16 v[58:59], v2 offset:4928
    v_mfma_f32_16x16x32_bf16 v[120:123], v[24:27], a[164:167], v[120:123]
    ds_read_b64_tr_b16 v[60:61], v2 offset:736
    v_mfma_f32_16x16x32_bf16 v[124:127], v[28:31], a[164:167], v[124:127]
    ds_read_b64_tr_b16 v[62:63], v2 offset:4960
    v_mfma_f32_16x16x32_bf16 v[144:147], v[16:19], a[168:171], v[144:147]
    v_mfma_f32_16x16x32_bf16 v[148:151], v[20:23], a[168:171], v[148:151]
    v_mfma_f32_16x16x32_bf16 v[152:155], v[24:27], a[168:171], v[152:155]
    v_mfma_f32_16x16x32_bf16 v[156:159], v[28:31], a[168:171], v[156:159]
    v_mfma_f32_16x16x32_bf16 v[176:179], v[16:19], a[172:175], v[176:179]
    v_mfma_f32_16x16x32_bf16 v[180:183], v[20:23], a[172:175], v[180:183]
    v_mfma_f32_16x16x32_bf16 v[184:187], v[24:27], a[172:175], v[184:187]
    v_mfma_f32_16x16x32_bf16 v[188:191], v[28:31], a[172:175], v[188:191]
    s_nop 0
    s_barrier
    s_waitcnt lgkmcnt(8)
    v_mfma_f32_16x16x32_bf16 v[64:67], v[32:35], a[176:179], v[64:67]
    v_add_u32 v2, s26, v1
    v_mfma_f32_16x16x32_bf16 v[68:71], v[36:39], a[176:179], v[68:71]
    s_add_u32 s26, s26, 17024
    s_cmp_ge_u32 s26, 153216
    s_cselect_b32 s26, 0, s26
    v_mfma_f32_16x16x32_bf16 v[72:75], v[40:43], a[176:179], v[72:75]
    ds_read_b64_tr_b16 v[16:17], v2 offset:0
    v_mfma_f32_16x16x32_bf16 v[76:79], v[44:47], a[176:179], v[76:79]
    ds_read_b64_tr_b16 v[18:19], v2 offset:4224
    v_mfma_f32_16x16x32_bf16 v[96:99], v[32:35], a[180:183], v[96:99]
    ds_read_b64_tr_b16 v[20:21], v2 offset:32
    v_mfma_f32_16x16x32_bf16 v[100:103], v[36:39], a[180:183], v[100:103]
    ds_read_b64_tr_b16 v[22:23], v2 offset:4256
    v_mfma_f32_16x16x32_bf16 v[104:107], v[40:43], a[180:183], v[104:107]
    ds_read_b64_tr_b16 v[24:25], v2 offset:64
    v_mfma_f32_16x16x32_bf16 v[108:111], v[44:47], a[180:183], v[108:111]
    ds_read_b64_tr_b16 v[26:27], v2 offset:4288
    v_mfma_f32_16x16x32_bf16 v[128:131], v[32:35], a[184:187], v[128:131]
    ds_read_b64_tr_b16 v[28:29], v2 offset:96
    v_mfma_f32_16x16x32_bf16 v[132:135], v[36:39], a[184:187], v[132:135]
    ds_read_b64_tr_b16 v[30:31], v2 offset:4320
    v_mfma_f32_16x16x32_bf16 v[136:139], v[40:43], a[184:187], v[136:139]
    v_mfma_f32_16x16x32_bf16 v[140:143], v[44:47], a[184:187], v[140:143]
    v_mfma_f32_16x16x32_bf16 v[160:163], v[32:35], a[188:191], v[160:163]
    v_mfma_f32_16x16x32_bf16 v[164:167], v[36:39], a[188:191], v[164:167]
    v_mfma_f32_16x16x32_bf16 v[168:171], v[40:43], a[188:191], v[168:171]
    v_mfma_f32_16x16x32_bf16 v[172:175], v[44:47], a[188:191], v[172:175]
    s_waitcnt lgkmcnt(8)
    v_mfma_f32_16x16x32_bf16 v[80:83], v[48:51], a[176:179], v[80:83]
    ds_read_b64_tr_b16 v[32:33], v2 offset:128
    ds_read_b64_tr_b16 v[34:35], v2 offset:4352
    v_mfma_f32_16x16x32_bf16 v[84:87], v[52:55], a[176:179], v[84:87]
    ds_read_b64_tr_b16 v[36:37], v2 offset:160
    ds_read_b64_tr_b16 v[38:39], v2 offset:4384
    v_mfma_f32_16x16x32_bf16 v[88:91], v[56:59], a[176:179], v[88:91]
    ds_read_b64_tr_b16 v[40:41], v2 offset:192
    ds_read_b64_tr_b16 v[42:43], v2 offset:4416
    v_mfma_f32_16x16x32_bf16 v[92:95], v[60:63], a[176:179], v[92:95]
    ds_read_b64_tr_b16 v[44:45], v2 offset:224
    ds_read_b64_tr_b16 v[46:47], v2 offset:4448
    v_mfma_f32_16x16x32_bf16 v[112:115], v[48:51], a[180:183], v[112:115]
    s_add_u32 m0, s27, 0
    s_nop 0
    global_load_lds_dwordx4 v[4:5], off
    v_mfma_f32_16x16x32_bf16 v[116:119], v[52:55], a[180:183], v[116:119]
    v_lshl_add_u64 v[4:5], v[4:5], 0, s[20:21]
    s_add_u32 m0, s27, 1056
    v_mfma_f32_16x16x32_bf16 v[120:123], v[56:59], a[180:183], v[120:123]
    global_load_lds_dwordx4 v[4:5], off
    v_lshl_add_u64 v[4:5], v[4:5], 0, s[20:21]
    v_mfma_f32_16x16x32_bf16 v[124:127], v[60:63], a[180:183], v[124:127]
    s_add_u32 m0, s27, 2112
    s_nop 0
    global_load_lds_dwordx4 v[4:5], off
    v_mfma_f32_16x16x32_bf16 v[144:147], v[48:51], a[184:187], v[144:147]
    v_lshl_add_u64 v[4:5], v[4:5], 0, s[20:21]
    s_add_u32 m0, s27, 3168
    v_mfma_f32_16x16x32_bf16 v[148:151], v[52:55], a[184:187], v[148:151]
    global_load_lds_dwordx4 v[4:5], off
    v_lshl_add_u64 v[4:5], v[4:5], 0, s[22:23]
    v_mfma_f32_16x16x32_bf16 v[152:155], v[56:59], a[184:187], v[152:155]
    s_add_u32 s27, s27, 17024
    s_cmp_ge_u32 s27, 153216
    s_cselect_b32 s27, s38, s27
    v_mfma_f32_16x16x32_bf16 v[156:159], v[60:63], a[184:187], v[156:159]
    v_mfma_f32_16x16x32_bf16 v[176:179], v[48:51], a[188:191], v[176:179]
    v_mfma_f32_16x16x32_bf16 v[180:183], v[52:55], a[188:191], v[180:183]
    v_mfma_f32_16x16x32_bf16 v[184:187], v[56:59], a[188:191], v[184:187]
    v_mfma_f32_16x16x32_bf16 v[188:191], v[60:63], a[188:191], v[188:191]
    s_cmp_eq_u32 s28, 0
    s_cbranch_scc1 gsw_fa_11
    s_waitcnt vmcnt(44)
gsw_fa_11:
    s_waitcnt lgkmcnt(8)
    v_mfma_f32_16x16x32_bf16 v[64:67], v[16:19], a[192:195], v[64:67]
    ds_read_b64_tr_b16 v[48:49], v2 offset:512
    v_mfma_f32_16x16x32_bf16 v[68:71], v[20:23], a[192:195], v[68:71]
    ds_read_b64_tr_b16 v[50:51], v2 offset:4736
    v_mfma_f32_16x16x32_bf16 v[72:75], v[24:27], a[192:195], v[72:75]
    ds_read_b64_tr_b16 v[52:53], v2 offset:544
    v_mfma_f32_16x16x32_bf16 v[76:79], v[28:31], a[192:195], v[76:79]
    ds_read_b64_tr_b16 v[54:55], v2 offset:4768
    v_mfma_f32_16x16x32_bf16 v[96:99], v[16:19], a[196:199], v[96:99]
    ds_read_b64_tr_b16 v[56:57], v2 offset:576
    v_mfma_f32_16x16x32_bf16 v[100:103], v[20:23], a[196:199], v[100:103]
    ds_read_b64_tr_b16 v[58:59], v2 offset:4800
    v_mfma_f32_16x16x32_bf16 v[104:107], v[24:27], a[196:199], v[104:107]
    ds_read_b64_tr_b16 v[60:61], v2 offset:608
    v_mfma_f32_16x16x32_bf16 v[108:111], v[28:31], a[196:199], v[108:111]
    ds_read_b64_tr_b16 v[62:63], v2 offset:4832
    v_mfma_f32_16x16x32_bf16 v[128:131], v[16:19], a[200:203], v[128:131]
    v_mfma_f32_16x16x32_bf16 v[132:135], v[20:23], a[200:203], v[132:135]
    v_mfma_f32_16x16x32_bf16 v[136:139], v[24:27], a[200:203], v[136:139]
    v_mfma_f32_16x16x32_bf16 v[140:143], v[28:31], a[200:203], v[140:143]
    v_mfma_f32_16x16x32_bf16 v[160:163], v[16:19], a[204:207], v[160:163]
    v_mfma_f32_16x16x32_bf16 v[164:167], v[20:23], a[204:207], v[164:167]
    v_mfma_f32_16x16x32_bf16 v[168:171], v[24:27], a[204:207], v[168:171]
    v_mfma_f32_16x16x32_bf16 v[172:175], v[28:31], a[204:207], v[172:175]
    s_waitcnt lgkmcnt(8)
    v_mfma_f32_16x16x32_bf16 v[80:83], v[32:35], a[192:195], v[80:83]
    ds_read_b64_tr_b16 v[16:17], v2 offset:640
    v_mfma_f32_16x16x32_bf16 v[84:87], v[36:39], a[192:195], v[84:87]
    ds_read_b64_tr_b16 v[18:19], v2 offset:4864
    v_mfma_f32_16x16x32_bf16 v[88:91], v[40:43], a[192:195], v[88:91]
    ds_read_b64_tr_b16 v[20:21], v2 offset:672
    v_mfma_f32_16x16x32_bf16 v[92:95], v[44:47], a[192:195], v[92:95]
    ds_read_b64_tr_b16 v[22:23], v2 offset:4896
    v_mfma_f32_16x16x32_bf16 v[112:115], v[32:35], a[196:199], v[112:115]
    ds_read_b64_tr_b16 v[24:25], v2 offset:704
    v_mfma_f32_16x16x32_bf16 v[116:119], v[36:39], a[196:199], v[116:119]
    ds_read_b64_tr_b16 v[26:27], v2 offset:4928
    v_mfma_f32_16x16x32_bf16 v[120:123], v[40:43], a[196:199], v[120:123]
    ds_read_b64_tr_b16 v[28:29], v2 offset:736
    v_mfma_f32_16x16x32_bf16 v[124:127], v[44:47], a[196:199], v[124:127]
    ds_read_b64_tr_b16 v[30:31], v2 offset:4960
    v_mfma_f32_16x16x32_bf16 v[144:147], v[32:35], a[200:203], v[144:147]
    v_mfma_f32_16x16x32_bf16 v[148:151], v[36:39], a[200:203], v[148:151]
    v_mfma_f32_16x16x32_bf16 v[152:155], v[40:43], a[200:203], v[152:155]
    v_mfma_f32_16x16x32_bf16 v[156:159], v[44:47], a[200:203], v[156:159]
    v_mfma_f32_16x16x32_bf16 v[176:179], v[32:35], a[204:207], v[176:179]
    v_mfma_f32_16x16x32_bf16 v[180:183], v[36:39], a[204:207], v[180:183]
    v_mfma_f32_16x16x32_bf16 v[184:187], v[40:43], a[204:207], v[184:187]
    v_mfma_f32_16x16x32_bf16 v[188:191], v[44:47], a[204:207], v[188:191]
    s_nop 0
    s_barrier
    s_waitcnt lgkmcnt(8)
    v_mfma_f32_16x16x32_bf16 v[64:67], v[48:51], a[208:211], v[64:67]
    v_add_u32 v2, s26, v1
    v_mfma_f32_16x16x32_bf16 v[68:71], v[52:55], a[208:211], v[68:71]
    s_add_u32 s26, s26, 17024
    s_cmp_ge_u32 s26, 153216
    s_cselect_b32 s26, 0, s26
    v_mfma_f32_16x16x32_bf16 v[72:75], v[56:59], a[208:211], v[72:75]
    ds_read_b64_tr_b16 v[32:33], v2 offset:0
    v_mfma_f32_16x16x32_bf16 v[76:79], v[60:63], a[208:211], v[76:79]
    ds_read_b64_tr_b16 v[34:35], v2 offset:4224
    v_mfma_f32_16x16x32_bf16 v[96:99], v[48:51], a[212:215], v[96:99]
    ds_read_b64_tr_b16 v[36:37], v2 offset:32
    v_mfma_f32_16x16x32_bf16 v[100:103], v[52:55], a[212:215], v[100:103]
    ds_read_b64_tr_b16 v[38:39], v2 offset:4256
    v_mfma_f32_16x16x32_bf16 v[104:107], v[56:59], a[212:215], v[104:107]
    ds_read_b64_tr_b16 v[40:41], v2 offset:64
    v_mfma_f32_16x16x32_bf16 v[108:111], v[60:63], a[212:215], v[108:111]
    ds_read_b64_tr_b16 v[42:43], v2 offset:4288
    v_mfma_f32_16x16x32_bf16 v[128:131], v[48:51], a[216:219], v[128:131]
    ds_read_b64_tr_b16 v[44:45], v2 offset:96
    v_mfma_f32_16x16x32_bf16 v[132:135], v[52:55], a[216:219], v[132:135]
    ds_read_b64_tr_b16 v[46:47], v2 offset:4320
    v_mfma_f32_16x16x32_bf16 v[136:139], v[56:59], a[216:219], v[136:139]
    v_mfma_f32_16x16x32_bf16 v[140:143], v[60:63], a[216:219], v[140:143]
    v_mfma_f32_16x16x32_bf16 v[160:163], v[48:51], a[220:223], v[160:163]
    v_mfma_f32_16x16x32_bf16 v[164:167], v[52:55], a[220:223], v[164:167]
    v_mfma_f32_16x16x32_bf16 v[168:171], v[56:59], a[220:223], v[168:171]
    v_mfma_f32_16x16x32_bf16 v[172:175], v[60:63], a[220:223], v[172:175]
    s_waitcnt lgkmcnt(8)
    v_mfma_f32_16x16x32_bf16 v[80:83], v[16:19], a[208:211], v[80:83]
    ds_read_b64_tr_b16 v[48:49], v2 offset:128
    ds_read_b64_tr_b16 v[50:51], v2 offset:4352
    v_mfma_f32_16x16x32_bf16 v[84:87], v[20:23], a[208:211], v[84:87]
    ds_read_b64_tr_b16 v[52:53], v2 offset:160
    ds_read_b64_tr_b16 v[54:55], v2 offset:4384
    v_mfma_f32_16x16x32_bf16 v[88:91], v[24:27], a[208:211], v[88:91]
    ds_read_b64_tr_b16 v[56:57], v2 offset:192
    ds_read_b64_tr_b16 v[58:59], v2 offset:4416
    v_mfma_f32_16x16x32_bf16 v[92:95], v[28:31], a[208:211], v[92:95]
    ds_read_b64_tr_b16 v[60:61], v2 offset:224
    ds_read_b64_tr_b16 v[62:63], v2 offset:4448
    v_mfma_f32_16x16x32_bf16 v[112:115], v[16:19], a[212:215], v[112:115]
    s_add_u32 m0, s27, 0
    s_nop 0
    global_load_lds_dwordx4 v[4:5], off
    v_mfma_f32_16x16x32_bf16 v[116:119], v[20:23], a[212:215], v[116:119]
    v_lshl_add_u64 v[4:5], v[4:5], 0, s[20:21]
    s_add_u32 m0, s27, 1056
    v_mfma_f32_16x16x32_bf16 v[120:123], v[24:27], a[212:215], v[120:123]
    global_load_lds_dwordx4 v[4:5], off
    v_lshl_add_u64 v[4:5], v[4:5], 0, s[20:21]
    v_mfma_f32_16x16x32_bf16 v[124:127], v[28:31], a[212:215], v[124:127]
    s_add_u32 m0, s27, 2112
    s_nop 0
    global_load_lds_dwordx4 v[4:5], off
    v_mfma_f32_16x16x32_bf16 v[144:147], v[16:19], a[216:219], v[144:147]
    v_lshl_add_u64 v[4:5], v[4:5], 0, s[20:21]
    s_add_u32 m0, s27, 3168
    v_mfma_f32_16x16x32_bf16 v[148:151], v[20:23], a[216:219], v[148:151]
    global_load_lds_dwordx4 v[4:5], off
    v_lshl_add_u64 v[4:5], v[4:5], 0, s[22:23]
    v_mfma_f32_16x16x32_bf16 v[152:155], v[24:27], a[216:219], v[152:155]
    s_add_u32 s27, s27, 17024
    s_cmp_ge_u32 s27, 153216
    s_cselect_b32 s27, s38, s27
    v_mfma_f32_16x16x32_bf16 v[156:159], v[28:31], a[216:219], v[156:159]
    v_mfma_f32_16x16x32_bf16 v[176:179], v[16:19], a[220:223], v[176:179]
    v_mfma_f32_16x16x32_bf16 v[180:183], v[20:23], a[220:223], v[180:183]
    v_mfma_f32_16x16x32_bf16 v[184:187], v[24:27], a[220:223], v[184:187]
    v_mfma_f32_16x16x32_bf16 v[188:191], v[28:31], a[220:223], v[188:191]
    s_cmp_eq_u32 s28, 0
    s_cbranch_scc1 gsw_fa_12
    s_waitcnt vmcnt(40)
gsw_fa_12:
    s_waitcnt lgkmcnt(8)
    v_mfma_f32_16x16x32_bf16 v[64:67], v[32:35], a[224:227], v[64:67]
    ds_read_b64_tr_b16 v[16:17], v2 offset:512
    v_mfma_f32_16x16x32_bf16 v[68:71], v[36:39], a[224:227], v[68:71]
    ds_read_b64_tr_b16 v[18:19], v2 offset:4736
    v_mfma_f32_16x16x32_bf16 v[72:75], v[40:43], a[224:227], v[72:75]
    ds_read_b64_tr_b16 v[20:21], v2 offset:544
    v_mfma_f32_16x16x32_bf16 v[76:79], v[44:47], a[224:227], v[76:79]
    ds_read_b64_tr_b16 v[22:23], v2 offset:4768
    v_mfma_f32_16x16x32_bf16 v[96:99], v[32:35], a[228:231], v[96:99]
    ds_read_b64_tr_b16 v[24:25], v2 offset:576
    v_mfma_f32_16x16x32_bf16 v[100:103], v[36:39], a[228:231], v[100:103]
    ds_read_b64_tr_b16 v[26:27], v2 offset:4800
    v_mfma_f32_16x16x32_bf16 v[104:107], v[40:43], a[228:231], v[104:107]
    ds_read_b64_tr_b16 v[28:29], v2 offset:608
    v_mfma_f32_16x16x32_bf16 v[108:111], v[44:47], a[228:231], v[108:111]
    ds_read_b64_tr_b16 v[30:31], v2 offset:4832
    v_mfma_f32_16x16x32_bf16 v[128:131], v[32:35], a[232:235], v[128:131]
    v_mfma_f32_16x16x32_bf16 v[132:135], v[36:39], a[232:235], v[132:135]
    v_mfma_f32_16x16x32_bf16 v[136:139], v[40:43], a[232:235], v[136:139]
    v_mfma_f32_16x16x32_bf16 v[140:143], v[44:47], a[232:235], v[140:143]
    v_mfma_f32_16x16x32_bf16 v[160:163], v[32:35], a[236:239], v[160:163]
    v_mfma_f32_16x16x32_bf16 v[164:167], v[36:39], a[236:239], v[164:167]
    v_mfma_f32_16x16x32_bf16 v[168:171], v[40:43], a[236:239], v[168:171]
    v_mfma_f32_16x16x32_bf16 v[172:175], v[44:47], a[236:239], v[172:175]
    s_waitcnt lgkmcnt(8)
    v_mfma_f32_16x16x32_bf16 v[80:83], v[48:51], a[224:227], v[80:83]
    ds_read_b64_tr_b16 v[32:33], v2 offset:640
    v_mfma_f32_16x16x32_bf16 v[84:87], v[52:55], a[224:227], v[84:87]
    ds_read_b64_tr_b16 v[34:35], v2 offset:4864
    v_mfma_f32_16x16x32_bf16 v[88:91], v[56:59], a[224:227], v[88:91]
    ds_read_b64_tr_b16 v[36:37], v2 offset:672
    v_mfma_f32_16x16x32_bf16 v[92:95], v[60:63], a[224:227], v[92:95]
    ds_read_b64_tr_b16 v[38:39], v2 offset:4896
    v_mfma_f32_16x16x32_bf16 v[112:115], v[48:51], a[228:231], v[112:115]
    ds_read_b64_tr_b16 v[40:41], v2 offset:704
    v_mfma_f32_16x16x32_bf16 v[116:119], v[52:55], a[228:231], v[116:119]
    ds_read_b64_tr_b16 v[42:43], v2 offset:4928
    v_mfma_f32_16x16x32_bf16 v[120:123], v[56:59], a[228:231], v[120:123]
    ds_read_b64_tr_b16 v[44:45], v2 offset:736
    v_mfma_f32_16x16x32_bf16 v[124:127], v[60:63], a[228:231], v[124:127]
    ds_read_b64_tr_b16 v[46:47], v2 offset:4960
    v_mfma_f32_16x16x32_bf16 v[144:147], v[48:51], a[232:235], v[144:147]
    v_mfma_f32_16x16x32_bf16 v[148:151], v[52:55], a[232:235], v[148:151]
    v_mfma_f32_16x16x32_bf16 v[152:155], v[56:59], a[232:235], v[152:155]
    v_mfma_f32_16x16x32_bf16 v[156:159], v[60:63], a[232:235], v[156:159]
    v_mfma_f32_16x16x32_bf16 v[176:179], v[48:51], a[236:239], v[176:179]
    v_mfma_f32_16x16x32_bf16 v[180:183], v[52:55], a[236:239], v[180:183]
    v_mfma_f32_16x16x32_bf16 v[184:187], v[56:59], a[236:239], v[184:187]
    v_mfma_f32_16x16x32_bf16 v[188:191], v[60:63], a[236:239], v[188:191]
    s_waitcnt vmcnt(24)
    s_barrier
    s_waitcnt lgkmcnt(8)
    v_mfma_f32_16x16x32_bf16 v[64:67], v[16:19], a[240:243], v[64:67]
    v_add_u32 v2, s26, v1
    v_mfma_f32_16x16x32_bf16 v[68:71], v[20:23], a[240:243], v[68:71]
    s_add_u32 s26, s26, 17024
    s_cmp_ge_u32 s26, 153216
    s_cselect_b32 s26, 0, s26
    v_mfma_f32_16x16x32_bf16 v[72:75], v[24:27], a[240:243], v[72:75]
    ds_read_b64_tr_b16 v[48:49], v2 offset:0
    v_mfma_f32_16x16x32_bf16 v[76:79], v[28:31], a[240:243], v[76:79]
    ds_read_b64_tr_b16 v[50:51], v2 offset:4224
    v_mfma_f32_16x16x32_bf16 v[96:99], v[16:19], a[244:247], v[96:99]
    ds_read_b64_tr_b16 v[52:53], v2 offset:32
    v_mfma_f32_16x16x32_bf16 v[100:103], v[20:23], a[244:247], v[100:103]
    ds_read_b64_tr_b16 v[54:55], v2 offset:4256
    v_mfma_f32_16x16x32_bf16 v[104:107], v[24:27], a[244:247], v[104:107]
    ds_read_b64_tr_b16 v[56:57], v2 offset:64
    v_mfma_f32_16x16x32_bf16 v[108:111], v[28:31], a[244:247], v[108:111]
    ds_read_b64_tr_b16 v[58:59], v2 offset:4288
    v_mfma_f32_16x16x32_bf16 v[128:131], v[16:19], a[248:251], v[128:131]
    ds_read_b64_tr_b16 v[60:61], v2 offset:96
    v_mfma_f32_16x16x32_bf16 v[132:135], v[20:23], a[248:251], v[132:135]
    ds_read_b64_tr_b16 v[62:63], v2 offset:4320
    v_mfma_f32_16x16x32_bf16 v[136:139], v[24:27], a[248:251], v[136:139]
    v_mfma_f32_16x16x32_bf16 v[140:143], v[28:31], a[248:251], v[140:143]
    v_mfma_f32_16x16x32_bf16 v[160:163], v[16:19], a[252:255], v[160:163]
    v_mfma_f32_16x16x32_bf16 v[164:167], v[20:23], a[252:255], v[164:167]
    v_mfma_f32_16x16x32_bf16 v[168:171], v[24:27], a[252:255], v[168:171]
    v_mfma_f32_16x16x32_bf16 v[172:175], v[28:31], a[252:255], v[172:175]
    s_waitcnt lgkmcnt(8)
    v_mfma_f32_16x16x32_bf16 v[80:83], v[32:35], a[240:243], v[80:83]
    ds_read_b64_tr_b16 v[16:17], v2 offset:128
    ds_read_b64_tr_b16 v[18:19], v2 offset:4352
    v_mfma_f32_16x16x32_bf16 v[84:87], v[36:39], a[240:243], v[84:87]
    ds_read_b64_tr_b16 v[20:21], v2 offset:160
    ds_read_b64_tr_b16 v[22:23], v2 offset:4384
    v_mfma_f32_16x16x32_bf16 v[88:91], v[40:43], a[240:243], v[88:91]
    ds_read_b64_tr_b16 v[24:25], v2 offset:192
    ds_read_b64_tr_b16 v[26:27], v2 offset:4416
    v_mfma_f32_16x16x32_bf16 v[92:95], v[44:47], a[240:243], v[92:95]
    ds_read_b64_tr_b16 v[28:29], v2 offset:224
    ds_read_b64_tr_b16 v[30:31], v2 offset:4448
    v_mfma_f32_16x16x32_bf16 v[112:115], v[32:35], a[244:247], v[112:115]
    s_add_u32 m0, s27, 0
    s_nop 0
    global_load_lds_dwordx4 v[4:5], off
    v_mfma_f32_16x16x32_bf16 v[116:119], v[36:39], a[244:247], v[116:119]
    v_lshl_add_u64 v[4:5], v[4:5], 0, s[20:21]
    s_add_u32 m0, s27, 1056
    v_mfma_f32_16x16x32_bf16 v[120:123], v[40:43], a[244:247], v[120:123]
    global_load_lds_dwordx4 v[4:5], off
    v_lshl_add_u64 v[4:5], v[4:5], 0, s[20:21]
    v_mfma_f32_16x16x32_bf16 v[124:127], v[44:47], a[244:247], v[124:127]
    s_add_u32 m0, s27, 2112
    s_nop 0
    global_load_lds_dwordx4 v[4:5], off
    v_mfma_f32_16x16x32_bf16 v[144:147], v[32:35], a[248:251], v[144:147]
    v_lshl_add_u64 v[4:5], v[4:5], 0, s[20:21]
    s_add_u32 m0, s27, 3168
    v_mfma_f32_16x16x32_bf16 v[148:151], v[36:39], a[248:251], v[148:151]
    global_load_lds_dwordx4 v[4:5], off
    v_lshl_add_u64 v[4:5], v[4:5], 0, s[22:23]
    v_mfma_f32_16x16x32_bf16 v[152:155], v[40:43], a[248:251], v[152:155]
    s_add_u32 s27, s27, 17024
    s_cmp_ge_u32 s27, 153216
    s_cselect_b32 s27, s38, s27
    v_mfma_f32_16x16x32_bf16 v[156:159], v[44:47], a[248:251], v[156:159]
    v_mfma_f32_16x16x32_bf16 v[176:179], v[32:35], a[252:255], v[176:179]
    v_mfma_f32_16x16x32_bf16 v[180:183], v[36:39], a[252:255], v[180:183]
    v_mfma_f32_16x16x32_bf16 v[184:187], v[40:43], a[252:255], v[184:187]
    v_mfma_f32_16x16x32_bf16 v[188:191], v[44:47], a[252:255], v[188:191]
    s_cmp_eq_u32 s28, 0
    s_cbranch_scc1 gsw_fa_13
    s_waitcnt vmcnt(32)
gsw_fa_13:
    s_waitcnt lgkmcnt(8)
    v_mfma_f32_16x16x32_bf16 v[64:67], v[48:51], v[192:195], v[64:67]
    ds_read_b64_tr_b16 v[32:33], v2 offset:512
    v_mfma_f32_16x16x32_bf16 v[68:71], v[52:55], v[192:195], v[68:71]
    ds_read_b64_tr_b16 v[34:35], v2 offset:4736
    v_mfma_f32_16x16x32_bf16 v[72:75], v[56:59], v[192:195], v[72:75]
    ds_read_b64_tr_b16 v[36:37], v2 offset:544
    v_mfma_f32_16x16x32_bf16 v[76:79], v[60:63], v[192:195], v[76:79]
    ds_read_b64_tr_b16 v[38:39], v2 offset:4768
    v_mfma_f32_16x16x32_bf16 v[96:99], v[48:51], v[196:199], v[96:99]
    ds_read_b64_tr_b16 v[40:41], v2 offset:576
    v_mfma_f32_16x16x32_bf16 v[100:103], v[52:55], v[196:199], v[100:103]
    ds_read_b64_tr_b16 v[42:43], v2 offset:4800
    v_mfma_f32_16x16x32_bf16 v[104:107], v[56:59], v[196:199], v[104:107]
    ds_read_b64_tr_b16 v[44:45], v2 offset:608
    v_mfma_f32_16x16x32_bf16 v[108:111], v[60:63], v[196:199], v[108:111]
    ds_read_b64_tr_b16 v[46:47], v2 offset:4832
    v_mfma_f32_16x16x32_bf16 v[128:131], v[48:51], v[200:203], v[128:131]
    v_mfma_f32_16x16x32_bf16 v[132:135], v[52:55], v[200:203], v[132:135]
    v_mfma_f32_16x16x32_bf16 v[136:139], v[56:59], v[200:203], v[136:139]
    v_mfma_f32_16x16x32_bf16 v[140:143], v[60:63], v[200:203], v[140:143]
    v_mfma_f32_16x16x32_bf16 v[160:163], v[48:51], v[204:207], v[160:163]
    v_mfma_f32_16x16x32_bf16 v[164:167], v[52:55], v[204:207], v[164:167]
    v_mfma_f32_16x16x32_bf16 v[168:171], v[56:59], v[204:207], v[168:171]
    v_mfma_f32_16x16x32_bf16 v[172:175], v[60:63], v[204:207], v[172:175]
    s_waitcnt lgkmcnt(8)
    v_mfma_f32_16x16x32_bf16 v[80:83], v[16:19], v[192:195], v[80:83]
    ds_read_b64_tr_b16 v[48:49], v2 offset:640
    v_mfma_f32_16x16x32_bf16 v[84:87], v[20:23], v[192:195], v[84:87]
    ds_read_b64_tr_b16 v[50:51], v2 offset:4864
    v_mfma_f32_16x16x32_bf16 v[88:91], v[24:27], v[192:195], v[88:91]
    ds_read_b64_tr_b16 v[52:53], v2 offset:672
    v_mfma_f32_16x16x32_bf16 v[92:95], v[28:31], v[192:195], v[92:95]
    ds_read_b64_tr_b16 v[54:55], v2 offset:4896
    v_mfma_f32_16x16x32_bf16 v[112:115], v[16:19], v[196:199], v[112:115]
    ds_read_b64_tr_b16 v[56:57], v2 offset:704
    v_mfma_f32_16x16x32_bf16 v[116:119], v[20:23], v[196:199], v[116:119]
    ds_read_b64_tr_b16 v[58:59], v2 offset:4928
    v_mfma_f32_16x16x32_bf16 v[120:123], v[24:27], v[196:199], v[120:123]
    ds_read_b64_tr_b16 v[60:61], v2 offset:736
    v_mfma_f32_16x16x32_bf16 v[124:127], v[28:31], v[196:199], v[124:127]
    ds_read_b64_tr_b16 v[62:63], v2 offset:4960
    v_mfma_f32_16x16x32_bf16 v[144:147], v[16:19], v[200:203], v[144:147]
    v_mfma_f32_16x16x32_bf16 v[148:151], v[20:23], v[200:203], v[148:151]
    v_mfma_f32_16x16x32_bf16 v[152:155], v[24:27], v[200:203], v[152:155]
    v_mfma_f32_16x16x32_bf16 v[156:159], v[28:31], v[200:203], v[156:159]
    v_mfma_f32_16x16x32_bf16 v[176:179], v[16:19], v[204:207], v[176:179]
    v_mfma_f32_16x16x32_bf16 v[180:183], v[20:23], v[204:207], v[180:183]
    v_mfma_f32_16x16x32_bf16 v[184:187], v[24:27], v[204:207], v[184:187]
    v_mfma_f32_16x16x32_bf16 v[188:191], v[28:31], v[204:207], v[188:191]
    s_waitcnt vmcnt(24)
    s_barrier
    s_waitcnt lgkmcnt(8)
    v_mfma_f32_16x16x32_bf16 v[64:67], v[32:35], v[208:211], v[64:67]
    v_add_u32 v2, s26, v1
    v_mfma_f32_16x16x32_bf16 v[68:71], v[36:39], v[208:211], v[68:71]
    s_add_u32 s26, s26, 17024
    s_cmp_ge_u32 s26, 153216
    s_cselect_b32 s26, 0, s26
    v_mfma_f32_16x16x32_bf16 v[72:75], v[40:43], v[208:211], v[72:75]
    ds_read_b64_tr_b16 v[16:17], v2 offset:0
    v_mfma_f32_16x16x32_bf16 v[76:79], v[44:47], v[208:211], v[76:79]
    ds_read_b64_tr_b16 v[18:19], v2 offset:4224
    v_mfma_f32_16x16x32_bf16 v[96:99], v[32:35], v[212:215], v[96:99]
    ds_read_b64_tr_b16 v[20:21], v2 offset:32
    v_mfma_f32_16x16x32_bf16 v[100:103], v[36:39], v[212:215], v[100:103]
    ds_read_b64_tr_b16 v[22:23], v2 offset:4256
    v_mfma_f32_16x16x32_bf16 v[104:107], v[40:43], v[212:215], v[104:107]
    ds_read_b64_tr_b16 v[24:25], v2 offset:64
    v_mfma_f32_16x16x32_bf16 v[108:111], v[44:47], v[212:215], v[108:111]
    ds_read_b64_tr_b16 v[26:27], v2 offset:4288
    v_mfma_f32_16x16x32_bf16 v[128:131], v[32:35], v[216:219], v[128:131]
    ds_read_b64_tr_b16 v[28:29], v2 offset:96
    v_mfma_f32_16x16x32_bf16 v[132:135], v[36:39], v[216:219], v[132:135]
    ds_read_b64_tr_b16 v[30:31], v2 offset:4320
    v_mfma_f32_16x16x32_bf16 v[136:139], v[40:43], v[216:219], v[136:139]
    v_mfma_f32_16x16x32_bf16 v[140:143], v[44:47], v[216:219], v[140:143]
    v_mfma_f32_16x16x32_bf16 v[160:163], v[32:35], v[220:223], v[160:163]
    v_mfma_f32_16x16x32_bf16 v[164:167], v[36:39], v[220:223], v[164:167]
    v_mfma_f32_16x16x32_bf16 v[168:171], v[40:43], v[220:223], v[168:171]
    v_mfma_f32_16x16x32_bf16 v[172:175], v[44:47], v[220:223], v[172:175]
    s_waitcnt lgkmcnt(8)
    v_mfma_f32_16x16x32_bf16 v[80:83], v[48:51], v[208:211], v[80:83]
    ds_read_b64_tr_b16 v[32:33], v2 offset:128
    ds_read_b64_tr_b16 v[34:35], v2 offset:4352
    v_mfma_f32_16x16x32_bf16 v[84:87], v[52:55], v[208:211], v[84:87]
    ds_read_b64_tr_b16 v[36:37], v2 offset:160
    ds_read_b64_tr_b16 v[38:39], v2 offset:4384
    v_mfma_f32_16x16x32_bf16 v[88:91], v[56:59], v[208:211], v[88:91]
    ds_read_b64_tr_b16 v[40:41], v2 offset:192
    ds_read_b64_tr_b16 v[42:43], v2 offset:4416
    v_mfma_f32_16x16x32_bf16 v[92:95], v[60:63], v[208:211], v[92:95]
    ds_read_b64_tr_b16 v[44:45], v2 offset:224
    ds_read_b64_tr_b16 v[46:47], v2 offset:4448
    v_mfma_f32_16x16x32_bf16 v[112:115], v[48:51], v[212:215], v[112:115]
    s_add_u32 m0, s27, 0
    s_nop 0
    global_load_lds_dwordx4 v[4:5], off
    v_mfma_f32_16x16x32_bf16 v[116:119], v[52:55], v[212:215], v[116:119]
    v_lshl_add_u64 v[4:5], v[4:5], 0, s[20:21]
    s_add_u32 m0, s27, 1056
    v_mfma_f32_16x16x32_bf16 v[120:123], v[56:59], v[212:215], v[120:123]
    global_load_lds_dwordx4 v[4:5], off
    v_lshl_add_u64 v[4:5], v[4:5], 0, s[20:21]
    v_mfma_f32_16x16x32_bf16 v[124:127], v[60:63], v[212:215], v[124:127]
    s_add_u32 m0, s27, 2112
    s_nop 0
    global_load_lds_dwordx4 v[4:5], off
    v_mfma_f32_16x16x32_bf16 v[144:147], v[48:51], v[216:219], v[144:147]
    v_lshl_add_u64 v[4:5], v[4:5], 0, s[20:21]
    s_add_u32 m0, s27, 3168
    v_mfma_f32_16x16x32_bf16 v[148:151], v[52:55], v[216:219], v[148:151]
    global_load_lds_dwordx4 v[4:5], off
    v_lshl_add_u64 v[4:5], v[4:5], 0, s[22:23]
    v_mfma_f32_16x16x32_bf16 v[152:155], v[56:59], v[216:219], v[152:155]
    s_add_u32 s27, s27, 17024
    s_cmp_ge_u32 s27, 153216
    s_cselect_b32 s27, s38, s27
    v_mfma_f32_16x16x32_bf16 v[156:159], v[60:63], v[216:219], v[156:159]
    v_mfma_f32_16x16x32_bf16 v[176:179], v[48:51], v[220:223], v[176:179]
    v_mfma_f32_16x16x32_bf16 v[180:183], v[52:55], v[220:223], v[180:183]
    v_mfma_f32_16x16x32_bf16 v[184:187], v[56:59], v[220:223], v[184:187]
    v_mfma_f32_16x16x32_bf16 v[188:191], v[60:63], v[220:223], v[188:191]
    s_cmp_eq_u32 s28, 0
    s_cbranch_scc1 gsw_fa_14
    s_waitcnt vmcnt(28)
gsw_fa_14:
    s_waitcnt lgkmcnt(8)
    v_mfma_f32_16x16x32_bf16 v[64:67], v[16:19], v[224:227], v[64:67]
    ds_read_b64_tr_b16 v[48:49], v2 offset:512
    v_mfma_f32_16x16x32_bf16 v[68:71], v[20:23], v[224:227], v[68:71]
    ds_read_b64_tr_b16 v[50:51], v2 offset:4736
    v_mfma_f32_16x16x32_bf16 v[72:75], v[24:27], v[224:227], v[72:75]
    ds_read_b64_tr_b16 v[52:53], v2 offset:544
    v_mfma_f32_16x16x32_bf16 v[76:79], v[28:31], v[224:227], v[76:79]
    ds_read_b64_tr_b16 v[54:55], v2 offset:4768
    v_mfma_f32_16x16x32_bf16 v[96:99], v[16:19], v[228:231], v[96:99]
    ds_read_b64_tr_b16 v[56:57], v2 offset:576
    v_mfma_f32_16x16x32_bf16 v[100:103], v[20:23], v[228:231], v[100:103]
    ds_read_b64_tr_b16 v[58:59], v2 offset:4800
    v_mfma_f32_16x16x32_bf16 v[104:107], v[24:27], v[228:231], v[104:107]
    ds_read_b64_tr_b16 v[60:61], v2 offset:608
    v_mfma_f32_16x16x32_bf16 v[108:111], v[28:31], v[228:231], v[108:111]
    ds_read_b64_tr_b16 v[62:63], v2 offset:4832
    v_mfma_f32_16x16x32_bf16 v[128:131], v[16:19], v[232:235], v[128:131]
    v_mfma_f32_16x16x32_bf16 v[132:135], v[20:23], v[232:235], v[132:135]
    v_mfma_f32_16x16x32_bf16 v[136:139], v[24:27], v[232:235], v[136:139]
    v_mfma_f32_16x16x32_bf16 v[140:143], v[28:31], v[232:235], v[140:143]
    v_mfma_f32_16x16x32_bf16 v[160:163], v[16:19], v[236:239], v[160:163]
    v_mfma_f32_16x16x32_bf16 v[164:167], v[20:23], v[236:239], v[164:167]
    v_mfma_f32_16x16x32_bf16 v[168:171], v[24:27], v[236:239], v[168:171]
    v_mfma_f32_16x16x32_bf16 v[172:175], v[28:31], v[236:239], v[172:175]
    s_waitcnt lgkmcnt(8)
    v_mfma_f32_16x16x32_bf16 v[80:83], v[32:35], v[224:227], v[80:83]
    ds_read_b64_tr_b16 v[16:17], v2 offset:640
    v_mfma_f32_16x16x32_bf16 v[84:87], v[36:39], v[224:227], v[84:87]
    ds_read_b64_tr_b16 v[18:19], v2 offset:4864
    v_mfma_f32_16x16x32_bf16 v[88:91], v[40:43], v[224:227], v[88:91]
    ds_read_b64_tr_b16 v[20:21], v2 offset:672
    v_mfma_f32_16x16x32_bf16 v[92:95], v[44:47], v[224:227], v[92:95]
    ds_read_b64_tr_b16 v[22:23], v2 offset:4896
    v_mfma_f32_16x16x32_bf16 v[112:115], v[32:35], v[228:231], v[112:115]
    ds_read_b64_tr_b16 v[24:25], v2 offset:704
    v_mfma_f32_16x16x32_bf16 v[116:119], v[36:39], v[228:231], v[116:119]
    ds_read_b64_tr_b16 v[26:27], v2 offset:4928
    v_mfma_f32_16x16x32_bf16 v[120:123], v[40:43], v[228:231], v[120:123]
    ds_read_b64_tr_b16 v[28:29], v2 offset:736
    v_mfma_f32_16x16x32_bf16 v[124:127], v[44:47], v[228:231], v[124:127]
    ds_read_b64_tr_b16 v[30:31], v2 offset:4960
    v_mfma_f32_16x16x32_bf16 v[144:147], v[32:35], v[232:235], v[144:147]
    v_mfma_f32_16x16x32_bf16 v[148:151], v[36:39], v[232:235], v[148:151]
    v_mfma_f32_16x16x32_bf16 v[152:155], v[40:43], v[232:235], v[152:155]
    v_mfma_f32_16x16x32_bf16 v[156:159], v[44:47], v[232:235], v[156:159]
    v_mfma_f32_16x16x32_bf16 v[176:179], v[32:35], v[236:239], v[176:179]
    v_mfma_f32_16x16x32_bf16 v[180:183], v[36:39], v[236:239], v[180:183]
    v_mfma_f32_16x16x32_bf16 v[184:187], v[40:43], v[236:239], v[184:187]
    v_mfma_f32_16x16x32_bf16 v[188:191], v[44:47], v[236:239], v[188:191]
    s_barrier
    s_waitcnt lgkmcnt(8)
    v_mfma_f32_16x16x32_bf16 v[64:67], v[48:51], v[240:243], v[64:67]
    v_mfma_f32_16x16x32_bf16 v[68:71], v[52:55], v[240:243], v[68:71]
    v_mfma_f32_16x16x32_bf16 v[72:75], v[56:59], v[240:243], v[72:75]
    v_mfma_f32_16x16x32_bf16 v[76:79], v[60:63], v[240:243], v[76:79]
    v_mfma_f32_16x16x32_bf16 v[96:99], v[48:51], v[244:247], v[96:99]
    v_mfma_f32_16x16x32_bf16 v[100:103], v[52:55], v[244:247], v[100:103]
    v_mfma_f32_16x16x32_bf16 v[104:107], v[56:59], v[244:247], v[104:107]
    v_mfma_f32_16x16x32_bf16 v[108:111], v[60:63], v[244:247], v[108:111]
    v_mfma_f32_16x16x32_bf16 v[128:131], v[48:51], v[248:251], v[128:131]
    v_mfma_f32_16x16x32_bf16 v[132:135], v[52:55], v[248:251], v[132:135]
    v_mfma_f32_16x16x32_bf16 v[136:139], v[56:59], v[248:251], v[136:139]
    v_mfma_f32_16x16x32_bf16 v[140:143], v[60:63], v[248:251], v[140:143]
    v_mfma_f32_16x16x32_bf16 v[160:163], v[48:51], v[252:255], v[160:163]
    v_mfma_f32_16x16x32_bf16 v[164:167], v[52:55], v[252:255], v[164:167]
    v_mfma_f32_16x16x32_bf16 v[168:171], v[56:59], v[252:255], v[168:171]
    v_mfma_f32_16x16x32_bf16 v[172:175], v[60:63], v[252:255], v[172:175]
    s_waitcnt lgkmcnt(0)
    v_mfma_f32_16x16x32_bf16 v[80:83], v[16:19], v[240:243], v[80:83]
    s_add_u32 m0, s27, 0
    v_mfma_f32_16x16x32_bf16 v[84:87], v[20:23], v[240:243], v[84:87]
    global_load_lds_dwordx4 v[4:5], off
    v_mfma_f32_16x16x32_bf16 v[88:91], v[24:27], v[240:243], v[88:91]
    v_lshl_add_u64 v[4:5], v[4:5], 0, s[20:21]
    v_mfma_f32_16x16x32_bf16 v[92:95], v[28:31], v[240:243], v[92:95]
    s_add_u32 m0, s27, 1056
    v_mfma_f32_16x16x32_bf16 v[112:115], v[16:19], v[244:247], v[112:115]
    global_load_lds_dwordx4 v[4:5], off
    v_mfma_f32_16x16x32_bf16 v[116:119], v[20:23], v[244:247], v[116:119]
    v_lshl_add_u64 v[4:5], v[4:5], 0, s[20:21]
    v_mfma_f32_16x16x32_bf16 v[120:123], v[24:27], v[244:247], v[120:123]
    s_add_u32 m0, s27, 2112
    v_mfma_f32_16x16x32_bf16 v[124:127], v[28:31], v[244:247], v[124:127]
    global_load_lds_dwordx4 v[4:5], off
    v_mfma_f32_16x16x32_bf16 v[144:147], v[16:19], v[248:251], v[144:147]
    v_lshl_add_u64 v[4:5], v[4:5], 0, s[20:21]
    v_mfma_f32_16x16x32_bf16 v[148:151], v[20:23], v[248:251], v[148:151]
    s_add_u32 m0, s27, 3168
    v_mfma_f32_16x16x32_bf16 v[152:155], v[24:27], v[248:251], v[152:155]
    global_load_lds_dwordx4 v[4:5], off
    v_mfma_f32_16x16x32_bf16 v[156:159], v[28:31], v[248:251], v[156:159]
    v_lshl_add_u64 v[4:5], v[4:5], 0, s[22:23]
    v_mfma_f32_16x16x32_bf16 v[176:179], v[16:19], v[252:255], v[176:179]
    s_add_u32 s27, s27, 17024
    s_cmp_ge_u32 s27, 153216
    s_cselect_b32 s27, s38, s27
    v_mfma_f32_16x16x32_bf16 v[180:183], v[20:23], v[252:255], v[180:183]
    v_mfma_f32_16x16x32_bf16 v[184:187], v[24:27], v[252:255], v[184:187]
    v_mfma_f32_16x16x32_bf16 v[188:191], v[28:31], v[252:255], v[188:191]
    s_mov_b32 s28, 0
    s_nop 7
    s_cmp_ge_u32 s43, 96
    s_cbranch_scc1 g1_eh
    s_lshl_b32 s34, s19, 19
    s_add_u32 s34, s34, 4096
    v_add_u32 v8, s34, v0
    v_add_u32 v9, 262144, v8
    v_cvt_pk_bf16_f32 v64, v64, v65
    v_cvt_pk_bf16_f32 v65, v66, v67
    v_cvt_pk_bf16_f32 v66, v68, v69
    v_cvt_pk_bf16_f32 v67, v70, v71
    global_store_dwordx4 v8, v[64:67], s[24:25] offset:-4096 sc1
    v_cvt_pk_bf16_f32 v72, v72, v73
    v_cvt_pk_bf16_f32 v73, v74, v75
    v_cvt_pk_bf16_f32 v74, v76, v77
    v_cvt_pk_bf16_f32 v75, v78, v79
    global_store_dwordx4 v8, v[72:75], s[24:25] offset:-3072 sc1
    v_cvt_pk_bf16_f32 v80, v80, v81
    v_cvt_pk_bf16_f32 v81, v82, v83
    v_cvt_pk_bf16_f32 v82, v84, v85
    v_cvt_pk_bf16_f32 v83, v86, v87
    global_store_dwordx4 v8, v[80:83], s[24:25] offset:-2048 sc1
    v_cvt_pk_bf16_f32 v88, v88, v89
    v_cvt_pk_bf16_f32 v89, v90, v91
    v_cvt_pk_bf16_f32 v90, v92, v93
    v_cvt_pk_bf16_f32 v91, v94, v95
    global_store_dwordx4 v8, v[88:91], s[24:25] offset:-1024 sc1
    v_cvt_pk_bf16_f32 v96, v96, v97
    v_cvt_pk_bf16_f32 v97, v98, v99
    v_cvt_pk_bf16_f32 v98, v100, v101
    v_cvt_pk_bf16_f32 v99, v102, v103
    global_store_dwordx4 v8, v[96:99], s[24:25] offset:0 sc1
    v_cvt_pk_bf16_f32 v104, v104, v105
    v_cvt_pk_bf16_f32 v105, v106, v107
    v_cvt_pk_bf16_f32 v106, v108, v109
    v_cvt_pk_bf16_f32 v107, v110, v111
    global_store_dwordx4 v8, v[104:107], s[24:25] offset:1024 sc1
    v_cvt_pk_bf16_f32 v112, v112, v113
    v_cvt_pk_bf16_f32 v113, v114, v115
    v_cvt_pk_bf16_f32 v114, v116, v117
    v_cvt_pk_bf16_f32 v115, v118, v119
    global_store_dwordx4 v8, v[112:115], s[24:25] offset:2048 sc1
    v_cvt_pk_bf16_f32 v120, v120, v121
    v_cvt_pk_bf16_f32 v121, v122, v123
    v_cvt_pk_bf16_f32 v122, v124, v125
    v_cvt_pk_bf16_f32 v123, v126, v127
    global_store_dwordx4 v8, v[120:123], s[24:25] offset:3072 sc1
    v_cvt_pk_bf16_f32 v128, v128, v129
    v_cvt_pk_bf16_f32 v129, v130, v131
    v_cvt_pk_bf16_f32 v130, v132, v133
    v_cvt_pk_bf16_f32 v131, v134, v135
    global_store_dwordx4 v9, v[128:131], s[24:25] offset:-4096 sc1
    v_cvt_pk_bf16_f32 v136, v136, v137
    v_cvt_pk_bf16_f32 v137, v138, v139
    v_cvt_pk_bf16_f32 v138, v140, v141
    v_cvt_pk_bf16_f32 v139, v142, v143
    global_store_dwordx4 v9, v[136:139], s[24:25] offset:-3072 sc1
    v_cvt_pk_bf16_f32 v144, v144, v145
    v_cvt_pk_bf16_f32 v145, v146, v147
    v_cvt_pk_bf16_f32 v146, v148, v149
    v_cvt_pk_bf16_f32 v147, v150, v151
    global_store_dwordx4 v9, v[144:147], s[24:25] offset:-2048 sc1
    v_cvt_pk_bf16_f32 v152, v152, v153
    v_cvt_pk_bf16_f32 v153, v154, v155
    v_cvt_pk_bf16_f32 v154, v156, v157
    v_cvt_pk_bf16_f32 v155, v158, v159
    global_store_dwordx4 v9, v[152:155], s[24:25] offset:-1024 sc1
    v_cvt_pk_bf16_f32 v160, v160, v161
    v_cvt_pk_bf16_f32 v161, v162, v163
    v_cvt_pk_bf16_f32 v162, v164, v165
    v_cvt_pk_bf16_f32 v163, v166, v167
    global_store_dwordx4 v9, v[160:163], s[24:25] offset:0 sc1
    v_cvt_pk_bf16_f32 v168, v168, v169
    v_cvt_pk_bf16_f32 v169, v170, v171
    v_cvt_pk_bf16_f32 v170, v172, v173
    v_cvt_pk_bf16_f32 v171, v174, v175
    global_store_dwordx4 v9, v[168:171], s[24:25] offset:1024 sc1
    v_cvt_pk_bf16_f32 v176, v176, v177
    v_cvt_pk_bf16_f32 v177, v178, v179
    v_cvt_pk_bf16_f32 v178, v180, v181
    v_cvt_pk_bf16_f32 v179, v182, v183
    global_store_dwordx4 v9, v[176:179], s[24:25] offset:2048 sc1
    v_cvt_pk_bf16_f32 v184, v184, v185
    v_cvt_pk_bf16_f32 v185, v186, v187
    v_cvt_pk_bf16_f32 v186, v188, v189
    v_cvt_pk_bf16_f32 v187, v190, v191
    global_store_dwordx4 v9, v[184:187], s[24:25] offset:3072 sc1
    s_branch g1_end
g1_eh:
    s_mul_i32 s34, s19, 221184
    v_add_u32 v8, s34, v0
    v_cvt_pk_bf16_f32 v64, v64, v65
    v_cvt_pk_bf16_f32 v65, v66, v67
    v_cvt_pk_bf16_f32 v66, v68, v69
    v_cvt_pk_bf16_f32 v67, v70, v71
    v_cvt_pk_bf16_f32 v80, v80, v81
    v_cvt_pk_bf16_f32 v81, v82, v83
    v_cvt_pk_bf16_f32 v82, v84, v85
    v_cvt_pk_bf16_f32 v83, v86, v87
    v_lshlrev_b32 v16, 16, v64
    v_and_b32 v17, 0xffff0000, v64
    v_lshlrev_b32 v18, 16, v80
    v_cmp_lt_f32 vcc, 0, v16
    v_cmp_lt_f32 s[40:41], 0, v17
    v_and_b32 v19, 0xffff0000, v80
    v_cndmask_b32 v20, 0, 1.0, vcc
    v_cndmask_b32 v21, 0, 1.0, s[40:41]
    v_mul_f32 v16, v16, v20
    v_mul_f32 v17, v17, v21
    v_mul_f32 v16, v16, v18
    v_mul_f32 v17, v17, v19
    v_cvt_pk_bf16_f32 v64, v16, v17
    v_lshlrev_b32 v16, 16, v65
    v_and_b32 v17, 0xffff0000, v65
    v_lshlrev_b32 v18, 16, v81
    v_cmp_lt_f32 vcc, 0, v16
    v_cmp_lt_f32 s[40:41], 0, v17
    v_and_b32 v19, 0xffff0000, v81
    v_cndmask_b32 v20, 0, 1.0, vcc
    v_cndmask_b32 v21, 0, 1.0, s[40:41]
    v_mul_f32 v16, v16, v20
    v_mul_f32 v17, v17, v21
    v_mul_f32 v16, v16, v18
    v_mul_f32 v17, v17, v19
    v_cvt_pk_bf16_f32 v65, v16, v17
    v_lshlrev_b32 v16, 16, v66
    v_and_b32 v17, 0xffff0000, v66
    v_lshlrev_b32 v18, 16, v82
    v_cmp_lt_f32 vcc, 0, v16
    v_cmp_lt_f32 s[40:41], 0, v17
    v_and_b32 v19, 0xffff0000, v82
    v_cndmask_b32 v20, 0, 1.0, vcc
    v_cndmask_b32 v21, 0, 1.0, s[40:41]
    v_mul_f32 v16, v16, v20
    v_mul_f32 v17, v17, v21
    v_mul_f32 v16, v16, v18
    v_mul_f32 v17, v17, v19
    v_cvt_pk_bf16_f32 v66, v16, v17
    v_lshlrev_b32 v16, 16, v67
    v_and_b32 v17, 0xffff0000, v67
    v_lshlrev_b32 v18, 16, v83
    v_cmp_lt_f32 vcc, 0, v16
    v_cmp_lt_f32 s[40:41], 0, v17
    v_and_b32 v19, 0xffff0000, v83
    v_cndmask_b32 v20, 0, 1.0, vcc
    v_cndmask_b32 v21, 0, 1.0, s[40:41]
    v_mul_f32 v16, v16, v20
    v_mul_f32 v17, v17, v21
    v_mul_f32 v16, v16, v18
    v_mul_f32 v17, v17, v19
    v_cvt_pk_bf16_f32 v67, v16, v17
    global_store_dwordx4 v8, v[64:67], s[24:25] offset:0 sc1
    v_cvt_pk_bf16_f32 v72, v72, v73
    v_cvt_pk_bf16_f32 v73, v74, v75
    v_cvt_pk_bf16_f32 v74, v76, v77
    v_cvt_pk_bf16_f32 v75, v78, v79
    v_cvt_pk_bf16_f32 v88, v88, v89
    v_cvt_pk_bf16_f32 v89, v90, v91
    v_cvt_pk_bf16_f32 v90, v92, v93
    v_cvt_pk_bf16_f32 v91, v94, v95
    v_lshlrev_b32 v16, 16, v72
    v_and_b32 v17, 0xffff0000, v72
    v_lshlrev_b32 v18, 16, v88
    v_cmp_lt_f32 vcc, 0, v16
    v_cmp_lt_f32 s[40:41], 0, v17
    v_and_b32 v19, 0xffff0000, v88
    v_cndmask_b32 v20, 0, 1.0, vcc
    v_cndmask_b32 v21, 0, 1.0, s[40:41]
    v_mul_f32 v16, v16, v20
    v_mul_f32 v17, v17, v21
    v_mul_f32 v16, v16, v18
    v_mul_f32 v17, v17, v19
    v_cvt_pk_bf16_f32 v72, v16, v17
    v_lshlrev_b32 v16, 16, v73
    v_and_b32 v17, 0xffff0000, v73
    v_lshlrev_b32 v18, 16, v89
    v_cmp_lt_f32 vcc, 0, v16
    v_cmp_lt_f32 s[40:41], 0, v17
    v_and_b32 v19, 0xffff0000, v89
    v_cndmask_b32 v20, 0, 1.0, vcc
    v_cndmask_b32 v21, 0, 1.0, s[40:41]
    v_mul_f32 v16, v16, v20
    v_mul_f32 v17, v17, v21
    v_mul_f32 v16, v16, v18
    v_mul_f32 v17, v17, v19
    v_cvt_pk_bf16_f32 v73, v16, v17
    v_lshlrev_b32 v16, 16, v74
    v_and_b32 v17, 0xffff0000, v74
    v_lshlrev_b32 v18, 16, v90
    v_cmp_lt_f32 vcc, 0, v16
    v_cmp_lt_f32 s[40:41], 0, v17
    v_and_b32 v19, 0xffff0000, v90
    v_cndmask_b32 v20, 0, 1.0, vcc
    v_cndmask_b32 v21, 0, 1.0, s[40:41]
    v_mul_f32 v16, v16, v20
    v_mul_f32 v17, v17, v21
    v_mul_f32 v16, v16, v18
    v_mul_f32 v17, v17, v19
    v_cvt_pk_bf16_f32 v74, v16, v17
    v_lshlrev_b32 v16, 16, v75
    v_and_b32 v17, 0xffff0000, v75
    v_lshlrev_b32 v18, 16, v91
    v_cmp_lt_f32 vcc, 0, v16
    v_cmp_lt_f32 s[40:41], 0, v17
    v_and_b32 v19, 0xffff0000, v91
    v_cndmask_b32 v20, 0, 1.0, vcc
    v_cndmask_b32 v21, 0, 1.0, s[40:41]
    v_mul_f32 v16, v16, v20
    v_mul_f32 v17, v17, v21
    v_mul_f32 v16, v16, v18
    v_mul_f32 v17, v17, v19
    v_cvt_pk_bf16_f32 v75, v16, v17
    global_store_dwordx4 v8, v[72:75], s[24:25] offset:1024 sc1
    v_add_u32 v8, 55296, v8
    v_cvt_pk_bf16_f32 v96, v96, v97
    v_cvt_pk_bf16_f32 v97, v98, v99
    v_cvt_pk_bf16_f32 v98, v100, v101
    v_cvt_pk_bf16_f32 v99, v102, v103
    v_cvt_pk_bf16_f32 v112, v112, v113
    v_cvt_pk_bf16_f32 v113, v114, v115
    v_cvt_pk_bf16_f32 v114, v116, v117
    v_cvt_pk_bf16_f32 v115, v118, v119
    v_lshlrev_b32 v16, 16, v96
    v_and_b32 v17, 0xffff0000, v96
    v_lshlrev_b32 v18, 16, v112
    v_cmp_lt_f32 vcc, 0, v16
    v_cmp_lt_f32 s[40:41], 0, v17
    v_and_b32 v19, 0xffff0000, v112
    v_cndmask_b32 v20, 0, 1.0, vcc
    v_cndmask_b32 v21, 0, 1.0, s[40:41]
    v_mul_f32 v16, v16, v20
    v_mul_f32 v17, v17, v21
    v_mul_f32 v16, v16, v18
    v_mul_f32 v17, v17, v19
    v_cvt_pk_bf16_f32 v96, v16, v17
    v_lshlrev_b32 v16, 16, v97
    v_and_b32 v17, 0xffff0000, v97
    v_lshlrev_b32 v18, 16, v113
    v_cmp_lt_f32 vcc, 0, v16
    v_cmp_lt_f32 s[40:41], 0, v17
    v_and_b32 v19, 0xffff0000, v113
    v_cndmask_b32 v20, 0, 1.0, vcc
    v_cndmask_b32 v21, 0, 1.0, s[40:41]
    v_mul_f32 v16, v16, v20
    v_mul_f32 v17, v17, v21
    v_mul_f32 v16, v16, v18
    v_mul_f32 v17, v17, v19
    v_cvt_pk_bf16_f32 v97, v16, v17
    v_lshlrev_b32 v16, 16, v98
    v_and_b32 v17, 0xffff0000, v98
    v_lshlrev_b32 v18, 16, v114
    v_cmp_lt_f32 vcc, 0, v16
    v_cmp_lt_f32 s[40:41], 0, v17
    v_and_b32 v19, 0xffff0000, v114
    v_cndmask_b32 v20, 0, 1.0, vcc
    v_cndmask_b32 v21, 0, 1.0, s[40:41]
    v_mul_f32 v16, v16, v20
    v_mul_f32 v17, v17, v21
    v_mul_f32 v16, v16, v18
    v_mul_f32 v17, v17, v19
    v_cvt_pk_bf16_f32 v98, v16, v17
    v_lshlrev_b32 v16, 16, v99
    v_and_b32 v17, 0xffff0000, v99
    v_lshlrev_b32 v18, 16, v115
    v_cmp_lt_f32 vcc, 0, v16
    v_cmp_lt_f32 s[40:41], 0, v17
    v_and_b32 v19, 0xffff0000, v115
    v_cndmask_b32 v20, 0, 1.0, vcc
    v_cndmask_b32 v21, 0, 1.0, s[40:41]
    v_mul_f32 v16, v16, v20
    v_mul_f32 v17, v17, v21
    v_mul_f32 v16, v16, v18
    v_mul_f32 v17, v17, v19
    v_cvt_pk_bf16_f32 v99, v16, v17
    global_store_dwordx4 v8, v[96:99], s[24:25] offset:0 sc1
    v_cvt_pk_bf16_f32 v104, v104, v105
    v_cvt_pk_bf16_f32 v105, v106, v107
    v_cvt_pk_bf16_f32 v106, v108, v109
    v_cvt_pk_bf16_f32 v107, v110, v111
    v_cvt_pk_bf16_f32 v120, v120, v121
    v_cvt_pk_bf16_f32 v121, v122, v123
    v_cvt_pk_bf16_f32 v122, v124, v125
    v_cvt_pk_bf16_f32 v123, v126, v127
    v_lshlrev_b32 v16, 16, v104
    v_and_b32 v17, 0xffff0000, v104
    v_lshlrev_b32 v18, 16, v120
    v_cmp_lt_f32 vcc, 0, v16
    v_cmp_lt_f32 s[40:41], 0, v17
    v_and_b32 v19, 0xffff0000, v120
    v_cndmask_b32 v20, 0, 1.0, vcc
    v_cndmask_b32 v21, 0, 1.0, s[40:41]
    v_mul_f32 v16, v16, v20
    v_mul_f32 v17, v17, v21
    v_mul_f32 v16, v16, v18
    v_mul_f32 v17, v17, v19
    v_cvt_pk_bf16_f32 v104, v16, v17
    v_lshlrev_b32 v16, 16, v105
    v_and_b32 v17, 0xffff0000, v105
    v_lshlrev_b32 v18, 16, v121
    v_cmp_lt_f32 vcc, 0, v16
    v_cmp_lt_f32 s[40:41], 0, v17
    v_and_b32 v19, 0xffff0000, v121
    v_cndmask_b32 v20, 0, 1.0, vcc
    v_cndmask_b32 v21, 0, 1.0, s[40:41]
    v_mul_f32 v16, v16, v20
    v_mul_f32 v17, v17, v21
    v_mul_f32 v16, v16, v18
    v_mul_f32 v17, v17, v19
    v_cvt_pk_bf16_f32 v105, v16, v17
    v_lshlrev_b32 v16, 16, v106
    v_and_b32 v17, 0xffff0000, v106
    v_lshlrev_b32 v18, 16, v122
    v_cmp_lt_f32 vcc, 0, v16
    v_cmp_lt_f32 s[40:41], 0, v17
    v_and_b32 v19, 0xffff0000, v122
    v_cndmask_b32 v20, 0, 1.0, vcc
    v_cndmask_b32 v21, 0, 1.0, s[40:41]
    v_mul_f32 v16, v16, v20
    v_mul_f32 v17, v17, v21
    v_mul_f32 v16, v16, v18
    v_mul_f32 v17, v17, v19
    v_cvt_pk_bf16_f32 v106, v16, v17
    v_lshlrev_b32 v16, 16, v107
    v_and_b32 v17, 0xffff0000, v107
    v_lshlrev_b32 v18, 16, v123
    v_cmp_lt_f32 vcc, 0, v16
    v_cmp_lt_f32 s[40:41], 0, v17
    v_and_b32 v19, 0xffff0000, v123
    v_cndmask_b32 v20, 0, 1.0, vcc
    v_cndmask_b32 v21, 0, 1.0, s[40:41]
    v_mul_f32 v16, v16, v20
    v_mul_f32 v17, v17, v21
    v_mul_f32 v16, v16, v18
    v_mul_f32 v17, v17, v19
    v_cvt_pk_bf16_f32 v107, v16, v17
    global_store_dwordx4 v8, v[104:107], s[24:25] offset:1024 sc1
    v_add_u32 v8, 55296, v8
    v_cvt_pk_bf16_f32 v128, v128, v129
    v_cvt_pk_bf16_f32 v129, v130, v131
    v_cvt_pk_bf16_f32 v130, v132, v133
    v_cvt_pk_bf16_f32 v131, v134, v135
    v_cvt_pk_bf16_f32 v144, v144, v145
    v_cvt_pk_bf16_f32 v145, v146, v147
    v_cvt_pk_bf16_f32 v146, v148, v149
    v_cvt_pk_bf16_f32 v147, v150, v151
    v_lshlrev_b32 v16, 16, v128
    v_and_b32 v17, 0xffff0000, v128
    v_lshlrev_b32 v18, 16, v144
    v_cmp_lt_f32 vcc, 0, v16
    v_cmp_lt_f32 s[40:41], 0, v17
    v_and_b32 v19, 0xffff0000, v144
    v_cndmask_b32 v20, 0, 1.0, vcc
    v_cndmask_b32 v21, 0, 1.0, s[40:41]
    v_mul_f32 v16, v16, v20
    v_mul_f32 v17, v17, v21
    v_mul_f32 v16, v16, v18
    v_mul_f32 v17, v17, v19
    v_cvt_pk_bf16_f32 v128, v16, v17
    v_lshlrev_b32 v16, 16, v129
    v_and_b32 v17, 0xffff0000, v129
    v_lshlrev_b32 v18, 16, v145
    v_cmp_lt_f32 vcc, 0, v16
    v_cmp_lt_f32 s[40:41], 0, v17
    v_and_b32 v19, 0xffff0000, v145
    v_cndmask_b32 v20, 0, 1.0, vcc
    v_cndmask_b32 v21, 0, 1.0, s[40:41]
    v_mul_f32 v16, v16, v20
    v_mul_f32 v17, v17, v21
    v_mul_f32 v16, v16, v18
    v_mul_f32 v17, v17, v19
    v_cvt_pk_bf16_f32 v129, v16, v17
    v_lshlrev_b32 v16, 16, v130
    v_and_b32 v17, 0xffff0000, v130
    v_lshlrev_b32 v18, 16, v146
    v_cmp_lt_f32 vcc, 0, v16
    v_cmp_lt_f32 s[40:41], 0, v17
    v_and_b32 v19, 0xffff0000, v146
    v_cndmask_b32 v20, 0, 1.0, vcc
    v_cndmask_b32 v21, 0, 1.0, s[40:41]
    v_mul_f32 v16, v16, v20
    v_mul_f32 v17, v17, v21
    v_mul_f32 v16, v16, v18
    v_mul_f32 v17, v17, v19
    v_cvt_pk_bf16_f32 v130, v16, v17
    v_lshlrev_b32 v16, 16, v131
    v_and_b32 v17, 0xffff0000, v131
    v_lshlrev_b32 v18, 16, v147
    v_cmp_lt_f32 vcc, 0, v16
    v_cmp_lt_f32 s[40:41], 0, v17
    v_and_b32 v19, 0xffff0000, v147
    v_cndmask_b32 v20, 0, 1.0, vcc
    v_cndmask_b32 v21, 0, 1.0, s[40:41]
    v_mul_f32 v16, v16, v20
    v_mul_f32 v17, v17, v21
    v_mul_f32 v16, v16, v18
    v_mul_f32 v17, v17, v19
    v_cvt_pk_bf16_f32 v131, v16, v17
    global_store_dwordx4 v8, v[128:131], s[24:25] offset:0 sc1
    v_cvt_pk_bf16_f32 v136, v136, v137
    v_cvt_pk_bf16_f32 v137, v138, v139
    v_cvt_pk_bf16_f32 v138, v140, v141
    v_cvt_pk_bf16_f32 v139, v142, v143
    v_cvt_pk_bf16_f32 v152, v152, v153
    v_cvt_pk_bf16_f32 v153, v154, v155
    v_cvt_pk_bf16_f32 v154, v156, v157
    v_cvt_pk_bf16_f32 v155, v158, v159
    v_lshlrev_b32 v16, 16, v136
    v_and_b32 v17, 0xffff0000, v136
    v_lshlrev_b32 v18, 16, v152
    v_cmp_lt_f32 vcc, 0, v16
    v_cmp_lt_f32 s[40:41], 0, v17
    v_and_b32 v19, 0xffff0000, v152
    v_cndmask_b32 v20, 0, 1.0, vcc
    v_cndmask_b32 v21, 0, 1.0, s[40:41]
    v_mul_f32 v16, v16, v20
    v_mul_f32 v17, v17, v21
    v_mul_f32 v16, v16, v18
    v_mul_f32 v17, v17, v19
    v_cvt_pk_bf16_f32 v136, v16, v17
    v_lshlrev_b32 v16, 16, v137
    v_and_b32 v17, 0xffff0000, v137
    v_lshlrev_b32 v18, 16, v153
    v_cmp_lt_f32 vcc, 0, v16
    v_cmp_lt_f32 s[40:41], 0, v17
    v_and_b32 v19, 0xffff0000, v153
    v_cndmask_b32 v20, 0, 1.0, vcc
    v_cndmask_b32 v21, 0, 1.0, s[40:41]
    v_mul_f32 v16, v16, v20
    v_mul_f32 v17, v17, v21
    v_mul_f32 v16, v16, v18
    v_mul_f32 v17, v17, v19
    v_cvt_pk_bf16_f32 v137, v16, v17
    v_lshlrev_b32 v16, 16, v138
    v_and_b32 v17, 0xffff0000, v138
    v_lshlrev_b32 v18, 16, v154
    v_cmp_lt_f32 vcc, 0, v16
    v_cmp_lt_f32 s[40:41], 0, v17
    v_and_b32 v19, 0xffff0000, v154
    v_cndmask_b32 v20, 0, 1.0, vcc
    v_cndmask_b32 v21, 0, 1.0, s[40:41]
    v_mul_f32 v16, v16, v20
    v_mul_f32 v17, v17, v21
    v_mul_f32 v16, v16, v18
    v_mul_f32 v17, v17, v19
    v_cvt_pk_bf16_f32 v138, v16, v17
    v_lshlrev_b32 v16, 16, v139
    v_and_b32 v17, 0xffff0000, v139
    v_lshlrev_b32 v18, 16, v155
    v_cmp_lt_f32 vcc, 0, v16
    v_cmp_lt_f32 s[40:41], 0, v17
    v_and_b32 v19, 0xffff0000, v155
    v_cndmask_b32 v20, 0, 1.0, vcc
    v_cndmask_b32 v21, 0, 1.0, s[40:41]
    v_mul_f32 v16, v16, v20
    v_mul_f32 v17, v17, v21
    v_mul_f32 v16, v16, v18
    v_mul_f32 v17, v17, v19
    v_cvt_pk_bf16_f32 v139, v16, v17
    global_store_dwordx4 v8, v[136:139], s[24:25] offset:1024 sc1
    v_add_u32 v8, 55296, v8
    v_cvt_pk_bf16_f32 v160, v160, v161
    v_cvt_pk_bf16_f32 v161, v162, v163
    v_cvt_pk_bf16_f32 v162, v164, v165
    v_cvt_pk_bf16_f32 v163, v166, v167
    v_cvt_pk_bf16_f32 v176, v176, v177
    v_cvt_pk_bf16_f32 v177, v178, v179
    v_cvt_pk_bf16_f32 v178, v180, v181
    v_cvt_pk_bf16_f32 v179, v182, v183
    v_lshlrev_b32 v16, 16, v160
    v_and_b32 v17, 0xffff0000, v160
    v_lshlrev_b32 v18, 16, v176
    v_cmp_lt_f32 vcc, 0, v16
    v_cmp_lt_f32 s[40:41], 0, v17
    v_and_b32 v19, 0xffff0000, v176
    v_cndmask_b32 v20, 0, 1.0, vcc
    v_cndmask_b32 v21, 0, 1.0, s[40:41]
    v_mul_f32 v16, v16, v20
    v_mul_f32 v17, v17, v21
    v_mul_f32 v16, v16, v18
    v_mul_f32 v17, v17, v19
    v_cvt_pk_bf16_f32 v160, v16, v17
    v_lshlrev_b32 v16, 16, v161
    v_and_b32 v17, 0xffff0000, v161
    v_lshlrev_b32 v18, 16, v177
    v_cmp_lt_f32 vcc, 0, v16
    v_cmp_lt_f32 s[40:41], 0, v17
    v_and_b32 v19, 0xffff0000, v177
    v_cndmask_b32 v20, 0, 1.0, vcc
    v_cndmask_b32 v21, 0, 1.0, s[40:41]
    v_mul_f32 v16, v16, v20
    v_mul_f32 v17, v17, v21
    v_mul_f32 v16, v16, v18
    v_mul_f32 v17, v17, v19
    v_cvt_pk_bf16_f32 v161, v16, v17
    v_lshlrev_b32 v16, 16, v162
    v_and_b32 v17, 0xffff0000, v162
    v_lshlrev_b32 v18, 16, v178
    v_cmp_lt_f32 vcc, 0, v16
    v_cmp_lt_f32 s[40:41], 0, v17
    v_and_b32 v19, 0xffff0000, v178
    v_cndmask_b32 v20, 0, 1.0, vcc
    v_cndmask_b32 v21, 0, 1.0, s[40:41]
    v_mul_f32 v16, v16, v20
    v_mul_f32 v17, v17, v21
    v_mul_f32 v16, v16, v18
    v_mul_f32 v17, v17, v19
    v_cvt_pk_bf16_f32 v162, v16, v17
    v_lshlrev_b32 v16, 16, v163
    v_and_b32 v17, 0xffff0000, v163
    v_lshlrev_b32 v18, 16, v179
    v_cmp_lt_f32 vcc, 0, v16
    v_cmp_lt_f32 s[40:41], 0, v17
    v_and_b32 v19, 0xffff0000, v179
    v_cndmask_b32 v20, 0, 1.0, vcc
    v_cndmask_b32 v21, 0, 1.0, s[40:41]
    v_mul_f32 v16, v16, v20
    v_mul_f32 v17, v17, v21
    v_mul_f32 v16, v16, v18
    v_mul_f32 v17, v17, v19
    v_cvt_pk_bf16_f32 v163, v16, v17
    global_store_dwordx4 v8, v[160:163], s[24:25] offset:0 sc1
    v_cvt_pk_bf16_f32 v168, v168, v169
    v_cvt_pk_bf16_f32 v169, v170, v171
    v_cvt_pk_bf16_f32 v170, v172, v173
    v_cvt_pk_bf16_f32 v171, v174, v175
    v_cvt_pk_bf16_f32 v184, v184, v185
    v_cvt_pk_bf16_f32 v185, v186, v187
    v_cvt_pk_bf16_f32 v186, v188, v189
    v_cvt_pk_bf16_f32 v187, v190, v191
    v_lshlrev_b32 v16, 16, v168
    v_and_b32 v17, 0xffff0000, v168
    v_lshlrev_b32 v18, 16, v184
    v_cmp_lt_f32 vcc, 0, v16
    v_cmp_lt_f32 s[40:41], 0, v17
    v_and_b32 v19, 0xffff0000, v184
    v_cndmask_b32 v20, 0, 1.0, vcc
    v_cndmask_b32 v21, 0, 1.0, s[40:41]
    v_mul_f32 v16, v16, v20
    v_mul_f32 v17, v17, v21
    v_mul_f32 v16, v16, v18
    v_mul_f32 v17, v17, v19
    v_cvt_pk_bf16_f32 v168, v16, v17
    v_lshlrev_b32 v16, 16, v169
    v_and_b32 v17, 0xffff0000, v169
    v_lshlrev_b32 v18, 16, v185
    v_cmp_lt_f32 vcc, 0, v16
    v_cmp_lt_f32 s[40:41], 0, v17
    v_and_b32 v19, 0xffff0000, v185
    v_cndmask_b32 v20, 0, 1.0, vcc
    v_cndmask_b32 v21, 0, 1.0, s[40:41]
    v_mul_f32 v16, v16, v20
    v_mul_f32 v17, v17, v21
    v_mul_f32 v16, v16, v18
    v_mul_f32 v17, v17, v19
    v_cvt_pk_bf16_f32 v169, v16, v17
    v_lshlrev_b32 v16, 16, v170
    v_and_b32 v17, 0xffff0000, v170
    v_lshlrev_b32 v18, 16, v186
    v_cmp_lt_f32 vcc, 0, v16
    v_cmp_lt_f32 s[40:41], 0, v17
    v_and_b32 v19, 0xffff0000, v186
    v_cndmask_b32 v20, 0, 1.0, vcc
    v_cndmask_b32 v21, 0, 1.0, s[40:41]
    v_mul_f32 v16, v16, v20
    v_mul_f32 v17, v17, v21
    v_mul_f32 v16, v16, v18
    v_mul_f32 v17, v17, v19
    v_cvt_pk_bf16_f32 v170, v16, v17
    v_lshlrev_b32 v16, 16, v171
    v_and_b32 v17, 0xffff0000, v171
    v_lshlrev_b32 v18, 16, v187
    v_cmp_lt_f32 vcc, 0, v16
    v_cmp_lt_f32 s[40:41], 0, v17
    v_and_b32 v19, 0xffff0000, v187
    v_cndmask_b32 v20, 0, 1.0, vcc
    v_cndmask_b32 v21, 0, 1.0, s[40:41]
    v_mul_f32 v16, v16, v20
    v_mul_f32 v17, v17, v21
    v_mul_f32 v16, v16, v18
    v_mul_f32 v17, v17, v19
    v_cvt_pk_bf16_f32 v171, v16, v17
    global_store_dwordx4 v8, v[168:171], s[24:25] offset:1024 sc1
    s_branch g1_end
g1_v:
    s_cmp_eq_u32 s28, 0
    s_cbranch_scc1 gsv_fa_15
    s_waitcnt vmcnt(24)
    v_add_u32 v8, 8192, v8
    v_add_u32 v9, 8192, v9
    v_add_u32 v10, 8192, v10
    v_add_u32 v11, 8192, v11
    global_load_dwordx4 a[128:131], v8, s[14:15] offset:-4096 sc1
    global_load_dwordx4 a[132:135], v9, s[14:15] offset:-4096 sc1
    global_load_dwordx4 a[136:139], v10, s[14:15] offset:-4096 sc1
    global_load_dwordx4 a[140:143], v11, s[14:15] offset:-4096 sc1
    global_load_dwordx4 a[144:147], v8, s[14:15] offset:-3072 sc1
    global_load_dwordx4 a[148:151], v9, s[14:15] offset:-3072 sc1
    global_load_dwordx4 a[152:155], v10, s[14:15] offset:-3072 sc1
    global_load_dwordx4 a[156:159], v11, s[14:15] offset:-3072 sc1
    global_load_dwordx4 a[160:163], v8, s[14:15] offset:-2048 sc1
    global_load_dwordx4 a[164:167], v9, s[14:15] offset:-2048 sc1
    global_load_dwordx4 a[168:171], v10, s[14:15] offset:-2048 sc1
    global_load_dwordx4 a[172:175], v11, s[14:15] offset:-2048 sc1
    global_load_dwordx4 a[176:179], v8, s[14:15] offset:-1024 sc1
    global_load_dwordx4 a[180:183], v9, s[14:15] offset:-1024 sc1
    global_load_dwordx4 a[184:187], v10, s[14:15] offset:-1024 sc1
    global_load_dwordx4 a[188:191], v11, s[14:15] offset:-1024 sc1
gsv_fa_15:
    s_barrier
    v_add_u32 v2, s26, v1
    s_add_u32 s26, s26, 17024
    s_cmp_ge_u32 s26, 153216
    s_cselect_b32 s26, 0, s26
    ds_read_b64_tr_b16 v[16:17], v2 offset:0
    ds_read_b64_tr_b16 v[18:19], v2 offset:4224
    ds_read_b64_tr_b16 v[20:21], v2 offset:32
    ds_read_b64_tr_b16 v[22:23], v2 offset:4256
    ds_read_b64_tr_b16 v[24:25], v2 offset:64
    ds_read_b64_tr_b16 v[26:27], v2 offset:4288
    ds_read_b64_tr_b16 v[28:29], v2 offset:96
    ds_read_b64_tr_b16 v[30:31], v2 offset:4320
    ds_read_b64_tr_b16 v[32:33], v2 offset:128
    ds_read_b64_tr_b16 v[34:35], v2 offset:4352
    ds_read_b64_tr_b16 v[36:37], v2 offset:160
    ds_read_b64_tr_b16 v[38:39], v2 offset:4384
    ds_read_b64_tr_b16 v[40:41], v2 offset:192
    ds_read_b64_tr_b16 v[42:43], v2 offset:4416
    ds_read_b64_tr_b16 v[44:45], v2 offset:224
    ds_read_b64_tr_b16 v[46:47], v2 offset:4448
    s_waitcnt lgkmcnt(8)
    v_mfma_f32_16x16x32_bf16 v[64:67], a[0:3], v[16:19], 0
    ds_read_b64_tr_b16 v[48:49], v2 offset:512
    v_mfma_f32_16x16x32_bf16 v[68:71], a[0:3], v[20:23], 0
    ds_read_b64_tr_b16 v[50:51], v2 offset:4736
    v_mfma_f32_16x16x32_bf16 v[72:75], a[0:3], v[24:27], 0
    ds_read_b64_tr_b16 v[52:53], v2 offset:544
    v_mfma_f32_16x16x32_bf16 v[76:79], a[0:3], v[28:31], 0
    ds_read_b64_tr_b16 v[54:55], v2 offset:4768
    v_mfma_f32_16x16x32_bf16 v[96:99], a[4:7], v[16:19], 0
    ds_read_b64_tr_b16 v[56:57], v2 offset:576
    v_mfma_f32_16x16x32_bf16 v[100:103], a[4:7], v[20:23], 0
    ds_read_b64_tr_b16 v[58:59], v2 offset:4800
    v_mfma_f32_16x16x32_bf16 v[104:107], a[4:7], v[24:27], 0
    ds_read_b64_tr_b16 v[60:61], v2 offset:608
    v_mfma_f32_16x16x32_bf16 v[108:111], a[4:7], v[28:31], 0
    ds_read_b64_tr_b16 v[62:63], v2 offset:4832
    v_mfma_f32_16x16x32_bf16 v[128:131], a[8:11], v[16:19], 0
    v_mfma_f32_16x16x32_bf16 v[132:135], a[8:11], v[20:23], 0
    v_mfma_f32_16x16x32_bf16 v[136:139], a[8:11], v[24:27], 0
    v_mfma_f32_16x16x32_bf16 v[140:143], a[8:11], v[28:31], 0
    v_mfma_f32_16x16x32_bf16 v[160:163], a[12:15], v[16:19], 0
    v_mfma_f32_16x16x32_bf16 v[164:167], a[12:15], v[20:23], 0
    v_mfma_f32_16x16x32_bf16 v[168:171], a[12:15], v[24:27], 0
    v_mfma_f32_16x16x32_bf16 v[172:175], a[12:15], v[28:31], 0
    s_waitcnt lgkmcnt(8)
    v_mfma_f32_16x16x32_bf16 v[80:83], a[0:3], v[32:35], 0
    ds_read_b64_tr_b16 v[16:17], v2 offset:640
    v_mfma_f32_16x16x32_bf16 v[84:87], a[0:3], v[36:39], 0
    ds_read_b64_tr_b16 v[18:19], v2 offset:4864
    v_mfma_f32_16x16x32_bf16 v[88:91], a[0:3], v[40:43], 0
    ds_read_b64_tr_b16 v[20:21], v2 offset:672
    v_mfma_f32_16x16x32_bf16 v[92:95], a[0:3], v[44:47], 0
    ds_read_b64_tr_b16 v[22:23], v2 offset:4896
    v_mfma_f32_16x16x32_bf16 v[112:115], a[4:7], v[32:35], 0
    ds_read_b64_tr_b16 v[24:25], v2 offset:704
    v_mfma_f32_16x16x32_bf16 v[116:119], a[4:7], v[36:39], 0
    ds_read_b64_tr_b16 v[26:27], v2 offset:4928
    v_mfma_f32_16x16x32_bf16 v[120:123], a[4:7], v[40:43], 0
    ds_read_b64_tr_b16 v[28:29], v2 offset:736
    v_mfma_f32_16x16x32_bf16 v[124:127], a[4:7], v[44:47], 0
    ds_read_b64_tr_b16 v[30:31], v2 offset:4960
    v_mfma_f32_16x16x32_bf16 v[144:147], a[8:11], v[32:35], 0
    v_mfma_f32_16x16x32_bf16 v[148:151], a[8:11], v[36:39], 0
    v_mfma_f32_16x16x32_bf16 v[152:155], a[8:11], v[40:43], 0
    v_mfma_f32_16x16x32_bf16 v[156:159], a[8:11], v[44:47], 0
    v_mfma_f32_16x16x32_bf16 v[176:179], a[12:15], v[32:35], 0
    v_mfma_f32_16x16x32_bf16 v[180:183], a[12:15], v[36:39], 0
    v_mfma_f32_16x16x32_bf16 v[184:187], a[12:15], v[40:43], 0
    v_mfma_f32_16x16x32_bf16 v[188:191], a[12:15], v[44:47], 0
    s_nop 0
    s_barrier
    s_waitcnt lgkmcnt(8)
    v_mfma_f32_16x16x32_bf16 v[64:67], a[16:19], v[48:51], v[64:67]
    v_add_u32 v2, s26, v1
    v_mfma_f32_16x16x32_bf16 v[68:71], a[16:19], v[52:55], v[68:71]
    s_add_u32 s26, s26, 17024
    s_cmp_ge_u32 s26, 153216
    s_cselect_b32 s26, 0, s26
    v_mfma_f32_16x16x32_bf16 v[72:75], a[16:19], v[56:59], v[72:75]
    ds_read_b64_tr_b16 v[32:33], v2 offset:0
    v_mfma_f32_16x16x32_bf16 v[76:79], a[16:19], v[60:63], v[76:79]
    ds_read_b64_tr_b16 v[34:35], v2 offset:4224
    v_mfma_f32_16x16x32_bf16 v[96:99], a[20:23], v[48:51], v[96:99]
    ds_read_b64_tr_b16 v[36:37], v2 offset:32
    v_mfma_f32_16x16x32_bf16 v[100:103], a[20:23], v[52:55], v[100:103]
    ds_read_b64_tr_b16 v[38:39], v2 offset:4256
    v_mfma_f32_16x16x32_bf16 v[104:107], a[20:23], v[56:59], v[104:107]
    ds_read_b64_tr_b16 v[40:41], v2 offset:64
    v_mfma_f32_16x16x32_bf16 v[108:111], a[20:23], v[60:63], v[108:111]
    ds_read_b64_tr_b16 v[42:43], v2 offset:4288
    v_mfma_f32_16x16x32_bf16 v[128:131], a[24:27], v[48:51], v[128:131]
    ds_read_b64_tr_b16 v[44:45], v2 offset:96
    v_mfma_f32_16x16x32_bf16 v[132:135], a[24:27], v[52:55], v[132:135]
    ds_read_b64_tr_b16 v[46:47], v2 offset:4320
    v_mfma_f32_16x16x32_bf16 v[136:139], a[24:27], v[56:59], v[136:139]
    v_mfma_f32_16x16x32_bf16 v[140:143], a[24:27], v[60:63], v[140:143]
    v_mfma_f32_16x16x32_bf16 v[160:163], a[28:31], v[48:51], v[160:163]
    v_mfma_f32_16x16x32_bf16 v[164:167], a[28:31], v[52:55], v[164:167]
    v_mfma_f32_16x16x32_bf16 v[168:171], a[28:31], v[56:59], v[168:171]
    v_mfma_f32_16x16x32_bf16 v[172:175], a[28:31], v[60:63], v[172:175]
    s_waitcnt lgkmcnt(8)
    v_mfma_f32_16x16x32_bf16 v[80:83], a[16:19], v[16:19], v[80:83]
    ds_read_b64_tr_b16 v[48:49], v2 offset:128
    ds_read_b64_tr_b16 v[50:51], v2 offset:4352
    v_mfma_f32_16x16x32_bf16 v[84:87], a[16:19], v[20:23], v[84:87]
    ds_read_b64_tr_b16 v[52:53], v2 offset:160
    ds_read_b64_tr_b16 v[54:55], v2 offset:4384
    v_mfma_f32_16x16x32_bf16 v[88:91], a[16:19], v[24:27], v[88:91]
    ds_read_b64_tr_b16 v[56:57], v2 offset:192
    ds_read_b64_tr_b16 v[58:59], v2 offset:4416
    v_mfma_f32_16x16x32_bf16 v[92:95], a[16:19], v[28:31], v[92:95]
    ds_read_b64_tr_b16 v[60:61], v2 offset:224
    ds_read_b64_tr_b16 v[62:63], v2 offset:4448
    v_mfma_f32_16x16x32_bf16 v[112:115], a[20:23], v[16:19], v[112:115]
    s_add_u32 m0, s27, 0
    s_nop 0
    global_load_lds_dwordx4 v[4:5], off
    v_mfma_f32_16x16x32_bf16 v[116:119], a[20:23], v[20:23], v[116:119]
    v_lshl_add_u64 v[4:5], v[4:5], 0, s[20:21]
    s_add_u32 m0, s27, 1056
    v_mfma_f32_16x16x32_bf16 v[120:123], a[20:23], v[24:27], v[120:123]
    global_load_lds_dwordx4 v[4:5], off
    v_lshl_add_u64 v[4:5], v[4:5], 0, s[20:21]
    v_mfma_f32_16x16x32_bf16 v[124:127], a[20:23], v[28:31], v[124:127]
    s_add_u32 m0, s27, 2112
    s_nop 0
    global_load_lds_dwordx4 v[4:5], off
    v_mfma_f32_16x16x32_bf16 v[144:147], a[24:27], v[16:19], v[144:147]
    v_lshl_add_u64 v[4:5], v[4:5], 0, s[20:21]
    s_add_u32 m0, s27, 3168
    v_mfma_f32_16x16x32_bf16 v[148:151], a[24:27], v[20:23], v[148:151]
    global_load_lds_dwordx4 v[4:5], off
    v_lshl_add_u64 v[4:5], v[4:5], 0, s[22:23]
    v_mfma_f32_16x16x32_bf16 v[152:155], a[24:27], v[24:27], v[152:155]
    s_add_u32 s27, s27, 17024
    s_cmp_ge_u32 s27, 153216
    s_cselect_b32 s27, s38, s27
    v_mfma_f32_16x16x32_bf16 v[156:159], a[24:27], v[28:31], v[156:159]
    v_mfma_f32_16x16x32_bf16 v[176:179], a[28:31], v[16:19], v[176:179]
    v_mfma_f32_16x16x32_bf16 v[180:183], a[28:31], v[20:23], v[180:183]
    v_mfma_f32_16x16x32_bf16 v[184:187], a[28:31], v[24:27], v[184:187]
    v_mfma_f32_16x16x32_bf16 v[188:191], a[28:31], v[28:31], v[188:191]
    s_cmp_eq_u32 s28, 0
    s_cbranch_scc1 gsv_fa_16
    s_waitcnt vmcnt(36)
    global_load_dwordx4 a[192:195], v8, s[14:15] offset:0 sc1
    global_load_dwordx4 a[196:199], v9, s[14:15] offset:0 sc1
    global_load_dwordx4 a[200:203], v10, s[14:15] offset:0 sc1
    global_load_dwordx4 a[204:207], v11, s[14:15] offset:0 sc1
    global_load_dwordx4 a[208:211], v8, s[14:15] offset:1024 sc1
    global_load_dwordx4 a[212:215], v9, s[14:15] offset:1024 sc1
    global_load_dwordx4 a[216:219], v10, s[14:15] offset:1024 sc1
    global_load_dwordx4 a[220:223], v11, s[14:15] offset:1024 sc1
    global_load_dwordx4 a[224:227], v8, s[14:15] offset:2048 sc1
    global_load_dwordx4 a[228:231], v9, s[14:15] offset:2048 sc1
    global_load_dwordx4 a[232:235], v10, s[14:15] offset:2048 sc1
    global_load_dwordx4 a[236:239], v11, s[14:15] offset:2048 sc1
    global_load_dwordx4 a[240:243], v8, s[14:15] offset:3072 sc1
    global_load_dwordx4 a[244:247], v9, s[14:15] offset:3072 sc1
    global_load_dwordx4 a[248:251], v10, s[14:15] offset:3072 sc1
    global_load_dwordx4 a[252:255], v11, s[14:15] offset:3072 sc1
gsv_fa_16:
    s_waitcnt lgkmcnt(8)
    v_mfma_f32_16x16x32_bf16 v[64:67], a[32:35], v[32:35], v[64:67]
    ds_read_b64_tr_b16 v[16:17], v2 offset:512
    v_mfma_f32_16x16x32_bf16 v[68:71], a[32:35], v[36:39], v[68:71]
    ds_read_b64_tr_b16 v[18:19], v2 offset:4736
    v_mfma_f32_16x16x32_bf16 v[72:75], a[32:35], v[40:43], v[72:75]
    ds_read_b64_tr_b16 v[20:21], v2 offset:544
    v_mfma_f32_16x16x32_bf16 v[76:79], a[32:35], v[44:47], v[76:79]
    ds_read_b64_tr_b16 v[22:23], v2 offset:4768
    v_mfma_f32_16x16x32_bf16 v[96:99], a[36:39], v[32:35], v[96:99]
    ds_read_b64_tr_b16 v[24:25], v2 offset:576
    v_mfma_f32_16x16x32_bf16 v[100:103], a[36:39], v[36:39], v[100:103]
    ds_read_b64_tr_b16 v[26:27], v2 offset:4800
    v_mfma_f32_16x16x32_bf16 v[104:107], a[36:39], v[40:43], v[104:107]
    ds_read_b64_tr_b16 v[28:29], v2 offset:608
    v_mfma_f32_16x16x32_bf16 v[108:111], a[36:39], v[44:47], v[108:111]
    ds_read_b64_tr_b16 v[30:31], v2 offset:4832
    v_mfma_f32_16x16x32_bf16 v[128:131], a[40:43], v[32:35], v[128:131]
    v_mfma_f32_16x16x32_bf16 v[132:135], a[40:43], v[36:39], v[132:135]
    v_mfma_f32_16x16x32_bf16 v[136:139], a[40:43], v[40:43], v[136:139]
    v_mfma_f32_16x16x32_bf16 v[140:143], a[40:43], v[44:47], v[140:143]
    v_mfma_f32_16x16x32_bf16 v[160:163], a[44:47], v[32:35], v[160:163]
    v_mfma_f32_16x16x32_bf16 v[164:167], a[44:47], v[36:39], v[164:167]
    v_mfma_f32_16x16x32_bf16 v[168:171], a[44:47], v[40:43], v[168:171]
    v_mfma_f32_16x16x32_bf16 v[172:175], a[44:47], v[44:47], v[172:175]
    s_waitcnt lgkmcnt(8)
    v_mfma_f32_16x16x32_bf16 v[80:83], a[32:35], v[48:51], v[80:83]
    ds_read_b64_tr_b16 v[32:33], v2 offset:640
    v_mfma_f32_16x16x32_bf16 v[84:87], a[32:35], v[52:55], v[84:87]
    ds_read_b64_tr_b16 v[34:35], v2 offset:4864
    v_mfma_f32_16x16x32_bf16 v[88:91], a[32:35], v[56:59], v[88:91]
    ds_read_b64_tr_b16 v[36:37], v2 offset:672
    v_mfma_f32_16x16x32_bf16 v[92:95], a[32:35], v[60:63], v[92:95]
    ds_read_b64_tr_b16 v[38:39], v2 offset:4896
    v_mfma_f32_16x16x32_bf16 v[112:115], a[36:39], v[48:51], v[112:115]
    ds_read_b64_tr_b16 v[40:41], v2 offset:704
    v_mfma_f32_16x16x32_bf16 v[116:119], a[36:39], v[52:55], v[116:119]
    ds_read_b64_tr_b16 v[42:43], v2 offset:4928
    v_mfma_f32_16x16x32_bf16 v[120:123], a[36:39], v[56:59], v[120:123]
    ds_read_b64_tr_b16 v[44:45], v2 offset:736
    v_mfma_f32_16x16x32_bf16 v[124:127], a[36:39], v[60:63], v[124:127]
    ds_read_b64_tr_b16 v[46:47], v2 offset:4960
    v_mfma_f32_16x16x32_bf16 v[144:147], a[40:43], v[48:51], v[144:147]
    v_mfma_f32_16x16x32_bf16 v[148:151], a[40:43], v[52:55], v[148:151]
    v_mfma_f32_16x16x32_bf16 v[152:155], a[40:43], v[56:59], v[152:155]
    v_mfma_f32_16x16x32_bf16 v[156:159], a[40:43], v[60:63], v[156:159]
    v_mfma_f32_16x16x32_bf16 v[176:179], a[44:47], v[48:51], v[176:179]
    v_mfma_f32_16x16x32_bf16 v[180:183], a[44:47], v[52:55], v[180:183]
    v_mfma_f32_16x16x32_bf16 v[184:187], a[44:47], v[56:59], v[184:187]
    v_mfma_f32_16x16x32_bf16 v[188:191], a[44:47], v[60:63], v[188:191]
    s_nop 0
    s_barrier
    s_waitcnt lgkmcnt(8)
    v_mfma_f32_16x16x32_bf16 v[64:67], a[48:51], v[16:19], v[64:67]
    v_add_u32 v2, s26, v1
    v_mfma_f32_16x16x32_bf16 v[68:71], a[48:51], v[20:23], v[68:71]
    s_add_u32 s26, s26, 17024
    s_cmp_ge_u32 s26, 153216
    s_cselect_b32 s26, 0, s26
    v_mfma_f32_16x16x32_bf16 v[72:75], a[48:51], v[24:27], v[72:75]
    ds_read_b64_tr_b16 v[48:49], v2 offset:0
    v_mfma_f32_16x16x32_bf16 v[76:79], a[48:51], v[28:31], v[76:79]
    ds_read_b64_tr_b16 v[50:51], v2 offset:4224
    v_mfma_f32_16x16x32_bf16 v[96:99], a[52:55], v[16:19], v[96:99]
    ds_read_b64_tr_b16 v[52:53], v2 offset:32
    v_mfma_f32_16x16x32_bf16 v[100:103], a[52:55], v[20:23], v[100:103]
    ds_read_b64_tr_b16 v[54:55], v2 offset:4256
    v_mfma_f32_16x16x32_bf16 v[104:107], a[52:55], v[24:27], v[104:107]
    ds_read_b64_tr_b16 v[56:57], v2 offset:64
    v_mfma_f32_16x16x32_bf16 v[108:111], a[52:55], v[28:31], v[108:111]
    ds_read_b64_tr_b16 v[58:59], v2 offset:4288
    v_mfma_f32_16x16x32_bf16 v[128:131], a[56:59], v[16:19], v[128:131]
    ds_read_b64_tr_b16 v[60:61], v2 offset:96
    v_mfma_f32_16x16x32_bf16 v[132:135], a[56:59], v[20:23], v[132:135]
    ds_read_b64_tr_b16 v[62:63], v2 offset:4320
    v_mfma_f32_16x16x32_bf16 v[136:139], a[56:59], v[24:27], v[136:139]
    v_mfma_f32_16x16x32_bf16 v[140:143], a[56:59], v[28:31], v[140:143]
    v_mfma_f32_16x16x32_bf16 v[160:163], a[60:63], v[16:19], v[160:163]
    v_mfma_f32_16x16x32_bf16 v[164:167], a[60:63], v[20:23], v[164:167]
    v_mfma_f32_16x16x32_bf16 v[168:171], a[60:63], v[24:27], v[168:171]
    v_mfma_f32_16x16x32_bf16 v[172:175], a[60:63], v[28:31], v[172:175]
    s_waitcnt lgkmcnt(8)
    v_mfma_f32_16x16x32_bf16 v[80:83], a[48:51], v[32:35], v[80:83]
    ds_read_b64_tr_b16 v[16:17], v2 offset:128
    ds_read_b64_tr_b16 v[18:19], v2 offset:4352
    v_mfma_f32_16x16x32_bf16 v[84:87], a[48:51], v[36:39], v[84:87]
    ds_read_b64_tr_b16 v[20:21], v2 offset:160
    ds_read_b64_tr_b16 v[22:23], v2 offset:4384
    v_mfma_f32_16x16x32_bf16 v[88:91], a[48:51], v[40:43], v[88:91]
    ds_read_b64_tr_b16 v[24:25], v2 offset:192
    ds_read_b64_tr_b16 v[26:27], v2 offset:4416
    v_mfma_f32_16x16x32_bf16 v[92:95], a[48:51], v[44:47], v[92:95]
    ds_read_b64_tr_b16 v[28:29], v2 offset:224
    ds_read_b64_tr_b16 v[30:31], v2 offset:4448
    v_mfma_f32_16x16x32_bf16 v[112:115], a[52:55], v[32:35], v[112:115]
    s_add_u32 m0, s27, 0
    s_nop 0
    global_load_lds_dwordx4 v[4:5], off
    v_mfma_f32_16x16x32_bf16 v[116:119], a[52:55], v[36:39], v[116:119]
    v_lshl_add_u64 v[4:5], v[4:5], 0, s[20:21]
    s_add_u32 m0, s27, 1056
    v_mfma_f32_16x16x32_bf16 v[120:123], a[52:55], v[40:43], v[120:123]
    global_load_lds_dwordx4 v[4:5], off
    v_lshl_add_u64 v[4:5], v[4:5], 0, s[20:21]
    v_mfma_f32_16x16x32_bf16 v[124:127], a[52:55], v[44:47], v[124:127]
    s_add_u32 m0, s27, 2112
    s_nop 0
    global_load_lds_dwordx4 v[4:5], off
    v_mfma_f32_16x16x32_bf16 v[144:147], a[56:59], v[32:35], v[144:147]
    v_lshl_add_u64 v[4:5], v[4:5], 0, s[20:21]
    s_add_u32 m0, s27, 3168
    v_mfma_f32_16x16x32_bf16 v[148:151], a[56:59], v[36:39], v[148:151]
    global_load_lds_dwordx4 v[4:5], off
    v_lshl_add_u64 v[4:5], v[4:5], 0, s[22:23]
    v_mfma_f32_16x16x32_bf16 v[152:155], a[56:59], v[40:43], v[152:155]
    s_add_u32 s27, s27, 17024
    s_cmp_ge_u32 s27, 153216
    s_cselect_b32 s27, s38, s27
    v_mfma_f32_16x16x32_bf16 v[156:159], a[56:59], v[44:47], v[156:159]
    v_mfma_f32_16x16x32_bf16 v[176:179], a[60:63], v[32:35], v[176:179]
    v_mfma_f32_16x16x32_bf16 v[180:183], a[60:63], v[36:39], v[180:183]
    v_mfma_f32_16x16x32_bf16 v[184:187], a[60:63], v[40:43], v[184:187]
    v_mfma_f32_16x16x32_bf16 v[188:191], a[60:63], v[44:47], v[188:191]
    s_cmp_eq_u32 s28, 0
    s_cbranch_scc1 gsv_fa_17
    s_waitcnt vmcnt(48)
    v_add_u32 v8, 8192, v8
    v_add_u32 v9, 8192, v9
    v_add_u32 v10, 8192, v10
    v_add_u32 v11, 8192, v11
    global_load_dwordx4 v[192:195], v8, s[14:15] offset:-4096 sc1
    global_load_dwordx4 v[196:199], v9, s[14:15] offset:-4096 sc1
    global_load_dwordx4 v[200:203], v10, s[14:15] offset:-4096 sc1
    global_load_dwordx4 v[204:207], v11, s[14:15] offset:-4096 sc1
    global_load_dwordx4 v[208:211], v8, s[14:15] offset:-3072 sc1
    global_load_dwordx4 v[212:215], v9, s[14:15] offset:-3072 sc1
    global_load_dwordx4 v[216:219], v10, s[14:15] offset:-3072 sc1
    global_load_dwordx4 v[220:223], v11, s[14:15] offset:-3072 sc1
    global_load_dwordx4 v[224:227], v8, s[14:15] offset:-2048 sc1
    global_load_dwordx4 v[228:231], v9, s[14:15] offset:-2048 sc1
    global_load_dwordx4 v[232:235], v10, s[14:15] offset:-2048 sc1
    global_load_dwordx4 v[236:239], v11, s[14:15] offset:-2048 sc1
    global_load_dwordx4 v[240:243], v8, s[14:15] offset:-1024 sc1
    global_load_dwordx4 v[244:247], v9, s[14:15] offset:-1024 sc1
    global_load_dwordx4 v[248:251], v10, s[14:15] offset:-1024 sc1
    global_load_dwordx4 v[252:255], v11, s[14:15] offset:-1024 sc1
gsv_fa_17:
    s_waitcnt lgkmcnt(8)
    v_mfma_f32_16x16x32_bf16 v[64:67], a[64:67], v[48:51], v[64:67]
    ds_read_b64_tr_b16 v[32:33], v2 offset:512
    v_mfma_f32_16x16x32_bf16 v[68:71], a[64:67], v[52:55], v[68:71]
    ds_read_b64_tr_b16 v[34:35], v2 offset:4736
    v_mfma_f32_16x16x32_bf16 v[72:75], a[64:67], v[56:59], v[72:75]
    ds_read_b64_tr_b16 v[36:37], v2 offset:544
    v_mfma_f32_16x16x32_bf16 v[76:79], a[64:67], v[60:63], v[76:79]
    ds_read_b64_tr_b16 v[38:39], v2 offset:4768
    v_mfma_f32_16x16x32_bf16 v[96:99], a[68:71], v[48:51], v[96:99]
    ds_read_b64_tr_b16 v[40:41], v2 offset:576
    v_mfma_f32_16x16x32_bf16 v[100:103], a[68:71], v[52:55], v[100:103]
    ds_read_b64_tr_b16 v[42:43], v2 offset:4800
    v_mfma_f32_16x16x32_bf16 v[104:107], a[68:71], v[56:59], v[104:107]
    ds_read_b64_tr_b16 v[44:45], v2 offset:608
    v_mfma_f32_16x16x32_bf16 v[108:111], a[68:71], v[60:63], v[108:111]
    ds_read_b64_tr_b16 v[46:47], v2 offset:4832
    v_mfma_f32_16x16x32_bf16 v[128:131], a[72:75], v[48:51], v[128:131]
    v_mfma_f32_16x16x32_bf16 v[132:135], a[72:75], v[52:55], v[132:135]
    v_mfma_f32_16x16x32_bf16 v[136:139], a[72:75], v[56:59], v[136:139]
    v_mfma_f32_16x16x32_bf16 v[140:143], a[72:75], v[60:63], v[140:143]
    v_mfma_f32_16x16x32_bf16 v[160:163], a[76:79], v[48:51], v[160:163]
    v_mfma_f32_16x16x32_bf16 v[164:167], a[76:79], v[52:55], v[164:167]
    v_mfma_f32_16x16x32_bf16 v[168:171], a[76:79], v[56:59], v[168:171]
    v_mfma_f32_16x16x32_bf16 v[172:175], a[76:79], v[60:63], v[172:175]
    s_waitcnt lgkmcnt(8)
    v_mfma_f32_16x16x32_bf16 v[80:83], a[64:67], v[16:19], v[80:83]
    ds_read_b64_tr_b16 v[48:49], v2 offset:640
    v_mfma_f32_16x16x32_bf16 v[84:87], a[64:67], v[20:23], v[84:87]
    ds_read_b64_tr_b16 v[50:51], v2 offset:4864
    v_mfma_f32_16x16x32_bf16 v[88:91], a[64:67], v[24:27], v[88:91]
    ds_read_b64_tr_b16 v[52:53], v2 offset:672
    v_mfma_f32_16x16x32_bf16 v[92:95], a[64:67], v[28:31], v[92:95]
    ds_read_b64_tr_b16 v[54:55], v2 offset:4896
    v_mfma_f32_16x16x32_bf16 v[112:115], a[68:71], v[16:19], v[112:115]
    ds_read_b64_tr_b16 v[56:57], v2 offset:704
    v_mfma_f32_16x16x32_bf16 v[116:119], a[68:71], v[20:23], v[116:119]
    ds_read_b64_tr_b16 v[58:59], v2 offset:4928
    v_mfma_f32_16x16x32_bf16 v[120:123], a[68:71], v[24:27], v[120:123]
    ds_read_b64_tr_b16 v[60:61], v2 offset:736
    v_mfma_f32_16x16x32_bf16 v[124:127], a[68:71], v[28:31], v[124:127]
    ds_read_b64_tr_b16 v[62:63], v2 offset:4960
    v_mfma_f32_16x16x32_bf16 v[144:147], a[72:75], v[16:19], v[144:147]
    v_mfma_f32_16x16x32_bf16 v[148:151], a[72:75], v[20:23], v[148:151]
    v_mfma_f32_16x16x32_bf16 v[152:155], a[72:75], v[24:27], v[152:155]
    v_mfma_f32_16x16x32_bf16 v[156:159], a[72:75], v[28:31], v[156:159]
    v_mfma_f32_16x16x32_bf16 v[176:179], a[76:79], v[16:19], v[176:179]
    v_mfma_f32_16x16x32_bf16 v[180:183], a[76:79], v[20:23], v[180:183]
    v_mfma_f32_16x16x32_bf16 v[184:187], a[76:79], v[24:27], v[184:187]
    v_mfma_f32_16x16x32_bf16 v[188:191], a[76:79], v[28:31], v[188:191]
    s_nop 0
    s_barrier
    s_waitcnt lgkmcnt(8)
    v_mfma_f32_16x16x32_bf16 v[64:67], a[80:83], v[32:35], v[64:67]
    v_add_u32 v2, s26, v1
    s_add_u32 s26, s26, 17024
    s_cmp_ge_u32 s26, 153216
    s_cselect_b32 s26, 0, s26
    v_mfma_f32_16x16x32_bf16 v[68:71], a[80:83], v[36:39], v[68:71]
    ds_read_b64_tr_b16 v[16:17], v2 offset:0
    ds_read_b64_tr_b16 v[18:19], v2 offset:4224
    v_mfma_f32_16x16x32_bf16 v[72:75], a[80:83], v[40:43], v[72:75]
    ds_read_b64_tr_b16 v[20:21], v2 offset:32
    ds_read_b64_tr_b16 v[22:23], v2 offset:4256
    v_mfma_f32_16x16x32_bf16 v[76:79], a[80:83], v[44:47], v[76:79]
    ds_read_b64_tr_b16 v[24:25], v2 offset:64
    ds_read_b64_tr_b16 v[26:27], v2 offset:4288
    v_mfma_f32_16x16x32_bf16 v[96:99], a[84:87], v[32:35], v[96:99]
    ds_read_b64_tr_b16 v[28:29], v2 offset:96
    ds_read_b64_tr_b16 v[30:31], v2 offset:4320
    v_mfma_f32_16x16x32_bf16 v[100:103], a[84:87], v[36:39], v[100:103]
    s_mov_b32 s20, s29
    s_mul_i32 s22, s29, 61
    v_mul_u32_u24 v12, s29, v6
    v_mfma_f32_16x16x32_bf16 v[104:107], a[84:87], v[40:43], v[104:107]
    v_lshl_add_u32 v12, v7, 4, v12
    v_cmp_lt_u32 vcc, 7, v7
    v_mfma_f32_16x16x32_bf16 v[108:111], a[84:87], v[44:47], v[108:111]
    v_mov_b32 v13, s30
    v_mov_b32 v14, s32
    v_mfma_f32_16x16x32_bf16 v[128:131], a[88:91], v[32:35], v[128:131]
    v_cndmask_b32 v4, v13, v14, vcc
    v_mov_b32 v13, s31
    v_mfma_f32_16x16x32_bf16 v[132:135], a[88:91], v[36:39], v[132:135]
    v_mov_b32 v14, s33
    v_cndmask_b32 v5, v13, v14, vcc
    v_mfma_f32_16x16x32_bf16 v[136:139], a[88:91], v[40:43], v[136:139]
    v_add_co_u32 v4, vcc, v4, v12
    s_nop 1
    v_addc_co_u32 v5, vcc, 0, v5, vcc
    v_mfma_f32_16x16x32_bf16 v[140:143], a[88:91], v[44:47], v[140:143]
    v_mfma_f32_16x16x32_bf16 v[160:163], a[92:95], v[32:35], v[160:163]
    v_mfma_f32_16x16x32_bf16 v[164:167], a[92:95], v[36:39], v[164:167]
    v_mfma_f32_16x16x32_bf16 v[168:171], a[92:95], v[40:43], v[168:171]
    v_mfma_f32_16x16x32_bf16 v[172:175], a[92:95], v[44:47], v[172:175]
    s_waitcnt lgkmcnt(8)
    v_mfma_f32_16x16x32_bf16 v[80:83], a[80:83], v[48:51], v[80:83]
    ds_read_b64_tr_b16 v[32:33], v2 offset:128
    ds_read_b64_tr_b16 v[34:35], v2 offset:4352
    v_mfma_f32_16x16x32_bf16 v[84:87], a[80:83], v[52:55], v[84:87]
    ds_read_b64_tr_b16 v[36:37], v2 offset:160
    ds_read_b64_tr_b16 v[38:39], v2 offset:4384
    v_mfma_f32_16x16x32_bf16 v[88:91], a[80:83], v[56:59], v[88:91]
    ds_read_b64_tr_b16 v[40:41], v2 offset:192
    ds_read_b64_tr_b16 v[42:43], v2 offset:4416
    v_mfma_f32_16x16x32_bf16 v[92:95], a[80:83], v[60:63], v[92:95]
    ds_read_b64_tr_b16 v[44:45], v2 offset:224
    ds_read_b64_tr_b16 v[46:47], v2 offset:4448
    v_mfma_f32_16x16x32_bf16 v[112:115], a[84:87], v[48:51], v[112:115]
    s_add_u32 m0, s27, 0
    s_nop 0
    global_load_lds_dwordx4 v[4:5], off
    v_mfma_f32_16x16x32_bf16 v[116:119], a[84:87], v[52:55], v[116:119]
    v_lshl_add_u64 v[4:5], v[4:5], 0, s[20:21]
    s_add_u32 m0, s27, 1056
    v_mfma_f32_16x16x32_bf16 v[120:123], a[84:87], v[56:59], v[120:123]
    global_load_lds_dwordx4 v[4:5], off
    v_lshl_add_u64 v[4:5], v[4:5], 0, s[20:21]
    v_mfma_f32_16x16x32_bf16 v[124:127], a[84:87], v[60:63], v[124:127]
    s_add_u32 m0, s27, 2112
    s_nop 0
    global_load_lds_dwordx4 v[4:5], off
    v_mfma_f32_16x16x32_bf16 v[144:147], a[88:91], v[48:51], v[144:147]
    v_lshl_add_u64 v[4:5], v[4:5], 0, s[20:21]
    s_add_u32 m0, s27, 3168
    v_mfma_f32_16x16x32_bf16 v[148:151], a[88:91], v[52:55], v[148:151]
    global_load_lds_dwordx4 v[4:5], off
    v_lshl_add_u64 v[4:5], v[4:5], 0, s[22:23]
    v_mfma_f32_16x16x32_bf16 v[152:155], a[88:91], v[56:59], v[152:155]
    s_add_u32 s27, s27, 17024
    s_cmp_ge_u32 s27, 153216
    s_cselect_b32 s27, s38, s27
    v_mfma_f32_16x16x32_bf16 v[156:159], a[88:91], v[60:63], v[156:159]
    v_mfma_f32_16x16x32_bf16 v[176:179], a[92:95], v[48:51], v[176:179]
    v_mfma_f32_16x16x32_bf16 v[180:183], a[92:95], v[52:55], v[180:183]
    v_mfma_f32_16x16x32_bf16 v[184:187], a[92:95], v[56:59], v[184:187]
    v_mfma_f32_16x16x32_bf16 v[188:191], a[92:95], v[60:63], v[188:191]
    s_cmp_eq_u32 s28, 0
    s_cbranch_scc1 gsv_fa_18
    s_waitcnt vmcnt(60)
gsv_fa_18:
    s_waitcnt lgkmcnt(8)
    v_mfma_f32_16x16x32_bf16 v[64:67], a[96:99], v[16:19], v[64:67]
    ds_read_b64_tr_b16 v[48:49], v2 offset:512
    v_mfma_f32_16x16x32_bf16 v[68:71], a[96:99], v[20:23], v[68:71]
    ds_read_b64_tr_b16 v[50:51], v2 offset:4736
    v_mfma_f32_16x16x32_bf16 v[72:75], a[96:99], v[24:27], v[72:75]
    ds_read_b64_tr_b16 v[52:53], v2 offset:544
    v_mfma_f32_16x16x32_bf16 v[76:79], a[96:99], v[28:31], v[76:79]
    ds_read_b64_tr_b16 v[54:55], v2 offset:4768
    v_mfma_f32_16x16x32_bf16 v[96:99], a[100:103], v[16:19], v[96:99]
    ds_read_b64_tr_b16 v[56:57], v2 offset:576
    v_mfma_f32_16x16x32_bf16 v[100:103], a[100:103], v[20:23], v[100:103]
    ds_read_b64_tr_b16 v[58:59], v2 offset:4800
    v_mfma_f32_16x16x32_bf16 v[104:107], a[100:103], v[24:27], v[104:107]
    ds_read_b64_tr_b16 v[60:61], v2 offset:608
    v_mfma_f32_16x16x32_bf16 v[108:111], a[100:103], v[28:31], v[108:111]
    ds_read_b64_tr_b16 v[62:63], v2 offset:4832
    v_mfma_f32_16x16x32_bf16 v[128:131], a[104:107], v[16:19], v[128:131]
    v_mfma_f32_16x16x32_bf16 v[132:135], a[104:107], v[20:23], v[132:135]
    v_mfma_f32_16x16x32_bf16 v[136:139], a[104:107], v[24:27], v[136:139]
    v_mfma_f32_16x16x32_bf16 v[140:143], a[104:107], v[28:31], v[140:143]
    v_mfma_f32_16x16x32_bf16 v[160:163], a[108:111], v[16:19], v[160:163]
    v_mfma_f32_16x16x32_bf16 v[164:167], a[108:111], v[20:23], v[164:167]
    v_mfma_f32_16x16x32_bf16 v[168:171], a[108:111], v[24:27], v[168:171]
    v_mfma_f32_16x16x32_bf16 v[172:175], a[108:111], v[28:31], v[172:175]
    s_waitcnt lgkmcnt(8)
    v_mfma_f32_16x16x32_bf16 v[80:83], a[96:99], v[32:35], v[80:83]
    ds_read_b64_tr_b16 v[16:17], v2 offset:640
    v_mfma_f32_16x16x32_bf16 v[84:87], a[96:99], v[36:39], v[84:87]
    ds_read_b64_tr_b16 v[18:19], v2 offset:4864
    v_mfma_f32_16x16x32_bf16 v[88:91], a[96:99], v[40:43], v[88:91]
    ds_read_b64_tr_b16 v[20:21], v2 offset:672
    v_mfma_f32_16x16x32_bf16 v[92:95], a[96:99], v[44:47], v[92:95]
    ds_read_b64_tr_b16 v[22:23], v2 offset:4896
    v_mfma_f32_16x16x32_bf16 v[112:115], a[100:103], v[32:35], v[112:115]
    ds_read_b64_tr_b16 v[24:25], v2 offset:704
    v_mfma_f32_16x16x32_bf16 v[116:119], a[100:103], v[36:39], v[116:119]
    ds_read_b64_tr_b16 v[26:27], v2 offset:4928
    v_mfma_f32_16x16x32_bf16 v[120:123], a[100:103], v[40:43], v[120:123]
    ds_read_b64_tr_b16 v[28:29], v2 offset:736
    v_mfma_f32_16x16x32_bf16 v[124:127], a[100:103], v[44:47], v[124:127]
    ds_read_b64_tr_b16 v[30:31], v2 offset:4960
    v_mfma_f32_16x16x32_bf16 v[144:147], a[104:107], v[32:35], v[144:147]
    v_mfma_f32_16x16x32_bf16 v[148:151], a[104:107], v[36:39], v[148:151]
    v_mfma_f32_16x16x32_bf16 v[152:155], a[104:107], v[40:43], v[152:155]
    v_mfma_f32_16x16x32_bf16 v[156:159], a[104:107], v[44:47], v[156:159]
    v_mfma_f32_16x16x32_bf16 v[176:179], a[108:111], v[32:35], v[176:179]
    v_mfma_f32_16x16x32_bf16 v[180:183], a[108:111], v[36:39], v[180:183]
    v_mfma_f32_16x16x32_bf16 v[184:187], a[108:111], v[40:43], v[184:187]
    v_mfma_f32_16x16x32_bf16 v[188:191], a[108:111], v[44:47], v[188:191]
    s_nop 0
    s_barrier
    s_waitcnt lgkmcnt(8)
    v_mfma_f32_16x16x32_bf16 v[64:67], a[112:115], v[48:51], v[64:67]
    v_add_u32 v2, s26, v1
    v_mfma_f32_16x16x32_bf16 v[68:71], a[112:115], v[52:55], v[68:71]
    s_add_u32 s26, s26, 17024
    s_cmp_ge_u32 s26, 153216
    s_cselect_b32 s26, 0, s26
    v_mfma_f32_16x16x32_bf16 v[72:75], a[112:115], v[56:59], v[72:75]
    ds_read_b64_tr_b16 v[32:33], v2 offset:0
    v_mfma_f32_16x16x32_bf16 v[76:79], a[112:115], v[60:63], v[76:79]
    ds_read_b64_tr_b16 v[34:35], v2 offset:4224
    v_mfma_f32_16x16x32_bf16 v[96:99], a[116:119], v[48:51], v[96:99]
    ds_read_b64_tr_b16 v[36:37], v2 offset:32
    v_mfma_f32_16x16x32_bf16 v[100:103], a[116:119], v[52:55], v[100:103]
    ds_read_b64_tr_b16 v[38:39], v2 offset:4256
    v_mfma_f32_16x16x32_bf16 v[104:107], a[116:119], v[56:59], v[104:107]
    ds_read_b64_tr_b16 v[40:41], v2 offset:64
    v_mfma_f32_16x16x32_bf16 v[108:111], a[116:119], v[60:63], v[108:111]
    ds_read_b64_tr_b16 v[42:43], v2 offset:4288
    v_mfma_f32_16x16x32_bf16 v[128:131], a[120:123], v[48:51], v[128:131]
    ds_read_b64_tr_b16 v[44:45], v2 offset:96
    v_mfma_f32_16x16x32_bf16 v[132:135], a[120:123], v[52:55], v[132:135]
    ds_read_b64_tr_b16 v[46:47], v2 offset:4320
    v_mfma_f32_16x16x32_bf16 v[136:139], a[120:123], v[56:59], v[136:139]
    v_mfma_f32_16x16x32_bf16 v[140:143], a[120:123], v[60:63], v[140:143]
    v_mfma_f32_16x16x32_bf16 v[160:163], a[124:127], v[48:51], v[160:163]
    v_mfma_f32_16x16x32_bf16 v[164:167], a[124:127], v[52:55], v[164:167]
    v_mfma_f32_16x16x32_bf16 v[168:171], a[124:127], v[56:59], v[168:171]
    v_mfma_f32_16x16x32_bf16 v[172:175], a[124:127], v[60:63], v[172:175]
    s_waitcnt lgkmcnt(8)
    v_mfma_f32_16x16x32_bf16 v[80:83], a[112:115], v[16:19], v[80:83]
    ds_read_b64_tr_b16 v[48:49], v2 offset:128
    ds_read_b64_tr_b16 v[50:51], v2 offset:4352
    v_mfma_f32_16x16x32_bf16 v[84:87], a[112:115], v[20:23], v[84:87]
    ds_read_b64_tr_b16 v[52:53], v2 offset:160
    ds_read_b64_tr_b16 v[54:55], v2 offset:4384
    v_mfma_f32_16x16x32_bf16 v[88:91], a[112:115], v[24:27], v[88:91]
    ds_read_b64_tr_b16 v[56:57], v2 offset:192
    ds_read_b64_tr_b16 v[58:59], v2 offset:4416
    v_mfma_f32_16x16x32_bf16 v[92:95], a[112:115], v[28:31], v[92:95]
    ds_read_b64_tr_b16 v[60:61], v2 offset:224
    ds_read_b64_tr_b16 v[62:63], v2 offset:4448
    v_mfma_f32_16x16x32_bf16 v[112:115], a[116:119], v[16:19], v[112:115]
    s_add_u32 m0, s27, 0
    s_nop 0
    global_load_lds_dwordx4 v[4:5], off
    v_mfma_f32_16x16x32_bf16 v[116:119], a[116:119], v[20:23], v[116:119]
    v_lshl_add_u64 v[4:5], v[4:5], 0, s[20:21]
    s_add_u32 m0, s27, 1056
    v_mfma_f32_16x16x32_bf16 v[120:123], a[116:119], v[24:27], v[120:123]
    global_load_lds_dwordx4 v[4:5], off
    v_lshl_add_u64 v[4:5], v[4:5], 0, s[20:21]
    v_mfma_f32_16x16x32_bf16 v[124:127], a[116:119], v[28:31], v[124:127]
    s_add_u32 m0, s27, 2112
    s_nop 0
    global_load_lds_dwordx4 v[4:5], off
    v_mfma_f32_16x16x32_bf16 v[144:147], a[120:123], v[16:19], v[144:147]
    v_lshl_add_u64 v[4:5], v[4:5], 0, s[20:21]
    s_add_u32 m0, s27, 3168
    v_mfma_f32_16x16x32_bf16 v[148:151], a[120:123], v[20:23], v[148:151]
    global_load_lds_dwordx4 v[4:5], off
    v_lshl_add_u64 v[4:5], v[4:5], 0, s[22:23]
    v_mfma_f32_16x16x32_bf16 v[152:155], a[120:123], v[24:27], v[152:155]
    s_add_u32 s27, s27, 17024
    s_cmp_ge_u32 s27, 153216
    s_cselect_b32 s27, s38, s27
    v_mfma_f32_16x16x32_bf16 v[156:159], a[120:123], v[28:31], v[156:159]
    v_mfma_f32_16x16x32_bf16 v[176:179], a[124:127], v[16:19], v[176:179]
    v_mfma_f32_16x16x32_bf16 v[180:183], a[124:127], v[20:23], v[180:183]
    v_mfma_f32_16x16x32_bf16 v[184:187], a[124:127], v[24:27], v[184:187]
    v_mfma_f32_16x16x32_bf16 v[188:191], a[124:127], v[28:31], v[188:191]
    s_cmp_eq_u32 s28, 0
    s_cbranch_scc1 gsv_fa_19
    s_waitcnt vmcnt(56)
gsv_fa_19:
    s_waitcnt lgkmcnt(8)
    v_mfma_f32_16x16x32_bf16 v[64:67], a[128:131], v[32:35], v[64:67]
    ds_read_b64_tr_b16 v[16:17], v2 offset:512
    v_mfma_f32_16x16x32_bf16 v[68:71], a[128:131], v[36:39], v[68:71]
    ds_read_b64_tr_b16 v[18:19], v2 offset:4736
    v_mfma_f32_16x16x32_bf16 v[72:75], a[128:131], v[40:43], v[72:75]
    ds_read_b64_tr_b16 v[20:21], v2 offset:544
    v_mfma_f32_16x16x32_bf16 v[76:79], a[128:131], v[44:47], v[76:79]
    ds_read_b64_tr_b16 v[22:23], v2 offset:4768
    v_mfma_f32_16x16x32_bf16 v[96:99], a[132:135], v[32:35], v[96:99]
    ds_read_b64_tr_b16 v[24:25], v2 offset:576
    v_mfma_f32_16x16x32_bf16 v[100:103], a[132:135], v[36:39], v[100:103]
    ds_read_b64_tr_b16 v[26:27], v2 offset:4800
    v_mfma_f32_16x16x32_bf16 v[104:107], a[132:135], v[40:43], v[104:107]
    ds_read_b64_tr_b16 v[28:29], v2 offset:608
    v_mfma_f32_16x16x32_bf16 v[108:111], a[132:135], v[44:47], v[108:111]
    ds_read_b64_tr_b16 v[30:31], v2 offset:4832
    v_mfma_f32_16x16x32_bf16 v[128:131], a[136:139], v[32:35], v[128:131]
    v_mfma_f32_16x16x32_bf16 v[132:135], a[136:139], v[36:39], v[132:135]
    v_mfma_f32_16x16x32_bf16 v[136:139], a[136:139], v[40:43], v[136:139]
    v_mfma_f32_16x16x32_bf16 v[140:143], a[136:139], v[44:47], v[140:143]
    v_mfma_f32_16x16x32_bf16 v[160:163], a[140:143], v[32:35], v[160:163]
    v_mfma_f32_16x16x32_bf16 v[164:167], a[140:143], v[36:39], v[164:167]
    v_mfma_f32_16x16x32_bf16 v[168:171], a[140:143], v[40:43], v[168:171]
    v_mfma_f32_16x16x32_bf16 v[172:175], a[140:143], v[44:47], v[172:175]
    s_waitcnt lgkmcnt(8)
    v_mfma_f32_16x16x32_bf16 v[80:83], a[128:131], v[48:51], v[80:83]
    ds_read_b64_tr_b16 v[32:33], v2 offset:640
    v_mfma_f32_16x16x32_bf16 v[84:87], a[128:131], v[52:55], v[84:87]
    ds_read_b64_tr_b16 v[34:35], v2 offset:4864
    v_mfma_f32_16x16x32_bf16 v[88:91], a[128:131], v[56:59], v[88:91]
    ds_read_b64_tr_b16 v[36:37], v2 offset:672
    v_mfma_f32_16x16x32_bf16 v[92:95], a[128:131], v[60:63], v[92:95]
    ds_read_b64_tr_b16 v[38:39], v2 offset:4896
    v_mfma_f32_16x16x32_bf16 v[112:115], a[132:135], v[48:51], v[112:115]
    ds_read_b64_tr_b16 v[40:41], v2 offset:704
    v_mfma_f32_16x16x32_bf16 v[116:119], a[132:135], v[52:55], v[116:119]
    ds_read_b64_tr_b16 v[42:43], v2 offset:4928
    v_mfma_f32_16x16x32_bf16 v[120:123], a[132:135], v[56:59], v[120:123]
    ds_read_b64_tr_b16 v[44:45], v2 offset:736
    v_mfma_f32_16x16x32_bf16 v[124:127], a[132:135], v[60:63], v[124:127]
    ds_read_b64_tr_b16 v[46:47], v2 offset:4960
    v_mfma_f32_16x16x32_bf16 v[144:147], a[136:139], v[48:51], v[144:147]
    v_mfma_f32_16x16x32_bf16 v[148:151], a[136:139], v[52:55], v[148:151]
    v_mfma_f32_16x16x32_bf16 v[152:155], a[136:139], v[56:59], v[152:155]
    v_mfma_f32_16x16x32_bf16 v[156:159], a[136:139], v[60:63], v[156:159]
    v_mfma_f32_16x16x32_bf16 v[176:179], a[140:143], v[48:51], v[176:179]
    v_mfma_f32_16x16x32_bf16 v[180:183], a[140:143], v[52:55], v[180:183]
    v_mfma_f32_16x16x32_bf16 v[184:187], a[140:143], v[56:59], v[184:187]
    v_mfma_f32_16x16x32_bf16 v[188:191], a[140:143], v[60:63], v[188:191]
    s_nop 0
    s_barrier
    s_waitcnt lgkmcnt(8)
    v_mfma_f32_16x16x32_bf16 v[64:67], a[144:147], v[16:19], v[64:67]
    v_add_u32 v2, s26, v1
    v_mfma_f32_16x16x32_bf16 v[68:71], a[144:147], v[20:23], v[68:71]
    s_add_u32 s26, s26, 17024
    s_cmp_ge_u32 s26, 153216
    s_cselect_b32 s26, 0, s26
    v_mfma_f32_16x16x32_bf16 v[72:75], a[144:147], v[24:27], v[72:75]
    ds_read_b64_tr_b16 v[48:49], v2 offset:0
    v_mfma_f32_16x16x32_bf16 v[76:79], a[144:147], v[28:31], v[76:79]
    ds_read_b64_tr_b16 v[50:51], v2 offset:4224
    v_mfma_f32_16x16x32_bf16 v[96:99], a[148:151], v[16:19], v[96:99]
    ds_read_b64_tr_b16 v[52:53], v2 offset:32
    v_mfma_f32_16x16x32_bf16 v[100:103], a[148:151], v[20:23], v[100:103]
    ds_read_b64_tr_b16 v[54:55], v2 offset:4256
    v_mfma_f32_16x16x32_bf16 v[104:107], a[148:151], v[24:27], v[104:107]
    ds_read_b64_tr_b16 v[56:57], v2 offset:64
    v_mfma_f32_16x16x32_bf16 v[108:111], a[148:151], v[28:31], v[108:111]
    ds_read_b64_tr_b16 v[58:59], v2 offset:4288
    v_mfma_f32_16x16x32_bf16 v[128:131], a[152:155], v[16:19], v[128:131]
    ds_read_b64_tr_b16 v[60:61], v2 offset:96
    v_mfma_f32_16x16x32_bf16 v[132:135], a[152:155], v[20:23], v[132:135]
    ds_read_b64_tr_b16 v[62:63], v2 offset:4320
    v_mfma_f32_16x16x32_bf16 v[136:139], a[152:155], v[24:27], v[136:139]
    v_mfma_f32_16x16x32_bf16 v[140:143], a[152:155], v[28:31], v[140:143]
    v_mfma_f32_16x16x32_bf16 v[160:163], a[156:159], v[16:19], v[160:163]
    v_mfma_f32_16x16x32_bf16 v[164:167], a[156:159], v[20:23], v[164:167]
    v_mfma_f32_16x16x32_bf16 v[168:171], a[156:159], v[24:27], v[168:171]
    v_mfma_f32_16x16x32_bf16 v[172:175], a[156:159], v[28:31], v[172:175]
    s_waitcnt lgkmcnt(8)
    v_mfma_f32_16x16x32_bf16 v[80:83], a[144:147], v[32:35], v[80:83]
    ds_read_b64_tr_b16 v[16:17], v2 offset:128
    ds_read_b64_tr_b16 v[18:19], v2 offset:4352
    v_mfma_f32_16x16x32_bf16 v[84:87], a[144:147], v[36:39], v[84:87]
    ds_read_b64_tr_b16 v[20:21], v2 offset:160
    ds_read_b64_tr_b16 v[22:23], v2 offset:4384
    v_mfma_f32_16x16x32_bf16 v[88:91], a[144:147], v[40:43], v[88:91]
    ds_read_b64_tr_b16 v[24:25], v2 offset:192
    ds_read_b64_tr_b16 v[26:27], v2 offset:4416
    v_mfma_f32_16x16x32_bf16 v[92:95], a[144:147], v[44:47], v[92:95]
    ds_read_b64_tr_b16 v[28:29], v2 offset:224
    ds_read_b64_tr_b16 v[30:31], v2 offset:4448
    v_mfma_f32_16x16x32_bf16 v[112:115], a[148:151], v[32:35], v[112:115]
    s_add_u32 m0, s27, 0
    s_nop 0
    global_load_lds_dwordx4 v[4:5], off
    v_mfma_f32_16x16x32_bf16 v[116:119], a[148:151], v[36:39], v[116:119]
    v_lshl_add_u64 v[4:5], v[4:5], 0, s[20:21]
    s_add_u32 m0, s27, 1056
    v_mfma_f32_16x16x32_bf16 v[120:123], a[148:151], v[40:43], v[120:123]
    global_load_lds_dwordx4 v[4:5], off
    v_lshl_add_u64 v[4:5], v[4:5], 0, s[20:21]
    v_mfma_f32_16x16x32_bf16 v[124:127], a[148:151], v[44:47], v[124:127]
    s_add_u32 m0, s27, 2112
    s_nop 0
    global_load_lds_dwordx4 v[4:5], off
    v_mfma_f32_16x16x32_bf16 v[144:147], a[152:155], v[32:35], v[144:147]
    v_lshl_add_u64 v[4:5], v[4:5], 0, s[20:21]
    s_add_u32 m0, s27, 3168
    v_mfma_f32_16x16x32_bf16 v[148:151], a[152:155], v[36:39], v[148:151]
    global_load_lds_dwordx4 v[4:5], off
    v_lshl_add_u64 v[4:5], v[4:5], 0, s[22:23]
    v_mfma_f32_16x16x32_bf16 v[152:155], a[152:155], v[40:43], v[152:155]
    s_add_u32 s27, s27, 17024
    s_cmp_ge_u32 s27, 153216
    s_cselect_b32 s27, s38, s27
    v_mfma_f32_16x16x32_bf16 v[156:159], a[152:155], v[44:47], v[156:159]
    v_mfma_f32_16x16x32_bf16 v[176:179], a[156:159], v[32:35], v[176:179]
    v_mfma_f32_16x16x32_bf16 v[180:183], a[156:159], v[36:39], v[180:183]
    v_mfma_f32_16x16x32_bf16 v[184:187], a[156:159], v[40:43], v[184:187]
    v_mfma_f32_16x16x32_bf16 v[188:191], a[156:159], v[44:47], v[188:191]
    s_cmp_eq_u32 s28, 0
    s_cbranch_scc1 gsv_fa_20
    s_waitcnt vmcnt(52)
gsv_fa_20:
    s_waitcnt lgkmcnt(8)
    v_mfma_f32_16x16x32_bf16 v[64:67], a[160:163], v[48:51], v[64:67]
    ds_read_b64_tr_b16 v[32:33], v2 offset:512
    v_mfma_f32_16x16x32_bf16 v[68:71], a[160:163], v[52:55], v[68:71]
    ds_read_b64_tr_b16 v[34:35], v2 offset:4736
    v_mfma_f32_16x16x32_bf16 v[72:75], a[160:163], v[56:59], v[72:75]
    ds_read_b64_tr_b16 v[36:37], v2 offset:544
    v_mfma_f32_16x16x32_bf16 v[76:79], a[160:163], v[60:63], v[76:79]
    ds_read_b64_tr_b16 v[38:39], v2 offset:4768
    v_mfma_f32_16x16x32_bf16 v[96:99], a[164:167], v[48:51], v[96:99]
    ds_read_b64_tr_b16 v[40:41], v2 offset:576
    v_mfma_f32_16x16x32_bf16 v[100:103], a[164:167], v[52:55], v[100:103]
    ds_read_b64_tr_b16 v[42:43], v2 offset:4800
    v_mfma_f32_16x16x32_bf16 v[104:107], a[164:167], v[56:59], v[104:107]
    ds_read_b64_tr_b16 v[44:45], v2 offset:608
    v_mfma_f32_16x16x32_bf16 v[108:111], a[164:167], v[60:63], v[108:111]
    ds_read_b64_tr_b16 v[46:47], v2 offset:4832
    v_mfma_f32_16x16x32_bf16 v[128:131], a[168:171], v[48:51], v[128:131]
    v_mfma_f32_16x16x32_bf16 v[132:135], a[168:171], v[52:55], v[132:135]
    v_mfma_f32_16x16x32_bf16 v[136:139], a[168:171], v[56:59], v[136:139]
    v_mfma_f32_16x16x32_bf16 v[140:143], a[168:171], v[60:63], v[140:143]
    v_mfma_f32_16x16x32_bf16 v[160:163], a[172:175], v[48:51], v[160:163]
    v_mfma_f32_16x16x32_bf16 v[164:167], a[172:175], v[52:55], v[164:167]
    v_mfma_f32_16x16x32_bf16 v[168:171], a[172:175], v[56:59], v[168:171]
    v_mfma_f32_16x16x32_bf16 v[172:175], a[172:175], v[60:63], v[172:175]
    s_waitcnt lgkmcnt(8)
    v_mfma_f32_16x16x32_bf16 v[80:83], a[160:163], v[16:19], v[80:83]
    ds_read_b64_tr_b16 v[48:49], v2 offset:640
    v_mfma_f32_16x16x32_bf16 v[84:87], a[160:163], v[20:23], v[84:87]
    ds_read_b64_tr_b16 v[50:51], v2 offset:4864
    v_mfma_f32_16x16x32_bf16 v[88:91], a[160:163], v[24:27], v[88:91]
    ds_read_b64_tr_b16 v[52:53], v2 offset:672
    v_mfma_f32_16x16x32_bf16 v[92:95], a[160:163], v[28:31], v[92:95]
    ds_read_b64_tr_b16 v[54:55], v2 offset:4896
    v_mfma_f32_16x16x32_bf16 v[112:115], a[164:167], v[16:19], v[112:115]
    ds_read_b64_tr_b16 v[56:57], v2 offset:704
    v_mfma_f32_16x16x32_bf16 v[116:119], a[164:167], v[20:23], v[116:119]
    ds_read_b64_tr_b16 v[58:59], v2 offset:4928
    v_mfma_f32_16x16x32_bf16 v[120:123], a[164:167], v[24:27], v[120:123]
    ds_read_b64_tr_b16 v[60:61], v2 offset:736
    v_mfma_f32_16x16x32_bf16 v[124:127], a[164:167], v[28:31], v[124:127]
    ds_read_b64_tr_b16 v[62:63], v2 offset:4960
    v_mfma_f32_16x16x32_bf16 v[144:147], a[168:171], v[16:19], v[144:147]
    v_mfma_f32_16x16x32_bf16 v[148:151], a[168:171], v[20:23], v[148:151]
    v_mfma_f32_16x16x32_bf16 v[152:155], a[168:171], v[24:27], v[152:155]
    v_mfma_f32_16x16x32_bf16 v[156:159], a[168:171], v[28:31], v[156:159]
    v_mfma_f32_16x16x32_bf16 v[176:179], a[172:175], v[16:19], v[176:179]
    v_mfma_f32_16x16x32_bf16 v[180:183], a[172:175], v[20:23], v[180:183]
    v_mfma_f32_16x16x32_bf16 v[184:187], a[172:175], v[24:27], v[184:187]
    v_mfma_f32_16x16x32_bf16 v[188:191], a[172:175], v[28:31], v[188:191]
    s_nop 0
    s_barrier
    s_waitcnt lgkmcnt(8)
    v_mfma_f32_16x16x32_bf16 v[64:67], a[176:179], v[32:35], v[64:67]
    v_add_u32 v2, s26, v1
    v_mfma_f32_16x16x32_bf16 v[68:71], a[176:179], v[36:39], v[68:71]
    s_add_u32 s26, s26, 17024
    s_cmp_ge_u32 s26, 153216
    s_cselect_b32 s26, 0, s26
    v_mfma_f32_16x16x32_bf16 v[72:75], a[176:179], v[40:43], v[72:75]
    ds_read_b64_tr_b16 v[16:17], v2 offset:0
    v_mfma_f32_16x16x32_bf16 v[76:79], a[176:179], v[44:47], v[76:79]
    ds_read_b64_tr_b16 v[18:19], v2 offset:4224
    v_mfma_f32_16x16x32_bf16 v[96:99], a[180:183], v[32:35], v[96:99]
    ds_read_b64_tr_b16 v[20:21], v2 offset:32
    v_mfma_f32_16x16x32_bf16 v[100:103], a[180:183], v[36:39], v[100:103]
    ds_read_b64_tr_b16 v[22:23], v2 offset:4256
    v_mfma_f32_16x16x32_bf16 v[104:107], a[180:183], v[40:43], v[104:107]
    ds_read_b64_tr_b16 v[24:25], v2 offset:64
    v_mfma_f32_16x16x32_bf16 v[108:111], a[180:183], v[44:47], v[108:111]
    ds_read_b64_tr_b16 v[26:27], v2 offset:4288
    v_mfma_f32_16x16x32_bf16 v[128:131], a[184:187], v[32:35], v[128:131]
    ds_read_b64_tr_b16 v[28:29], v2 offset:96
    v_mfma_f32_16x16x32_bf16 v[132:135], a[184:187], v[36:39], v[132:135]
    ds_read_b64_tr_b16 v[30:31], v2 offset:4320
    v_mfma_f32_16x16x32_bf16 v[136:139], a[184:187], v[40:43], v[136:139]
    v_mfma_f32_16x16x32_bf16 v[140:143], a[184:187], v[44:47], v[140:143]
    v_mfma_f32_16x16x32_bf16 v[160:163], a[188:191], v[32:35], v[160:163]
    v_mfma_f32_16x16x32_bf16 v[164:167], a[188:191], v[36:39], v[164:167]
    v_mfma_f32_16x16x32_bf16 v[168:171], a[188:191], v[40:43], v[168:171]
    v_mfma_f32_16x16x32_bf16 v[172:175], a[188:191], v[44:47], v[172:175]
    s_waitcnt lgkmcnt(8)
    v_mfma_f32_16x16x32_bf16 v[80:83], a[176:179], v[48:51], v[80:83]
    ds_read_b64_tr_b16 v[32:33], v2 offset:128
    ds_read_b64_tr_b16 v[34:35], v2 offset:4352
    v_mfma_f32_16x16x32_bf16 v[84:87], a[176:179], v[52:55], v[84:87]
    ds_read_b64_tr_b16 v[36:37], v2 offset:160
    ds_read_b64_tr_b16 v[38:39], v2 offset:4384
    v_mfma_f32_16x16x32_bf16 v[88:91], a[176:179], v[56:59], v[88:91]
    ds_read_b64_tr_b16 v[40:41], v2 offset:192
    ds_read_b64_tr_b16 v[42:43], v2 offset:4416
    v_mfma_f32_16x16x32_bf16 v[92:95], a[176:179], v[60:63], v[92:95]
    ds_read_b64_tr_b16 v[44:45], v2 offset:224
    ds_read_b64_tr_b16 v[46:47], v2 offset:4448
    v_mfma_f32_16x16x32_bf16 v[112:115], a[180:183], v[48:51], v[112:115]
    s_add_u32 m0, s27, 0
    s_nop 0
    global_load_lds_dwordx4 v[4:5], off
    v_mfma_f32_16x16x32_bf16 v[116:119], a[180:183], v[52:55], v[116:119]
    v_lshl_add_u64 v[4:5], v[4:5], 0, s[20:21]
    s_add_u32 m0, s27, 1056
    v_mfma_f32_16x16x32_bf16 v[120:123], a[180:183], v[56:59], v[120:123]
    global_load_lds_dwordx4 v[4:5], off
    v_lshl_add_u64 v[4:5], v[4:5], 0, s[20:21]
    v_mfma_f32_16x16x32_bf16 v[124:127], a[180:183], v[60:63], v[124:127]
    s_add_u32 m0, s27, 2112
    s_nop 0
    global_load_lds_dwordx4 v[4:5], off
    v_mfma_f32_16x16x32_bf16 v[144:147], a[184:187], v[48:51], v[144:147]
    v_lshl_add_u64 v[4:5], v[4:5], 0, s[20:21]
    s_add_u32 m0, s27, 3168
    v_mfma_f32_16x16x32_bf16 v[148:151], a[184:187], v[52:55], v[148:151]
    global_load_lds_dwordx4 v[4:5], off
    v_lshl_add_u64 v[4:5], v[4:5], 0, s[22:23]
    v_mfma_f32_16x16x32_bf16 v[152:155], a[184:187], v[56:59], v[152:155]
    s_add_u32 s27, s27, 17024
    s_cmp_ge_u32 s27, 153216
    s_cselect_b32 s27, s38, s27
    v_mfma_f32_16x16x32_bf16 v[156:159], a[184:187], v[60:63], v[156:159]
    v_mfma_f32_16x16x32_bf16 v[176:179], a[188:191], v[48:51], v[176:179]
    v_mfma_f32_16x16x32_bf16 v[180:183], a[188:191], v[52:55], v[180:183]
    v_mfma_f32_16x16x32_bf16 v[184:187], a[188:191], v[56:59], v[184:187]
    v_mfma_f32_16x16x32_bf16 v[188:191], a[188:191], v[60:63], v[188:191]
    s_cmp_eq_u32 s28, 0
    s_cbranch_scc1 gsv_fa_21
    s_waitcnt vmcnt(44)
gsv_fa_21:
    s_waitcnt lgkmcnt(8)
    v_mfma_f32_16x16x32_bf16 v[64:67], a[192:195], v[16:19], v[64:67]
    ds_read_b64_tr_b16 v[48:49], v2 offset:512
    v_mfma_f32_16x16x32_bf16 v[68:71], a[192:195], v[20:23], v[68:71]
    ds_read_b64_tr_b16 v[50:51], v2 offset:4736
    v_mfma_f32_16x16x32_bf16 v[72:75], a[192:195], v[24:27], v[72:75]
    ds_read_b64_tr_b16 v[52:53], v2 offset:544
    v_mfma_f32_16x16x32_bf16 v[76:79], a[192:195], v[28:31], v[76:79]
    ds_read_b64_tr_b16 v[54:55], v2 offset:4768
    v_mfma_f32_16x16x32_bf16 v[96:99], a[196:199], v[16:19], v[96:99]
    ds_read_b64_tr_b16 v[56:57], v2 offset:576
    v_mfma_f32_16x16x32_bf16 v[100:103], a[196:199], v[20:23], v[100:103]
    ds_read_b64_tr_b16 v[58:59], v2 offset:4800
    v_mfma_f32_16x16x32_bf16 v[104:107], a[196:199], v[24:27], v[104:107]
    ds_read_b64_tr_b16 v[60:61], v2 offset:608
    v_mfma_f32_16x16x32_bf16 v[108:111], a[196:199], v[28:31], v[108:111]
    ds_read_b64_tr_b16 v[62:63], v2 offset:4832
    v_mfma_f32_16x16x32_bf16 v[128:131], a[200:203], v[16:19], v[128:131]
    v_mfma_f32_16x16x32_bf16 v[132:135], a[200:203], v[20:23], v[132:135]
    v_mfma_f32_16x16x32_bf16 v[136:139], a[200:203], v[24:27], v[136:139]
    v_mfma_f32_16x16x32_bf16 v[140:143], a[200:203], v[28:31], v[140:143]
    v_mfma_f32_16x16x32_bf16 v[160:163], a[204:207], v[16:19], v[160:163]
    v_mfma_f32_16x16x32_bf16 v[164:167], a[204:207], v[20:23], v[164:167]
    v_mfma_f32_16x16x32_bf16 v[168:171], a[204:207], v[24:27], v[168:171]
    v_mfma_f32_16x16x32_bf16 v[172:175], a[204:207], v[28:31], v[172:175]
    s_waitcnt lgkmcnt(8)
    v_mfma_f32_16x16x32_bf16 v[80:83], a[192:195], v[32:35], v[80:83]
    ds_read_b64_tr_b16 v[16:17], v2 offset:640
    v_mfma_f32_16x16x32_bf16 v[84:87], a[192:195], v[36:39], v[84:87]
    ds_read_b64_tr_b16 v[18:19], v2 offset:4864
    v_mfma_f32_16x16x32_bf16 v[88:91], a[192:195], v[40:43], v[88:91]
    ds_read_b64_tr_b16 v[20:21], v2 offset:672
    v_mfma_f32_16x16x32_bf16 v[92:95], a[192:195], v[44:47], v[92:95]
    ds_read_b64_tr_b16 v[22:23], v2 offset:4896
    v_mfma_f32_16x16x32_bf16 v[112:115], a[196:199], v[32:35], v[112:115]
    ds_read_b64_tr_b16 v[24:25], v2 offset:704
    v_mfma_f32_16x16x32_bf16 v[116:119], a[196:199], v[36:39], v[116:119]
    ds_read_b64_tr_b16 v[26:27], v2 offset:4928
    v_mfma_f32_16x16x32_bf16 v[120:123], a[196:199], v[40:43], v[120:123]
    ds_read_b64_tr_b16 v[28:29], v2 offset:736
    v_mfma_f32_16x16x32_bf16 v[124:127], a[196:199], v[44:47], v[124:127]
    ds_read_b64_tr_b16 v[30:31], v2 offset:4960
    v_mfma_f32_16x16x32_bf16 v[144:147], a[200:203], v[32:35], v[144:147]
    v_mfma_f32_16x16x32_bf16 v[148:151], a[200:203], v[36:39], v[148:151]
    v_mfma_f32_16x16x32_bf16 v[152:155], a[200:203], v[40:43], v[152:155]
    v_mfma_f32_16x16x32_bf16 v[156:159], a[200:203], v[44:47], v[156:159]
    v_mfma_f32_16x16x32_bf16 v[176:179], a[204:207], v[32:35], v[176:179]
    v_mfma_f32_16x16x32_bf16 v[180:183], a[204:207], v[36:39], v[180:183]
    v_mfma_f32_16x16x32_bf16 v[184:187], a[204:207], v[40:43], v[184:187]
    v_mfma_f32_16x16x32_bf16 v[188:191], a[204:207], v[44:47], v[188:191]
    s_nop 0
    s_barrier
    s_waitcnt lgkmcnt(8)
    v_mfma_f32_16x16x32_bf16 v[64:67], a[208:211], v[48:51], v[64:67]
    v_add_u32 v2, s26, v1
    v_mfma_f32_16x16x32_bf16 v[68:71], a[208:211], v[52:55], v[68:71]
    s_add_u32 s26, s26, 17024
    s_cmp_ge_u32 s26, 153216
    s_cselect_b32 s26, 0, s26
    v_mfma_f32_16x16x32_bf16 v[72:75], a[208:211], v[56:59], v[72:75]
    ds_read_b64_tr_b16 v[32:33], v2 offset:0
    v_mfma_f32_16x16x32_bf16 v[76:79], a[208:211], v[60:63], v[76:79]
    ds_read_b64_tr_b16 v[34:35], v2 offset:4224
    v_mfma_f32_16x16x32_bf16 v[96:99], a[212:215], v[48:51], v[96:99]
    ds_read_b64_tr_b16 v[36:37], v2 offset:32
    v_mfma_f32_16x16x32_bf16 v[100:103], a[212:215], v[52:55], v[100:103]
    ds_read_b64_tr_b16 v[38:39], v2 offset:4256
    v_mfma_f32_16x16x32_bf16 v[104:107], a[212:215], v[56:59], v[104:107]
    ds_read_b64_tr_b16 v[40:41], v2 offset:64
    v_mfma_f32_16x16x32_bf16 v[108:111], a[212:215], v[60:63], v[108:111]
    ds_read_b64_tr_b16 v[42:43], v2 offset:4288
    v_mfma_f32_16x16x32_bf16 v[128:131], a[216:219], v[48:51], v[128:131]
    ds_read_b64_tr_b16 v[44:45], v2 offset:96
    v_mfma_f32_16x16x32_bf16 v[132:135], a[216:219], v[52:55], v[132:135]
    ds_read_b64_tr_b16 v[46:47], v2 offset:4320
    v_mfma_f32_16x16x32_bf16 v[136:139], a[216:219], v[56:59], v[136:139]
    v_mfma_f32_16x16x32_bf16 v[140:143], a[216:219], v[60:63], v[140:143]
    v_mfma_f32_16x16x32_bf16 v[160:163], a[220:223], v[48:51], v[160:163]
    v_mfma_f32_16x16x32_bf16 v[164:167], a[220:223], v[52:55], v[164:167]
    v_mfma_f32_16x16x32_bf16 v[168:171], a[220:223], v[56:59], v[168:171]
    v_mfma_f32_16x16x32_bf16 v[172:175], a[220:223], v[60:63], v[172:175]
    s_waitcnt lgkmcnt(8)
    v_mfma_f32_16x16x32_bf16 v[80:83], a[208:211], v[16:19], v[80:83]
    ds_read_b64_tr_b16 v[48:49], v2 offset:128
    ds_read_b64_tr_b16 v[50:51], v2 offset:4352
    v_mfma_f32_16x16x32_bf16 v[84:87], a[208:211], v[20:23], v[84:87]
    ds_read_b64_tr_b16 v[52:53], v2 offset:160
    ds_read_b64_tr_b16 v[54:55], v2 offset:4384
    v_mfma_f32_16x16x32_bf16 v[88:91], a[208:211], v[24:27], v[88:91]
    ds_read_b64_tr_b16 v[56:57], v2 offset:192
    ds_read_b64_tr_b16 v[58:59], v2 offset:4416
    v_mfma_f32_16x16x32_bf16 v[92:95], a[208:211], v[28:31], v[92:95]
    ds_read_b64_tr_b16 v[60:61], v2 offset:224
    ds_read_b64_tr_b16 v[62:63], v2 offset:4448
    v_mfma_f32_16x16x32_bf16 v[112:115], a[212:215], v[16:19], v[112:115]
    s_add_u32 m0, s27, 0
    s_nop 0
    global_load_lds_dwordx4 v[4:5], off
    v_mfma_f32_16x16x32_bf16 v[116:119], a[212:215], v[20:23], v[116:119]
    v_lshl_add_u64 v[4:5], v[4:5], 0, s[20:21]
    s_add_u32 m0, s27, 1056
    v_mfma_f32_16x16x32_bf16 v[120:123], a[212:215], v[24:27], v[120:123]
    global_load_lds_dwordx4 v[4:5], off
    v_lshl_add_u64 v[4:5], v[4:5], 0, s[20:21]
    v_mfma_f32_16x16x32_bf16 v[124:127], a[212:215], v[28:31], v[124:127]
    s_add_u32 m0, s27, 2112
    s_nop 0
    global_load_lds_dwordx4 v[4:5], off
    v_mfma_f32_16x16x32_bf16 v[144:147], a[216:219], v[16:19], v[144:147]
    v_lshl_add_u64 v[4:5], v[4:5], 0, s[20:21]
    s_add_u32 m0, s27, 3168
    v_mfma_f32_16x16x32_bf16 v[148:151], a[216:219], v[20:23], v[148:151]
    global_load_lds_dwordx4 v[4:5], off
    v_lshl_add_u64 v[4:5], v[4:5], 0, s[22:23]
    v_mfma_f32_16x16x32_bf16 v[152:155], a[216:219], v[24:27], v[152:155]
    s_add_u32 s27, s27, 17024
    s_cmp_ge_u32 s27, 153216
    s_cselect_b32 s27, s38, s27
    v_mfma_f32_16x16x32_bf16 v[156:159], a[216:219], v[28:31], v[156:159]
    v_mfma_f32_16x16x32_bf16 v[176:179], a[220:223], v[16:19], v[176:179]
    v_mfma_f32_16x16x32_bf16 v[180:183], a[220:223], v[20:23], v[180:183]
    v_mfma_f32_16x16x32_bf16 v[184:187], a[220:223], v[24:27], v[184:187]
    v_mfma_f32_16x16x32_bf16 v[188:191], a[220:223], v[28:31], v[188:191]
    s_cmp_eq_u32 s28, 0
    s_cbranch_scc1 gsv_fa_22
    s_waitcnt vmcnt(40)
gsv_fa_22:
    s_waitcnt lgkmcnt(8)
    v_mfma_f32_16x16x32_bf16 v[64:67], a[224:227], v[32:35], v[64:67]
    ds_read_b64_tr_b16 v[16:17], v2 offset:512
    v_mfma_f32_16x16x32_bf16 v[68:71], a[224:227], v[36:39], v[68:71]
    ds_read_b64_tr_b16 v[18:19], v2 offset:4736
    v_mfma_f32_16x16x32_bf16 v[72:75], a[224:227], v[40:43], v[72:75]
    ds_read_b64_tr_b16 v[20:21], v2 offset:544
    v_mfma_f32_16x16x32_bf16 v[76:79], a[224:227], v[44:47], v[76:79]
    ds_read_b64_tr_b16 v[22:23], v2 offset:4768
    v_mfma_f32_16x16x32_bf16 v[96:99], a[228:231], v[32:35], v[96:99]
    ds_read_b64_tr_b16 v[24:25], v2 offset:576
    v_mfma_f32_16x16x32_bf16 v[100:103], a[228:231], v[36:39], v[100:103]
    ds_read_b64_tr_b16 v[26:27], v2 offset:4800
    v_mfma_f32_16x16x32_bf16 v[104:107], a[228:231], v[40:43], v[104:107]
    ds_read_b64_tr_b16 v[28:29], v2 offset:608
    v_mfma_f32_16x16x32_bf16 v[108:111], a[228:231], v[44:47], v[108:111]
    ds_read_b64_tr_b16 v[30:31], v2 offset:4832
    v_mfma_f32_16x16x32_bf16 v[128:131], a[232:235], v[32:35], v[128:131]
    v_mfma_f32_16x16x32_bf16 v[132:135], a[232:235], v[36:39], v[132:135]
    v_mfma_f32_16x16x32_bf16 v[136:139], a[232:235], v[40:43], v[136:139]
    v_mfma_f32_16x16x32_bf16 v[140:143], a[232:235], v[44:47], v[140:143]
    v_mfma_f32_16x16x32_bf16 v[160:163], a[236:239], v[32:35], v[160:163]
    v_mfma_f32_16x16x32_bf16 v[164:167], a[236:239], v[36:39], v[164:167]
    v_mfma_f32_16x16x32_bf16 v[168:171], a[236:239], v[40:43], v[168:171]
    v_mfma_f32_16x16x32_bf16 v[172:175], a[236:239], v[44:47], v[172:175]
    s_waitcnt lgkmcnt(8)
    v_mfma_f32_16x16x32_bf16 v[80:83], a[224:227], v[48:51], v[80:83]
    ds_read_b64_tr_b16 v[32:33], v2 offset:640
    v_mfma_f32_16x16x32_bf16 v[84:87], a[224:227], v[52:55], v[84:87]
    ds_read_b64_tr_b16 v[34:35], v2 offset:4864
    v_mfma_f32_16x16x32_bf16 v[88:91], a[224:227], v[56:59], v[88:91]
    ds_read_b64_tr_b16 v[36:37], v2 offset:672
    v_mfma_f32_16x16x32_bf16 v[92:95], a[224:227], v[60:63], v[92:95]
    ds_read_b64_tr_b16 v[38:39], v2 offset:4896
    v_mfma_f32_16x16x32_bf16 v[112:115], a[228:231], v[48:51], v[112:115]
    ds_read_b64_tr_b16 v[40:41], v2 offset:704
    v_mfma_f32_16x16x32_bf16 v[116:119], a[228:231], v[52:55], v[116:119]
    ds_read_b64_tr_b16 v[42:43], v2 offset:4928
    v_mfma_f32_16x16x32_bf16 v[120:123], a[228:231], v[56:59], v[120:123]
    ds_read_b64_tr_b16 v[44:45], v2 offset:736
    v_mfma_f32_16x16x32_bf16 v[124:127], a[228:231], v[60:63], v[124:127]
    ds_read_b64_tr_b16 v[46:47], v2 offset:4960
    v_mfma_f32_16x16x32_bf16 v[144:147], a[232:235], v[48:51], v[144:147]
    v_mfma_f32_16x16x32_bf16 v[148:151], a[232:235], v[52:55], v[148:151]
    v_mfma_f32_16x16x32_bf16 v[152:155], a[232:235], v[56:59], v[152:155]
    v_mfma_f32_16x16x32_bf16 v[156:159], a[232:235], v[60:63], v[156:159]
    v_mfma_f32_16x16x32_bf16 v[176:179], a[236:239], v[48:51], v[176:179]
    v_mfma_f32_16x16x32_bf16 v[180:183], a[236:239], v[52:55], v[180:183]
    v_mfma_f32_16x16x32_bf16 v[184:187], a[236:239], v[56:59], v[184:187]
    v_mfma_f32_16x16x32_bf16 v[188:191], a[236:239], v[60:63], v[188:191]
    s_waitcnt vmcnt(24)
    s_barrier
    s_waitcnt lgkmcnt(8)
    v_mfma_f32_16x16x32_bf16 v[64:67], a[240:243], v[16:19], v[64:67]
    v_add_u32 v2, s26, v1
    v_mfma_f32_16x16x32_bf16 v[68:71], a[240:243], v[20:23], v[68:71]
    s_add_u32 s26, s26, 17024
    s_cmp_ge_u32 s26, 153216
    s_cselect_b32 s26, 0, s26
    v_mfma_f32_16x16x32_bf16 v[72:75], a[240:243], v[24:27], v[72:75]
    ds_read_b64_tr_b16 v[48:49], v2 offset:0
    v_mfma_f32_16x16x32_bf16 v[76:79], a[240:243], v[28:31], v[76:79]
    ds_read_b64_tr_b16 v[50:51], v2 offset:4224
    v_mfma_f32_16x16x32_bf16 v[96:99], a[244:247], v[16:19], v[96:99]
    ds_read_b64_tr_b16 v[52:53], v2 offset:32
    v_mfma_f32_16x16x32_bf16 v[100:103], a[244:247], v[20:23], v[100:103]
    ds_read_b64_tr_b16 v[54:55], v2 offset:4256
    v_mfma_f32_16x16x32_bf16 v[104:107], a[244:247], v[24:27], v[104:107]
    ds_read_b64_tr_b16 v[56:57], v2 offset:64
    v_mfma_f32_16x16x32_bf16 v[108:111], a[244:247], v[28:31], v[108:111]
    ds_read_b64_tr_b16 v[58:59], v2 offset:4288
    v_mfma_f32_16x16x32_bf16 v[128:131], a[248:251], v[16:19], v[128:131]
    ds_read_b64_tr_b16 v[60:61], v2 offset:96
    v_mfma_f32_16x16x32_bf16 v[132:135], a[248:251], v[20:23], v[132:135]
    ds_read_b64_tr_b16 v[62:63], v2 offset:4320
    v_mfma_f32_16x16x32_bf16 v[136:139], a[248:251], v[24:27], v[136:139]
    v_mfma_f32_16x16x32_bf16 v[140:143], a[248:251], v[28:31], v[140:143]
    v_mfma_f32_16x16x32_bf16 v[160:163], a[252:255], v[16:19], v[160:163]
    v_mfma_f32_16x16x32_bf16 v[164:167], a[252:255], v[20:23], v[164:167]
    v_mfma_f32_16x16x32_bf16 v[168:171], a[252:255], v[24:27], v[168:171]
    v_mfma_f32_16x16x32_bf16 v[172:175], a[252:255], v[28:31], v[172:175]
    s_waitcnt lgkmcnt(8)
    v_mfma_f32_16x16x32_bf16 v[80:83], a[240:243], v[32:35], v[80:83]
    ds_read_b64_tr_b16 v[16:17], v2 offset:128
    ds_read_b64_tr_b16 v[18:19], v2 offset:4352
    v_mfma_f32_16x16x32_bf16 v[84:87], a[240:243], v[36:39], v[84:87]
    ds_read_b64_tr_b16 v[20:21], v2 offset:160
    ds_read_b64_tr_b16 v[22:23], v2 offset:4384
    v_mfma_f32_16x16x32_bf16 v[88:91], a[240:243], v[40:43], v[88:91]
    ds_read_b64_tr_b16 v[24:25], v2 offset:192
    ds_read_b64_tr_b16 v[26:27], v2 offset:4416
    v_mfma_f32_16x16x32_bf16 v[92:95], a[240:243], v[44:47], v[92:95]
    ds_read_b64_tr_b16 v[28:29], v2 offset:224
    ds_read_b64_tr_b16 v[30:31], v2 offset:4448
    v_mfma_f32_16x16x32_bf16 v[112:115], a[244:247], v[32:35], v[112:115]
    s_add_u32 m0, s27, 0
    s_nop 0
    global_load_lds_dwordx4 v[4:5], off
    v_mfma_f32_16x16x32_bf16 v[116:119], a[244:247], v[36:39], v[116:119]
    v_lshl_add_u64 v[4:5], v[4:5], 0, s[20:21]
    s_add_u32 m0, s27, 1056
    v_mfma_f32_16x16x32_bf16 v[120:123], a[244:247], v[40:43], v[120:123]
    global_load_lds_dwordx4 v[4:5], off
    v_lshl_add_u64 v[4:5], v[4:5], 0, s[20:21]
    v_mfma_f32_16x16x32_bf16 v[124:127], a[244:247], v[44:47], v[124:127]
    s_add_u32 m0, s27, 2112
    s_nop 0
    global_load_lds_dwordx4 v[4:5], off
    v_mfma_f32_16x16x32_bf16 v[144:147], a[248:251], v[32:35], v[144:147]
    v_lshl_add_u64 v[4:5], v[4:5], 0, s[20:21]
    s_add_u32 m0, s27, 3168
    v_mfma_f32_16x16x32_bf16 v[148:151], a[248:251], v[36:39], v[148:151]
    global_load_lds_dwordx4 v[4:5], off
    v_lshl_add_u64 v[4:5], v[4:5], 0, s[22:23]
    v_mfma_f32_16x16x32_bf16 v[152:155], a[248:251], v[40:43], v[152:155]
    s_add_u32 s27, s27, 17024
    s_cmp_ge_u32 s27, 153216
    s_cselect_b32 s27, s38, s27
    v_mfma_f32_16x16x32_bf16 v[156:159], a[248:251], v[44:47], v[156:159]
    v_mfma_f32_16x16x32_bf16 v[176:179], a[252:255], v[32:35], v[176:179]
    v_mfma_f32_16x16x32_bf16 v[180:183], a[252:255], v[36:39], v[180:183]
    v_mfma_f32_16x16x32_bf16 v[184:187], a[252:255], v[40:43], v[184:187]
    v_mfma_f32_16x16x32_bf16 v[188:191], a[252:255], v[44:47], v[188:191]
    s_cmp_eq_u32 s28, 0
    s_cbranch_scc1 gsv_fa_23
    s_waitcnt vmcnt(32)
gsv_fa_23:
    s_waitcnt lgkmcnt(8)
    v_mfma_f32_16x16x32_bf16 v[64:67], v[192:195], v[48:51], v[64:67]
    ds_read_b64_tr_b16 v[32:33], v2 offset:512
    v_mfma_f32_16x16x32_bf16 v[68:71], v[192:195], v[52:55], v[68:71]
    ds_read_b64_tr_b16 v[34:35], v2 offset:4736
    v_mfma_f32_16x16x32_bf16 v[72:75], v[192:195], v[56:59], v[72:75]
    ds_read_b64_tr_b16 v[36:37], v2 offset:544
    v_mfma_f32_16x16x32_bf16 v[76:79], v[192:195], v[60:63], v[76:79]
    ds_read_b64_tr_b16 v[38:39], v2 offset:4768
    v_mfma_f32_16x16x32_bf16 v[96:99], v[196:199], v[48:51], v[96:99]
    ds_read_b64_tr_b16 v[40:41], v2 offset:576
    v_mfma_f32_16x16x32_bf16 v[100:103], v[196:199], v[52:55], v[100:103]
    ds_read_b64_tr_b16 v[42:43], v2 offset:4800
    v_mfma_f32_16x16x32_bf16 v[104:107], v[196:199], v[56:59], v[104:107]
    ds_read_b64_tr_b16 v[44:45], v2 offset:608
    v_mfma_f32_16x16x32_bf16 v[108:111], v[196:199], v[60:63], v[108:111]
    ds_read_b64_tr_b16 v[46:47], v2 offset:4832
    v_mfma_f32_16x16x32_bf16 v[128:131], v[200:203], v[48:51], v[128:131]
    v_mfma_f32_16x16x32_bf16 v[132:135], v[200:203], v[52:55], v[132:135]
    v_mfma_f32_16x16x32_bf16 v[136:139], v[200:203], v[56:59], v[136:139]
    v_mfma_f32_16x16x32_bf16 v[140:143], v[200:203], v[60:63], v[140:143]
    v_mfma_f32_16x16x32_bf16 v[160:163], v[204:207], v[48:51], v[160:163]
    v_mfma_f32_16x16x32_bf16 v[164:167], v[204:207], v[52:55], v[164:167]
    v_mfma_f32_16x16x32_bf16 v[168:171], v[204:207], v[56:59], v[168:171]
    v_mfma_f32_16x16x32_bf16 v[172:175], v[204:207], v[60:63], v[172:175]
    s_waitcnt lgkmcnt(8)
    v_mfma_f32_16x16x32_bf16 v[80:83], v[192:195], v[16:19], v[80:83]
    ds_read_b64_tr_b16 v[48:49], v2 offset:640
    v_mfma_f32_16x16x32_bf16 v[84:87], v[192:195], v[20:23], v[84:87]
    ds_read_b64_tr_b16 v[50:51], v2 offset:4864
    v_mfma_f32_16x16x32_bf16 v[88:91], v[192:195], v[24:27], v[88:91]
    ds_read_b64_tr_b16 v[52:53], v2 offset:672
    v_mfma_f32_16x16x32_bf16 v[92:95], v[192:195], v[28:31], v[92:95]
    ds_read_b64_tr_b16 v[54:55], v2 offset:4896
    v_mfma_f32_16x16x32_bf16 v[112:115], v[196:199], v[16:19], v[112:115]
    ds_read_b64_tr_b16 v[56:57], v2 offset:704
    v_mfma_f32_16x16x32_bf16 v[116:119], v[196:199], v[20:23], v[116:119]
    ds_read_b64_tr_b16 v[58:59], v2 offset:4928
    v_mfma_f32_16x16x32_bf16 v[120:123], v[196:199], v[24:27], v[120:123]
    ds_read_b64_tr_b16 v[60:61], v2 offset:736
    v_mfma_f32_16x16x32_bf16 v[124:127], v[196:199], v[28:31], v[124:127]
    ds_read_b64_tr_b16 v[62:63], v2 offset:4960
    v_mfma_f32_16x16x32_bf16 v[144:147], v[200:203], v[16:19], v[144:147]
    v_mfma_f32_16x16x32_bf16 v[148:151], v[200:203], v[20:23], v[148:151]
    v_mfma_f32_16x16x32_bf16 v[152:155], v[200:203], v[24:27], v[152:155]
    v_mfma_f32_16x16x32_bf16 v[156:159], v[200:203], v[28:31], v[156:159]
    v_mfma_f32_16x16x32_bf16 v[176:179], v[204:207], v[16:19], v[176:179]
    v_mfma_f32_16x16x32_bf16 v[180:183], v[204:207], v[20:23], v[180:183]
    v_mfma_f32_16x16x32_bf16 v[184:187], v[204:207], v[24:27], v[184:187]
    v_mfma_f32_16x16x32_bf16 v[188:191], v[204:207], v[28:31], v[188:191]
    s_waitcnt vmcnt(24)
    s_barrier
    s_waitcnt lgkmcnt(8)
    v_mfma_f32_16x16x32_bf16 v[64:67], v[208:211], v[32:35], v[64:67]
    v_add_u32 v2, s26, v1
    v_mfma_f32_16x16x32_bf16 v[68:71], v[208:211], v[36:39], v[68:71]
    s_add_u32 s26, s26, 17024
    s_cmp_ge_u32 s26, 153216
    s_cselect_b32 s26, 0, s26
    v_mfma_f32_16x16x32_bf16 v[72:75], v[208:211], v[40:43], v[72:75]
    ds_read_b64_tr_b16 v[16:17], v2 offset:0
    v_mfma_f32_16x16x32_bf16 v[76:79], v[208:211], v[44:47], v[76:79]
    ds_read_b64_tr_b16 v[18:19], v2 offset:4224
    v_mfma_f32_16x16x32_bf16 v[96:99], v[212:215], v[32:35], v[96:99]
    ds_read_b64_tr_b16 v[20:21], v2 offset:32
    v_mfma_f32_16x16x32_bf16 v[100:103], v[212:215], v[36:39], v[100:103]
    ds_read_b64_tr_b16 v[22:23], v2 offset:4256
    v_mfma_f32_16x16x32_bf16 v[104:107], v[212:215], v[40:43], v[104:107]
    ds_read_b64_tr_b16 v[24:25], v2 offset:64
    v_mfma_f32_16x16x32_bf16 v[108:111], v[212:215], v[44:47], v[108:111]
    ds_read_b64_tr_b16 v[26:27], v2 offset:4288
    v_mfma_f32_16x16x32_bf16 v[128:131], v[216:219], v[32:35], v[128:131]
    ds_read_b64_tr_b16 v[28:29], v2 offset:96
    v_mfma_f32_16x16x32_bf16 v[132:135], v[216:219], v[36:39], v[132:135]
    ds_read_b64_tr_b16 v[30:31], v2 offset:4320
    v_mfma_f32_16x16x32_bf16 v[136:139], v[216:219], v[40:43], v[136:139]
    v_mfma_f32_16x16x32_bf16 v[140:143], v[216:219], v[44:47], v[140:143]
    v_mfma_f32_16x16x32_bf16 v[160:163], v[220:223], v[32:35], v[160:163]
    v_mfma_f32_16x16x32_bf16 v[164:167], v[220:223], v[36:39], v[164:167]
    v_mfma_f32_16x16x32_bf16 v[168:171], v[220:223], v[40:43], v[168:171]
    v_mfma_f32_16x16x32_bf16 v[172:175], v[220:223], v[44:47], v[172:175]
    s_waitcnt lgkmcnt(8)
    v_mfma_f32_16x16x32_bf16 v[80:83], v[208:211], v[48:51], v[80:83]
    ds_read_b64_tr_b16 v[32:33], v2 offset:128
    ds_read_b64_tr_b16 v[34:35], v2 offset:4352
    v_mfma_f32_16x16x32_bf16 v[84:87], v[208:211], v[52:55], v[84:87]
    ds_read_b64_tr_b16 v[36:37], v2 offset:160
    ds_read_b64_tr_b16 v[38:39], v2 offset:4384
    v_mfma_f32_16x16x32_bf16 v[88:91], v[208:211], v[56:59], v[88:91]
    ds_read_b64_tr_b16 v[40:41], v2 offset:192
    ds_read_b64_tr_b16 v[42:43], v2 offset:4416
    v_mfma_f32_16x16x32_bf16 v[92:95], v[208:211], v[60:63], v[92:95]
    ds_read_b64_tr_b16 v[44:45], v2 offset:224
    ds_read_b64_tr_b16 v[46:47], v2 offset:4448
    v_mfma_f32_16x16x32_bf16 v[112:115], v[212:215], v[48:51], v[112:115]
    s_add_u32 m0, s27, 0
    s_nop 0
    global_load_lds_dwordx4 v[4:5], off
    v_mfma_f32_16x16x32_bf16 v[116:119], v[212:215], v[52:55], v[116:119]
    v_lshl_add_u64 v[4:5], v[4:5], 0, s[20:21]
    s_add_u32 m0, s27, 1056
    v_mfma_f32_16x16x32_bf16 v[120:123], v[212:215], v[56:59], v[120:123]
    global_load_lds_dwordx4 v[4:5], off
    v_lshl_add_u64 v[4:5], v[4:5], 0, s[20:21]
    v_mfma_f32_16x16x32_bf16 v[124:127], v[212:215], v[60:63], v[124:127]
    s_add_u32 m0, s27, 2112
    s_nop 0
    global_load_lds_dwordx4 v[4:5], off
    v_mfma_f32_16x16x32_bf16 v[144:147], v[216:219], v[48:51], v[144:147]
    v_lshl_add_u64 v[4:5], v[4:5], 0, s[20:21]
    s_add_u32 m0, s27, 3168
    v_mfma_f32_16x16x32_bf16 v[148:151], v[216:219], v[52:55], v[148:151]
    global_load_lds_dwordx4 v[4:5], off
    v_lshl_add_u64 v[4:5], v[4:5], 0, s[22:23]
    v_mfma_f32_16x16x32_bf16 v[152:155], v[216:219], v[56:59], v[152:155]
    s_add_u32 s27, s27, 17024
    s_cmp_ge_u32 s27, 153216
    s_cselect_b32 s27, s38, s27
    v_mfma_f32_16x16x32_bf16 v[156:159], v[216:219], v[60:63], v[156:159]
    v_mfma_f32_16x16x32_bf16 v[176:179], v[220:223], v[48:51], v[176:179]
    v_mfma_f32_16x16x32_bf16 v[180:183], v[220:223], v[52:55], v[180:183]
    v_mfma_f32_16x16x32_bf16 v[184:187], v[220:223], v[56:59], v[184:187]
    v_mfma_f32_16x16x32_bf16 v[188:191], v[220:223], v[60:63], v[188:191]
    s_cmp_eq_u32 s28, 0
    s_cbranch_scc1 gsv_fa_24
    s_waitcnt vmcnt(28)
gsv_fa_24:
    s_waitcnt lgkmcnt(8)
    v_mfma_f32_16x16x32_bf16 v[64:67], v[224:227], v[16:19], v[64:67]
    ds_read_b64_tr_b16 v[48:49], v2 offset:512
    v_mfma_f32_16x16x32_bf16 v[68:71], v[224:227], v[20:23], v[68:71]
    ds_read_b64_tr_b16 v[50:51], v2 offset:4736
    v_mfma_f32_16x16x32_bf16 v[72:75], v[224:227], v[24:27], v[72:75]
    ds_read_b64_tr_b16 v[52:53], v2 offset:544
    v_mfma_f32_16x16x32_bf16 v[76:79], v[224:227], v[28:31], v[76:79]
    ds_read_b64_tr_b16 v[54:55], v2 offset:4768
    v_mfma_f32_16x16x32_bf16 v[96:99], v[228:231], v[16:19], v[96:99]
    ds_read_b64_tr_b16 v[56:57], v2 offset:576
    v_mfma_f32_16x16x32_bf16 v[100:103], v[228:231], v[20:23], v[100:103]
    ds_read_b64_tr_b16 v[58:59], v2 offset:4800
    v_mfma_f32_16x16x32_bf16 v[104:107], v[228:231], v[24:27], v[104:107]
    ds_read_b64_tr_b16 v[60:61], v2 offset:608
    v_mfma_f32_16x16x32_bf16 v[108:111], v[228:231], v[28:31], v[108:111]
    ds_read_b64_tr_b16 v[62:63], v2 offset:4832
    v_mfma_f32_16x16x32_bf16 v[128:131], v[232:235], v[16:19], v[128:131]
    v_mfma_f32_16x16x32_bf16 v[132:135], v[232:235], v[20:23], v[132:135]
    v_mfma_f32_16x16x32_bf16 v[136:139], v[232:235], v[24:27], v[136:139]
    v_mfma_f32_16x16x32_bf16 v[140:143], v[232:235], v[28:31], v[140:143]
    v_mfma_f32_16x16x32_bf16 v[160:163], v[236:239], v[16:19], v[160:163]
    v_mfma_f32_16x16x32_bf16 v[164:167], v[236:239], v[20:23], v[164:167]
    v_mfma_f32_16x16x32_bf16 v[168:171], v[236:239], v[24:27], v[168:171]
    v_mfma_f32_16x16x32_bf16 v[172:175], v[236:239], v[28:31], v[172:175]
    s_waitcnt lgkmcnt(8)
    v_mfma_f32_16x16x32_bf16 v[80:83], v[224:227], v[32:35], v[80:83]
    ds_read_b64_tr_b16 v[16:17], v2 offset:640
    v_mfma_f32_16x16x32_bf16 v[84:87], v[224:227], v[36:39], v[84:87]
    ds_read_b64_tr_b16 v[18:19], v2 offset:4864
    v_mfma_f32_16x16x32_bf16 v[88:91], v[224:227], v[40:43], v[88:91]
    ds_read_b64_tr_b16 v[20:21], v2 offset:672
    v_mfma_f32_16x16x32_bf16 v[92:95], v[224:227], v[44:47], v[92:95]
    ds_read_b64_tr_b16 v[22:23], v2 offset:4896
    v_mfma_f32_16x16x32_bf16 v[112:115], v[228:231], v[32:35], v[112:115]
    ds_read_b64_tr_b16 v[24:25], v2 offset:704
    v_mfma_f32_16x16x32_bf16 v[116:119], v[228:231], v[36:39], v[116:119]
    ds_read_b64_tr_b16 v[26:27], v2 offset:4928
    v_mfma_f32_16x16x32_bf16 v[120:123], v[228:231], v[40:43], v[120:123]
    ds_read_b64_tr_b16 v[28:29], v2 offset:736
    v_mfma_f32_16x16x32_bf16 v[124:127], v[228:231], v[44:47], v[124:127]
    ds_read_b64_tr_b16 v[30:31], v2 offset:4960
    v_mfma_f32_16x16x32_bf16 v[144:147], v[232:235], v[32:35], v[144:147]
    v_mfma_f32_16x16x32_bf16 v[148:151], v[232:235], v[36:39], v[148:151]
    v_mfma_f32_16x16x32_bf16 v[152:155], v[232:235], v[40:43], v[152:155]
    v_mfma_f32_16x16x32_bf16 v[156:159], v[232:235], v[44:47], v[156:159]
    v_mfma_f32_16x16x32_bf16 v[176:179], v[236:239], v[32:35], v[176:179]
    v_mfma_f32_16x16x32_bf16 v[180:183], v[236:239], v[36:39], v[180:183]
    v_mfma_f32_16x16x32_bf16 v[184:187], v[236:239], v[40:43], v[184:187]
    v_mfma_f32_16x16x32_bf16 v[188:191], v[236:239], v[44:47], v[188:191]
    s_barrier
    s_waitcnt lgkmcnt(8)
    v_mfma_f32_16x16x32_bf16 v[64:67], v[240:243], v[48:51], v[64:67]
    v_mfma_f32_16x16x32_bf16 v[68:71], v[240:243], v[52:55], v[68:71]
    v_mfma_f32_16x16x32_bf16 v[72:75], v[240:243], v[56:59], v[72:75]
    v_mfma_f32_16x16x32_bf16 v[76:79], v[240:243], v[60:63], v[76:79]
    v_mfma_f32_16x16x32_bf16 v[96:99], v[244:247], v[48:51], v[96:99]
    v_mfma_f32_16x16x32_bf16 v[100:103], v[244:247], v[52:55], v[100:103]
    v_mfma_f32_16x16x32_bf16 v[104:107], v[244:247], v[56:59], v[104:107]
    v_mfma_f32_16x16x32_bf16 v[108:111], v[244:247], v[60:63], v[108:111]
    v_mfma_f32_16x16x32_bf16 v[128:131], v[248:251], v[48:51], v[128:131]
    v_mfma_f32_16x16x32_bf16 v[132:135], v[248:251], v[52:55], v[132:135]
    v_mfma_f32_16x16x32_bf16 v[136:139], v[248:251], v[56:59], v[136:139]
    v_mfma_f32_16x16x32_bf16 v[140:143], v[248:251], v[60:63], v[140:143]
    v_mfma_f32_16x16x32_bf16 v[160:163], v[252:255], v[48:51], v[160:163]
    v_mfma_f32_16x16x32_bf16 v[164:167], v[252:255], v[52:55], v[164:167]
    v_mfma_f32_16x16x32_bf16 v[168:171], v[252:255], v[56:59], v[168:171]
    v_mfma_f32_16x16x32_bf16 v[172:175], v[252:255], v[60:63], v[172:175]
    s_waitcnt lgkmcnt(0)
    v_mfma_f32_16x16x32_bf16 v[80:83], v[240:243], v[16:19], v[80:83]
    s_add_u32 m0, s27, 0
    v_mfma_f32_16x16x32_bf16 v[84:87], v[240:243], v[20:23], v[84:87]
    global_load_lds_dwordx4 v[4:5], off
    v_mfma_f32_16x16x32_bf16 v[88:91], v[240:243], v[24:27], v[88:91]
    v_lshl_add_u64 v[4:5], v[4:5], 0, s[20:21]
    v_mfma_f32_16x16x32_bf16 v[92:95], v[240:243], v[28:31], v[92:95]
    s_add_u32 m0, s27, 1056
    v_mfma_f32_16x16x32_bf16 v[112:115], v[244:247], v[16:19], v[112:115]
    global_load_lds_dwordx4 v[4:5], off
    v_mfma_f32_16x16x32_bf16 v[116:119], v[244:247], v[20:23], v[116:119]
    v_lshl_add_u64 v[4:5], v[4:5], 0, s[20:21]
    v_mfma_f32_16x16x32_bf16 v[120:123], v[244:247], v[24:27], v[120:123]
    s_add_u32 m0, s27, 2112
    v_mfma_f32_16x16x32_bf16 v[124:127], v[244:247], v[28:31], v[124:127]
    global_load_lds_dwordx4 v[4:5], off
    v_mfma_f32_16x16x32_bf16 v[144:147], v[248:251], v[16:19], v[144:147]
    v_lshl_add_u64 v[4:5], v[4:5], 0, s[20:21]
    v_mfma_f32_16x16x32_bf16 v[148:151], v[248:251], v[20:23], v[148:151]
    s_add_u32 m0, s27, 3168
    v_mfma_f32_16x16x32_bf16 v[152:155], v[248:251], v[24:27], v[152:155]
    global_load_lds_dwordx4 v[4:5], off
    v_mfma_f32_16x16x32_bf16 v[156:159], v[248:251], v[28:31], v[156:159]
    v_lshl_add_u64 v[4:5], v[4:5], 0, s[22:23]
    v_mfma_f32_16x16x32_bf16 v[176:179], v[252:255], v[16:19], v[176:179]
    s_add_u32 s27, s27, 17024
    s_cmp_ge_u32 s27, 153216
    s_cselect_b32 s27, s38, s27
    v_mfma_f32_16x16x32_bf16 v[180:183], v[252:255], v[20:23], v[180:183]
    v_mfma_f32_16x16x32_bf16 v[184:187], v[252:255], v[24:27], v[184:187]
    v_mfma_f32_16x16x32_bf16 v[188:191], v[252:255], v[28:31], v[188:191]
    s_mov_b32 s28, 0
    s_nop 7
    s_lshl_b32 s34, s19, 19
    s_add_u32 s34, s34, 4096
    v_add_u32 v8, s34, v0
    v_add_u32 v9, 262144, v8
    v_cvt_pk_bf16_f32 v64, v64, v65
    v_cvt_pk_bf16_f32 v65, v66, v67
    v_cvt_pk_bf16_f32 v66, v96, v97
    v_cvt_pk_bf16_f32 v67, v98, v99
    global_store_dwordx4 v8, v[64:67], s[24:25] offset:-4096 sc1
    v_cvt_pk_bf16_f32 v68, v68, v69
    v_cvt_pk_bf16_f32 v69, v70, v71
    v_cvt_pk_bf16_f32 v70, v100, v101
    v_cvt_pk_bf16_f32 v71, v102, v103
    global_store_dwordx4 v8, v[68:71], s[24:25] offset:-3072 sc1
    v_cvt_pk_bf16_f32 v72, v72, v73
    v_cvt_pk_bf16_f32 v73, v74, v75
    v_cvt_pk_bf16_f32 v74, v104, v105
    v_cvt_pk_bf16_f32 v75, v106, v107
    global_store_dwordx4 v8, v[72:75], s[24:25] offset:-2048 sc1
    v_cvt_pk_bf16_f32 v76, v76, v77
    v_cvt_pk_bf16_f32 v77, v78, v79
    v_cvt_pk_bf16_f32 v78, v108, v109
    v_cvt_pk_bf16_f32 v79, v110, v111
    global_store_dwordx4 v8, v[76:79], s[24:25] offset:-1024 sc1
    v_cvt_pk_bf16_f32 v80, v80, v81
    v_cvt_pk_bf16_f32 v81, v82, v83
    v_cvt_pk_bf16_f32 v82, v112, v113
    v_cvt_pk_bf16_f32 v83, v114, v115
    global_store_dwordx4 v8, v[80:83], s[24:25] offset:0 sc1
    v_cvt_pk_bf16_f32 v84, v84, v85
    v_cvt_pk_bf16_f32 v85, v86, v87
    v_cvt_pk_bf16_f32 v86, v116, v117
    v_cvt_pk_bf16_f32 v87, v118, v119
    global_store_dwordx4 v8, v[84:87], s[24:25] offset:1024 sc1
    v_cvt_pk_bf16_f32 v88, v88, v89
    v_cvt_pk_bf16_f32 v89, v90, v91
    v_cvt_pk_bf16_f32 v90, v120, v121
    v_cvt_pk_bf16_f32 v91, v122, v123
    global_store_dwordx4 v8, v[88:91], s[24:25] offset:2048 sc1
    v_cvt_pk_bf16_f32 v92, v92, v93
    v_cvt_pk_bf16_f32 v93, v94, v95
    v_cvt_pk_bf16_f32 v94, v124, v125
    v_cvt_pk_bf16_f32 v95, v126, v127
    global_store_dwordx4 v8, v[92:95], s[24:25] offset:3072 sc1
    v_cvt_pk_bf16_f32 v128, v128, v129
    v_cvt_pk_bf16_f32 v129, v130, v131
    v_cvt_pk_bf16_f32 v130, v160, v161
    v_cvt_pk_bf16_f32 v131, v162, v163
    global_store_dwordx4 v9, v[128:131], s[24:25] offset:-4096 sc1
    v_cvt_pk_bf16_f32 v132, v132, v133
    v_cvt_pk_bf16_f32 v133, v134, v135
    v_cvt_pk_bf16_f32 v134, v164, v165
    v_cvt_pk_bf16_f32 v135, v166, v167
    global_store_dwordx4 v9, v[132:135], s[24:25] offset:-3072 sc1
    v_cvt_pk_bf16_f32 v136, v136, v137
    v_cvt_pk_bf16_f32 v137, v138, v139
    v_cvt_pk_bf16_f32 v138, v168, v169
    v_cvt_pk_bf16_f32 v139, v170, v171
    global_store_dwordx4 v9, v[136:139], s[24:25] offset:-2048 sc1
    v_cvt_pk_bf16_f32 v140, v140, v141
    v_cvt_pk_bf16_f32 v141, v142, v143
    v_cvt_pk_bf16_f32 v142, v172, v173
    v_cvt_pk_bf16_f32 v143, v174, v175
    global_store_dwordx4 v9, v[140:143], s[24:25] offset:-1024 sc1
    v_cvt_pk_bf16_f32 v144, v144, v145
    v_cvt_pk_bf16_f32 v145, v146, v147
    v_cvt_pk_bf16_f32 v146, v176, v177
    v_cvt_pk_bf16_f32 v147, v178, v179
    global_store_dwordx4 v9, v[144:147], s[24:25] offset:0 sc1
    v_cvt_pk_bf16_f32 v148, v148, v149
    v_cvt_pk_bf16_f32 v149, v150, v151
    v_cvt_pk_bf16_f32 v150, v180, v181
    v_cvt_pk_bf16_f32 v151, v182, v183
    global_store_dwordx4 v9, v[148:151], s[24:25] offset:1024 sc1
    v_cvt_pk_bf16_f32 v152, v152, v153
    v_cvt_pk_bf16_f32 v153, v154, v155
    v_cvt_pk_bf16_f32 v154, v184, v185
    v_cvt_pk_bf16_f32 v155, v186, v187
    global_store_dwordx4 v9, v[152:155], s[24:25] offset:2048 sc1
    v_cvt_pk_bf16_f32 v156, v156, v157
    v_cvt_pk_bf16_f32 v157, v158, v159
    v_cvt_pk_bf16_f32 v158, v188, v189
    v_cvt_pk_bf16_f32 v159, v190, v191
    global_store_dwordx4 v9, v[156:159], s[24:25] offset:3072 sc1
g1_end:
    s_lshr_b32 s50, s43, 5
    s_max_u32 s50, s50, 1
    s_lshl_b32 s50, s50, 3
    s_add_u32 s50, s50, s42
    s_mov_b32 s42, s44
    s_mov_b32 s43, s45
    s_waitcnt vmcnt(0)
    s_barrier
    s_cmp_lg_u32 s19, 0
    s_cbranch_scc1 g1_f2
    s_mov_b64 exec, 1
    s_lshl_b32 s34, s50, 7
    s_add_u32 s34, s34, 103809024
    v_mov_b32 v124, s34
    v_mov_b32 v125, 1
    global_atomic_add v124, v125, s[14:15] sc1
    s_cmp_ge_u32 s43, 0xfffe
    s_cbranch_scc1 g1_fc_done
g1_fc_again:
    s_mov_b64 exec, -1
    v_lshlrev_b32 v124, 3, v0
    v_add_u32 v124, 103833600, v124
    global_load_dword v125, v124, s[14:15] sc1
    v_lshrrev_b32 v124, 2, v0
    v_min_u32 v124, 20, v124
    global_load_dword v126, v124, s[12:13] offset:116 sc1
    s_waitcnt vmcnt(0)
    v_cmp_gt_u32 s[68:69], 10, v125
    v_and_b32 v126, 0xffff, v126
    v_and_b32 v124, 16, v124
    v_lshrrev_b32 v124, 1, v124
    v_add_u32 v126, v126, v124
    v_cmp_gt_u32 vcc, 88, v126
    s_mov_b64 exec, 1
    s_and_b32 s69, s69, 0xffff
    s_and_b32 s36, vcc_lo, 63
    s_lshl_b32 s75, s48, 3
    s_lshr_b64 s[70:71], s[68:69], s75
    s_and_b32 s70, s70, 255
    s_mov_b32 s74, s48
    s_add_u32 s75, s75, s42
    s_bitcmp1_b32 s70, s42
    s_cbranch_scc1 g1_fc_cq
    s_bitcmp1_b32 s36, s48
    s_cbranch_scc1 g1_fc_gk
    s_sub_u32 s75, s75, s42
    s_ff1_i32_b32 s71, s70
    s_add_u32 s75, s75, s71
    s_cmp_lg_u32 s70, 0
    s_cbranch_scc1 g1_fc_cq
    s_ff1_i32_b32 s74, s36
    s_cmp_lg_u32 s36, 0
    s_cbranch_scc1 g1_fc_gk
    s_mov_b32 s45, 0xffff
    s_cmp_eq_u64 s[68:69], 0
    s_cbranch_scc1 g1_fc_done
    s_ff1_i32_b64 s75, s[68:69]
g1_fc_cq:
    s_lshl_b32 s34, s75, 7
    s_add_u32 s34, s34, 103833600
    v_mov_b32 v124, s34
    v_mov_b32 v125, 1
    global_atomic_add v126, v124, v125, s[14:15] sc0 sc1
    s_waitcnt vmcnt(0)
    v_readfirstlane_b32 s45, v126
    s_cmp_ge_u32 s45, 10
    s_cbranch_scc1 g1_fc_again
    s_mul_i32 s45, s45, 6
    s_lshr_b32 s34, s75, 3
    s_add_u32 s45, s45, s34
    s_add_u32 s45, s45, 64
    s_and_b32 s44, s75, 7
    s_cmp_ge_u32 s45, 123
    s_cbranch_scc1 g1_fc_again
    s_branch g1_fc_done
g1_fc_gk:
    s_add_u32 s75, s74, 29
    s_lshl_b32 s34, s75, 2
    v_mov_b32 v124, s34
    v_mov_b32 v125, 1
    global_atomic_add v126, v124, v125, s[12:13] sc0 sc1
    s_waitcnt vmcnt(0)
    v_readfirstlane_b32 s75, v126
    s_and_b32 s75, s75, 0xffff
    s_min_u32 s75, s75, 88
    s_cmp_lt_u32 s74, 4
    s_cselect_b32 s34, 0, 18
    s_cselect_b32 s35, 11, 10
    s_add_u32 s34, s34, 187
    s_mul_i32 s44, s75, s34
    s_lshr_b32 s44, s44, 11
    s_mul_i32 s34, s44, s35
    s_sub_u32 s34, s75, s34
    s_mul_i32 s34, s34, 3
    s_lshr_b32 s35, s74, 1
    s_add_u32 s34, s34, s35
    s_and_b32 s35, s74, 1
    s_lshl_b32 s35, s35, 5
    s_add_u32 s45, s34, s35
    s_cmp_ge_u32 s44, 8
    s_cbranch_scc1 g1_fc_again
g1_fc_done:
    v_mov_b32 v124, 163776
    v_mov_b32 v125, s44
    ds_write_b32 v124, v125 offset:0
    v_mov_b32 v125, s45
    ds_write_b32 v124, v125 offset:4
    s_waitcnt lgkmcnt(0)
    s_mov_b64 exec, -1
g1_f2:
    s_barrier
    v_mov_b32 v124, 163776
    ds_read_b32 v125, v124 offset:0
    s_waitcnt lgkmcnt(0)
    v_readfirstlane_b32 s44, v125
    ds_read_b32 v125, v124 offset:4
    s_waitcnt lgkmcnt(0)
    v_readfirstlane_b32 s45, v125
    s_cmp_lt_u32 s43, 123
    s_cbranch_scc1 g1_tile
    s_cmp_lg_u32 s43, 0xfffd
    s_cbranch_scc1 g1_out
    s_mov_b32 s42, s44
    s_mov_b32 s43, s45
    s_cmp_ge_u32 s43, 123
    s_cbranch_scc1 g1_out
    s_mov_b32 s26, 0
    s_mov_b32 s27, s38
    s_barrier
    s_cmp_lg_u32 s19, 0
    s_cbranch_scc1 g1_f3
    s_mov_b64 exec, 1
g1_fd_again:
    s_mov_b64 exec, -1
    v_lshlrev_b32 v124, 3, v0
    v_add_u32 v124, 103833600, v124
    global_load_dword v125, v124, s[14:15] sc1
    v_lshrrev_b32 v124, 2, v0
    v_min_u32 v124, 20, v124
    global_load_dword v126, v124, s[12:13] offset:116 sc1
    s_waitcnt vmcnt(0)
    v_cmp_gt_u32 s[68:69], 10, v125
    v_and_b32 v126, 0xffff, v126
    v_and_b32 v124, 16, v124
    v_lshrrev_b32 v124, 1, v124
    v_add_u32 v126, v126, v124
    v_cmp_gt_u32 vcc, 88, v126
    s_mov_b64 exec, 1
    s_and_b32 s69, s69, 0xffff
    s_and_b32 s36, vcc_lo, 63
    s_lshl_b32 s75, s48, 3
    s_lshr_b64 s[70:71], s[68:69], s75
    s_and_b32 s70, s70, 255
    s_mov_b32 s74, s48
    s_add_u32 s75, s75, s42
    s_bitcmp1_b32 s70, s42
    s_cbranch_scc1 g1_fd_cq
    s_bitcmp1_b32 s36, s48
    s_cbranch_scc1 g1_fd_gk
    s_sub_u32 s75, s75, s42
    s_ff1_i32_b32 s71, s70
    s_add_u32 s75, s75, s71
    s_cmp_lg_u32 s70, 0
    s_cbranch_scc1 g1_fd_cq
    s_ff1_i32_b32 s74, s36
    s_cmp_lg_u32 s36, 0
    s_cbranch_scc1 g1_fd_gk
    s_mov_b32 s45, 0xffff
    s_cmp_eq_u64 s[68:69], 0
    s_cbranch_scc1 g1_fd_done
    s_ff1_i32_b64 s75, s[68:69]
g1_fd_cq:
    s_lshl_b32 s34, s75, 7
    s_add_u32 s34, s34, 103833600
    v_mov_b32 v124, s34
    v_mov_b32 v125, 1
    global_atomic_add v126, v124, v125, s[14:15] sc0 sc1
    s_waitcnt vmcnt(0)
    v_readfirstlane_b32 s45, v126
    s_cmp_ge_u32 s45, 10
    s_cbranch_scc1 g1_fd_again
    s_mul_i32 s45, s45, 6
    s_lshr_b32 s34, s75, 3
    s_add_u32 s45, s45, s34
    s_add_u32 s45, s45, 64
    s_and_b32 s44, s75, 7
    s_cmp_ge_u32 s45, 123
    s_cbranch_scc1 g1_fd_again
    s_branch g1_fd_done
g1_fd_gk:
    s_add_u32 s75, s74, 29
    s_lshl_b32 s34, s75, 2
    v_mov_b32 v124, s34
    v_mov_b32 v125, 1
    global_atomic_add v126, v124, v125, s[12:13] sc0 sc1
    s_waitcnt vmcnt(0)
    v_readfirstlane_b32 s75, v126
    s_and_b32 s75, s75, 0xffff
    s_min_u32 s75, s75, 88
    s_cmp_lt_u32 s74, 4
    s_cselect_b32 s34, 0, 18
    s_cselect_b32 s35, 11, 10
    s_add_u32 s34, s34, 187
    s_mul_i32 s44, s75, s34
    s_lshr_b32 s44, s44, 11
    s_mul_i32 s34, s44, s35
    s_sub_u32 s34, s75, s34
    s_mul_i32 s34, s34, 3
    s_lshr_b32 s35, s74, 1
    s_add_u32 s34, s34, s35
    s_and_b32 s35, s74, 1
    s_lshl_b32 s35, s35, 5
    s_add_u32 s45, s34, s35
    s_cmp_ge_u32 s44, 8
    s_cbranch_scc1 g1_fd_again
g1_fd_done:
    v_mov_b32 v124, 163776
    v_mov_b32 v125, s44
    ds_write_b32 v124, v125 offset:0
    v_mov_b32 v125, s45
    ds_write_b32 v124, v125 offset:4
    s_waitcnt lgkmcnt(0)
    s_mov_b64 exec, -1
g1_f3:
    s_cmp_ge_u32 s43, 123
    s_cbranch_scc1 g1_d2_e
    s_cmp_ge_u32 s43, 96
    s_cbranch_scc1 g1_d2_f
    s_cmp_lt_u32 s43, 32
    s_cselect_b32 s30, s58, s60
    s_cselect_b32 s31, s59, s61
    s_cmp_ge_u32 s43, 64
    s_cselect_b32 s30, s56, s30
    s_cselect_b32 s31, s57, s31
    s_and_b32 s34, s43, 31
    s_lshl_b32 s34, s34, 8
    s_add_u32 s30, s30, s34
    s_addc_u32 s31, s31, 0
    s_mov_b64 s[32:33], s[30:31]
    s_mov_b32 s29, 8192
    s_branch g1_d2_e
g1_d2_f:
    s_sub_u32 s34, s43, 96
    s_lshl_b32 s34, s34, 7
    s_add_u32 s30, s64, s34
    s_addc_u32 s31, s65, 0
    s_add_u32 s32, s66, s34
    s_addc_u32 s33, s67, 0
    s_sub_u32 s32, s32, 128
    s_subb_u32 s33, s33, 0
    s_mov_b32 s29, 3456
g1_d2_e:
    s_mov_b32 s74, 8
    s_mov_b32 s20, s29
    s_mul_i32 s22, s29, 61
    v_mul_u32_u24 v12, s29, v6
    v_lshl_add_u32 v12, v7, 4, v12
    v_cmp_lt_u32 vcc, 7, v7
    v_mov_b32 v13, s30
    v_mov_b32 v14, s32
    v_cndmask_b32 v4, v13, v14, vcc
    v_mov_b32 v13, s31
    v_mov_b32 v14, s33
    v_cndmask_b32 v5, v13, v14, vcc
    v_add_co_u32 v4, vcc, v4, v12
    s_nop 1
    v_addc_co_u32 v5, vcc, 0, v5, vcc
g1_rp:
    s_add_u32 m0, s27, 0
    s_nop 0
    global_load_lds_dwordx4 v[4:5], off
    v_lshl_add_u64 v[4:5], v[4:5], 0, s[20:21]
    s_add_u32 m0, s27, 1056
    s_nop 0
    global_load_lds_dwordx4 v[4:5], off
    v_lshl_add_u64 v[4:5], v[4:5], 0, s[20:21]
    s_add_u32 m0, s27, 2112
    s_nop 0
    global_load_lds_dwordx4 v[4:5], off
    v_lshl_add_u64 v[4:5], v[4:5], 0, s[20:21]
    s_add_u32 m0, s27, 3168
    s_nop 0
    global_load_lds_dwordx4 v[4:5], off
    v_lshl_add_u64 v[4:5], v[4:5], 0, s[22:23]
    s_add_u32 s27, s27, 17024
    s_cmp_ge_u32 s27, 153216
    s_cselect_b32 s27, s38, s27
    s_sub_u32 s74, s74, 1
    s_cmp_lg_u32 s74, 0
    s_cbranch_scc1 g1_rp
    s_waitcnt vmcnt(0)
    s_barrier
    v_mov_b32 v124, 163776
    ds_read_b32 v125, v124 offset:0
    s_waitcnt lgkmcnt(0)
    v_readfirstlane_b32 s44, v125
    ds_read_b32 v125, v124 offset:4
    s_waitcnt lgkmcnt(0)
    v_readfirstlane_b32 s45, v125
    s_branch g1_tile
g1_out:
    v_mov_b32 v127, v15
wk_f2e:
wk_f2:
    s_barrier
    s_cmp_lg_u32 s19, 0
    s_cbranch_scc1 f2_f
    s_mov_b64 exec, 1
    v_mov_b32 v124, 103815168
    v_mov_b32 v125, 1
    global_atomic_add v126, v124, v125, s[14:15] sc0 sc1
    s_waitcnt vmcnt(0)
    v_readfirstlane_b32 s49, v126
    s_cmp_ge_u32 s49, 80
    s_cbranch_scc1 f2_put
    s_mul_i32 s42, s49, 205
    s_lshr_b32 s42, s42, 10
    s_lshr_b32 s34, s42, 1
    s_lshl_b32 s34, s34, 7
    s_add_u32 s34, s34, 103812096
    v_mov_b32 v124, s34
poll_25:
    global_load_dword v125, v124, s[14:15] sc1
    s_add_u32 s54, s54, 1
    s_cmp_gt_u32 s54, 1048576
    s_cbranch_scc1 wk_fail
    s_waitcnt vmcnt(0)
    v_readfirstlane_b32 s35, v125
    s_cmp_ge_u32 s35, 27
    s_cbranch_scc1 poll_25_ok
    s_sleep 2
    s_branch poll_25
poll_25_ok:
f2_put:
    v_mov_b32 v124, 163776
    v_mov_b32 v125, s49
    ds_write_b32 v124, v125 offset:0
    s_waitcnt lgkmcnt(0)
    s_mov_b64 exec, -1
f2_f:
    s_barrier
    v_mov_b32 v124, 163776
    ds_read_b32 v125, v124 offset:0
    s_waitcnt lgkmcnt(0)
    v_readfirstlane_b32 s49, v125
    s_cmp_ge_u32 s49, 80
    s_cbranch_scc1 wk_role
    s_load_dwordx2 s[4:5], s[0:1], 80
    s_mul_i32 s42, s49, 205
    s_lshr_b32 s42, s42, 10
    s_mul_i32 s44, s42, 5
    s_sub_u32 s43, s49, s44
    s_waitcnt lgkmcnt(0)
    s_lshl_b32 s46, s43, 8
    s_add_u32 s24, s4, s46
    s_addc_u32 s25, s5, 0
    s_mul_i32 s34, s42, 442368
    s_add_u32 s34, s34, 71303168
    s_add_u32 s20, s14, s34
    s_addc_u32 s21, s15, 0
    s_mul_i32 s34, s42, 163840
    s_add_u32 s34, s34, s46
    s_add_u32 s35, s34, 79691776
    s_add_u32 s28, s14, s35
    s_addc_u32 s29, s15, 0
    v_and_b32 v16, 63, v127
    v_lshlrev_b32 v0, 4, v16
    v_and_b32 v17, 15, v16
    v_lshrrev_b32 v18, 4, v16
    s_mul_i32 s34, s19, 110592
    v_add_u32 v4, s34, v0
    v_add_u32 v5, 55296, v4
    s_mul_i32 s40, s19, 4096
    s_lshl_b32 s41, s19, 12
    s_add_u32 s41, s41, 16384
    s_lshr_b32 s34, s19, 1
    s_mul_i32 s34, s34, 8192
    v_add_u32 v1, s34, v0
    v_lshlrev_b32 v19, 1, v18
    v_xor_b32 v19, v19, v17
    s_lshl_b32 s34, s19, 4
    s_add_u32 s34, s34, 0
    v_add_u32 v20, s34, v18
    v_mul_u32_u24 v20, 1280, v20
    v_lshl_add_u32 v20, v19, 4, v20
    v_mov_b32 v8, s24
    v_mov_b32 v9, s25
    v_add_co_u32 v8, vcc, v8, v20
    s_nop 1
    v_addc_co_u32 v9, vcc, 0, v9, vcc
    v_lshlrev_b32 v19, 1, v18
    v_xor_b32 v19, v19, v17
    v_xor_b32 v19, 8, v19
    s_lshl_b32 s34, s19, 4
    s_add_u32 s34, s34, 4
    v_add_u32 v20, s34, v18
    v_mul_u32_u24 v20, 1280, v20
    v_lshl_add_u32 v20, v19, 4, v20
    v_mov_b32 v10, s24
    v_mov_b32 v11, s25
    v_add_co_u32 v10, vcc, v10, v20
    s_nop 1
    v_addc_co_u32 v11, vcc, 0, v11, vcc
    v_lshlrev_b32 v19, 1, v18
    v_xor_b32 v19, v19, v17
    s_lshl_b32 s34, s19, 4
    s_add_u32 s34, s34, 8
    v_add_u32 v20, s34, v18
    v_mul_u32_u24 v20, 1280, v20
    v_lshl_add_u32 v20, v19, 4, v20
    v_mov_b32 v12, s24
    v_mov_b32 v13, s25
    v_add_co_u32 v12, vcc, v12, v20
    s_nop 1
    v_addc_co_u32 v13, vcc, 0, v13, vcc
    v_lshlrev_b32 v19, 1, v18
    v_xor_b32 v19, v19, v17
    v_xor_b32 v19, 8, v19
    s_lshl_b32 s34, s19, 4
    s_add_u32 s34, s34, 12
    v_add_u32 v20, s34, v18
    v_mul_u32_u24 v20, 1280, v20
    v_lshl_add_u32 v20, v19, 4, v20
    v_mov_b32 v14, s24
    v_mov_b32 v15, s25
    v_add_co_u32 v14, vcc, v14, v20
    s_nop 1
    v_addc_co_u32 v15, vcc, 0, v15, vcc
    s_mov_b32 s22, 81920
    s_mov_b32 s23, 0
    v_lshrrev_b32 v19, 2, v17
    v_lshl_add_u32 v21, v18, 2, v19
    v_and_b32 v20, 7, v21
    v_lshlrev_b32 v20, 1, v20
    s_and_b32 s34, s19, 1
    s_lshl_b32 s34, s34, 3
    v_and_b32 v22, 3, v17
    v_mov_b32 v23, 0
    v_add_u32 v22, s34, v22
    v_xor_b32 v22, v22, v20
    v_lshlrev_b32 v22, 4, v22
    v_lshl_add_u32 v22, v21, 8, v22
    v_lshl_add_u32 v22, v23, 3, v22
    v_add_u32 v22, 16384, v22
    v_mov_b32 v120, v22
    v_xor_b32 v121, 8, v22
    v_xor_b32 v122, 64, v22
    v_xor_b32 v123, 72, v22
    s_mov_b32 s39, 0
    s_mov_b32 s38, 0
    s_add_u32 m0, s39, s40
    s_nop 0
    global_load_lds_dwordx4 v4, s[20:21] sc1
    global_load_lds_dwordx4 v4, s[20:21] offset:1024 sc1
    s_add_u32 m0, m0, 2048
    s_nop 0
    global_load_lds_dwordx4 v5, s[20:21] sc1
    global_load_lds_dwordx4 v5, s[20:21] offset:1024 sc1
    s_add_u32 m0, s39, s41
    s_nop 0
    global_load_lds_dwordx4 v[8:9], off
    v_lshl_add_u64 v[8:9], v[8:9], 0, s[22:23]
    s_add_u32 m0, m0, 1024
    s_nop 0
    global_load_lds_dwordx4 v[10:11], off
    v_lshl_add_u64 v[10:11], v[10:11], 0, s[22:23]
    s_add_u32 m0, m0, 1024
    s_nop 0
    global_load_lds_dwordx4 v[12:13], off
    v_lshl_add_u64 v[12:13], v[12:13], 0, s[22:23]
    s_add_u32 m0, m0, 1024
    s_nop 0
    global_load_lds_dwordx4 v[14:15], off
    v_lshl_add_u64 v[14:15], v[14:15], 0, s[22:23]
    s_add_u32 s20, s20, 2048
    s_addc_u32 s21, s21, 0
    s_add_u32 s39, s39, 32768
    s_cmp_eq_u32 s39, 98304
    s_cselect_b32 s39, 0, s39
    s_add_u32 m0, s39, s40
    s_nop 0
    global_load_lds_dwordx4 v4, s[20:21] sc1
    global_load_lds_dwordx4 v4, s[20:21] offset:1024 sc1
    s_add_u32 m0, m0, 2048
    s_nop 0
    global_load_lds_dwordx4 v5, s[20:21] sc1
    global_load_lds_dwordx4 v5, s[20:21] offset:1024 sc1
    s_add_u32 m0, s39, s41
    s_nop 0
    global_load_lds_dwordx4 v[8:9], off
    v_lshl_add_u64 v[8:9], v[8:9], 0, s[22:23]
    s_add_u32 m0, m0, 1024
    s_nop 0
    global_load_lds_dwordx4 v[10:11], off
    v_lshl_add_u64 v[10:11], v[10:11], 0, s[22:23]
    s_add_u32 m0, m0, 1024
    s_nop 0
    global_load_lds_dwordx4 v[12:13], off
    v_lshl_add_u64 v[12:13], v[12:13], 0, s[22:23]
    s_add_u32 m0, m0, 1024
    s_nop 0
    global_load_lds_dwordx4 v[14:15], off
    v_lshl_add_u64 v[14:15], v[14:15], 0, s[22:23]
    s_add_u32 s20, s20, 2048
    s_addc_u32 s21, s21, 0
    s_add_u32 s39, s39, 32768
    s_cmp_eq_u32 s39, 98304
    s_cselect_b32 s39, 0, s39
    v_accvgpr_write_b32 a0, 0
    v_accvgpr_write_b32 a1, 0
    v_accvgpr_write_b32 a2, 0
    v_accvgpr_write_b32 a3, 0
    v_accvgpr_write_b32 a4, 0
    v_accvgpr_write_b32 a5, 0
    v_accvgpr_write_b32 a6, 0
    v_accvgpr_write_b32 a7, 0
    v_accvgpr_write_b32 a8, 0
    v_accvgpr_write_b32 a9, 0
    v_accvgpr_write_b32 a10, 0
    v_accvgpr_write_b32 a11, 0
    v_accvgpr_write_b32 a12, 0
    v_accvgpr_write_b32 a13, 0
    v_accvgpr_write_b32 a14, 0
    v_accvgpr_write_b32 a15, 0
    v_accvgpr_write_b32 a16, 0
    v_accvgpr_write_b32 a17, 0
    v_accvgpr_write_b32 a18, 0
    v_accvgpr_write_b32 a19, 0
    v_accvgpr_write_b32 a20, 0
    v_accvgpr_write_b32 a21, 0
    v_accvgpr_write_b32 a22, 0
    v_accvgpr_write_b32 a23, 0
    v_accvgpr_write_b32 a24, 0
    v_accvgpr_write_b32 a25, 0
    v_accvgpr_write_b32 a26, 0
    v_accvgpr_write_b32 a27, 0
    v_accvgpr_write_b32 a28, 0
    v_accvgpr_write_b32 a29, 0
    v_accvgpr_write_b32 a30, 0
    v_accvgpr_write_b32 a31, 0
    v_accvgpr_write_b32 a32, 0
    v_accvgpr_write_b32 a33, 0
    v_accvgpr_write_b32 a34, 0
    v_accvgpr_write_b32 a35, 0
    v_accvgpr_write_b32 a36, 0
    v_accvgpr_write_b32 a37, 0
    v_accvgpr_write_b32 a38, 0
    v_accvgpr_write_b32 a39, 0
    v_accvgpr_write_b32 a40, 0
    v_accvgpr_write_b32 a41, 0
    v_accvgpr_write_b32 a42, 0
    v_accvgpr_write_b32 a43, 0
    v_accvgpr_write_b32 a44, 0
    v_accvgpr_write_b32 a45, 0
    v_accvgpr_write_b32 a46, 0
    v_accvgpr_write_b32 a47, 0
    v_accvgpr_write_b32 a48, 0
    v_accvgpr_write_b32 a49, 0
    v_accvgpr_write_b32 a50, 0
    v_accvgpr_write_b32 a51, 0
    v_accvgpr_write_b32 a52, 0
    v_accvgpr_write_b32 a53, 0
    v_accvgpr_write_b32 a54, 0
    v_accvgpr_write_b32 a55, 0
    v_accvgpr_write_b32 a56, 0
    v_accvgpr_write_b32 a57, 0
    v_accvgpr_write_b32 a58, 0
    v_accvgpr_write_b32 a59, 0
    v_accvgpr_write_b32 a60, 0
    v_accvgpr_write_b32 a61, 0
    v_accvgpr_write_b32 a62, 0
    v_accvgpr_write_b32 a63, 0
    s_waitcnt vmcnt(8)
    s_barrier
    v_add_u32 v16, s38, v1
    v_add_u32 v17, s38, v120
    v_add_u32 v18, s38, v121
    v_add_u32 v19, s38, v122
    v_add_u32 v20, s38, v123
    ds_read_b64_tr_b16 v[88:89], v17 offset:0
    ds_read_b64_tr_b16 v[90:91], v17 offset:4096
    ds_read_b64_tr_b16 v[92:93], v18 offset:0
    ds_read_b64_tr_b16 v[94:95], v18 offset:4096
    ds_read_b64_tr_b16 v[96:97], v19 offset:0
    ds_read_b64_tr_b16 v[98:99], v19 offset:4096
    ds_read_b64_tr_b16 v[100:101], v20 offset:0
    ds_read_b64_tr_b16 v[102:103], v20 offset:4096
    ds_read_b128 v[24:27], v16 offset:0
    ds_read_b128 v[28:31], v16 offset:2048
    ds_read_b128 v[32:35], v16 offset:4096
    ds_read_b128 v[36:39], v16 offset:6144
    s_mov_b32 s37, 25
f2t_k:
    s_waitcnt lgkmcnt(0)
    v_mfma_f32_16x16x32_bf16 a[0:3], v[88:91], v[24:27], a[0:3]
    ds_read_b64_tr_b16 v[104:105], v17 offset:8192
    ds_read_b64_tr_b16 v[106:107], v17 offset:12288
    v_mfma_f32_16x16x32_bf16 a[4:7], v[92:95], v[24:27], a[4:7]
    ds_read_b64_tr_b16 v[108:109], v18 offset:8192
    ds_read_b64_tr_b16 v[110:111], v18 offset:12288
    v_mfma_f32_16x16x32_bf16 a[8:11], v[96:99], v[24:27], a[8:11]
    ds_read_b64_tr_b16 v[112:113], v19 offset:8192
    ds_read_b64_tr_b16 v[114:115], v19 offset:12288
    v_mfma_f32_16x16x32_bf16 a[12:15], v[100:103], v[24:27], a[12:15]
    ds_read_b64_tr_b16 v[116:117], v20 offset:8192
    ds_read_b64_tr_b16 v[118:119], v20 offset:12288
    v_mfma_f32_16x16x32_bf16 a[16:19], v[88:91], v[28:31], a[16:19]
    ds_read_b128 v[56:59], v16 offset:1024
    ds_read_b128 v[60:63], v16 offset:3072
    v_mfma_f32_16x16x32_bf16 a[20:23], v[92:95], v[28:31], a[20:23]
    ds_read_b128 v[64:67], v16 offset:5120
    ds_read_b128 v[68:71], v16 offset:7168
    v_mfma_f32_16x16x32_bf16 a[24:27], v[96:99], v[28:31], a[24:27]
    s_add_u32 m0, s39, s40
    s_nop 0
    global_load_lds_dwordx4 v4, s[20:21] sc1
    v_mfma_f32_16x16x32_bf16 a[28:31], v[100:103], v[28:31], a[28:31]
    global_load_lds_dwordx4 v4, s[20:21] offset:1024 sc1
    s_add_u32 m0, m0, 2048
    v_mfma_f32_16x16x32_bf16 a[32:35], v[88:91], v[32:35], a[32:35]
    global_load_lds_dwordx4 v5, s[20:21] sc1
    global_load_lds_dwordx4 v5, s[20:21] offset:1024 sc1
    v_mfma_f32_16x16x32_bf16 a[36:39], v[92:95], v[32:35], a[36:39]
    s_add_u32 m0, s39, s41
    s_nop 0
    global_load_lds_dwordx4 v[8:9], off
    v_mfma_f32_16x16x32_bf16 a[40:43], v[96:99], v[32:35], a[40:43]
    v_lshl_add_u64 v[8:9], v[8:9], 0, s[22:23]
    s_add_u32 m0, m0, 1024
    v_mfma_f32_16x16x32_bf16 a[44:47], v[100:103], v[32:35], a[44:47]
    global_load_lds_dwordx4 v[10:11], off
    v_lshl_add_u64 v[10:11], v[10:11], 0, s[22:23]
    v_mfma_f32_16x16x32_bf16 a[48:51], v[88:91], v[36:39], a[48:51]
    s_add_u32 m0, m0, 1024
    s_nop 0
    global_load_lds_dwordx4 v[12:13], off
    v_mfma_f32_16x16x32_bf16 a[52:55], v[92:95], v[36:39], a[52:55]
    v_lshl_add_u64 v[12:13], v[12:13], 0, s[22:23]
    s_add_u32 m0, m0, 1024
    v_mfma_f32_16x16x32_bf16 a[56:59], v[96:99], v[36:39], a[56:59]
    global_load_lds_dwordx4 v[14:15], off
    v_lshl_add_u64 v[14:15], v[14:15], 0, s[22:23]
    v_mfma_f32_16x16x32_bf16 a[60:63], v[100:103], v[36:39], a[60:63]
    s_add_u32 s20, s20, 2048
    s_addc_u32 s21, s21, 0
    s_add_u32 s39, s39, 32768
    s_cmp_eq_u32 s39, 98304
    s_cselect_b32 s39, 0, s39
    s_waitcnt lgkmcnt(0)
    s_waitcnt vmcnt(8)
    s_barrier
    s_add_u32 s38, s38, 32768
    s_cmp_eq_u32 s38, 98304
    s_cselect_b32 s38, 0, s38
    v_mfma_f32_16x16x32_bf16 a[0:3], v[104:107], v[56:59], a[0:3]
    v_add_u32 v16, s38, v1
    v_add_u32 v17, s38, v120
    v_mfma_f32_16x16x32_bf16 a[4:7], v[108:111], v[56:59], a[4:7]
    v_add_u32 v18, s38, v121
    v_add_u32 v19, s38, v122
    v_mfma_f32_16x16x32_bf16 a[8:11], v[112:115], v[56:59], a[8:11]
    v_add_u32 v20, s38, v123
    ds_read_b64_tr_b16 v[88:89], v17 offset:0
    v_mfma_f32_16x16x32_bf16 a[12:15], v[116:119], v[56:59], a[12:15]
    ds_read_b64_tr_b16 v[90:91], v17 offset:4096
    ds_read_b64_tr_b16 v[92:93], v18 offset:0
    v_mfma_f32_16x16x32_bf16 a[16:19], v[104:107], v[60:63], a[16:19]
    ds_read_b64_tr_b16 v[94:95], v18 offset:4096
    ds_read_b64_tr_b16 v[96:97], v19 offset:0
    v_mfma_f32_16x16x32_bf16 a[20:23], v[108:111], v[60:63], a[20:23]
    ds_read_b64_tr_b16 v[98:99], v19 offset:4096
    ds_read_b64_tr_b16 v[100:101], v20 offset:0
    v_mfma_f32_16x16x32_bf16 a[24:27], v[112:115], v[60:63], a[24:27]
    ds_read_b64_tr_b16 v[102:103], v20 offset:4096
    ds_read_b128 v[24:27], v16 offset:0
    v_mfma_f32_16x16x32_bf16 a[28:31], v[116:119], v[60:63], a[28:31]
    ds_read_b128 v[28:31], v16 offset:2048
    ds_read_b128 v[32:35], v16 offset:4096
    v_mfma_f32_16x16x32_bf16 a[32:35], v[104:107], v[64:67], a[32:35]
    ds_read_b128 v[36:39], v16 offset:6144
    v_mfma_f32_16x16x32_bf16 a[36:39], v[108:111], v[64:67], a[36:39]
    v_mfma_f32_16x16x32_bf16 a[40:43], v[112:115], v[64:67], a[40:43]
    v_mfma_f32_16x16x32_bf16 a[44:47], v[116:119], v[64:67], a[44:47]
    v_mfma_f32_16x16x32_bf16 a[48:51], v[104:107], v[68:71], a[48:51]
    v_mfma_f32_16x16x32_bf16 a[52:55], v[108:111], v[68:71], a[52:55]
    v_mfma_f32_16x16x32_bf16 a[56:59], v[112:115], v[68:71], a[56:59]
    v_mfma_f32_16x16x32_bf16 a[60:63], v[116:119], v[68:71], a[60:63]
    s_sub_u32 s37, s37, 1
    s_cmp_lg_u32 s37, 0
    s_cbranch_scc1 f2t_k
    s_waitcnt lgkmcnt(0)
    v_mfma_f32_16x16x32_bf16 a[0:3], v[88:91], v[24:27], a[0:3]
    ds_read_b64_tr_b16 v[104:105], v17 offset:8192
    v_mfma_f32_16x16x32_bf16 a[4:7], v[92:95], v[24:27], a[4:7]
    ds_read_b64_tr_b16 v[106:107], v17 offset:12288
    v_mfma_f32_16x16x32_bf16 a[8:11], v[96:99], v[24:27], a[8:11]
    ds_read_b64_tr_b16 v[108:109], v18 offset:8192
    v_mfma_f32_16x16x32_bf16 a[12:15], v[100:103], v[24:27], a[12:15]
    ds_read_b64_tr_b16 v[110:111], v18 offset:12288
    v_mfma_f32_16x16x32_bf16 a[16:19], v[88:91], v[28:31], a[16:19]
    ds_read_b64_tr_b16 v[112:113], v19 offset:8192
    v_mfma_f32_16x16x32_bf16 a[20:23], v[92:95], v[28:31], a[20:23]
    ds_read_b64_tr_b16 v[114:115], v19 offset:12288
    v_mfma_f32_16x16x32_bf16 a[24:27], v[96:99], v[28:31], a[24:27]
    ds_read_b64_tr_b16 v[116:117], v20 offset:8192
    v_mfma_f32_16x16x32_bf16 a[28:31], v[100:103], v[28:31], a[28:31]
    ds_read_b64_tr_b16 v[118:119], v20 offset:12288
    v_mfma_f32_16x16x32_bf16 a[32:35], v[88:91], v[32:35], a[32:35]
    ds_read_b128 v[56:59], v16 offset:1024
    v_mfma_f32_16x16x32_bf16 a[36:39], v[92:95], v[32:35], a[36:39]
    ds_read_b128 v[60:63], v16 offset:3072
    v_mfma_f32_16x16x32_bf16 a[40:43], v[96:99], v[32:35], a[40:43]
    ds_read_b128 v[64:67], v16 offset:5120
    v_mfma_f32_16x16x32_bf16 a[44:47], v[100:103], v[32:35], a[44:47]
    ds_read_b128 v[68:71], v16 offset:7168
    v_mfma_f32_16x16x32_bf16 a[48:51], v[88:91], v[36:39], a[48:51]
    v_mfma_f32_16x16x32_bf16 a[52:55], v[92:95], v[36:39], a[52:55]
    v_mfma_f32_16x16x32_bf16 a[56:59], v[96:99], v[36:39], a[56:59]
    v_mfma_f32_16x16x32_bf16 a[60:63], v[100:103], v[36:39], a[60:63]
    s_waitcnt lgkmcnt(0)
    s_waitcnt vmcnt(0)
    s_barrier
    s_add_u32 s38, s38, 32768
    s_cmp_eq_u32 s38, 98304
    s_cselect_b32 s38, 0, s38
    v_mfma_f32_16x16x32_bf16 a[0:3], v[104:107], v[56:59], a[0:3]
    v_add_u32 v16, s38, v1
    v_add_u32 v17, s38, v120
    v_mfma_f32_16x16x32_bf16 a[4:7], v[108:111], v[56:59], a[4:7]
    v_add_u32 v18, s38, v121
    v_add_u32 v19, s38, v122
    v_mfma_f32_16x16x32_bf16 a[8:11], v[112:115], v[56:59], a[8:11]
    v_add_u32 v20, s38, v123
    ds_read_b64_tr_b16 v[88:89], v17 offset:0
    v_mfma_f32_16x16x32_bf16 a[12:15], v[116:119], v[56:59], a[12:15]
    ds_read_b64_tr_b16 v[90:91], v17 offset:4096
    ds_read_b64_tr_b16 v[92:93], v18 offset:0
    v_mfma_f32_16x16x32_bf16 a[16:19], v[104:107], v[60:63], a[16:19]
    ds_read_b64_tr_b16 v[94:95], v18 offset:4096
    ds_read_b64_tr_b16 v[96:97], v19 offset:0
    v_mfma_f32_16x16x32_bf16 a[20:23], v[108:111], v[60:63], a[20:23]
    ds_read_b64_tr_b16 v[98:99], v19 offset:4096
    ds_read_b64_tr_b16 v[100:101], v20 offset:0
    v_mfma_f32_16x16x32_bf16 a[24:27], v[112:115], v[60:63], a[24:27]
    ds_read_b64_tr_b16 v[102:103], v20 offset:4096
    ds_read_b128 v[24:27], v16 offset:0
    v_mfma_f32_16x16x32_bf16 a[28:31], v[116:119], v[60:63], a[28:31]
    ds_read_b128 v[28:31], v16 offset:2048
    ds_read_b128 v[32:35], v16 offset:4096
    v_mfma_f32_16x16x32_bf16 a[32:35], v[104:107], v[64:67], a[32:35]
    ds_read_b128 v[36:39], v16 offset:6144
    v_mfma_f32_16x16x32_bf16 a[36:39], v[108:111], v[64:67], a[36:39]
    v_mfma_f32_16x16x32_bf16 a[40:43], v[112:115], v[64:67], a[40:43]
    v_mfma_f32_16x16x32_bf16 a[44:47], v[116:119], v[64:67], a[44:47]
    v_mfma_f32_16x16x32_bf16 a[48:51], v[104:107], v[68:71], a[48:51]
    v_mfma_f32_16x16x32_bf16 a[52:55], v[108:111], v[68:71], a[52:55]
    v_mfma_f32_16x16x32_bf16 a[56:59], v[112:115], v[68:71], a[56:59]
    v_mfma_f32_16x16x32_bf16 a[60:63], v[116:119], v[68:71], a[60:63]
    s_waitcnt lgkmcnt(0)
    v_mfma_f32_16x16x32_bf16 a[0:3], v[88:91], v[24:27], a[0:3]
    ds_read_b64_tr_b16 v[104:105], v17 offset:8192
    v_mfma_f32_16x16x32_bf16 a[4:7], v[92:95], v[24:27], a[4:7]
    ds_read_b64_tr_b16 v[106:107], v17 offset:12288
    v_mfma_f32_16x16x32_bf16 a[8:11], v[96:99], v[24:27], a[8:11]
    ds_read_b64_tr_b16 v[108:109], v18 offset:8192
    v_mfma_f32_16x16x32_bf16 a[12:15], v[100:103], v[24:27], a[12:15]
    ds_read_b64_tr_b16 v[110:111], v18 offset:12288
    v_mfma_f32_16x16x32_bf16 a[16:19], v[88:91], v[28:31], a[16:19]
    ds_read_b64_tr_b16 v[112:113], v19 offset:8192
    v_mfma_f32_16x16x32_bf16 a[20:23], v[92:95], v[28:31], a[20:23]
    ds_read_b64_tr_b16 v[114:115], v19 offset:12288
    v_mfma_f32_16x16x32_bf16 a[24:27], v[96:99], v[28:31], a[24:27]
    ds_read_b64_tr_b16 v[116:117], v20 offset:8192
    v_mfma_f32_16x16x32_bf16 a[28:31], v[100:103], v[28:31], a[28:31]
    ds_read_b64_tr_b16 v[118:119], v20 offset:12288
    v_mfma_f32_16x16x32_bf16 a[32:35], v[88:91], v[32:35], a[32:35]
    ds_read_b128 v[56:59], v16 offset:1024
    v_mfma_f32_16x16x32_bf16 a[36:39], v[92:95], v[32:35], a[36:39]
    ds_read_b128 v[60:63], v16 offset:3072
    v_mfma_f32_16x16x32_bf16 a[40:43], v[96:99], v[32:35], a[40:43]
    ds_read_b128 v[64:67], v16 offset:5120
    v_mfma_f32_16x16x32_bf16 a[44:47], v[100:103], v[32:35], a[44:47]
    ds_read_b128 v[68:71], v16 offset:7168
    v_mfma_f32_16x16x32_bf16 a[48:51], v[88:91], v[36:39], a[48:51]
    v_mfma_f32_16x16x32_bf16 a[52:55], v[92:95], v[36:39], a[52:55]
    v_mfma_f32_16x16x32_bf16 a[56:59], v[96:99], v[36:39], a[56:59]
    v_mfma_f32_16x16x32_bf16 a[60:63], v[100:103], v[36:39], a[60:63]
    s_waitcnt lgkmcnt(0)
    v_mfma_f32_16x16x32_bf16 a[0:3], v[104:107], v[56:59], a[0:3]
    v_mfma_f32_16x16x32_bf16 a[4:7], v[108:111], v[56:59], a[4:7]
    v_mfma_f32_16x16x32_bf16 a[8:11], v[112:115], v[56:59], a[8:11]
    v_mfma_f32_16x16x32_bf16 a[12:15], v[116:119], v[56:59], a[12:15]
    v_mfma_f32_16x16x32_bf16 a[16:19], v[104:107], v[60:63], a[16:19]
    v_mfma_f32_16x16x32_bf16 a[20:23], v[108:111], v[60:63], a[20:23]
    v_mfma_f32_16x16x32_bf16 a[24:27], v[112:115], v[60:63], a[24:27]
    v_mfma_f32_16x16x32_bf16 a[28:31], v[116:119], v[60:63], a[28:31]
    v_mfma_f32_16x16x32_bf16 a[32:35], v[104:107], v[64:67], a[32:35]
    v_mfma_f32_16x16x32_bf16 a[36:39], v[108:111], v[64:67], a[36:39]
    v_mfma_f32_16x16x32_bf16 a[40:43], v[112:115], v[64:67], a[40:43]
    v_mfma_f32_16x16x32_bf16 a[44:47], v[116:119], v[64:67], a[44:47]
    v_mfma_f32_16x16x32_bf16 a[48:51], v[104:107], v[68:71], a[48:51]
    v_mfma_f32_16x16x32_bf16 a[52:55], v[108:111], v[68:71], a[52:55]
    v_mfma_f32_16x16x32_bf16 a[56:59], v[112:115], v[68:71], a[56:59]
    v_mfma_f32_16x16x32_bf16 a[60:63], v[116:119], v[68:71], a[60:63]
    s_nop 7
    v_bfe_u32 v16, v0, 4, 4
    v_mul_u32_u24 v16, 1280, v16
    v_lshrrev_b32 v17, 8, v0
    v_lshl_add_u32 v16, v17, 4, v16
    s_lshr_b32 s34, s19, 1
    s_mul_i32 s34, s34, 81920
    s_and_b32 s35, s19, 1
    s_lshl_b32 s35, s35, 7
    s_add_u32 s34, s34, s35
    v_add_u32 v16, s34, v16
    v_accvgpr_read_b32 v28, a0
    v_accvgpr_read_b32 v29, a1
    v_accvgpr_read_b32 v30, a2
    v_accvgpr_read_b32 v31, a3
    v_cvt_pk_bf16_f32 v24, v28, v29
    v_cvt_pk_bf16_f32 v25, v30, v31
    v_accvgpr_read_b32 v28, a4
    v_accvgpr_read_b32 v29, a5
    v_accvgpr_read_b32 v30, a6
    v_accvgpr_read_b32 v31, a7
    v_cvt_pk_bf16_f32 v26, v28, v29
    v_cvt_pk_bf16_f32 v27, v30, v31
    global_store_dwordx4 v16, v[24:27], s[28:29] offset:0 sc1
    v_accvgpr_read_b32 v36, a8
    v_accvgpr_read_b32 v37, a9
    v_accvgpr_read_b32 v38, a10
    v_accvgpr_read_b32 v39, a11
    v_cvt_pk_bf16_f32 v32, v36, v37
    v_cvt_pk_bf16_f32 v33, v38, v39
    v_accvgpr_read_b32 v36, a12
    v_accvgpr_read_b32 v37, a13
    v_accvgpr_read_b32 v38, a14
    v_accvgpr_read_b32 v39, a15
    v_cvt_pk_bf16_f32 v34, v36, v37
    v_cvt_pk_bf16_f32 v35, v38, v39
    global_store_dwordx4 v16, v[32:35], s[28:29] offset:64 sc1
    v_add_u32 v16, 20480, v16
    v_accvgpr_read_b32 v44, a16
    v_accvgpr_read_b32 v45, a17
    v_accvgpr_read_b32 v46, a18
    v_accvgpr_read_b32 v47, a19
    v_cvt_pk_bf16_f32 v40, v44, v45
    v_cvt_pk_bf16_f32 v41, v46, v47
    v_accvgpr_read_b32 v44, a20
    v_accvgpr_read_b32 v45, a21
    v_accvgpr_read_b32 v46, a22
    v_accvgpr_read_b32 v47, a23
    v_cvt_pk_bf16_f32 v42, v44, v45
    v_cvt_pk_bf16_f32 v43, v46, v47
    global_store_dwordx4 v16, v[40:43], s[28:29] offset:0 sc1
    v_accvgpr_read_b32 v52, a24
    v_accvgpr_read_b32 v53, a25
    v_accvgpr_read_b32 v54, a26
    v_accvgpr_read_b32 v55, a27
    v_cvt_pk_bf16_f32 v48, v52, v53
    v_cvt_pk_bf16_f32 v49, v54, v55
    v_accvgpr_read_b32 v52, a28
    v_accvgpr_read_b32 v53, a29
    v_accvgpr_read_b32 v54, a30
    v_accvgpr_read_b32 v55, a31
    v_cvt_pk_bf16_f32 v50, v52, v53
    v_cvt_pk_bf16_f32 v51, v54, v55
    global_store_dwordx4 v16, v[48:51], s[28:29] offset:64 sc1
    v_add_u32 v16, 20480, v16
    v_accvgpr_read_b32 v60, a32
    v_accvgpr_read_b32 v61, a33
    v_accvgpr_read_b32 v62, a34
    v_accvgpr_read_b32 v63, a35
    v_cvt_pk_bf16_f32 v56, v60, v61
    v_cvt_pk_bf16_f32 v57, v62, v63
    v_accvgpr_read_b32 v60, a36
    v_accvgpr_read_b32 v61, a37
    v_accvgpr_read_b32 v62, a38
    v_accvgpr_read_b32 v63, a39
    v_cvt_pk_bf16_f32 v58, v60, v61
    v_cvt_pk_bf16_f32 v59, v62, v63
    global_store_dwordx4 v16, v[56:59], s[28:29] offset:0 sc1
    v_accvgpr_read_b32 v68, a40
    v_accvgpr_read_b32 v69, a41
    v_accvgpr_read_b32 v70, a42
    v_accvgpr_read_b32 v71, a43
    v_cvt_pk_bf16_f32 v64, v68, v69
    v_cvt_pk_bf16_f32 v65, v70, v71
    v_accvgpr_read_b32 v68, a44
    v_accvgpr_read_b32 v69, a45
    v_accvgpr_read_b32 v70, a46
    v_accvgpr_read_b32 v71, a47
    v_cvt_pk_bf16_f32 v66, v68, v69
    v_cvt_pk_bf16_f32 v67, v70, v71
    global_store_dwordx4 v16, v[64:67], s[28:29] offset:64 sc1
    v_add_u32 v16, 20480, v16
    v_accvgpr_read_b32 v76, a48
    v_accvgpr_read_b32 v77, a49
    v_accvgpr_read_b32 v78, a50
    v_accvgpr_read_b32 v79, a51
    v_cvt_pk_bf16_f32 v72, v76, v77
    v_cvt_pk_bf16_f32 v73, v78, v79
    v_accvgpr_read_b32 v76, a52
    v_accvgpr_read_b32 v77, a53
    v_accvgpr_read_b32 v78, a54
    v_accvgpr_read_b32 v79, a55
    v_cvt_pk_bf16_f32 v74, v76, v77
    v_cvt_pk_bf16_f32 v75, v78, v79
    global_store_dwordx4 v16, v[72:75], s[28:29] offset:0 sc1
    v_accvgpr_read_b32 v84, a56
    v_accvgpr_read_b32 v85, a57
    v_accvgpr_read_b32 v86, a58
    v_accvgpr_read_b32 v87, a59
    v_cvt_pk_bf16_f32 v80, v84, v85
    v_cvt_pk_bf16_f32 v81, v86, v87
    v_accvgpr_read_b32 v84, a60
    v_accvgpr_read_b32 v85, a61
    v_accvgpr_read_b32 v86, a62
    v_accvgpr_read_b32 v87, a63
    v_cvt_pk_bf16_f32 v82, v84, v85
    v_cvt_pk_bf16_f32 v83, v86, v87
    global_store_dwordx4 v16, v[80:83], s[28:29] offset:64 sc1
    s_waitcnt vmcnt(0)
    s_barrier
    s_cmp_lg_u32 s19, 0
    s_cbranch_scc1 sig_26
    s_mov_b64 exec, 1
    s_lshl_b32 s34, s42, 7
    s_add_u32 s34, s34, 103813120
    v_mov_b32 v124, s34
    v_mov_b32 v125, 1
    global_atomic_add v124, v125, s[14:15] sc1
    s_mov_b64 exec, -1
sig_26:
    s_branch wk_f2
wk_role:
    s_barrier
    s_cmp_lg_u32 s19, 0
    s_cbranch_scc1 ro_f
    s_mov_b64 exec, 1
    v_mov_b32 v124, 16
    s_mov_b32 s50, 0
    s_mov_b32 s43, 0xffff
ro_l:
    global_load_dword v123, v124, s[12:13] sc1
    s_add_u32 s50, s50, 1
    s_cmp_gt_u32 s50, 1048576
    s_cbranch_scc1 wk_fail
    s_waitcnt vmcnt(0)
    v_readfirstlane_b32 s35, v123
    s_cmp_ge_u32 s35, 65536
    s_cbranch_scc1 ro_fb
    s_cmp_ge_u32 s35, 64
    s_cbranch_scc1 ro_go
    s_cmp_lt_u32 s50, 5000
    s_cbranch_scc1 ro_l
    v_or_b32 v122, 65536, v123
    global_atomic_cmpswap v124, v[122:123], s[12:13] sc1
    s_branch ro_l
ro_fb:
    v_mov_b32 v124, 12
    v_mov_b32 v125, 1
    global_atomic_add v126, v124, v125, s[12:13] sc0 sc1
    s_waitcnt vmcnt(0)
    v_readfirstlane_b32 s43, v126
    s_cmp_lt_u32 s43, 64
    s_cbranch_scc1 ro_put
ro_go:
    v_mov_b32 v124, 103815296
    v_mov_b32 v125, 1
    global_atomic_add v126, v124, v125, s[14:15] sc0 sc1
    s_waitcnt vmcnt(0)
    v_readfirstlane_b32 s49, v126
ro_put:
    v_mov_b32 v124, 163776
    s_nop 0
    v_mov_b32 v125, s49
    ds_write_b32 v124, v125 offset:0
    v_mov_b32 v125, s43
    ds_write_b32 v124, v125 offset:4
    s_waitcnt lgkmcnt(0)
    s_mov_b64 exec, -1
ro_f:
    s_barrier
    v_mov_b32 v124, 163776
    ds_read_b32 v125, v124 offset:0
    s_waitcnt lgkmcnt(0)
    v_readfirstlane_b32 s49, v125
    ds_read_b32 v125, v124 offset:4
    s_waitcnt lgkmcnt(0)
    v_readfirstlane_b32 s43, v125
    s_cmp_ge_u32 s43, 64
    s_cbranch_scc1 ro_nochain
    s_lshr_b32 s21, s43, 5
    s_and_b32 s20, s43, 31
    s_mov_b32 s17, 2
    v_mov_b32 v0, v127
    s_branch ch_go
ro_nochain:
    s_cmp_ge_u32 s49, 112
    s_cbranch_scc1 wk_red
    s_and_b32 s51, s49, 15
    s_mov_b32 s50, 0
    s_mov_b32 s55, 255
    s_mov_b32 s53, 15
wk_ao:
    s_barrier
    s_cmp_lg_u32 s19, 0
    s_cbranch_scc1 ao_f
    s_mov_b64 exec, 1
ao_again:
    s_mov_b32 s49, 0xffff
    s_cmp_lg_u32 s53, 15
    s_mov_b32 s53, 15
    s_cbranch_scc1 ao_peek
    s_lshl_b32 s34, s51, 7
    s_add_u32 s34, s34, 103839744
    v_mov_b32 v124, s34
    v_mov_b32 v125, 1
    global_atomic_add v126, v124, v125, s[14:15] sc0 sc1
    s_waitcnt vmcnt(0)
    v_readfirstlane_b32 s49, v126
    s_cmp_lt_u32 s49, 66
    s_cbranch_scc1 ao_have
ao_peek:
    s_mov_b64 exec, 0xffff
    v_and_b32 v124, 15, v127
    v_lshlrev_b32 v124, 7, v124
    v_add_u32 v124, 103839744, v124
    global_load_dword v125, v124, s[14:15] sc1
    s_waitcnt vmcnt(0)
    v_cmp_gt_u32 vcc, 66, v125
    s_mov_b64 exec, 1
    s_cbranch_vccz ao_put
    s_bitcmp1_b32 vcc_lo, s51
    s_cbranch_scc1 ao_again
    s_add_u32 s50, s50, 1
    s_cmp_lt_u32 s50, 40
    s_cbranch_scc1 ao_peek
    s_ff1_i32_b32 s51, vcc_lo
    s_branch ao_again
ao_have:
    s_min_u32 s52, s49, 63
    s_lshr_b32 s34, s52, 3
    s_lshl_b32 s34, s34, 7
    s_add_u32 s34, s34, 103810048
    v_mov_b32 v124, s34
poll_27:
    global_load_dword v125, v124, s[14:15] sc1
    s_add_u32 s54, s54, 1
    s_cmp_gt_u32 s54, 1048576
    s_cbranch_scc1 wk_fail
    s_waitcnt vmcnt(0)
    v_readfirstlane_b32 s35, v125
    s_cmp_ge_u32 s35, 64
    s_cbranch_scc1 poll_27_ok
    s_sleep 2
    s_branch poll_27
poll_27_ok:
    s_lshr_b32 s34, s52, 3
    s_lshl_b32 s34, s34, 7
    s_add_u32 s34, s34, 103811072
    v_mov_b32 v124, s34
poll_28:
    global_load_dword v125, v124, s[14:15] sc1
    s_add_u32 s54, s54, 1
    s_cmp_gt_u32 s54, 1048576
    s_cbranch_scc1 wk_fail
    s_waitcnt vmcnt(0)
    v_readfirstlane_b32 s35, v125
    s_cmp_ge_u32 s35, 32
    s_cbranch_scc1 poll_28_ok
    s_sleep 2
    s_branch poll_28
poll_28_ok:
ao_put:
    v_mov_b32 v124, 163776
    v_mov_b32 v125, s49
    ds_write_b32 v124, v125 offset:0
    v_mov_b32 v125, s51
    ds_write_b32 v124, v125 offset:4
    s_waitcnt lgkmcnt(0)
    s_mov_b64 exec, -1
ao_f:
    s_barrier
    v_mov_b32 v124, 163776
    ds_read_b32 v125, v124 offset:0
    s_waitcnt lgkmcnt(0)
    v_readfirstlane_b32 s49, v125
    ds_read_b32 v125, v124 offset:4
    s_waitcnt lgkmcnt(0)
    v_readfirstlane_b32 s51, v125
    s_cmp_ge_u32 s49, 66
    s_cbranch_scc1 wk_red
    s_mov_b32 s52, s49
    s_mov_b32 s53, 15
    s_cmp_lt_u32 s49, 62
    s_cbranch_scc1 ao_whole
    s_sub_u32 s49, s49, 62
    s_lshr_b32 s52, s49, 1
    s_add_u32 s52, s52, 62
    s_and_b32 s49, s49, 1
    s_lshl_b32 s49, s49, 1
    s_lshl_b32 s53, 3, s49
ao_whole:
    s_cmp_eq_u32 s55, s51
    s_cbranch_scc1 ao_loaded
    s_load_dwordx2 s[4:5], s[0:1], 40
    s_mov_b32 s55, s51
    s_waitcnt lgkmcnt(0)
    v_and_b32 v1, 63, v127
    v_and_b32 v2, 15, v1
    v_lshrrev_b32 v3, 4, v1
    v_lshlrev_b32 v4, 1, v3
    v_xor_b32 v4, v4, v2
    s_lshl_b32 s34, s19, 4
    s_add_u32 s34, s34, 0
    v_add_u32 v5, s34, v3
    v_mul_u32_u24 v5, 1280, v5
    v_lshl_add_u32 v8, v4, 4, v5
    v_lshlrev_b32 v4, 1, v3
    v_xor_b32 v4, v4, v2
    v_xor_b32 v4, 8, v4
    s_lshl_b32 s34, s19, 4
    s_add_u32 s34, s34, 4
    v_add_u32 v5, s34, v3
    v_mul_u32_u24 v5, 1280, v5
    v_lshl_add_u32 v9, v4, 4, v5
    v_lshlrev_b32 v4, 1, v3
    v_xor_b32 v4, v4, v2
    s_lshl_b32 s34, s19, 4
    s_add_u32 s34, s34, 8
    v_add_u32 v5, s34, v3
    v_mul_u32_u24 v5, 1280, v5
    v_lshl_add_u32 v10, v4, 4, v5
    v_lshlrev_b32 v4, 1, v3
    v_xor_b32 v4, v4, v2
    v_xor_b32 v4, 8, v4
    s_lshl_b32 s34, s19, 4
    s_add_u32 s34, s34, 12
    v_add_u32 v5, s34, v3
    v_mul_u32_u24 v5, 1280, v5
    v_lshl_add_u32 v11, v4, 4, v5
    v_lshrrev_b32 v4, 2, v2
    v_lshl_add_u32 v4, v3, 2, v4
    v_and_b32 v5, 7, v4
    v_lshlrev_b32 v5, 1, v5
    v_and_b32 v6, 3, v2
    s_lshl_b32 s34, s19, 2
    v_add_u32 v6, s34, v6
    v_xor_b32 v6, v6, v5
    v_lshlrev_b32 v6, 4, v6
    v_lshl_add_u32 v12, v4, 8, v6
    s_mul_i32 s34, s51, 327680
    s_add_u32 s8, s4, s34
    s_addc_u32 s9, s5, 0
    s_lshl_b32 s36, s19, 12
    s_add_u32 s10, s8, 0
    s_addc_u32 s11, s9, 0
    s_add_u32 m0, s36, 0
    s_nop 0
    global_load_lds_dwordx4 v8, s[10:11]
    s_add_u32 m0, s36, 1024
    s_nop 0
    global_load_lds_dwordx4 v9, s[10:11]
    s_add_u32 m0, s36, 2048
    s_nop 0
    global_load_lds_dwordx4 v10, s[10:11]
    s_add_u32 m0, s36, 3072
    s_nop 0
    global_load_lds_dwordx4 v11, s[10:11]
    s_add_u32 s10, s8, 256
    s_addc_u32 s11, s9, 0
    s_add_u32 m0, s36, 16384
    s_nop 0
    global_load_lds_dwordx4 v8, s[10:11]
    s_add_u32 m0, s36, 17408
    s_nop 0
    global_load_lds_dwordx4 v9, s[10:11]
    s_add_u32 m0, s36, 18432
    s_nop 0
    global_load_lds_dwordx4 v10, s[10:11]
    s_add_u32 m0, s36, 19456
    s_nop 0
    global_load_lds_dwordx4 v11, s[10:11]
    s_add_u32 s10, s8, 512
    s_addc_u32 s11, s9, 0
    s_add_u32 m0, s36, 32768
    s_nop 0
    global_load_lds_dwordx4 v8, s[10:11]
    s_add_u32 m0, s36, 33792
    s_nop 0
    global_load_lds_dwordx4 v9, s[10:11]
    s_add_u32 m0, s36, 34816
    s_nop 0
    global_load_lds_dwordx4 v10, s[10:11]
    s_add_u32 m0, s36, 35840
    s_nop 0
    global_load_lds_dwordx4 v11, s[10:11]
    s_add_u32 s10, s8, 768
    s_addc_u32 s11, s9, 0
    s_add_u32 m0, s36, 49152
    s_nop 0
    global_load_lds_dwordx4 v8, s[10:11]
    s_add_u32 m0, s36, 50176
    s_nop 0
    global_load_lds_dwordx4 v9, s[10:11]
    s_add_u32 m0, s36, 51200
    s_nop 0
    global_load_lds_dwordx4 v10, s[10:11]
    s_add_u32 m0, s36, 52224
    s_nop 0
    global_load_lds_dwordx4 v11, s[10:11]
    s_add_u32 s10, s8, 1024
    s_addc_u32 s11, s9, 0
    s_add_u32 m0, s36, 65536
    s_nop 0
    global_load_lds_dwordx4 v8, s[10:11]
    s_add_u32 m0, s36, 66560
    s_nop 0
    global_load_lds_dwordx4 v9, s[10:11]
    s_add_u32 m0, s36, 67584
    s_nop 0
    global_load_lds_dwordx4 v10, s[10:11]
    s_add_u32 m0, s36, 68608
    s_nop 0
    global_load_lds_dwordx4 v11, s[10:11]
    s_add_u32 s10, s8, 81920
    s_addc_u32 s11, s9, 0
    s_add_u32 m0, s36, 81920
    s_nop 0
    global_load_lds_dwordx4 v8, s[10:11]
    s_add_u32 m0, s36, 82944
    s_nop 0
    global_load_lds_dwordx4 v9, s[10:11]
    s_add_u32 m0, s36, 83968
    s_nop 0
    global_load_lds_dwordx4 v10, s[10:11]
    s_add_u32 m0, s36, 84992
    s_nop 0
    global_load_lds_dwordx4 v11, s[10:11]
    s_add_u32 s10, s8, 82176
    s_addc_u32 s11, s9, 0
    s_add_u32 m0, s36, 98304
    s_nop 0
    global_load_lds_dwordx4 v8, s[10:11]
    s_add_u32 m0, s36, 99328
    s_nop 0
    global_load_lds_dwordx4 v9, s[10:11]
    s_add_u32 m0, s36, 100352
    s_nop 0
    global_load_lds_dwordx4 v10, s[10:11]
    s_add_u32 m0, s36, 101376
    s_nop 0
    global_load_lds_dwordx4 v11, s[10:11]
    s_add_u32 s10, s8, 82432
    s_addc_u32 s11, s9, 0
    s_add_u32 m0, s36, 114688
    s_nop 0
    global_load_lds_dwordx4 v8, s[10:11]
    s_add_u32 m0, s36, 115712
    s_nop 0
    global_load_lds_dwordx4 v9, s[10:11]
    s_add_u32 m0, s36, 116736
    s_nop 0
    global_load_lds_dwordx4 v10, s[10:11]
    s_add_u32 m0, s36, 117760
    s_nop 0
    global_load_lds_dwordx4 v11, s[10:11]
    s_waitcnt vmcnt(28)
    s_barrier
    s_add_u32 s10, s8, 82688
    s_addc_u32 s11, s9, 0
    s_add_u32 m0, s36, 131072
    s_nop 0
    global_load_lds_dwordx4 v8, s[10:11]
    s_add_u32 m0, s36, 132096
    s_nop 0
    global_load_lds_dwordx4 v9, s[10:11]
    s_add_u32 m0, s36, 133120
    s_nop 0
    global_load_lds_dwordx4 v10, s[10:11]
    s_add_u32 m0, s36, 134144
    s_nop 0
    global_load_lds_dwordx4 v11, s[10:11]
    v_add_u32 v13, 0, v12
    ds_read_b64_tr_b16 a[0:1], v13 offset:0
    ds_read_b64_tr_b16 a[2:3], v13 offset:4096
    ds_read_b64_tr_b16 a[4:5], v13 offset:8
    ds_read_b64_tr_b16 a[6:7], v13 offset:4104
    ds_read_b64_tr_b16 a[40:41], v13 offset:8192
    ds_read_b64_tr_b16 a[42:43], v13 offset:12288
    ds_read_b64_tr_b16 a[44:45], v13 offset:8200
    ds_read_b64_tr_b16 a[46:47], v13 offset:12296
    s_waitcnt lgkmcnt(0)
    s_waitcnt vmcnt(28)
    s_barrier
    s_add_u32 s10, s8, 82944
    s_addc_u32 s11, s9, 0
    s_add_u32 m0, s36, 0
    s_nop 0
    global_load_lds_dwordx4 v8, s[10:11]
    s_add_u32 m0, s36, 1024
    s_nop 0
    global_load_lds_dwordx4 v9, s[10:11]
    s_add_u32 m0, s36, 2048
    s_nop 0
    global_load_lds_dwordx4 v10, s[10:11]
    s_add_u32 m0, s36, 3072
    s_nop 0
    global_load_lds_dwordx4 v11, s[10:11]
    v_add_u32 v13, 16384, v12
    ds_read_b64_tr_b16 a[8:9], v13 offset:0
    ds_read_b64_tr_b16 a[10:11], v13 offset:4096
    ds_read_b64_tr_b16 a[12:13], v13 offset:8
    ds_read_b64_tr_b16 a[14:15], v13 offset:4104
    ds_read_b64_tr_b16 a[48:49], v13 offset:8192
    ds_read_b64_tr_b16 a[50:51], v13 offset:12288
    ds_read_b64_tr_b16 a[52:53], v13 offset:8200
    ds_read_b64_tr_b16 a[54:55], v13 offset:12296
    s_waitcnt lgkmcnt(0)
    s_waitcnt vmcnt(28)
    s_barrier
    s_add_u32 s10, s8, 163840
    s_addc_u32 s11, s9, 0
    s_add_u32 m0, s36, 16384
    s_nop 0
    global_load_lds_dwordx4 v8, s[10:11]
    s_add_u32 m0, s36, 17408
    s_nop 0
    global_load_lds_dwordx4 v9, s[10:11]
    s_add_u32 m0, s36, 18432
    s_nop 0
    global_load_lds_dwordx4 v10, s[10:11]
    s_add_u32 m0, s36, 19456
    s_nop 0
    global_load_lds_dwordx4 v11, s[10:11]
    v_add_u32 v13, 32768, v12
    ds_read_b64_tr_b16 a[16:17], v13 offset:0
    ds_read_b64_tr_b16 a[18:19], v13 offset:4096
    ds_read_b64_tr_b16 a[20:21], v13 offset:8
    ds_read_b64_tr_b16 a[22:23], v13 offset:4104
    ds_read_b64_tr_b16 a[56:57], v13 offset:8192
    ds_read_b64_tr_b16 a[58:59], v13 offset:12288
    ds_read_b64_tr_b16 a[60:61], v13 offset:8200
    ds_read_b64_tr_b16 a[62:63], v13 offset:12296
    s_waitcnt lgkmcnt(0)
    s_waitcnt vmcnt(28)
    s_barrier
    s_add_u32 s10, s8, 164096
    s_addc_u32 s11, s9, 0
    s_add_u32 m0, s36, 32768
    s_nop 0
    global_load_lds_dwordx4 v8, s[10:11]
    s_add_u32 m0, s36, 33792
    s_nop 0
    global_load_lds_dwordx4 v9, s[10:11]
    s_add_u32 m0, s36, 34816
    s_nop 0
    global_load_lds_dwordx4 v10, s[10:11]
    s_add_u32 m0, s36, 35840
    s_nop 0
    global_load_lds_dwordx4 v11, s[10:11]
    v_add_u32 v13, 49152, v12
    ds_read_b64_tr_b16 a[24:25], v13 offset:0
    ds_read_b64_tr_b16 a[26:27], v13 offset:4096
    ds_read_b64_tr_b16 a[28:29], v13 offset:8
    ds_read_b64_tr_b16 a[30:31], v13 offset:4104
    ds_read_b64_tr_b16 a[64:65], v13 offset:8192
    ds_read_b64_tr_b16 a[66:67], v13 offset:12288
    ds_read_b64_tr_b16 a[68:69], v13 offset:8200
    ds_read_b64_tr_b16 a[70:71], v13 offset:12296
    s_waitcnt lgkmcnt(0)
    s_waitcnt vmcnt(28)
    s_barrier
    s_add_u32 s10, s8, 164352
    s_addc_u32 s11, s9, 0
    s_add_u32 m0, s36, 49152
    s_nop 0
    global_load_lds_dwordx4 v8, s[10:11]
    s_add_u32 m0, s36, 50176
    s_nop 0
    global_load_lds_dwordx4 v9, s[10:11]
    s_add_u32 m0, s36, 51200
    s_nop 0
    global_load_lds_dwordx4 v10, s[10:11]
    s_add_u32 m0, s36, 52224
    s_nop 0
    global_load_lds_dwordx4 v11, s[10:11]
    v_add_u32 v13, 65536, v12
    ds_read_b64_tr_b16 a[32:33], v13 offset:0
    ds_read_b64_tr_b16 a[34:35], v13 offset:4096
    ds_read_b64_tr_b16 a[36:37], v13 offset:8
    ds_read_b64_tr_b16 a[38:39], v13 offset:4104
    ds_read_b64_tr_b16 a[72:73], v13 offset:8192
    ds_read_b64_tr_b16 a[74:75], v13 offset:12288
    ds_read_b64_tr_b16 a[76:77], v13 offset:8200
    ds_read_b64_tr_b16 a[78:79], v13 offset:12296
    s_waitcnt lgkmcnt(0)
    s_waitcnt vmcnt(28)
    s_barrier
    s_add_u32 s10, s8, 164608
    s_addc_u32 s11, s9, 0
    s_add_u32 m0, s36, 65536
    s_nop 0
    global_load_lds_dwordx4 v8, s[10:11]
    s_add_u32 m0, s36, 66560
    s_nop 0
    global_load_lds_dwordx4 v9, s[10:11]
    s_add_u32 m0, s36, 67584
    s_nop 0
    global_load_lds_dwordx4 v10, s[10:11]
    s_add_u32 m0, s36, 68608
    s_nop 0
    global_load_lds_dwordx4 v11, s[10:11]
    v_add_u32 v13, 81920, v12
    ds_read_b64_tr_b16 a[80:81], v13 offset:0
    ds_read_b64_tr_b16 a[82:83], v13 offset:4096
    ds_read_b64_tr_b16 a[84:85], v13 offset:8
    ds_read_b64_tr_b16 a[86:87], v13 offset:4104
    ds_read_b64_tr_b16 a[120:121], v13 offset:8192
    ds_read_b64_tr_b16 a[122:123], v13 offset:12288
    ds_read_b64_tr_b16 a[124:125], v13 offset:8200
    ds_read_b64_tr_b16 a[126:127], v13 offset:12296
    s_waitcnt lgkmcnt(0)
    s_waitcnt vmcnt(28)
    s_barrier
    s_add_u32 s10, s8, 164864
    s_addc_u32 s11, s9, 0
    s_add_u32 m0, s36, 81920
    s_nop 0
    global_load_lds_dwordx4 v8, s[10:11]
    s_add_u32 m0, s36, 82944
    s_nop 0
    global_load_lds_dwordx4 v9, s[10:11]
    s_add_u32 m0, s36, 83968
    s_nop 0
    global_load_lds_dwordx4 v10, s[10:11]
    s_add_u32 m0, s36, 84992
    s_nop 0
    global_load_lds_dwordx4 v11, s[10:11]
    v_add_u32 v13, 98304, v12
    ds_read_b64_tr_b16 a[88:89], v13 offset:0
    ds_read_b64_tr_b16 a[90:91], v13 offset:4096
    ds_read_b64_tr_b16 a[92:93], v13 offset:8
    ds_read_b64_tr_b16 a[94:95], v13 offset:4104
    ds_read_b64_tr_b16 a[128:129], v13 offset:8192
    ds_read_b64_tr_b16 a[130:131], v13 offset:12288
    ds_read_b64_tr_b16 a[132:133], v13 offset:8200
    ds_read_b64_tr_b16 a[134:135], v13 offset:12296
    s_waitcnt lgkmcnt(0)
    s_waitcnt vmcnt(28)
    s_barrier
    s_add_u32 s10, s8, 245760
    s_addc_u32 s11, s9, 0
    s_add_u32 m0, s36, 98304
    s_nop 0
    global_load_lds_dwordx4 v8, s[10:11]
    s_add_u32 m0, s36, 99328
    s_nop 0
    global_load_lds_dwordx4 v9, s[10:11]
    s_add_u32 m0, s36, 100352
    s_nop 0
    global_load_lds_dwordx4 v10, s[10:11]
    s_add_u32 m0, s36, 101376
    s_nop 0
    global_load_lds_dwordx4 v11, s[10:11]
    v_add_u32 v13, 114688, v12
    ds_read_b64_tr_b16 a[96:97], v13 offset:0
    ds_read_b64_tr_b16 a[98:99], v13 offset:4096
    ds_read_b64_tr_b16 a[100:101], v13 offset:8
    ds_read_b64_tr_b16 a[102:103], v13 offset:4104
    ds_read_b64_tr_b16 a[136:137], v13 offset:8192
    ds_read_b64_tr_b16 a[138:139], v13 offset:12288
    ds_read_b64_tr_b16 a[140:141], v13 offset:8200
    ds_read_b64_tr_b16 a[142:143], v13 offset:12296
    s_waitcnt lgkmcnt(0)
    s_waitcnt vmcnt(28)
    s_barrier
    s_add_u32 s10, s8, 246016
    s_addc_u32 s11, s9, 0
    s_add_u32 m0, s36, 114688
    s_nop 0
    global_load_lds_dwordx4 v8, s[10:11]
    s_add_u32 m0, s36, 115712
    s_nop 0
    global_load_lds_dwordx4 v9, s[10:11]
    s_add_u32 m0, s36, 116736
    s_nop 0
    global_load_lds_dwordx4 v10, s[10:11]
    s_add_u32 m0, s36, 117760
    s_nop 0
    global_load_lds_dwordx4 v11, s[10:11]
    v_add_u32 v13, 131072, v12
    ds_read_b64_tr_b16 a[104:105], v13 offset:0
    ds_read_b64_tr_b16 a[106:107], v13 offset:4096
    ds_read_b64_tr_b16 a[108:109], v13 offset:8
    ds_read_b64_tr_b16 a[110:111], v13 offset:4104
    ds_read_b64_tr_b16 a[144:145], v13 offset:8192
    ds_read_b64_tr_b16 a[146:147], v13 offset:12288
    ds_read_b64_tr_b16 a[148:149], v13 offset:8200
    ds_read_b64_tr_b16 a[150:151], v13 offset:12296
    s_waitcnt lgkmcnt(0)
    s_waitcnt vmcnt(28)
    s_barrier
    s_add_u32 s10, s8, 246272
    s_addc_u32 s11, s9, 0
    s_add_u32 m0, s36, 131072
    s_nop 0
    global_load_lds_dwordx4 v8, s[10:11]
    s_add_u32 m0, s36, 132096
    s_nop 0
    global_load_lds_dwordx4 v9, s[10:11]
    s_add_u32 m0, s36, 133120
    s_nop 0
    global_load_lds_dwordx4 v10, s[10:11]
    s_add_u32 m0, s36, 134144
    s_nop 0
    global_load_lds_dwordx4 v11, s[10:11]
    v_add_u32 v13, 0, v12
    ds_read_b64_tr_b16 a[112:113], v13 offset:0
    ds_read_b64_tr_b16 a[114:115], v13 offset:4096
    ds_read_b64_tr_b16 a[116:117], v13 offset:8
    ds_read_b64_tr_b16 a[118:119], v13 offset:4104
    ds_read_b64_tr_b16 a[152:153], v13 offset:8192
    ds_read_b64_tr_b16 a[154:155], v13 offset:12288
    ds_read_b64_tr_b16 a[156:157], v13 offset:8200
    ds_read_b64_tr_b16 a[158:159], v13 offset:12296
    s_waitcnt lgkmcnt(0)
    s_waitcnt vmcnt(28)
    s_barrier
    s_add_u32 s10, s8, 246528
    s_addc_u32 s11, s9, 0
    s_add_u32 m0, s36, 0
    s_nop 0
    global_load_lds_dwordx4 v8, s[10:11]
    s_add_u32 m0, s36, 1024
    s_nop 0
    global_load_lds_dwordx4 v9, s[10:11]
    s_add_u32 m0, s36, 2048
    s_nop 0
    global_load_lds_dwordx4 v10, s[10:11]
    s_add_u32 m0, s36, 3072
    s_nop 0
    global_load_lds_dwordx4 v11, s[10:11]
    v_add_u32 v13, 16384, v12
    ds_read_b64_tr_b16 a[160:161], v13 offset:0
    ds_read_b64_tr_b16 a[162:163], v13 offset:4096
    ds_read_b64_tr_b16 a[164:165], v13 offset:8
    ds_read_b64_tr_b16 a[166:167], v13 offset:4104
    ds_read_b64_tr_b16 a[200:201], v13 offset:8192
    ds_read_b64_tr_b16 a[202:203], v13 offset:12288
    ds_read_b64_tr_b16 a[204:205], v13 offset:8200
    ds_read_b64_tr_b16 a[206:207], v13 offset:12296
    s_waitcnt lgkmcnt(0)
    s_waitcnt vmcnt(28)
    s_barrier
    s_add_u32 s10, s8, 246784
    s_addc_u32 s11, s9, 0
    s_add_u32 m0, s36, 16384
    s_nop 0
    global_load_lds_dwordx4 v8, s[10:11]
    s_add_u32 m0, s36, 17408
    s_nop 0
    global_load_lds_dwordx4 v9, s[10:11]
    s_add_u32 m0, s36, 18432
    s_nop 0
    global_load_lds_dwordx4 v10, s[10:11]
    s_add_u32 m0, s36, 19456
    s_nop 0
    global_load_lds_dwordx4 v11, s[10:11]
    v_add_u32 v13, 32768, v12
    ds_read_b64_tr_b16 a[168:169], v13 offset:0
    ds_read_b64_tr_b16 a[170:171], v13 offset:4096
    ds_read_b64_tr_b16 a[172:173], v13 offset:8
    ds_read_b64_tr_b16 a[174:175], v13 offset:4104
    ds_read_b64_tr_b16 a[208:209], v13 offset:8192
    ds_read_b64_tr_b16 a[210:211], v13 offset:12288
    ds_read_b64_tr_b16 a[212:213], v13 offset:8200
    ds_read_b64_tr_b16 a[214:215], v13 offset:12296
    s_waitcnt lgkmcnt(0)
    s_waitcnt vmcnt(28)
    s_barrier
    v_add_u32 v13, 49152, v12
    ds_read_b64_tr_b16 a[176:177], v13 offset:0
    ds_read_b64_tr_b16 a[178:179], v13 offset:4096
    ds_read_b64_tr_b16 a[180:181], v13 offset:8
    ds_read_b64_tr_b16 a[182:183], v13 offset:4104
    ds_read_b64_tr_b16 a[216:217], v13 offset:8192
    ds_read_b64_tr_b16 a[218:219], v13 offset:12288
    ds_read_b64_tr_b16 a[220:221], v13 offset:8200
    ds_read_b64_tr_b16 a[222:223], v13 offset:12296
    s_waitcnt lgkmcnt(0)
    s_waitcnt vmcnt(24)
    s_barrier
    v_add_u32 v13, 65536, v12
    ds_read_b64_tr_b16 a[184:185], v13 offset:0
    ds_read_b64_tr_b16 a[186:187], v13 offset:4096
    ds_read_b64_tr_b16 a[188:189], v13 offset:8
    ds_read_b64_tr_b16 a[190:191], v13 offset:4104
    ds_read_b64_tr_b16 a[224:225], v13 offset:8192
    ds_read_b64_tr_b16 a[226:227], v13 offset:12288
    ds_read_b64_tr_b16 a[228:229], v13 offset:8200
    ds_read_b64_tr_b16 a[230:231], v13 offset:12296
    s_waitcnt lgkmcnt(0)
    s_waitcnt vmcnt(20)
    s_barrier
    v_add_u32 v13, 81920, v12
    ds_read_b64_tr_b16 a[192:193], v13 offset:0
    ds_read_b64_tr_b16 a[194:195], v13 offset:4096
    ds_read_b64_tr_b16 a[196:197], v13 offset:8
    ds_read_b64_tr_b16 a[198:199], v13 offset:4104
    ds_read_b64_tr_b16 a[232:233], v13 offset:8192
    ds_read_b64_tr_b16 a[234:235], v13 offset:12288
    ds_read_b64_tr_b16 a[236:237], v13 offset:8200
    ds_read_b64_tr_b16 a[238:239], v13 offset:12296
    s_waitcnt lgkmcnt(0)
    s_waitcnt vmcnt(16)
    s_barrier
    v_add_u32 v13, 98304, v12
    ds_read_b64_tr_b16 a[240:241], v13 offset:0
    ds_read_b64_tr_b16 a[242:243], v13 offset:4096
    ds_read_b64_tr_b16 a[244:245], v13 offset:8
    ds_read_b64_tr_b16 a[246:247], v13 offset:4104
    ds_read_b64_tr_b16 v[216:217], v13 offset:8192
    ds_read_b64_tr_b16 v[218:219], v13 offset:12288
    ds_read_b64_tr_b16 v[220:221], v13 offset:8200
    ds_read_b64_tr_b16 v[222:223], v13 offset:12296
    s_waitcnt lgkmcnt(0)
    s_waitcnt vmcnt(12)
    s_barrier
    v_add_u32 v13, 114688, v12
    ds_read_b64_tr_b16 a[248:249], v13 offset:0
    ds_read_b64_tr_b16 a[250:251], v13 offset:4096
    ds_read_b64_tr_b16 a[252:253], v13 offset:8
    ds_read_b64_tr_b16 a[254:255], v13 offset:4104
    ds_read_b64_tr_b16 v[224:225], v13 offset:8192
    ds_read_b64_tr_b16 v[226:227], v13 offset:12288
    ds_read_b64_tr_b16 v[228:229], v13 offset:8200
    ds_read_b64_tr_b16 v[230:231], v13 offset:12296
    s_waitcnt lgkmcnt(0)
    s_waitcnt vmcnt(8)
    s_barrier
    v_add_u32 v13, 131072, v12
    ds_read_b64_tr_b16 v[192:193], v13 offset:0
    ds_read_b64_tr_b16 v[194:195], v13 offset:4096
    ds_read_b64_tr_b16 v[196:197], v13 offset:8
    ds_read_b64_tr_b16 v[198:199], v13 offset:4104
    ds_read_b64_tr_b16 v[232:233], v13 offset:8192
    ds_read_b64_tr_b16 v[234:235], v13 offset:12288
    ds_read_b64_tr_b16 v[236:237], v13 offset:8200
    ds_read_b64_tr_b16 v[238:239], v13 offset:12296
    s_waitcnt lgkmcnt(0)
    s_waitcnt vmcnt(4)
    s_barrier
    v_add_u32 v13, 0, v12
    ds_read_b64_tr_b16 v[200:201], v13 offset:0
    ds_read_b64_tr_b16 v[202:203], v13 offset:4096
    ds_read_b64_tr_b16 v[204:205], v13 offset:8
    ds_read_b64_tr_b16 v[206:207], v13 offset:4104
    ds_read_b64_tr_b16 v[240:241], v13 offset:8192
    ds_read_b64_tr_b16 v[242:243], v13 offset:12288
    ds_read_b64_tr_b16 v[244:245], v13 offset:8200
    ds_read_b64_tr_b16 v[246:247], v13 offset:12296
    s_waitcnt lgkmcnt(0)
    s_waitcnt vmcnt(0)
    s_barrier
    v_add_u32 v13, 16384, v12
    ds_read_b64_tr_b16 v[208:209], v13 offset:0
    ds_read_b64_tr_b16 v[210:211], v13 offset:4096
    ds_read_b64_tr_b16 v[212:213], v13 offset:8
    ds_read_b64_tr_b16 v[214:215], v13 offset:4104
    ds_read_b64_tr_b16 v[248:249], v13 offset:8192
    ds_read_b64_tr_b16 v[250:251], v13 offset:12288
    ds_read_b64_tr_b16 v[252:253], v13 offset:8200
    ds_read_b64_tr_b16 v[254:255], v13 offset:12296
    s_waitcnt lgkmcnt(0)
    s_barrier
ao_loaded:
    v_and_b32 v1, 63, v127
    v_lshlrev_b32 v0, 4, v1
    s_lshl_b32 s34, s52, 5
    s_lshl_b32 s35, s51, 1
    s_add_u32 s34, s34, s35
    s_lshr_b32 s35, s19, 1
    s_add_u32 s34, s34, s35
    s_lshl_b32 s35, s34, 13
    s_add_u32 s35, s35, 4096
    v_add_u32 v2, s35, v0
    v_add_u32 v4, 16777216, v2
    s_and_b32 s36, s19, 1
    s_lshl_b32 s35, s36, 12
    s_add_u32 s35, s35, 33550336
    v_add_u32 v3, s35, v2
    global_load_dwordx4 v[8:11], v3, s[14:15] offset:0 sc1
    global_load_dwordx4 v[12:15], v3, s[14:15] offset:1024 sc1
    global_load_dwordx4 v[16:19], v3, s[14:15] offset:2048 sc1
    global_load_dwordx4 v[20:23], v3, s[14:15] offset:3072 sc1
    global_load_dwordx4 v[24:27], v2, s[14:15] offset:-4096 sc1
    global_load_dwordx4 v[28:31], v2, s[14:15] offset:-3072 sc1
    global_load_dwordx4 v[32:35], v2, s[14:15] offset:-2048 sc1
    global_load_dwordx4 v[36:39], v2, s[14:15] offset:-1024 sc1
    global_load_dwordx4 v[40:43], v2, s[14:15] offset:0 sc1
    global_load_dwordx4 v[44:47], v2, s[14:15] offset:1024 sc1
    global_load_dwordx4 v[48:51], v2, s[14:15] offset:2048 sc1
    global_load_dwordx4 v[52:55], v2, s[14:15] offset:3072 sc1
    global_load_dwordx4 v[56:59], v4, s[14:15] offset:-4096 sc1
    global_load_dwordx4 v[60:63], v4, s[14:15] offset:-3072 sc1
    global_load_dwordx4 v[64:67], v4, s[14:15] offset:-2048 sc1
    global_load_dwordx4 v[68:71], v4, s[14:15] offset:-1024 sc1
    global_load_dwordx4 v[72:75], v4, s[14:15] offset:0 sc1
    global_load_dwordx4 v[76:79], v4, s[14:15] offset:1024 sc1
    global_load_dwordx4 v[80:83], v4, s[14:15] offset:2048 sc1
    global_load_dwordx4 v[84:87], v4, s[14:15] offset:3072 sc1
    s_lshl_b32 s35, s34, 12
    v_add_u32 v5, s35, v0
    v_add_u32 v5, 83886080, v5
    s_add_u32 s35, s35, 218103808
    v_lshrrev_b32 v6, 1, v0
    v_add_u32 v6, s35, v6
    v_and_b32 v2, 15, v1
    v_lshrrev_b32 v3, 4, v1
    v_lshlrev_b32 v3, 2, v3
    v_sub_u32 v2, v2, v3
    s_lshl_b32 s36, s36, 4
    v_add_u32 v2, s36, v2
    s_waitcnt vmcnt(8)
    v_mfma_f32_16x16x32_bf16 v[112:115], v[24:27], v[8:11], 0
    v_mfma_f32_16x16x32_bf16 v[112:115], v[28:31], v[12:15], v[112:115]
    v_mfma_f32_16x16x32_bf16 v[112:115], v[32:35], v[16:19], v[112:115]
    v_mfma_f32_16x16x32_bf16 v[112:115], v[36:39], v[20:23], v[112:115]
    v_mfma_f32_16x16x32_bf16 v[116:119], v[40:43], v[8:11], 0
    v_mfma_f32_16x16x32_bf16 v[116:119], v[44:47], v[12:15], v[116:119]
    v_mfma_f32_16x16x32_bf16 v[116:119], v[48:51], v[16:19], v[116:119]
    v_mfma_f32_16x16x32_bf16 v[116:119], v[52:55], v[20:23], v[116:119]
    s_nop 3
    v_cvt_pk_bf16_f32 v24, v112, v113
    v_lshlrev_b32 v112, 16, v24
    v_and_b32 v113, 0xffff0000, v24
    v_mul_f32 v112, 1035273459, v112
    v_mul_f32 v113, 1035273459, v113
    v_cvt_pk_bf16_f32 v24, v112, v113
    v_lshlrev_b32 v112, 16, v24
    v_and_b32 v113, 0xffff0000, v24
    v_cvt_pk_bf16_f32 v24, v114, v115
    v_lshlrev_b32 v114, 16, v24
    v_and_b32 v115, 0xffff0000, v24
    v_mul_f32 v114, 1035273459, v114
    v_mul_f32 v115, 1035273459, v115
    v_cvt_pk_bf16_f32 v24, v114, v115
    v_lshlrev_b32 v114, 16, v24
    v_and_b32 v115, 0xffff0000, v24
    v_cvt_pk_bf16_f32 v24, v116, v117
    v_lshlrev_b32 v116, 16, v24
    v_and_b32 v117, 0xffff0000, v24
    v_mul_f32 v116, 1035273459, v116
    v_mul_f32 v117, 1035273459, v117
    v_cvt_pk_bf16_f32 v24, v116, v117
    v_lshlrev_b32 v116, 16, v24
    v_and_b32 v117, 0xffff0000, v24
    v_cvt_pk_bf16_f32 v24, v118, v119
    v_lshlrev_b32 v118, 16, v24
    v_and_b32 v119, 0xffff0000, v24
    v_mul_f32 v118, 1035273459, v118
    v_mul_f32 v119, 1035273459, v119
    v_cvt_pk_bf16_f32 v24, v118, v119
    v_lshlrev_b32 v118, 16, v24
    v_and_b32 v119, 0xffff0000, v24
    v_mov_b32 v24, 3463331840
    v_cmp_le_i32 vcc, 0, v2
    s_nop 1
    v_cndmask_b32 v112, v24, v112, vcc
    v_cmp_le_i32 vcc, 1, v2
    s_nop 1
    v_cndmask_b32 v113, v24, v113, vcc
    v_cmp_le_i32 vcc, 2, v2
    s_nop 1
    v_cndmask_b32 v114, v24, v114, vcc
    v_cmp_le_i32 vcc, 3, v2
    s_nop 1
    v_cndmask_b32 v115, v24, v115, vcc
    v_cmp_le_i32 vcc, 16, v2
    s_nop 1
    v_cndmask_b32 v116, v24, v116, vcc
    v_cmp_le_i32 vcc, 17, v2
    s_nop 1
    v_cndmask_b32 v117, v24, v117, vcc
    v_cmp_le_i32 vcc, 18, v2
    s_nop 1
    v_cndmask_b32 v118, v24, v118, vcc
    v_cmp_le_i32 vcc, 19, v2
    s_nop 1
    v_cndmask_b32 v119, v24, v119, vcc
    v_max3_f32 v26, v112, v113, v114
    v_max3_f32 v26, v26, v115, v116
    v_max3_f32 v26, v26, v117, v118
    v_max_f32 v26, v26, v119
    s_lshl_b32 s34, s51, 1
    s_lshr_b32 s35, s19, 1
    s_add_u32 s34, s34, s35
    s_lshl_b32 s34, s34, 7
    s_add_u32 s34, s34, 103817216
    v_lshlrev_b32 v124, 8, v0
    v_add_u32 v124, s34, v124
    s_min_u32 s75, s52, 62
    s_sub_u32 s75, s75, 1
    s_cmp_eq_u32 s53, 15
    s_cselect_b32 s75, 0xffff, -1
    s_mov_b64 exec, 3
ao_cw:
    global_load_dword v125, v124, s[14:15] sc1
    s_add_u32 s54, s54, 1
    s_cmp_gt_u32 s54, 1048576
    s_cbranch_scc1 wk_fail
    s_waitcnt vmcnt(0)
    v_readlane_b32 s34, v125, 0
    v_readlane_b32 s35, v125, 1
    s_min_u32 s34, s34, s35
    s_mov_b32 s74, 1
    s_cmp_gt_u32 s34, s52
    s_cbranch_scc1 ao_cok
    s_mov_b32 s74, 0
    s_cmp_ge_u32 s34, s75
    s_cbranch_scc1 ao_cok
    s_sleep 1
    s_add_u32 s34, s34, 1
    s_cmp_ge_u32 s34, s52
    s_cbranch_scc1 ao_cw
    s_sleep 24
    s_branch ao_cw
ao_cok:
    s_mov_b64 exec, -1
    global_load_dwordx4 v[88:91], v5, s[14:15] offset:0 sc1
    global_load_dwordx4 v[92:95], v5, s[14:15] offset:1024 sc1
    global_load_dwordx4 v[96:99], v5, s[14:15] offset:2048 sc1
    global_load_dwordx4 v[100:103], v5, s[14:15] offset:3072 sc1
    global_load_dwordx2 v[104:105], v6, s[14:15] offset:0 sc1
    global_load_dwordx2 v[106:107], v6, s[14:15] offset:512 sc1
    global_load_dwordx2 v[108:109], v6, s[14:15] offset:1024 sc1
    global_load_dwordx2 v[110:111], v6, s[14:15] offset:1536 sc1
    s_cmp_eq_u32 s74, 1
    s_cbranch_scc1 ao_dok
    s_mov_b64 exec, 3
    global_load_dword v125, v124, s[14:15] sc1
    s_mov_b64 exec, -1
    s_add_u32 s54, s54, 1
    s_cmp_gt_u32 s54, 1048576
    s_cbranch_scc1 wk_fail
    s_waitcnt vmcnt(0)
    v_readlane_b32 s34, v125, 0
    v_readlane_b32 s35, v125, 1
    v_max3_u32 v126, v88, v89, v90
    v_max3_u32 v126, v126, v91, v92
    v_max3_u32 v126, v126, v93, v94
    v_max3_u32 v126, v126, v95, v96
    v_max3_u32 v126, v126, v97, v98
    v_max3_u32 v126, v126, v99, v100
    v_max3_u32 v126, v126, v101, v102
    v_max3_u32 v126, v126, v103, v104
    v_max3_u32 v126, v126, v105, v106
    v_max3_u32 v126, v126, v107, v108
    v_max3_u32 v126, v126, v109, v110
    v_max_u32 v126, v126, v111
    s_min_u32 s34, s34, s35
    s_cmp_gt_u32 s34, s52
    s_cselect_b32 s74, 1, 0
    v_cmp_eq_u32 vcc, -1, v126
    s_cbranch_vccnz ao_cok
ao_dok:
    s_waitcnt vmcnt(7)
    v_mfma_f32_16x16x32_bf16 v[120:123], v[88:91], v[8:11], 0
    s_waitcnt vmcnt(6)
    v_mfma_f32_16x16x32_bf16 v[120:123], v[92:95], v[12:15], v[120:123]
    s_waitcnt vmcnt(5)
    v_mfma_f32_16x16x32_bf16 v[120:123], v[96:99], v[16:19], v[120:123]
    s_waitcnt vmcnt(4)
    v_mfma_f32_16x16x32_bf16 v[120:123], v[100:103], v[20:23], v[120:123]
    s_mov_b32 vcc_lo, 0xffff0000
    s_mov_b32 vcc_hi, 0xffff0000
    s_nop 5
    v_cndmask_b32 v120, v120, v122, vcc
    v_cndmask_b32 v121, v121, v123, vcc
    v_cvt_pk_bf16_f32 v24, v120, v121
    v_lshlrev_b32 v120, 16, v24
    v_and_b32 v121, 0xffff0000, v24
    v_mul_f32 v120, 1035273459, v120
    v_mul_f32 v121, 1035273459, v121
    v_cvt_pk_bf16_f32 v24, v120, v121
    v_lshlrev_b32 v120, 16, v24
    v_and_b32 v121, 0xffff0000, v24
    v_max3_f32 v26, v26, v120, v121
    v_mov_b32 v27, v26
    s_nop 1
    v_permlane16_swap_b32 v26, v27
    v_max_f32 v26, v26, v27
    v_mov_b32 v27, v26
    s_nop 1
    v_permlane32_swap_b32 v26, v27
    v_max_f32 v26, v26, v27
    v_sub_f32 v112, v112, v26
    v_sub_f32 v113, v113, v26
    v_sub_f32 v114, v114, v26
    v_sub_f32 v115, v115, v26
    v_sub_f32 v116, v116, v26
    v_sub_f32 v117, v117, v26
    v_sub_f32 v118, v118, v26
    v_sub_f32 v119, v119, v26
    v_sub_f32 v120, v120, v26
    v_sub_f32 v121, v121, v26
    v_mul_f32 v112, 1069066811, v112
    v_mul_f32 v113, 1069066811, v113
    v_mul_f32 v114, 1069066811, v114
    v_mul_f32 v115, 1069066811, v115
    v_mul_f32 v116, 1069066811, v116
    v_mul_f32 v117, 1069066811, v117
    v_mul_f32 v118, 1069066811, v118
    v_mul_f32 v119, 1069066811, v119
    v_mul_f32 v120, 1069066811, v120
    v_mul_f32 v121, 1069066811, v121
    v_exp_f32 v112, v112
    v_exp_f32 v113, v113
    v_exp_f32 v114, v114
    v_exp_f32 v115, v115
    v_exp_f32 v116, v116
    v_exp_f32 v117, v117
    v_exp_f32 v118, v118
    v_exp_f32 v119, v119
    v_exp_f32 v120, v120
    v_exp_f32 v121, v121
    v_add_f32 v26, v112, v113
    v_add_f32 v27, v114, v115
    v_add_f32 v26, v26, v116
    v_add_f32 v27, v27, v117
    v_add_f32 v26, v26, v118
    v_add_f32 v27, v27, v119
    v_add_f32 v26, v26, v120
    v_add_f32 v27, v27, v121
    v_add_f32 v26, v26, v27
    v_mov_b32 v27, v26
    s_nop 1
    v_permlane16_swap_b32 v26, v27
    v_add_f32 v26, v26, v27
    v_mov_b32 v27, v26
    s_nop 1
    v_permlane32_swap_b32 v26, v27
    v_add_f32 v26, v26, v27
    v_rcp_f32 v26, v26
    s_nop 0
    v_mul_f32 v112, v112, v26
    v_mul_f32 v113, v113, v26
    v_mul_f32 v114, v114, v26
    v_mul_f32 v115, v115, v26
    v_mul_f32 v116, v116, v26
    v_mul_f32 v117, v117, v26
    v_mul_f32 v118, v118, v26
    v_mul_f32 v119, v119, v26
    v_mul_f32 v120, v120, v26
    v_mul_f32 v121, v121, v26
    v_cvt_pk_bf16_f32 v28, v112, v113
    v_cvt_pk_bf16_f32 v29, v114, v115
    v_cvt_pk_bf16_f32 v30, v116, v117
    v_cvt_pk_bf16_f32 v31, v118, v119
    v_cvt_pk_bf16_f32 v32, v120, v121
    v_mov_b32 v33, 0
    v_mov_b32 v34, 0
    v_cvt_pk_bf16_f32 v35, v120, v121
    s_waitcnt vmcnt(0)
    v_mfma_f32_16x16x32_bf16 v[128:131], v[56:59], v[28:31], 0
    v_mfma_f32_16x16x32_bf16 v[132:135], v[60:63], v[28:31], 0
    v_mfma_f32_16x16x32_bf16 v[136:139], v[64:67], v[28:31], 0
    v_mfma_f32_16x16x32_bf16 v[140:143], v[68:71], v[28:31], 0
    v_mfma_f32_16x16x32_bf16 v[144:147], v[72:75], v[28:31], 0
    v_mfma_f32_16x16x32_bf16 v[148:151], v[76:79], v[28:31], 0
    v_mfma_f32_16x16x32_bf16 v[152:155], v[80:83], v[28:31], 0
    v_mfma_f32_16x16x32_bf16 v[156:159], v[84:87], v[28:31], 0
    v_mfma_f32_16x16x16_bf16 v[128:131], v[104:105], v[32:33], v[128:131]
    v_mfma_f32_16x16x16_bf16 v[132:135], v[104:105], v[34:35], v[132:135]
    v_mfma_f32_16x16x16_bf16 v[136:139], v[106:107], v[32:33], v[136:139]
    v_mfma_f32_16x16x16_bf16 v[140:143], v[106:107], v[34:35], v[140:143]
    v_mfma_f32_16x16x16_bf16 v[144:147], v[108:109], v[32:33], v[144:147]
    v_mfma_f32_16x16x16_bf16 v[148:151], v[108:109], v[34:35], v[148:151]
    v_mfma_f32_16x16x16_bf16 v[152:155], v[110:111], v[32:33], v[152:155]
    v_mfma_f32_16x16x16_bf16 v[156:159], v[110:111], v[34:35], v[156:159]
    s_and_b32 s34, s19, 1
    s_lshl_b32 s34, s34, 13
    s_lshr_b32 s35, s19, 1
    s_lshl_b32 s35, s35, 12
    s_add_u32 s34, s34, s35
    v_add_u32 v3, s34, v0
    v_cvt_pk_bf16_f32 v8, v128, v129
    v_cvt_pk_bf16_f32 v9, v130, v131
    v_cvt_pk_bf16_f32 v10, v132, v133
    v_cvt_pk_bf16_f32 v11, v134, v135
    ds_write_b128 v3, v[8:11] offset:0
    v_cvt_pk_bf16_f32 v12, v136, v137
    v_cvt_pk_bf16_f32 v13, v138, v139
    v_cvt_pk_bf16_f32 v14, v140, v141
    v_cvt_pk_bf16_f32 v15, v142, v143
    ds_write_b128 v3, v[12:15] offset:1024
    v_cvt_pk_bf16_f32 v16, v144, v145
    v_cvt_pk_bf16_f32 v17, v146, v147
    v_cvt_pk_bf16_f32 v18, v148, v149
    v_cvt_pk_bf16_f32 v19, v150, v151
    ds_write_b128 v3, v[16:19] offset:2048
    v_cvt_pk_bf16_f32 v20, v152, v153
    v_cvt_pk_bf16_f32 v21, v154, v155
    v_cvt_pk_bf16_f32 v22, v156, v157
    v_cvt_pk_bf16_f32 v23, v158, v159
    ds_write_b128 v3, v[20:23] offset:3072
    s_waitcnt lgkmcnt(0)
    s_barrier
    ds_read_b128 v[128:131], v0 offset:0
    ds_read_b128 v[160:163], v0 offset:8192
    ds_read_b128 v[132:135], v0 offset:1024
    ds_read_b128 v[164:167], v0 offset:9216
    ds_read_b128 v[136:139], v0 offset:2048
    ds_read_b128 v[168:171], v0 offset:10240
    ds_read_b128 v[140:143], v0 offset:3072
    ds_read_b128 v[172:175], v0 offset:11264
    ds_read_b128 v[144:147], v0 offset:4096
    ds_read_b128 v[176:179], v0 offset:12288
    ds_read_b128 v[148:151], v0 offset:5120
    ds_read_b128 v[180:183], v0 offset:13312
    ds_read_b128 v[152:155], v0 offset:6144
    ds_read_b128 v[184:187], v0 offset:14336
    ds_read_b128 v[156:159], v0 offset:7168
    ds_read_b128 v[188:191], v0 offset:15360
    s_and_b32 s34, s52, 63
    s_lshl_b32 s34, s34, 4
    s_add_u32 s34, s34, s51
    s_lshl_b32 s34, s34, 2
    s_add_u32 s34, s34, s19
    s_mul_i32 s34, s34, 20480
    s_add_u32 s34, s34, 117444608
    v_add_u32 v4, s34, v0
    v_add_u32 v5, 8192, v4
    v_add_u32 v6, 16384, v4
    s_waitcnt lgkmcnt(0)
    s_bitcmp1_b32 s53, 0
    s_cbranch_scc0 ao_sk0
    v_mfma_f32_16x16x32_bf16 v[8:11], a[0:3], v[128:131], 0
    v_mfma_f32_16x16x32_bf16 v[8:11], a[40:43], v[132:135], v[8:11]
    v_mfma_f32_16x16x32_bf16 v[8:11], a[80:83], v[136:139], v[8:11]
    v_mfma_f32_16x16x32_bf16 v[8:11], a[120:123], v[140:143], v[8:11]
    v_mfma_f32_16x16x32_bf16 v[8:11], a[160:163], v[144:147], v[8:11]
    v_mfma_f32_16x16x32_bf16 v[8:11], a[200:203], v[148:151], v[8:11]
    v_mfma_f32_16x16x32_bf16 v[8:11], a[240:243], v[152:155], v[8:11]
    v_mfma_f32_16x16x32_bf16 v[8:11], v[216:219], v[156:159], v[8:11]
    v_mfma_f32_16x16x32_bf16 v[12:15], a[4:7], v[128:131], 0
    v_mfma_f32_16x16x32_bf16 v[12:15], a[44:47], v[132:135], v[12:15]
    v_mfma_f32_16x16x32_bf16 v[12:15], a[84:87], v[136:139], v[12:15]
    v_mfma_f32_16x16x32_bf16 v[12:15], a[124:127], v[140:143], v[12:15]
    v_mfma_f32_16x16x32_bf16 v[12:15], a[164:167], v[144:147], v[12:15]
    v_mfma_f32_16x16x32_bf16 v[12:15], a[204:207], v[148:151], v[12:15]
    v_mfma_f32_16x16x32_bf16 v[12:15], a[244:247], v[152:155], v[12:15]
    v_mfma_f32_16x16x32_bf16 v[12:15], v[220:223], v[156:159], v[12:15]
    global_store_dwordx4 v4, v[8:11], s[14:15] offset:-4096 sc1
    v_mfma_f32_16x16x32_bf16 v[16:19], a[8:11], v[128:131], 0
    v_mfma_f32_16x16x32_bf16 v[16:19], a[48:51], v[132:135], v[16:19]
    v_mfma_f32_16x16x32_bf16 v[16:19], a[88:91], v[136:139], v[16:19]
    v_mfma_f32_16x16x32_bf16 v[16:19], a[128:131], v[140:143], v[16:19]
    v_mfma_f32_16x16x32_bf16 v[16:19], a[168:171], v[144:147], v[16:19]
    v_mfma_f32_16x16x32_bf16 v[16:19], a[208:211], v[148:151], v[16:19]
    v_mfma_f32_16x16x32_bf16 v[16:19], a[248:251], v[152:155], v[16:19]
    v_mfma_f32_16x16x32_bf16 v[16:19], v[224:227], v[156:159], v[16:19]
    global_store_dwordx4 v4, v[12:15], s[14:15] offset:-3072 sc1
    v_mfma_f32_16x16x32_bf16 v[20:23], a[12:15], v[128:131], 0
    v_mfma_f32_16x16x32_bf16 v[20:23], a[52:55], v[132:135], v[20:23]
    v_mfma_f32_16x16x32_bf16 v[20:23], a[92:95], v[136:139], v[20:23]
    v_mfma_f32_16x16x32_bf16 v[20:23], a[132:135], v[140:143], v[20:23]
    v_mfma_f32_16x16x32_bf16 v[20:23], a[172:175], v[144:147], v[20:23]
    v_mfma_f32_16x16x32_bf16 v[20:23], a[212:215], v[148:151], v[20:23]
    v_mfma_f32_16x16x32_bf16 v[20:23], a[252:255], v[152:155], v[20:23]
    v_mfma_f32_16x16x32_bf16 v[20:23], v[228:231], v[156:159], v[20:23]
    global_store_dwordx4 v4, v[16:19], s[14:15] offset:-2048 sc1
    v_mfma_f32_16x16x32_bf16 v[24:27], a[16:19], v[128:131], 0
    v_mfma_f32_16x16x32_bf16 v[24:27], a[56:59], v[132:135], v[24:27]
    v_mfma_f32_16x16x32_bf16 v[24:27], a[96:99], v[136:139], v[24:27]
    v_mfma_f32_16x16x32_bf16 v[24:27], a[136:139], v[140:143], v[24:27]
    v_mfma_f32_16x16x32_bf16 v[24:27], a[176:179], v[144:147], v[24:27]
    v_mfma_f32_16x16x32_bf16 v[24:27], a[216:219], v[148:151], v[24:27]
    v_mfma_f32_16x16x32_bf16 v[24:27], v[192:195], v[152:155], v[24:27]
    v_mfma_f32_16x16x32_bf16 v[24:27], v[232:235], v[156:159], v[24:27]
    global_store_dwordx4 v4, v[20:23], s[14:15] offset:-1024 sc1
    v_mfma_f32_16x16x32_bf16 v[28:31], a[20:23], v[128:131], 0
    v_mfma_f32_16x16x32_bf16 v[28:31], a[60:63], v[132:135], v[28:31]
    v_mfma_f32_16x16x32_bf16 v[28:31], a[100:103], v[136:139], v[28:31]
    v_mfma_f32_16x16x32_bf16 v[28:31], a[140:143], v[140:143], v[28:31]
    v_mfma_f32_16x16x32_bf16 v[28:31], a[180:183], v[144:147], v[28:31]
    v_mfma_f32_16x16x32_bf16 v[28:31], a[220:223], v[148:151], v[28:31]
    v_mfma_f32_16x16x32_bf16 v[28:31], v[196:199], v[152:155], v[28:31]
    v_mfma_f32_16x16x32_bf16 v[28:31], v[236:239], v[156:159], v[28:31]
    global_store_dwordx4 v4, v[24:27], s[14:15] offset:0 sc1
    s_nop 6
    global_store_dwordx4 v4, v[28:31], s[14:15] offset:1024 sc1
ao_sk0:
    s_bitcmp1_b32 s53, 1
    s_cbranch_scc0 ao_sk1
    v_mfma_f32_16x16x32_bf16 v[32:35], a[24:27], v[128:131], 0
    v_mfma_f32_16x16x32_bf16 v[32:35], a[64:67], v[132:135], v[32:35]
    v_mfma_f32_16x16x32_bf16 v[32:35], a[104:107], v[136:139], v[32:35]
    v_mfma_f32_16x16x32_bf16 v[32:35], a[144:147], v[140:143], v[32:35]
    v_mfma_f32_16x16x32_bf16 v[32:35], a[184:187], v[144:147], v[32:35]
    v_mfma_f32_16x16x32_bf16 v[32:35], a[224:227], v[148:151], v[32:35]
    v_mfma_f32_16x16x32_bf16 v[32:35], v[200:203], v[152:155], v[32:35]
    v_mfma_f32_16x16x32_bf16 v[32:35], v[240:243], v[156:159], v[32:35]
    v_mfma_f32_16x16x32_bf16 v[36:39], a[28:31], v[128:131], 0
    v_mfma_f32_16x16x32_bf16 v[36:39], a[68:71], v[132:135], v[36:39]
    v_mfma_f32_16x16x32_bf16 v[36:39], a[108:111], v[136:139], v[36:39]
    v_mfma_f32_16x16x32_bf16 v[36:39], a[148:151], v[140:143], v[36:39]
    v_mfma_f32_16x16x32_bf16 v[36:39], a[188:191], v[144:147], v[36:39]
    v_mfma_f32_16x16x32_bf16 v[36:39], a[228:231], v[148:151], v[36:39]
    v_mfma_f32_16x16x32_bf16 v[36:39], v[204:207], v[152:155], v[36:39]
    v_mfma_f32_16x16x32_bf16 v[36:39], v[244:247], v[156:159], v[36:39]
    global_store_dwordx4 v4, v[32:35], s[14:15] offset:2048 sc1
    v_mfma_f32_16x16x32_bf16 v[40:43], a[32:35], v[128:131], 0
    v_mfma_f32_16x16x32_bf16 v[40:43], a[72:75], v[132:135], v[40:43]
    v_mfma_f32_16x16x32_bf16 v[40:43], a[112:115], v[136:139], v[40:43]
    v_mfma_f32_16x16x32_bf16 v[40:43], a[152:155], v[140:143], v[40:43]
    v_mfma_f32_16x16x32_bf16 v[40:43], a[192:195], v[144:147], v[40:43]
    v_mfma_f32_16x16x32_bf16 v[40:43], a[232:235], v[148:151], v[40:43]
    v_mfma_f32_16x16x32_bf16 v[40:43], v[208:211], v[152:155], v[40:43]
    v_mfma_f32_16x16x32_bf16 v[40:43], v[248:251], v[156:159], v[40:43]
    global_store_dwordx4 v4, v[36:39], s[14:15] offset:3072 sc1
    v_mfma_f32_16x16x32_bf16 v[44:47], a[36:39], v[128:131], 0
    v_mfma_f32_16x16x32_bf16 v[44:47], a[76:79], v[132:135], v[44:47]
    v_mfma_f32_16x16x32_bf16 v[44:47], a[116:119], v[136:139], v[44:47]
    v_mfma_f32_16x16x32_bf16 v[44:47], a[156:159], v[140:143], v[44:47]
    v_mfma_f32_16x16x32_bf16 v[44:47], a[196:199], v[144:147], v[44:47]
    v_mfma_f32_16x16x32_bf16 v[44:47], a[236:239], v[148:151], v[44:47]
    v_mfma_f32_16x16x32_bf16 v[44:47], v[212:215], v[152:155], v[44:47]
    v_mfma_f32_16x16x32_bf16 v[44:47], v[252:255], v[156:159], v[44:47]
    global_store_dwordx4 v5, v[40:43], s[14:15] offset:-4096 sc1
    s_nop 6
    global_store_dwordx4 v5, v[44:47], s[14:15] offset:-3072 sc1
ao_sk1:
    s_bitcmp1_b32 s53, 2
    s_cbranch_scc0 ao_sk2
    v_mfma_f32_16x16x32_bf16 v[48:51], a[0:3], v[160:163], 0
    v_mfma_f32_16x16x32_bf16 v[48:51], a[40:43], v[164:167], v[48:51]
    v_mfma_f32_16x16x32_bf16 v[48:51], a[80:83], v[168:171], v[48:51]
    v_mfma_f32_16x16x32_bf16 v[48:51], a[120:123], v[172:175], v[48:51]
    v_mfma_f32_16x16x32_bf16 v[48:51], a[160:163], v[176:179], v[48:51]
    v_mfma_f32_16x16x32_bf16 v[48:51], a[200:203], v[180:183], v[48:51]
    v_mfma_f32_16x16x32_bf16 v[48:51], a[240:243], v[184:187], v[48:51]
    v_mfma_f32_16x16x32_bf16 v[48:51], v[216:219], v[188:191], v[48:51]
    v_mfma_f32_16x16x32_bf16 v[52:55], a[4:7], v[160:163], 0
    v_mfma_f32_16x16x32_bf16 v[52:55], a[44:47], v[164:167], v[52:55]
    v_mfma_f32_16x16x32_bf16 v[52:55], a[84:87], v[168:171], v[52:55]
    v_mfma_f32_16x16x32_bf16 v[52:55], a[124:127], v[172:175], v[52:55]
    v_mfma_f32_16x16x32_bf16 v[52:55], a[164:167], v[176:179], v[52:55]
    v_mfma_f32_16x16x32_bf16 v[52:55], a[204:207], v[180:183], v[52:55]
    v_mfma_f32_16x16x32_bf16 v[52:55], a[244:247], v[184:187], v[52:55]
    v_mfma_f32_16x16x32_bf16 v[52:55], v[220:223], v[188:191], v[52:55]
    global_store_dwordx4 v5, v[48:51], s[14:15] offset:-2048 sc1
    v_mfma_f32_16x16x32_bf16 v[56:59], a[8:11], v[160:163], 0
    v_mfma_f32_16x16x32_bf16 v[56:59], a[48:51], v[164:167], v[56:59]
    v_mfma_f32_16x16x32_bf16 v[56:59], a[88:91], v[168:171], v[56:59]
    v_mfma_f32_16x16x32_bf16 v[56:59], a[128:131], v[172:175], v[56:59]
    v_mfma_f32_16x16x32_bf16 v[56:59], a[168:171], v[176:179], v[56:59]
    v_mfma_f32_16x16x32_bf16 v[56:59], a[208:211], v[180:183], v[56:59]
    v_mfma_f32_16x16x32_bf16 v[56:59], a[248:251], v[184:187], v[56:59]
    v_mfma_f32_16x16x32_bf16 v[56:59], v[224:227], v[188:191], v[56:59]
    global_store_dwordx4 v5, v[52:55], s[14:15] offset:-1024 sc1
    v_mfma_f32_16x16x32_bf16 v[60:63], a[12:15], v[160:163], 0
    v_mfma_f32_16x16x32_bf16 v[60:63], a[52:55], v[164:167], v[60:63]
    v_mfma_f32_16x16x32_bf16 v[60:63], a[92:95], v[168:171], v[60:63]
    v_mfma_f32_16x16x32_bf16 v[60:63], a[132:135], v[172:175], v[60:63]
    v_mfma_f32_16x16x32_bf16 v[60:63], a[172:175], v[176:179], v[60:63]
    v_mfma_f32_16x16x32_bf16 v[60:63], a[212:215], v[180:183], v[60:63]
    v_mfma_f32_16x16x32_bf16 v[60:63], a[252:255], v[184:187], v[60:63]
    v_mfma_f32_16x16x32_bf16 v[60:63], v[228:231], v[188:191], v[60:63]
    global_store_dwordx4 v5, v[56:59], s[14:15] offset:0 sc1
    v_mfma_f32_16x16x32_bf16 v[64:67], a[16:19], v[160:163], 0
    v_mfma_f32_16x16x32_bf16 v[64:67], a[56:59], v[164:167], v[64:67]
    v_mfma_f32_16x16x32_bf16 v[64:67], a[96:99], v[168:171], v[64:67]
    v_mfma_f32_16x16x32_bf16 v[64:67], a[136:139], v[172:175], v[64:67]
    v_mfma_f32_16x16x32_bf16 v[64:67], a[176:179], v[176:179], v[64:67]
    v_mfma_f32_16x16x32_bf16 v[64:67], a[216:219], v[180:183], v[64:67]
    v_mfma_f32_16x16x32_bf16 v[64:67], v[192:195], v[184:187], v[64:67]
    v_mfma_f32_16x16x32_bf16 v[64:67], v[232:235], v[188:191], v[64:67]
    global_store_dwordx4 v5, v[60:63], s[14:15] offset:1024 sc1
    v_mfma_f32_16x16x32_bf16 v[68:71], a[20:23], v[160:163], 0
    v_mfma_f32_16x16x32_bf16 v[68:71], a[60:63], v[164:167], v[68:71]
    v_mfma_f32_16x16x32_bf16 v[68:71], a[100:103], v[168:171], v[68:71]
    v_mfma_f32_16x16x32_bf16 v[68:71], a[140:143], v[172:175], v[68:71]
    v_mfma_f32_16x16x32_bf16 v[68:71], a[180:183], v[176:179], v[68:71]
    v_mfma_f32_16x16x32_bf16 v[68:71], a[220:223], v[180:183], v[68:71]
    v_mfma_f32_16x16x32_bf16 v[68:71], v[196:199], v[184:187], v[68:71]
    v_mfma_f32_16x16x32_bf16 v[68:71], v[236:239], v[188:191], v[68:71]
    global_store_dwordx4 v5, v[64:67], s[14:15] offset:2048 sc1
    s_nop 6
    global_store_dwordx4 v5, v[68:71], s[14:15] offset:3072 sc1
ao_sk2:
    s_bitcmp1_b32 s53, 3
    s_cbranch_scc0 ao_sk3
    v_mfma_f32_16x16x32_bf16 v[72:75], a[24:27], v[160:163], 0
    v_mfma_f32_16x16x32_bf16 v[72:75], a[64:67], v[164:167], v[72:75]
    v_mfma_f32_16x16x32_bf16 v[72:75], a[104:107], v[168:171], v[72:75]
    v_mfma_f32_16x16x32_bf16 v[72:75], a[144:147], v[172:175], v[72:75]
    v_mfma_f32_16x16x32_bf16 v[72:75], a[184:187], v[176:179], v[72:75]
    v_mfma_f32_16x16x32_bf16 v[72:75], a[224:227], v[180:183], v[72:75]
    v_mfma_f32_16x16x32_bf16 v[72:75], v[200:203], v[184:187], v[72:75]
    v_mfma_f32_16x16x32_bf16 v[72:75], v[240:243], v[188:191], v[72:75]
    v_mfma_f32_16x16x32_bf16 v[76:79], a[28:31], v[160:163], 0
    v_mfma_f32_16x16x32_bf16 v[76:79], a[68:71], v[164:167], v[76:79]
    v_mfma_f32_16x16x32_bf16 v[76:79], a[108:111], v[168:171], v[76:79]
    v_mfma_f32_16x16x32_bf16 v[76:79], a[148:151], v[172:175], v[76:79]
    v_mfma_f32_16x16x32_bf16 v[76:79], a[188:191], v[176:179], v[76:79]
    v_mfma_f32_16x16x32_bf16 v[76:79], a[228:231], v[180:183], v[76:79]
    v_mfma_f32_16x16x32_bf16 v[76:79], v[204:207], v[184:187], v[76:79]
    v_mfma_f32_16x16x32_bf16 v[76:79], v[244:247], v[188:191], v[76:79]
    global_store_dwordx4 v6, v[72:75], s[14:15] offset:-4096 sc1
    v_mfma_f32_16x16x32_bf16 v[80:83], a[32:35], v[160:163], 0
    v_mfma_f32_16x16x32_bf16 v[80:83], a[72:75], v[164:167], v[80:83]
    v_mfma_f32_16x16x32_bf16 v[80:83], a[112:115], v[168:171], v[80:83]
    v_mfma_f32_16x16x32_bf16 v[80:83], a[152:155], v[172:175], v[80:83]
    v_mfma_f32_16x16x32_bf16 v[80:83], a[192:195], v[176:179], v[80:83]
    v_mfma_f32_16x16x32_bf16 v[80:83], a[232:235], v[180:183], v[80:83]
    v_mfma_f32_16x16x32_bf16 v[80:83], v[208:211], v[184:187], v[80:83]
    v_mfma_f32_16x16x32_bf16 v[80:83], v[248:251], v[188:191], v[80:83]
    global_store_dwordx4 v6, v[76:79], s[14:15] offset:-3072 sc1
    v_mfma_f32_16x16x32_bf16 v[84:87], a[36:39], v[160:163], 0
    v_mfma_f32_16x16x32_bf16 v[84:87], a[76:79], v[164:167], v[84:87]
    v_mfma_f32_16x16x32_bf16 v[84:87], a[116:119], v[168:171], v[84:87]
    v_mfma_f32_16x16x32_bf16 v[84:87], a[156:159], v[172:175], v[84:87]
    v_mfma_f32_16x16x32_bf16 v[84:87], a[196:199], v[176:179], v[84:87]
    v_mfma_f32_16x16x32_bf16 v[84:87], a[236:239], v[180:183], v[84:87]
    v_mfma_f32_16x16x32_bf16 v[84:87], v[212:215], v[184:187], v[84:87]
    v_mfma_f32_16x16x32_bf16 v[84:87], v[252:255], v[188:191], v[84:87]
    global_store_dwordx4 v6, v[80:83], s[14:15] offset:-2048 sc1
    s_nop 6
    global_store_dwordx4 v6, v[84:87], s[14:15] offset:-1024 sc1
ao_sk3:
    s_waitcnt vmcnt(0)
    s_barrier
    s_cmp_lg_u32 s19, 0
    s_cbranch_scc1 sig_29
    s_mov_b64 exec, 1
    s_lshl_b32 s34, s52, 7
    s_add_u32 s34, s34, 103825408
    v_mov_b32 v124, s34
    v_mov_b32 v125, 1
    global_atomic_add v124, v125, s[14:15] sc1
    s_mov_b64 exec, -1
sig_29:
    s_branch wk_ao
wk_red:
    s_load_dwordx2 s[4:5], s[0:1], 0
    s_load_dwordx2 s[6:7], s[0:1], 88
    s_waitcnt lgkmcnt(0)
wk_redl:
    s_barrier
    s_cmp_lg_u32 s19, 0
    s_cbranch_scc1 rd_f
    s_mov_b64 exec, 1
    v_mov_b32 v124, 103815424
    global_load_dword v125, v124, s[14:15] sc1
    s_waitcnt vmcnt(0)
    v_readfirstlane_b32 s49, v125
    s_cmp_ge_u32 s49, 760
    s_cbranch_scc1 rd_put
    v_mov_b32 v124, 103815424
    v_mov_b32 v125, 1
    global_atomic_add v126, v124, v125, s[14:15] sc0 sc1
    s_waitcnt vmcnt(0)
    v_readfirstlane_b32 s49, v126
    s_cmp_ge_u32 s49, 760
    s_cbranch_scc1 rd_put
    s_sub_u32 s44, s49, 60
    s_mul_i32 s52, s44, 6554
    s_lshr_b32 s52, s52, 16
    s_mul_i32 s45, s52, 10
    s_sub_u32 s44, s44, s45
    s_mov_b32 s45, 16
    s_mov_b32 s75, 0
    s_sub_u32 s74, s49, 80
    s_cmp_lt_u32 s74, 600
    s_cbranch_scc1 rd_d0
    s_mov_b32 s75, 1
    s_cmp_lt_u32 s49, 80
    s_cselect_b32 s44, 0, 680
    s_cselect_b32 s74, 0, 62
    s_cselect_b32 s45, 16, 32
    s_sub_u32 s44, s49, s44
    s_mul_i32 s52, s44, 1639
    s_lshr_b32 s52, s52, 16
    s_mul_i32 s34, s52, 40
    s_sub_u32 s44, s44, s34
    s_add_u32 s52, s52, s74
rd_d0:
    s_lshr_b32 s34, s52, 2
    s_lshl_b32 s34, s34, 7
    s_add_u32 s34, s34, 103813120
    v_mov_b32 v124, s34
poll_30:
    global_load_dword v125, v124, s[14:15] sc1
    s_add_u32 s54, s54, 1
    s_cmp_gt_u32 s54, 1048576
    s_cbranch_scc1 wk_fail
    s_waitcnt vmcnt(0)
    v_readfirstlane_b32 s35, v125
    s_cmp_ge_u32 s35, 5
    s_cbranch_scc1 poll_30_ok
    s_sleep 8
    s_branch poll_30
poll_30_ok:
    s_cmp_eq_u32 s75, 1
    s_cbranch_scc1 rd_put
    s_lshl_b32 s34, s52, 7
    s_add_u32 s34, s34, 103825408
    v_mov_b32 v124, s34
poll_31:
    global_load_dword v125, v124, s[14:15] sc1
    s_add_u32 s54, s54, 1
    s_cmp_gt_u32 s54, 1048576
    s_cbranch_scc1 wk_fail
    s_waitcnt vmcnt(0)
    v_readfirstlane_b32 s35, v125
    s_cmp_ge_u32 s35, s45
    s_cbranch_scc1 poll_31_ok
    s_sleep 2
    s_branch poll_31
poll_31_ok:
rd_put:
    v_mov_b32 v124, 163776
    v_mov_b32 v125, s49
    ds_write_b32 v124, v125 offset:0
    s_waitcnt lgkmcnt(0)
    s_mov_b64 exec, -1
rd_f:
    s_barrier
    v_mov_b32 v124, 163776
    ds_read_b32 v125, v124 offset:0
    s_waitcnt lgkmcnt(0)
    v_readfirstlane_b32 s49, v125
    s_cmp_ge_u32 s49, 760
    s_cbranch_scc1 wk_fin
    s_sub_u32 s44, s49, 60
    s_mul_i32 s52, s44, 6554
    s_lshr_b32 s52, s52, 16
    s_mul_i32 s45, s52, 10
    s_sub_u32 s44, s44, s45
    s_mov_b32 s45, 16
    s_mov_b32 s75, 0
    s_sub_u32 s74, s49, 80
    s_cmp_lt_u32 s74, 600
    s_cbranch_scc1 rd_d1
    s_mov_b32 s75, 1
    s_cmp_lt_u32 s49, 80
    s_cselect_b32 s44, 0, 680
    s_cselect_b32 s74, 0, 62
    s_cselect_b32 s45, 16, 32
    s_sub_u32 s44, s49, s44
    s_mul_i32 s52, s44, 1639
    s_lshr_b32 s52, s52, 16
    s_mul_i32 s34, s52, 40
    s_sub_u32 s44, s44, s34
    s_add_u32 s52, s52, s74
rd_d1:
    s_cmp_eq_u32 s75, 1
    s_cbranch_scc1 rd_fine
    v_and_b32 v1, 63, v127
    v_lshlrev_b32 v0, 4, v1
    s_lshl_b32 s34, s44, 2
    s_add_u32 s34, s34, s19
    s_and_b32 s35, s52, 63
    s_mul_i32 s35, s35, 1310720
    s_lshl_b32 s36, s34, 11
    s_add_u32 s35, s35, s36
    s_add_u32 s35, s35, 117440512
    v_add_u32 v2, s35, v0
    v_mov_b32 v6, v2
    global_load_dwordx4 v[128:131], v6, s[14:15] offset:0 sc1
    global_load_dwordx4 v[132:135], v6, s[14:15] offset:1024 sc1
    v_add_u32 v6, 81920, v6
    global_load_dwordx4 v[136:139], v6, s[14:15] offset:0 sc1
    global_load_dwordx4 v[140:143], v6, s[14:15] offset:1024 sc1
    v_add_u32 v6, 81920, v6
    global_load_dwordx4 v[144:147], v6, s[14:15] offset:0 sc1
    global_load_dwordx4 v[148:151], v6, s[14:15] offset:1024 sc1
    v_add_u32 v6, 81920, v6
    global_load_dwordx4 v[152:155], v6, s[14:15] offset:0 sc1
    global_load_dwordx4 v[156:159], v6, s[14:15] offset:1024 sc1
    v_add_u32 v6, 81920, v6
    global_load_dwordx4 v[160:163], v6, s[14:15] offset:0 sc1
    global_load_dwordx4 v[164:167], v6, s[14:15] offset:1024 sc1
    v_add_u32 v6, 81920, v6
    global_load_dwordx4 v[168:171], v6, s[14:15] offset:0 sc1
    global_load_dwordx4 v[172:175], v6, s[14:15] offset:1024 sc1
    v_add_u32 v6, 81920, v6
    global_load_dwordx4 v[176:179], v6, s[14:15] offset:0 sc1
    global_load_dwordx4 v[180:183], v6, s[14:15] offset:1024 sc1
    v_add_u32 v6, 81920, v6
    global_load_dwordx4 v[184:187], v6, s[14:15] offset:0 sc1
    global_load_dwordx4 v[188:191], v6, s[14:15] offset:1024 sc1
    v_add_u32 v6, 81920, v6
    global_load_dwordx4 v[192:195], v6, s[14:15] offset:0 sc1
    global_load_dwordx4 v[196:199], v6, s[14:15] offset:1024 sc1
    v_add_u32 v6, 81920, v6
    global_load_dwordx4 v[200:203], v6, s[14:15] offset:0 sc1
    global_load_dwordx4 v[204:207], v6, s[14:15] offset:1024 sc1
    v_add_u32 v6, 81920, v6
    global_load_dwordx4 v[208:211], v6, s[14:15] offset:0 sc1
    global_load_dwordx4 v[212:215], v6, s[14:15] offset:1024 sc1
    v_add_u32 v6, 81920, v6
    global_load_dwordx4 v[216:219], v6, s[14:15] offset:0 sc1
    global_load_dwordx4 v[220:223], v6, s[14:15] offset:1024 sc1
    v_add_u32 v6, 81920, v6
    global_load_dwordx4 v[224:227], v6, s[14:15] offset:0 sc1
    global_load_dwordx4 v[228:231], v6, s[14:15] offset:1024 sc1
    v_add_u32 v6, 81920, v6
    global_load_dwordx4 v[232:235], v6, s[14:15] offset:0 sc1
    global_load_dwordx4 v[236:239], v6, s[14:15] offset:1024 sc1
    v_add_u32 v6, 81920, v6
    global_load_dwordx4 v[240:243], v6, s[14:15] offset:0 sc1
    global_load_dwordx4 v[244:247], v6, s[14:15] offset:1024 sc1
    v_add_u32 v6, 81920, v6
    global_load_dwordx4 v[248:251], v6, s[14:15] offset:0 sc1
    global_load_dwordx4 v[252:255], v6, s[14:15] offset:1024 sc1
    s_mul_i32 s35, s34, 205
    s_lshr_b32 s35, s35, 10
    s_mul_i32 s36, s35, 5
    s_sub_u32 s34, s34, s36
    s_lshl_b32 s34, s34, 8
    s_lshr_b32 s36, s35, 1
    s_lshl_b32 s36, s36, 6
    s_add_u32 s34, s34, s36
    s_and_b32 s35, s35, 1
    s_lshl_b32 s36, s52, 1
    s_add_u32 s35, s35, s36
    s_mul_i32 s35, s35, 20480
    s_add_u32 s34, s34, s35
    v_and_b32 v3, 15, v1
    v_mul_u32_u24 v3, 1280, v3
    v_lshrrev_b32 v4, 4, v1
    v_lshl_add_u32 v3, v4, 4, v3
    v_add_u32 v3, s34, v3
    v_add_u32 v4, 79691776, v3
    global_load_dwordx4 v[8:11], v3, s[4:5]
    global_load_dwordx4 v[12:15], v4, s[14:15] sc1
    s_waitcnt vmcnt(30)
    v_pk_add_f32 v[128:129], v[128:129], v[136:137]
    v_pk_add_f32 v[130:131], v[130:131], v[138:139]
    v_pk_add_f32 v[132:133], v[132:133], v[140:141]
    v_pk_add_f32 v[134:135], v[134:135], v[142:143]
    s_waitcnt vmcnt(28)
    v_pk_add_f32 v[128:129], v[128:129], v[144:145]
    v_pk_add_f32 v[130:131], v[130:131], v[146:147]
    v_pk_add_f32 v[132:133], v[132:133], v[148:149]
    v_pk_add_f32 v[134:135], v[134:135], v[150:151]
    s_waitcnt vmcnt(26)
    v_pk_add_f32 v[128:129], v[128:129], v[152:153]
    v_pk_add_f32 v[130:131], v[130:131], v[154:155]
    v_pk_add_f32 v[132:133], v[132:133], v[156:157]
    v_pk_add_f32 v[134:135], v[134:135], v[158:159]
    s_waitcnt vmcnt(24)
    v_pk_add_f32 v[128:129], v[128:129], v[160:161]
    v_pk_add_f32 v[130:131], v[130:131], v[162:163]
    v_pk_add_f32 v[132:133], v[132:133], v[164:165]
    v_pk_add_f32 v[134:135], v[134:135], v[166:167]
    s_waitcnt vmcnt(22)
    v_pk_add_f32 v[128:129], v[128:129], v[168:169]
    v_pk_add_f32 v[130:131], v[130:131], v[170:171]
    v_pk_add_f32 v[132:133], v[132:133], v[172:173]
    v_pk_add_f32 v[134:135], v[134:135], v[174:175]
    s_waitcnt vmcnt(20)
    v_pk_add_f32 v[128:129], v[128:129], v[176:177]
    v_pk_add_f32 v[130:131], v[130:131], v[178:179]
    v_pk_add_f32 v[132:133], v[132:133], v[180:181]
    v_pk_add_f32 v[134:135], v[134:135], v[182:183]
    s_waitcnt vmcnt(18)
    v_pk_add_f32 v[128:129], v[128:129], v[184:185]
    v_pk_add_f32 v[130:131], v[130:131], v[186:187]
    v_pk_add_f32 v[132:133], v[132:133], v[188:189]
    v_pk_add_f32 v[134:135], v[134:135], v[190:191]
    s_waitcnt vmcnt(16)
    v_pk_add_f32 v[128:129], v[128:129], v[192:193]
    v_pk_add_f32 v[130:131], v[130:131], v[194:195]
    v_pk_add_f32 v[132:133], v[132:133], v[196:197]
    v_pk_add_f32 v[134:135], v[134:135], v[198:199]
    s_waitcnt vmcnt(14)
    v_pk_add_f32 v[128:129], v[128:129], v[200:201]
    v_pk_add_f32 v[130:131], v[130:131], v[202:203]
    v_pk_add_f32 v[132:133], v[132:133], v[204:205]
    v_pk_add_f32 v[134:135], v[134:135], v[206:207]
    s_waitcnt vmcnt(12)
    v_pk_add_f32 v[128:129], v[128:129], v[208:209]
    v_pk_add_f32 v[130:131], v[130:131], v[210:211]
    v_pk_add_f32 v[132:133], v[132:133], v[212:213]
    v_pk_add_f32 v[134:135], v[134:135], v[214:215]
    s_waitcnt vmcnt(10)
    v_pk_add_f32 v[128:129], v[128:129], v[216:217]
    v_pk_add_f32 v[130:131], v[130:131], v[218:219]
    v_pk_add_f32 v[132:133], v[132:133], v[220:221]
    v_pk_add_f32 v[134:135], v[134:135], v[222:223]
    s_waitcnt vmcnt(8)
    v_pk_add_f32 v[128:129], v[128:129], v[224:225]
    v_pk_add_f32 v[130:131], v[130:131], v[226:227]
    v_pk_add_f32 v[132:133], v[132:133], v[228:229]
    v_pk_add_f32 v[134:135], v[134:135], v[230:231]
    s_waitcnt vmcnt(6)
    v_pk_add_f32 v[128:129], v[128:129], v[232:233]
    v_pk_add_f32 v[130:131], v[130:131], v[234:235]
    v_pk_add_f32 v[132:133], v[132:133], v[236:237]
    v_pk_add_f32 v[134:135], v[134:135], v[238:239]
    s_waitcnt vmcnt(4)
    v_pk_add_f32 v[128:129], v[128:129], v[240:241]
    v_pk_add_f32 v[130:131], v[130:131], v[242:243]
    v_pk_add_f32 v[132:133], v[132:133], v[244:245]
    v_pk_add_f32 v[134:135], v[134:135], v[246:247]
    s_waitcnt vmcnt(2)
    v_pk_add_f32 v[128:129], v[128:129], v[248:249]
    v_pk_add_f32 v[130:131], v[130:131], v[250:251]
    v_pk_add_f32 v[132:133], v[132:133], v[252:253]
    v_pk_add_f32 v[134:135], v[134:135], v[254:255]
    s_waitcnt vmcnt(0)
    v_cvt_pk_bf16_f32 v16, v128, v129
    v_lshlrev_b32 v17, 16, v16
    v_and_b32 v18, 0xffff0000, v16
    v_lshlrev_b32 v19, 16, v8
    v_and_b32 v20, 0xffff0000, v8
    v_add_f32 v17, v17, v19
    v_add_f32 v18, v18, v20
    v_cvt_pk_bf16_f32 v16, v17, v18
    v_lshlrev_b32 v19, 16, v12
    v_and_b32 v20, 0xffff0000, v12
    v_lshlrev_b32 v17, 16, v16
    v_and_b32 v18, 0xffff0000, v16
    v_add_f32 v17, v17, v19
    v_add_f32 v18, v18, v20
    v_cvt_pk_bf16_f32 v24, v17, v18
    v_cvt_pk_bf16_f32 v16, v130, v131
    v_lshlrev_b32 v17, 16, v16
    v_and_b32 v18, 0xffff0000, v16
    v_lshlrev_b32 v19, 16, v9
    v_and_b32 v20, 0xffff0000, v9
    v_add_f32 v17, v17, v19
    v_add_f32 v18, v18, v20
    v_cvt_pk_bf16_f32 v16, v17, v18
    v_lshlrev_b32 v19, 16, v13
    v_and_b32 v20, 0xffff0000, v13
    v_lshlrev_b32 v17, 16, v16
    v_and_b32 v18, 0xffff0000, v16
    v_add_f32 v17, v17, v19
    v_add_f32 v18, v18, v20
    v_cvt_pk_bf16_f32 v25, v17, v18
    v_cvt_pk_bf16_f32 v16, v132, v133
    v_lshlrev_b32 v17, 16, v16
    v_and_b32 v18, 0xffff0000, v16
    v_lshlrev_b32 v19, 16, v10
    v_and_b32 v20, 0xffff0000, v10
    v_add_f32 v17, v17, v19
    v_add_f32 v18, v18, v20
    v_cvt_pk_bf16_f32 v16, v17, v18
    v_lshlrev_b32 v19, 16, v14
    v_and_b32 v20, 0xffff0000, v14
    v_lshlrev_b32 v17, 16, v16
    v_and_b32 v18, 0xffff0000, v16
    v_add_f32 v17, v17, v19
    v_add_f32 v18, v18, v20
    v_cvt_pk_bf16_f32 v26, v17, v18
    v_cvt_pk_bf16_f32 v16, v134, v135
    v_lshlrev_b32 v17, 16, v16
    v_and_b32 v18, 0xffff0000, v16
    v_lshlrev_b32 v19, 16, v11
    v_and_b32 v20, 0xffff0000, v11
    v_add_f32 v17, v17, v19
    v_add_f32 v18, v18, v20
    v_cvt_pk_bf16_f32 v16, v17, v18
    v_lshlrev_b32 v19, 16, v15
    v_and_b32 v20, 0xffff0000, v15
    v_lshlrev_b32 v17, 16, v16
    v_and_b32 v18, 0xffff0000, v16
    v_add_f32 v17, v17, v19
    v_add_f32 v18, v18, v20
    v_cvt_pk_bf16_f32 v27, v17, v18
    global_store_dwordx4 v3, v[24:27], s[6:7]
    s_branch wk_redl
rd_fine:
    v_and_b32 v1, 63, v127
    v_lshlrev_b32 v0, 4, v1
    s_mov_b32 s34, s44
    s_and_b32 s35, s52, 63
    s_mul_i32 s35, s35, 1310720
    s_mul_i32 s36, s19, 327680
    s_add_u32 s35, s35, s36
    s_lshl_b32 s36, s34, 11
    s_add_u32 s35, s35, s36
    s_add_u32 s35, s35, 117440512
    v_add_u32 v2, s35, v0
    s_mul_i32 s35, s34, 205
    s_lshr_b32 s35, s35, 10
    s_mul_i32 s36, s35, 5
    s_sub_u32 s34, s34, s36
    s_lshl_b32 s34, s34, 8
    s_lshr_b32 s36, s35, 1
    s_lshl_b32 s36, s36, 6
    s_add_u32 s34, s34, s36
    s_and_b32 s35, s35, 1
    s_lshl_b32 s36, s52, 1
    s_add_u32 s35, s35, s36
    s_mul_i32 s35, s35, 20480
    s_add_u32 s34, s34, s35
    v_and_b32 v3, 15, v1
    v_mul_u32_u24 v3, 1280, v3
    v_lshrrev_b32 v4, 4, v1
    v_lshl_add_u32 v3, v4, 4, v3
    v_add_u32 v3, s34, v3
    v_add_u32 v4, 79691776, v3
    global_load_dwordx4 v[8:11], v3, s[4:5]
    global_load_dwordx4 v[12:15], v4, s[14:15] sc1
    s_cmp_lg_u32 s19, 0
    s_cbranch_scc1 rd_w
    s_mov_b64 exec, 1
    s_lshl_b32 s34, s52, 7
    s_add_u32 s34, s34, 103825408
    v_mov_b32 v124, s34
poll_32:
    global_load_dword v125, v124, s[14:15] sc1
    s_add_u32 s54, s54, 1
    s_cmp_gt_u32 s54, 1048576
    s_cbranch_scc1 wk_fail
    s_waitcnt vmcnt(0)
    v_readfirstlane_b32 s35, v125
    s_cmp_ge_u32 s35, s45
    s_cbranch_scc1 poll_32_ok
    s_sleep 1
    s_branch poll_32
poll_32_ok:
    s_mov_b64 exec, -1
rd_w:
    s_barrier
    v_mov_b32 v6, v2
    global_load_dwordx4 v[128:131], v6, s[14:15] offset:0 sc1
    global_load_dwordx4 v[132:135], v6, s[14:15] offset:1024 sc1
    v_add_u32 v6, 81920, v6
    global_load_dwordx4 v[136:139], v6, s[14:15] offset:0 sc1
    global_load_dwordx4 v[140:143], v6, s[14:15] offset:1024 sc1
    v_add_u32 v6, 81920, v6
    global_load_dwordx4 v[144:147], v6, s[14:15] offset:0 sc1
    global_load_dwordx4 v[148:151], v6, s[14:15] offset:1024 sc1
    v_add_u32 v6, 81920, v6
    global_load_dwordx4 v[152:155], v6, s[14:15] offset:0 sc1
    global_load_dwordx4 v[156:159], v6, s[14:15] offset:1024 sc1
    s_waitcnt vmcnt(0)
    v_pk_add_f32 v[128:129], v[128:129], v[136:137]
    v_pk_add_f32 v[130:131], v[130:131], v[138:139]
    v_pk_add_f32 v[132:133], v[132:133], v[140:141]
    v_pk_add_f32 v[134:135], v[134:135], v[142:143]
    v_pk_add_f32 v[128:129], v[128:129], v[144:145]
    v_pk_add_f32 v[130:131], v[130:131], v[146:147]
    v_pk_add_f32 v[132:133], v[132:133], v[148:149]
    v_pk_add_f32 v[134:135], v[134:135], v[150:151]
    v_pk_add_f32 v[128:129], v[128:129], v[152:153]
    v_pk_add_f32 v[130:131], v[130:131], v[154:155]
    v_pk_add_f32 v[132:133], v[132:133], v[156:157]
    v_pk_add_f32 v[134:135], v[134:135], v[158:159]
    s_lshl_b32 s34, s19, 11
    v_add_u32 v5, s34, v0
    ds_write_b128 v5, v[128:131]
    ds_write_b128 v5, v[132:135] offset:1024
    s_waitcnt lgkmcnt(0)
    s_barrier
    s_cmp_lg_u32 s19, 0
    s_cbranch_scc1 rdf_end
    ds_read_b128 v[136:139], v0 offset:2048
    ds_read_b128 v[140:143], v0 offset:3072
    ds_read_b128 v[144:147], v0 offset:4096
    ds_read_b128 v[148:151], v0 offset:5120
    ds_read_b128 v[152:155], v0 offset:6144
    ds_read_b128 v[156:159], v0 offset:7168
    s_waitcnt lgkmcnt(0)
    v_pk_add_f32 v[128:129], v[128:129], v[136:137]
    v_pk_add_f32 v[130:131], v[130:131], v[138:139]
    v_pk_add_f32 v[132:133], v[132:133], v[140:141]
    v_pk_add_f32 v[134:135], v[134:135], v[142:143]
    v_pk_add_f32 v[128:129], v[128:129], v[144:145]
    v_pk_add_f32 v[130:131], v[130:131], v[146:147]
    v_pk_add_f32 v[132:133], v[132:133], v[148:149]
    v_pk_add_f32 v[134:135], v[134:135], v[150:151]
    v_pk_add_f32 v[128:129], v[128:129], v[152:153]
    v_pk_add_f32 v[130:131], v[130:131], v[154:155]
    v_pk_add_f32 v[132:133], v[132:133], v[156:157]
    v_pk_add_f32 v[134:135], v[134:135], v[158:159]
    s_waitcnt vmcnt(0)
    v_cvt_pk_bf16_f32 v16, v128, v129
    v_lshlrev_b32 v17, 16, v16
    v_and_b32 v18, 0xffff0000, v16
    v_lshlrev_b32 v19, 16, v8
    v_and_b32 v20, 0xffff0000, v8
    v_add_f32 v17, v17, v19
    v_add_f32 v18, v18, v20
    v_cvt_pk_bf16_f32 v16, v17, v18
    v_lshlrev_b32 v19, 16, v12
    v_and_b32 v20, 0xffff0000, v12
    v_lshlrev_b32 v17, 16, v16
    v_and_b32 v18, 0xffff0000, v16
    v_add_f32 v17, v17, v19
    v_add_f32 v18, v18, v20
    v_cvt_pk_bf16_f32 v24, v17, v18
    v_cvt_pk_bf16_f32 v16, v130, v131
    v_lshlrev_b32 v17, 16, v16
    v_and_b32 v18, 0xffff0000, v16
    v_lshlrev_b32 v19, 16, v9
    v_and_b32 v20, 0xffff0000, v9
    v_add_f32 v17, v17, v19
    v_add_f32 v18, v18, v20
    v_cvt_pk_bf16_f32 v16, v17, v18
    v_lshlrev_b32 v19, 16, v13
    v_and_b32 v20, 0xffff0000, v13
    v_lshlrev_b32 v17, 16, v16
    v_and_b32 v18, 0xffff0000, v16
    v_add_f32 v17, v17, v19
    v_add_f32 v18, v18, v20
    v_cvt_pk_bf16_f32 v25, v17, v18
    v_cvt_pk_bf16_f32 v16, v132, v133
    v_lshlrev_b32 v17, 16, v16
    v_and_b32 v18, 0xffff0000, v16
    v_lshlrev_b32 v19, 16, v10
    v_and_b32 v20, 0xffff0000, v10
    v_add_f32 v17, v17, v19
    v_add_f32 v18, v18, v20
    v_cvt_pk_bf16_f32 v16, v17, v18
    v_lshlrev_b32 v19, 16, v14
    v_and_b32 v20, 0xffff0000, v14
    v_lshlrev_b32 v17, 16, v16
    v_and_b32 v18, 0xffff0000, v16
    v_add_f32 v17, v17, v19
    v_add_f32 v18, v18, v20
    v_cvt_pk_bf16_f32 v26, v17, v18
    v_cvt_pk_bf16_f32 v16, v134, v135
    v_lshlrev_b32 v17, 16, v16
    v_and_b32 v18, 0xffff0000, v16
    v_lshlrev_b32 v19, 16, v11
    v_and_b32 v20, 0xffff0000, v11
    v_add_f32 v17, v17, v19
    v_add_f32 v18, v18, v20
    v_cvt_pk_bf16_f32 v16, v17, v18
    v_lshlrev_b32 v19, 16, v15
    v_and_b32 v20, 0xffff0000, v15
    v_lshlrev_b32 v17, 16, v16
    v_and_b32 v18, 0xffff0000, v16
    v_add_f32 v17, v17, v19
    v_add_f32 v18, v18, v20
    v_cvt_pk_bf16_f32 v27, v17, v18
    global_store_dwordx4 v3, v[24:27], s[6:7]
rdf_end:
    s_branch wk_redl
wk_fin:
    s_endpgm
wk_fail:
    v_mov_b32 v124, 8
    v_mov_b32 v125, 0x7777
    global_store_dword v124, v125, s[12:13] sc1
    v_mov_b32 v124, 163776
    v_mov_b32 v125, 0xffff
    ds_write_b32 v124, v125 offset:0
    ds_write_b32 v124, v125 offset:4
    ds_write_b32 v124, v125 offset:8
    s_waitcnt vmcnt(0) lgkmcnt(0)
wk_exit:
    s_endpgm
.section .rodata,"a"
.p2align 6
.amdhsa_kernel parallel_sum__memory_aug_recurrent_mem_tr__glu_gated_reglu__prompt_kernel
  .amdhsa_next_free_vgpr 512
  .amdhsa_next_free_sgpr 102
  .amdhsa_accum_offset 256
  .amdhsa_group_segment_fixed_size 0
  .amdhsa_kernarg_size 112
  .amdhsa_user_sgpr_count 2
  .amdhsa_user_sgpr_kernarg_segment_ptr 1
  .amdhsa_system_sgpr_workgroup_id_x 1
.end_amdhsa_kernel
```
